```python
import torch

def _softmax(x, axis=-1):
    return torch.softmax(x, dim=axis)

def _gelu(x):
    return torch.nn.functional.gelu(x, approximate='tanh')

def _silu(x):
    return torch.nn.functional.silu(x)

def _sigmoid(x):
    return torch.sigmoid(x)

def _layernorm(x, axis=-1, eps=1e-05):
    m = x.mean(dim=axis, keepdim=True)
    v = x.var(dim=axis, keepdim=True, unbiased=False)
    return (x - m) / torch.sqrt(v + eps)

def _scatter_add(tgt, idx, src, axis=0):
    return tgt.clone().index_add_(axis, idx, src)

def _segment_sum(src, seg, n):
    out = torch.zeros((n,) + src.shape[1:], dtype=src.dtype)
    return out.index_add_(0, seg, src)

def _pad(x, pw):
    flat = tuple((v for pair in reversed(pw) for v in pair))
    return torch.nn.functional.pad(x, flat)
kernel_name = 'adaLN_cond__sliding_block_cached__glu_gated_reglu__prompt'

def setup_inputs():

    _w = lambda a: (lambda t: t.to(torch.bfloat16) if t.is_floating_point() else t)(torch.as_tensor(a))

    def _A_setup():
        B, Sq, D = (1, 2048, 576)
        Hq, Hkv, Sk, Dh = (32, 16, 2048, 128)
        assert Hq % Hkv == 0, (Hq, Hkv)
        return {'x': _w((lambda *s: torch.randn(*s, dtype=torch.bfloat16) * 0.05)(B, Sq, D)), 'k_cache': _w((lambda *s: torch.randn(*s, dtype=torch.bfloat16) * 1.6)(B, Hkv, Sk, Dh)), 'v_cache': _w((lambda *s: torch.randn(*s, dtype=torch.bfloat16) * 0.8)(B, Hkv, Sk, Dh)), 'wq': _w((lambda *s: torch.randn(*s, dtype=torch.bfloat16) * 1.6)(D, Hq * Dh) * D ** (-0.5)), 'wo': _w((lambda *s: torch.randn(*s, dtype=torch.bfloat16) * 0.8)(Hq * Dh, D) * (Hq * Dh) ** (-0.5))}
    _A_in = _A_setup()

    def _B_setup():
        B, S, D, F = (1, 2048, 576, 4608)
        return {'x': _w((lambda *s: torch.randn(*s, dtype=torch.bfloat16) * 0.05)(B, S, D)), 'W_gate': _w((lambda *s: torch.randn(*s, dtype=torch.bfloat16) * 0.4)(D, F) * (2.0 / D) ** 0.5), 'W_up': _w((lambda *s: torch.randn(*s, dtype=torch.bfloat16) * 0.4)(D, F) * (2.0 / D) ** 0.5), 'W_down': _w((lambda *s: torch.randn(*s, dtype=torch.bfloat16) * 0.4)(F, D) * (1.0 / F) ** 0.5)}
    _B_in = _B_setup()
    return {'A_x': _A_in['x'], 'A_k_cache': _A_in['k_cache'], 'A_v_cache': _A_in['v_cache'], 'A_wq': _A_in['wq'], 'A_wo': _A_in['wo'], 'B_x': _B_in['x'], 'B_W_gate': _B_in['W_gate'], 'B_W_up': _B_in['W_up'], 'B_W_down': _B_in['W_down'], 'c': _w((lambda *s: torch.randn(*s, dtype=torch.bfloat16) * 0.2)(1, 576) * 8.0), 'w_mod': _w((lambda *s: torch.randn(*s, dtype=torch.bfloat16) * 0.2)(576, 6 * 576) * 576 ** (-0.5) * 8.0)}

def reference(A_x, A_k_cache, A_v_cache, A_wq, A_wo, B_x, B_W_gate, B_W_up, B_W_down, c, w_mod):

    def _A_ref(x, k_cache, v_cache, wq, wo):
        B, Sq, D = x.shape
        Hq, Dh = (32, 128)
        Hkv, Sk = (k_cache.shape[1], k_cache.shape[2])
        W = min(4096, max(256, Sk // 4))
        rep = Hq // Hkv
        q = (lambda x, *d: x.permute(*d))((x @ wq).reshape(B, Sq, Hq, Dh), 0, 2, 1, 3)
        k = (lambda x, n, axis: torch.repeat_interleave(x, n, dim=axis))(k_cache[:, :, Sk - W:, :], rep, axis=1)
        v = (lambda x, n, axis: torch.repeat_interleave(x, n, dim=axis))(v_cache[:, :, Sk - W:, :], rep, axis=1)
        scores = torch.einsum('bhqd,bhkd->bhqk', q, k) * Dh ** (-0.5)
        p = _softmax(scores, axis=-1)
        o = torch.einsum('bhqk,bhkd->bhqd', p, v)
        return (lambda x, *d: x.permute(*d))(o, 0, 2, 1, 3).reshape(B, Sq, Hq * Dh) @ wo

    def _B_ref(x, W_gate, W_up, W_down):
        gate = torch.einsum('bsd,df->bsf', x, W_gate)
        up = torch.einsum('bsd,df->bsf', x, W_up)
        gate = gate * (lambda x, dt: x.to(dt))(gate > 0, gate.dtype)
        h = gate * up
        return torch.einsum('bsf,fd->bsd', h, W_down)
    x = A_x
    mod = (_silu(c) @ w_mod).reshape(c.shape[0], 6, 1, -1)
    sa, ca, ga, sb, cb, gb = (mod[:, 0].clone(), mod[:, 1].clone(), mod[:, 2].clone(), mod[:, 3].clone(), mod[:, 4].clone(), mod[:, 5].clone())
    h = _layernorm(x, axis=-1) * (1 + ca) + sa
    x = x + ga * _A_ref(h, A_k_cache, A_v_cache, A_wq, A_wo)
    h = _layernorm(x, axis=-1) * (1 + cb) + sb
    x = x + gb * _B_ref(h, B_W_gate, B_W_up, B_W_down)
    return x
```

```asm
; @launch kernel=k0_kernel grid=(368,1,1) block=(576,1,1) lds=4096
; @launch kernel=k1_kernel grid=(256,1,1) block=(256,1,1) lds=163840
.amdgcn_target "amdgcn-amd-amdhsa--gfx950"
.text
.globl k0_kernel
.p2align 8
.type k0_kernel,@function
k0_kernel:
s_cmp_ge_u32 s2, 368
s_cbranch_scc1 K0_END
s_load_dwordx2 s[8:9], s[0:1], 104
s_load_dwordx2 s[20:21], s[0:1], 0
s_load_dwordx4 s[36:39], s[0:1], 72
s_load_dwordx8 s[52:59], s[0:1], 8
s_getpc_b64 s[64:65]
K0_HERE:
s_add_u32 s64, s64, k0_kernel-K0_HERE
s_addc_u32 s65, s65, (k0_kernel-K0_HERE)>>32
s_mov_b32 s66, K3_CODE_END-k0_kernel
s_mov_b32 s67, 0x20000
v_lshlrev_b32 v62, 4, v0
s_lshr_b32 s11, s2, 3
s_mul_i32 s11, s11, 9216
buffer_load_dword v63, v62, s[64:67], s11 offen
s_cmp_lt_u32 s2, 108
s_cbranch_scc1 K0_MOD
s_cmp_lt_u32 s2, 112
s_cbranch_scc1 K0_END
s_sub_u32 s12, s2, 112
s_mov_b32 s13, s12
v_lshrrev_b32 v5, 3, v0
v_and_b32 v6, 7, v0
v_lshlrev_b32 v1, 8, v5
v_lshl_add_u32 v1, v6, 4, v1
v_lshrrev_b32 v2, 2, v5
v_lshlrev_b32 v2, 7, v2
v_and_b32 v5, 3, v5
v_lshl_add_u32 v2, v5, 4, v2
s_lshr_b32 s11, s13, 1
s_mul_i32 s10, s11, 18432
s_and_b32 s11, s13, 1
s_lshl_b32 s11, s11, 7
s_add_u32 s10, s10, s11
v_and_b32 v6, 7, v0
v_mul_u32_u24 v6, 1152, v6
v_lshrrev_b32 v7, 1, v2
v_add_u32 v7, v7, v6
s_mul_i32 s12, s13, 9216
s_waitcnt lgkmcnt(0)
s_mov_b32 s16, s20
s_mov_b32 s17, s21
s_mov_b32 s18, 0x240000
s_mov_b32 s19, 0x20000
buffer_load_dwordx2 v[8:9], v7, s[16:19], s12 offen
buffer_load_dwordx2 v[10:11], v7, s[16:19], s12 offen offset:32
s_mov_b32 s4, s8
s_mov_b32 s5, s9
s_mov_b32 s6, 0x3400000
s_mov_b32 s7, 0x20000
v_lshlrev_b32 v57, 2, v0
v_mov_b32 v58, 0x7ff00000
v_cmp_gt_u32 vcc, 32, v0
s_nop 1
v_cndmask_b32 v57, v58, v57, vcc
v_mov_b32 v58, 0
s_mul_i32 s11, s13, 128
s_add_u32 s11, s11, 9961472
buffer_store_dword v58, v57, s[4:7], s11 offen
s_sub_u32 s49, s2, 112
s_and_b32 s48, s49, 7
s_lshr_b32 s49, s49, 3
v_lshrrev_b32 v50, 5, v0
v_lshlrev_b32 v50, 13, v50
v_and_b32 v51, 31, v0
v_lshl_add_u32 v50, v51, 5, v50
s_mul_i32 s50, s49, 147456
v_cmp_gt_u32 vcc, 576, v0
v_mov_b32 v56, 0x7ff00000
s_nop 0
v_cndmask_b32 v50, v56, v50, vcc
s_lshl_b32 s11, s48, 10
s_add_u32 s50, s50, s11
s_mov_b32 s44, s56
s_mov_b32 s45, s57
s_mov_b32 s46, 0x480000
s_mov_b32 s47, 0x20000
buffer_load_dword v52, v50, s[44:47], s50 offen
v_and_b32 v4, 7, v0
v_lshlrev_b32 v4, 6, v4
v_lshrrev_b32 v5, 6, v0
v_lshl_add_u32 v3, v5, 2, v4
s_add_u32 s11, s10, 2424832
s_waitcnt vmcnt(2)
buffer_store_dwordx4 v[8:11], v1, s[4:7], s11 offen
v_lshlrev_b32 v12, 16, v8
v_and_b32 v13, 0xffff0000, v8
v_lshlrev_b32 v14, 16, v9
v_and_b32 v15, 0xffff0000, v9
v_lshlrev_b32 v16, 16, v10
v_and_b32 v17, 0xffff0000, v10
v_lshlrev_b32 v18, 16, v11
v_and_b32 v19, 0xffff0000, v11
v_add_f32 v5, v12, v13
v_add_f32 v6, v14, v15
v_add_f32 v5, v5, v16
v_add_f32 v6, v6, v17
v_add_f32 v5, v5, v18
v_add_f32 v6, v6, v19
v_add_f32 v5, v5, v6
s_nop 1
v_add_f32_dpp v5, v5, v5 row_ror:8 row_mask:0xf bank_mask:0xf
v_mov_b32 v6, v5
s_nop 1
v_permlane16_swap_b32 v5, v6
v_add_f32 v5, v5, v6
v_mov_b32 v6, v5
s_nop 1
v_permlane32_swap_b32 v5, v6
v_add_f32 v5, v5, v6
ds_write_b32 v3, v5
s_waitcnt lgkmcnt(0)
s_barrier
ds_read_b128 v[28:31], v4
ds_read_b128 v[32:35], v4 offset:16
ds_read_b32 v36, v4 offset:32
s_waitcnt lgkmcnt(2)
v_add_f32 v5, v28, v29
v_add_f32 v6, v30, v31
s_waitcnt lgkmcnt(1)
v_add_f32 v5, v5, v32
v_add_f32 v6, v6, v33
v_add_f32 v5, v5, v34
v_add_f32 v6, v6, v35
s_waitcnt lgkmcnt(0)
v_add_f32 v5, v5, v36
v_add_f32 v5, v5, v6
s_mov_b32 s12, 0x3ae38e39
v_mul_f32 v5, s12, v5
v_sub_f32 v20, v12, v5
v_sub_f32 v21, v13, v5
v_sub_f32 v22, v14, v5
v_sub_f32 v23, v15, v5
v_sub_f32 v24, v16, v5
v_sub_f32 v25, v17, v5
v_sub_f32 v26, v18, v5
v_sub_f32 v27, v19, v5
v_mul_f32 v39, v20, v20
v_fmac_f32 v39, v21, v21
v_fmac_f32 v39, v22, v22
v_fmac_f32 v39, v23, v23
v_fmac_f32 v39, v24, v24
v_fmac_f32 v39, v25, v25
v_fmac_f32 v39, v26, v26
v_fmac_f32 v39, v27, v27
s_nop 1
v_add_f32_dpp v39, v39, v39 row_ror:8 row_mask:0xf bank_mask:0xf
v_mov_b32 v6, v39
s_nop 1
v_permlane16_swap_b32 v39, v6
v_add_f32 v39, v39, v6
v_mov_b32 v6, v39
s_nop 1
v_permlane32_swap_b32 v39, v6
v_add_f32 v39, v39, v6
ds_write_b32 v3, v39 offset:512
s_waitcnt lgkmcnt(0)
s_barrier
ds_read_b128 v[28:31], v4 offset:512
ds_read_b128 v[32:35], v4 offset:528
ds_read_b32 v36, v4 offset:544
s_waitcnt lgkmcnt(2)
v_add_f32 v39, v28, v29
v_add_f32 v6, v30, v31
s_waitcnt lgkmcnt(1)
v_add_f32 v39, v39, v32
v_add_f32 v6, v6, v33
v_add_f32 v39, v39, v34
v_add_f32 v6, v6, v35
s_waitcnt lgkmcnt(0)
v_add_f32 v39, v39, v36
v_add_f32 v39, v39, v6
v_mul_f32 v39, s12, v39
v_cvt_pk_bf16_f32 v5, v5, v5
v_and_b32 v5, 0xffff0000, v5
v_cvt_pk_bf16_f32 v39, v39, v39
v_and_b32 v39, 0xffff0000, v39
v_add_f32 v39, 0x3727c5ac, v39
v_cvt_pk_bf16_f32 v39, v39, v39
v_and_b32 v39, 0xffff0000, v39
v_sqrt_f32 v39, v39
s_nop 0
v_cvt_pk_bf16_f32 v39, v39, v39
v_and_b32 v39, 0xffff0000, v39
v_rcp_f32 v39, v39
v_sub_f32 v20, v12, v5
v_sub_f32 v21, v13, v5
v_sub_f32 v22, v14, v5
v_sub_f32 v23, v15, v5
v_sub_f32 v24, v16, v5
v_sub_f32 v25, v17, v5
v_sub_f32 v26, v18, v5
v_sub_f32 v27, v19, v5
v_cvt_pk_bf16_f32 v40, v20, v21
v_cvt_pk_bf16_f32 v41, v22, v23
v_cvt_pk_bf16_f32 v42, v24, v25
v_cvt_pk_bf16_f32 v43, v26, v27
v_lshlrev_b32 v20, 16, v40
v_and_b32 v21, 0xffff0000, v40
v_lshlrev_b32 v22, 16, v41
v_and_b32 v23, 0xffff0000, v41
v_lshlrev_b32 v24, 16, v42
v_and_b32 v25, 0xffff0000, v42
v_lshlrev_b32 v26, 16, v43
v_and_b32 v27, 0xffff0000, v43
v_mul_f32 v20, v20, v39
v_mul_f32 v21, v21, v39
v_mul_f32 v22, v22, v39
v_mul_f32 v23, v23, v39
v_mul_f32 v24, v24, v39
v_mul_f32 v25, v25, v39
v_mul_f32 v26, v26, v39
v_mul_f32 v27, v27, v39
v_cvt_pk_bf16_f32 v40, v20, v21
v_cvt_pk_bf16_f32 v41, v22, v23
v_cvt_pk_bf16_f32 v42, v24, v25
v_cvt_pk_bf16_f32 v43, v26, v27
v_lshlrev_b32 v20, 16, v40
v_and_b32 v21, 0xffff0000, v40
v_lshlrev_b32 v22, 16, v41
v_and_b32 v23, 0xffff0000, v41
v_lshlrev_b32 v24, 16, v42
v_and_b32 v25, 0xffff0000, v42
v_lshlrev_b32 v26, 16, v43
v_and_b32 v27, 0xffff0000, v43
v_cvt_pkrtz_f16_f32 v44, v20, v21
v_cvt_pkrtz_f16_f32 v45, v22, v23
v_cvt_pkrtz_f16_f32 v46, v24, v25
v_cvt_pkrtz_f16_f32 v47, v26, v27
s_add_u32 s11, s10, 65536
buffer_store_dwordx4 v[44:47], v1, s[4:7], s11 offen
s_endpgm
K0_MOD:
s_nop 0
v_lshrrev_b32 v44, 6, v0
v_lshlrev_b32 v44, 6, v44
v_and_b32 v45, 63, v0
v_lshrrev_b32 v45, 2, v45
v_add_u32 v44, v44, v45
v_lshlrev_b32 v2, 1, v44
v_mul_u32_u24 v1, 6912, v44
v_and_b32 v45, 3, v0
v_lshl_add_u32 v1, v45, 4, v1
s_lshl_b32 s10, s2, 6
s_waitcnt lgkmcnt(0)
s_mov_b32 s24, s38
s_mov_b32 s25, s39
s_mov_b32 s26, 0x3cc000
s_mov_b32 s27, 0x20000
s_mov_b32 s16, s36
s_mov_b32 s17, s37
s_mov_b32 s18, 1152
s_mov_b32 s19, 0x20000
s_add_u32 s11, s10, 0
buffer_load_dwordx4 v[8:11], v1, s[24:27], s11 offen
s_add_u32 s11, s10, 110592
buffer_load_dwordx4 v[12:15], v1, s[24:27], s11 offen
s_add_u32 s11, s10, 221184
buffer_load_dwordx4 v[16:19], v1, s[24:27], s11 offen
s_add_u32 s11, s10, 331776
buffer_load_dwordx4 v[20:23], v1, s[24:27], s11 offen
buffer_load_ushort v24, v2, s[16:19], 0 offen
buffer_load_ushort v25, v2, s[16:19], 0 offen offset:32
buffer_load_ushort v26, v2, s[16:19], 0 offen offset:64
buffer_load_ushort v27, v2, s[16:19], 0 offen offset:96
s_mov_b32 s4, s8
s_mov_b32 s5, s9
s_mov_b32 s6, 0x3400000
s_mov_b32 s7, 0x20000
s_mov_b32 s12, 0xbfb8aa3b
s_waitcnt vmcnt(3)
v_lshlrev_b32 v24, 16, v24
v_mul_f32 v44, s12, v24
v_exp_f32 v44, v44
s_nop 0
v_add_f32 v44, 1.0, v44
v_rcp_f32 v44, v44
s_nop 0
v_mul_f32 v24, v24, v44
v_cvt_pk_bf16_f32 v24, v24, v24
v_and_b32 v24, 0xffff0000, v24
s_waitcnt vmcnt(2)
v_lshlrev_b32 v25, 16, v25
v_mul_f32 v44, s12, v25
v_exp_f32 v44, v44
s_nop 0
v_add_f32 v44, 1.0, v44
v_rcp_f32 v44, v44
s_nop 0
v_mul_f32 v25, v25, v44
v_cvt_pk_bf16_f32 v25, v25, v25
v_and_b32 v25, 0xffff0000, v25
s_waitcnt vmcnt(1)
v_lshlrev_b32 v26, 16, v26
v_mul_f32 v44, s12, v26
v_exp_f32 v44, v44
s_nop 0
v_add_f32 v44, 1.0, v44
v_rcp_f32 v44, v44
s_nop 0
v_mul_f32 v26, v26, v44
v_cvt_pk_bf16_f32 v26, v26, v26
v_and_b32 v26, 0xffff0000, v26
s_waitcnt vmcnt(0)
v_lshlrev_b32 v27, 16, v27
v_mul_f32 v44, s12, v27
v_exp_f32 v44, v44
s_nop 0
v_add_f32 v44, 1.0, v44
v_rcp_f32 v44, v44
s_nop 0
v_mul_f32 v27, v27, v44
v_cvt_pk_bf16_f32 v27, v27, v27
v_and_b32 v27, 0xffff0000, v27
v_lshlrev_b32 v36, 16, v8
v_and_b32 v37, 0xffff0000, v8
v_lshlrev_b32 v38, 16, v9
v_and_b32 v39, 0xffff0000, v9
v_lshlrev_b32 v40, 16, v10
v_and_b32 v41, 0xffff0000, v10
v_lshlrev_b32 v42, 16, v11
v_and_b32 v43, 0xffff0000, v11
v_mul_f32 v28, v36, v24
v_mul_f32 v29, v37, v24
v_mul_f32 v30, v38, v24
v_mul_f32 v31, v39, v24
v_mul_f32 v32, v40, v24
v_mul_f32 v33, v41, v24
v_mul_f32 v34, v42, v24
v_mul_f32 v35, v43, v24
v_lshlrev_b32 v36, 16, v12
v_and_b32 v37, 0xffff0000, v12
v_lshlrev_b32 v38, 16, v13
v_and_b32 v39, 0xffff0000, v13
v_lshlrev_b32 v40, 16, v14
v_and_b32 v41, 0xffff0000, v14
v_lshlrev_b32 v42, 16, v15
v_and_b32 v43, 0xffff0000, v15
v_fmac_f32 v28, v36, v25
v_fmac_f32 v29, v37, v25
v_fmac_f32 v30, v38, v25
v_fmac_f32 v31, v39, v25
v_fmac_f32 v32, v40, v25
v_fmac_f32 v33, v41, v25
v_fmac_f32 v34, v42, v25
v_fmac_f32 v35, v43, v25
v_lshlrev_b32 v36, 16, v16
v_and_b32 v37, 0xffff0000, v16
v_lshlrev_b32 v38, 16, v17
v_and_b32 v39, 0xffff0000, v17
v_lshlrev_b32 v40, 16, v18
v_and_b32 v41, 0xffff0000, v18
v_lshlrev_b32 v42, 16, v19
v_and_b32 v43, 0xffff0000, v19
v_fmac_f32 v28, v36, v26
v_fmac_f32 v29, v37, v26
v_fmac_f32 v30, v38, v26
v_fmac_f32 v31, v39, v26
v_fmac_f32 v32, v40, v26
v_fmac_f32 v33, v41, v26
v_fmac_f32 v34, v42, v26
v_fmac_f32 v35, v43, v26
v_lshlrev_b32 v36, 16, v20
v_and_b32 v37, 0xffff0000, v20
v_lshlrev_b32 v38, 16, v21
v_and_b32 v39, 0xffff0000, v21
v_lshlrev_b32 v40, 16, v22
v_and_b32 v41, 0xffff0000, v22
v_lshlrev_b32 v42, 16, v23
v_and_b32 v43, 0xffff0000, v23
v_fmac_f32 v28, v36, v27
v_fmac_f32 v29, v37, v27
v_fmac_f32 v30, v38, v27
v_fmac_f32 v31, v39, v27
v_fmac_f32 v32, v40, v27
v_fmac_f32 v33, v41, v27
v_fmac_f32 v34, v42, v27
v_fmac_f32 v35, v43, v27
v_add_f32_dpp v28, v28, v28 row_ror:4 row_mask:0xf bank_mask:0xf
v_add_f32_dpp v29, v29, v29 row_ror:4 row_mask:0xf bank_mask:0xf
v_add_f32_dpp v30, v30, v30 row_ror:4 row_mask:0xf bank_mask:0xf
v_add_f32_dpp v31, v31, v31 row_ror:4 row_mask:0xf bank_mask:0xf
v_add_f32_dpp v32, v32, v32 row_ror:4 row_mask:0xf bank_mask:0xf
v_add_f32_dpp v33, v33, v33 row_ror:4 row_mask:0xf bank_mask:0xf
v_add_f32_dpp v34, v34, v34 row_ror:4 row_mask:0xf bank_mask:0xf
v_add_f32_dpp v35, v35, v35 row_ror:4 row_mask:0xf bank_mask:0xf
v_add_f32_dpp v28, v28, v28 row_ror:8 row_mask:0xf bank_mask:0xf
v_add_f32_dpp v29, v29, v29 row_ror:8 row_mask:0xf bank_mask:0xf
v_add_f32_dpp v30, v30, v30 row_ror:8 row_mask:0xf bank_mask:0xf
v_add_f32_dpp v31, v31, v31 row_ror:8 row_mask:0xf bank_mask:0xf
v_add_f32_dpp v32, v32, v32 row_ror:8 row_mask:0xf bank_mask:0xf
v_add_f32_dpp v33, v33, v33 row_ror:8 row_mask:0xf bank_mask:0xf
v_add_f32_dpp v34, v34, v34 row_ror:8 row_mask:0xf bank_mask:0xf
v_add_f32_dpp v35, v35, v35 row_ror:8 row_mask:0xf bank_mask:0xf
v_mov_b32 v36, v28
v_mov_b32 v37, v29
v_mov_b32 v38, v30
v_mov_b32 v39, v31
v_mov_b32 v40, v32
v_mov_b32 v41, v33
v_mov_b32 v42, v34
v_mov_b32 v43, v35
v_permlane16_swap_b32 v28, v36
v_permlane16_swap_b32 v29, v37
v_permlane16_swap_b32 v30, v38
v_permlane16_swap_b32 v31, v39
v_permlane16_swap_b32 v32, v40
v_permlane16_swap_b32 v33, v41
v_permlane16_swap_b32 v34, v42
v_permlane16_swap_b32 v35, v43
v_add_f32 v28, v28, v36
v_add_f32 v29, v29, v37
v_add_f32 v30, v30, v38
v_add_f32 v31, v31, v39
v_add_f32 v32, v32, v40
v_add_f32 v33, v33, v41
v_add_f32 v34, v34, v42
v_add_f32 v35, v35, v43
v_mov_b32 v36, v28
v_mov_b32 v37, v29
v_mov_b32 v38, v30
v_mov_b32 v39, v31
v_mov_b32 v40, v32
v_mov_b32 v41, v33
v_mov_b32 v42, v34
v_mov_b32 v43, v35
v_permlane32_swap_b32 v28, v36
v_permlane32_swap_b32 v29, v37
v_permlane32_swap_b32 v30, v38
v_permlane32_swap_b32 v31, v39
v_permlane32_swap_b32 v32, v40
v_permlane32_swap_b32 v33, v41
v_permlane32_swap_b32 v34, v42
v_permlane32_swap_b32 v35, v43
v_add_f32 v28, v28, v36
v_add_f32 v29, v29, v37
v_add_f32 v30, v30, v38
v_add_f32 v31, v31, v39
v_add_f32 v32, v32, v40
v_add_f32 v33, v33, v41
v_add_f32 v34, v34, v42
v_add_f32 v35, v35, v43
v_lshrrev_b32 v44, 6, v0
v_lshlrev_b32 v44, 7, v44
v_and_b32 v45, 3, v0
v_lshl_add_u32 v3, v45, 5, v44
ds_write_b128 v3, v[28:31]
ds_write_b128 v3, v[32:35] offset:16
s_waitcnt lgkmcnt(0)
s_barrier
v_and_b32 v44, 31, v0
v_lshlrev_b32 v3, 2, v44
ds_read_b32 v8, v3
ds_read_b32 v9, v3 offset:128
ds_read_b32 v10, v3 offset:256
ds_read_b32 v11, v3 offset:384
ds_read_b32 v12, v3 offset:512
ds_read_b32 v13, v3 offset:640
ds_read_b32 v14, v3 offset:768
ds_read_b32 v15, v3 offset:896
ds_read_b32 v16, v3 offset:1024
s_waitcnt lgkmcnt(7)
v_add_f32 v8, v8, v9
s_waitcnt lgkmcnt(6)
v_add_f32 v8, v8, v10
s_waitcnt lgkmcnt(5)
v_add_f32 v8, v8, v11
s_waitcnt lgkmcnt(4)
v_add_f32 v8, v8, v12
s_waitcnt lgkmcnt(3)
v_add_f32 v8, v8, v13
s_waitcnt lgkmcnt(2)
v_add_f32 v8, v8, v14
s_waitcnt lgkmcnt(1)
v_add_f32 v8, v8, v15
s_waitcnt lgkmcnt(0)
v_add_f32 v8, v8, v16
v_cvt_pk_bf16_f32 v8, v8, v8
v_and_b32 v8, 0xffff0000, v8
s_mul_i32 s11, s2, 3641
s_lshr_b32 s11, s11, 16
s_cmp_eq_u32 s11, 1
s_cselect_b32 s12, 1.0, 0
s_cmp_eq_u32 s11, 4
s_cselect_b32 s12, 1.0, s12
v_add_f32 v8, s12, v8
v_cvt_pk_bf16_f32 v8, v8, v8
v_and_b32 v8, 0xffff0000, v8
s_cmp_lt_u32 s11, 2
s_cselect_b32 s12, 0x3e0293ee, 1.0
v_mul_f32 v8, s12, v8
s_lshl_b32 s10, s2, 7
v_cmp_gt_u32 vcc, 32, v0
s_nop 1
s_and_saveexec_b64 s[40:41], vcc
s_cbranch_execz K0_END
buffer_store_dword v8, v3, s[4:7], s10 offen
K0_END:
s_endpgm
.section .rodata,"a"
.p2align 6
k0_kernel_kdl:
.amdhsa_kernel k0_kernel
  .amdhsa_next_free_vgpr 64
  .amdhsa_next_free_sgpr 102
  .amdhsa_accum_offset 64
  .amdhsa_group_segment_fixed_size 0
  .amdhsa_kernarg_size 112
  .amdhsa_user_sgpr_count 2
  .amdhsa_user_sgpr_kernarg_segment_ptr 1
  .amdhsa_system_sgpr_workgroup_id_x 1
  .amdhsa_float_denorm_mode_32 3
.end_amdhsa_kernel

.text
.globl k1_kernel
.p2align 8
.type k1_kernel,@function
k1_kernel:
s_cmp_ge_u32 s2, 256
s_cbranch_scc1 K1_END
s_load_dwordx8 s[36:43], s[0:1], 8
s_load_dwordx2 s[44:45], s[0:1], 104
v_lshrrev_b32 v22, 6, v0
s_nop 0
v_readfirstlane_b32 s20, v22
v_and_b32 v0, 63, v0
s_and_b32 s30, s2, 7
s_lshr_b32 s31, s2, 3
s_and_b32 s32, s31, 1
s_lshl_b32 s21, s30, 1
s_add_u32 s21, s21, s32
s_lshr_b32 s22, s31, 1
s_lshl_b32 s23, s20, 13
s_lshl_b32 s24, s20, 17
s_lshl_b32 s31, s21, 9
s_add_u32 s24, s24, s31
s_lshl_b32 s31, s22, 3
s_lshl_b32 s33, s20, 1
s_add_u32 s31, s31, s33
s_mul_i32 s31, s31, 18432
s_add_u32 s27, s31, 65536
s_mul_i32 s28, s21, 2359296
s_add_u32 s28, s28, s31
s_add_u32 s28, s28, 16777216
v_lshrrev_b32 v22, 2, v0
v_mul_u32_u24 v22, 8192, v22
v_lshrrev_b32 v23, 3, v0
v_and_b32 v23, 2, v23
v_and_b32 v10, 3, v0
v_xor_b32 v10, v10, v23
v_lshl_add_u32 v10, v10, 4, v22
v_add_u32 v13, 192, v10
v_add_u32 v12, 1152, v10
v_add_u32 v11, 2112, v10
v_add_u32 v10, 3072, v10
v_lshlrev_b32 v8, 4, v0
v_add_u32 v9, 18432, v8
v_lshrrev_b32 v7, 4, v0
v_lshlrev_b32 v7, 4, v7
s_waitcnt lgkmcnt(0)
s_sub_u32 s4, s40, 3072
s_subb_u32 s5, s41, 0
s_mov_b32 s6, 0x480c00
s_mov_b32 s7, 0x20000
s_mov_b32 s16, s44
s_mov_b32 s17, s45
s_mov_b32 s18, 0x3400000
s_mov_b32 s19, 0x20000
s_add_u32 s33, s27, 0
buffer_load_dwordx4 v[152:155], v8, s[16:19], s33 offen
buffer_load_dwordx4 v[156:159], v9, s[16:19], s33 offen
buffer_load_dwordx4 v[216:219], v7, s[16:19], 0 offen offset:2304
buffer_load_dwordx4 v[220:223], v7, s[16:19], 0 offen offset:2368
buffer_load_dwordx4 v[224:227], v7, s[16:19], 0 offen
buffer_load_dwordx4 v[228:231], v7, s[16:19], 0 offen offset:64
buffer_load_dwordx4 v[232:235], v7, s[16:19], 0 offen offset:2432
buffer_load_dwordx4 v[236:239], v7, s[16:19], 0 offen offset:2496
buffer_load_dwordx4 v[240:243], v7, s[16:19], 0 offen offset:128
buffer_load_dwordx4 v[244:247], v7, s[16:19], 0 offen offset:192
s_add_u32 m0, s23, 0
s_add_u32 s30, s24, 0
buffer_load_dwordx4 v10, s[4:7], s30 offen lds
buffer_load_dwordx4 v11, s[4:7], s30 offen offset:1024 lds
buffer_load_dwordx4 v12, s[4:7], s30 offen offset:2048 lds
buffer_load_dwordx4 v13, s[4:7], s30 offen offset:3072 lds
s_add_u32 m0, s23, 4096
s_add_u32 s31, s24, 256
buffer_load_dwordx4 v10, s[4:7], s31 offen lds
buffer_load_dwordx4 v11, s[4:7], s31 offen offset:1024 lds
buffer_load_dwordx4 v12, s[4:7], s31 offen offset:2048 lds
buffer_load_dwordx4 v13, s[4:7], s31 offen offset:3072 lds
buffer_load_dwordx4 v[160:163], v8, s[16:19], s33 offen offset:1024
buffer_load_dwordx4 v[164:167], v9, s[16:19], s33 offen offset:1024
s_lshl_b32 s32, s20, 12
s_add_u32 m0, s32, 147456
s_nop 0
buffer_load_dwordx4 v8, s[16:19], s32 offen lds
buffer_load_dwordx4 v8, s[16:19], s32 offen offset:1024 lds
buffer_load_dwordx4 v8, s[16:19], s32 offen offset:2048 lds
buffer_load_dwordx4 v8, s[16:19], s32 offen offset:3072 lds
s_getpc_b64 s[84:85]
K1_HERE:
s_add_u32 s84, s84, k1_kernel-K1_HERE
s_addc_u32 s85, s85, (k1_kernel-K1_HERE)>>32
s_mov_b32 s86, K1_CODE_END-k1_kernel
s_mov_b32 s87, 0x20000
s_lshr_b32 s101, s2, 3
s_lshl_b32 s101, s101, 2
s_add_u32 s101, s101, s20
s_lshl_b32 s101, s101, 10
buffer_load_dword a164, v8, s[84:87], s101 offen
buffer_load_dwordx4 v[168:171], v8, s[16:19], s33 offen offset:2048
buffer_load_dwordx4 v[172:175], v9, s[16:19], s33 offen offset:2048
buffer_load_dwordx4 v[176:179], v8, s[16:19], s33 offen offset:3072
buffer_load_dwordx4 v[180:183], v9, s[16:19], s33 offen offset:3072
s_add_u32 m0, s23, 32768
s_add_u32 s30, s24, 524288
buffer_load_dwordx4 v10, s[4:7], s30 offen lds
buffer_load_dwordx4 v11, s[4:7], s30 offen offset:1024 lds
buffer_load_dwordx4 v12, s[4:7], s30 offen offset:2048 lds
buffer_load_dwordx4 v13, s[4:7], s30 offen offset:3072 lds
s_add_u32 m0, s23, 36864
s_add_u32 s31, s24, 524544
buffer_load_dwordx4 v10, s[4:7], s31 offen lds
buffer_load_dwordx4 v11, s[4:7], s31 offen offset:1024 lds
buffer_load_dwordx4 v12, s[4:7], s31 offen offset:2048 lds
buffer_load_dwordx4 v13, s[4:7], s31 offen offset:3072 lds
s_add_u32 s33, s27, 4096
buffer_load_dwordx4 v[184:187], v8, s[16:19], s33 offen
buffer_load_dwordx4 v[188:191], v9, s[16:19], s33 offen
buffer_load_dwordx4 v[192:195], v8, s[16:19], s33 offen offset:1024
buffer_load_dwordx4 v[196:199], v9, s[16:19], s33 offen offset:1024
v_lshrrev_b32 v22, 2, v0
v_lshlrev_b32 v22, 6, v22
v_and_b32 v23, 3, v0
v_lshl_add_u32 v22, v23, 3, v22
v_lshlrev_b32 v23, 1, v0
v_and_b32 v23, 32, v23
v_add_u32 v1, v22, v23
v_xor_b32 v2, 32, v1
v_add_u32 v3, 65536, v1
v_add_u32 v4, 65536, v2
v_add_u32 v7, 147456, v7
s_cmp_lt_u32 s20, 2
s_cselect_b32 s34, s36, s38
s_cselect_b32 s35, s37, s39
s_sub_u32 s8, s34, 3072
s_subb_u32 s9, s35, 0
s_mov_b32 s10, 0x800c00
s_mov_b32 s11, 0x20000
s_mov_b32 s12, s42
s_mov_b32 s13, s43
s_mov_b32 s14, 0x480000
s_mov_b32 s15, 0x20000
s_lshl_b32 s25, s21, 19
s_and_b32 s32, s20, 1
s_lshl_b32 s34, s32, 13
s_add_u32 s25, s25, s34
s_add_u32 s25, s25, 393216
s_mul_i32 s26, s21, 294912
s_mul_i32 s34, s32, 147456
s_add_u32 s26, s26, s34
s_lshr_b32 s34, s20, 1
s_lshl_b32 s34, s34, 6
s_add_u32 s26, s26, s34
s_mov_b32 s29, 0x5f800000
v_lshrrev_b32 v22, 2, v0
v_mul_u32_u24 v22, 256, v22
v_lshrrev_b32 v23, 3, v0
v_and_b32 v23, 2, v23
v_and_b32 v14, 3, v0
v_xor_b32 v14, v14, v23
v_lshl_add_u32 v14, v14, 4, v22
v_add_u32 v17, 192, v14
v_add_u32 v16, 1152, v14
v_add_u32 v15, 2112, v14
v_add_u32 v14, 3072, v14
v_lshrrev_b32 v22, 2, v0
v_mul_u32_u24 v22, 1152, v22
v_lshrrev_b32 v23, 3, v0
v_and_b32 v23, 2, v23
v_and_b32 v18, 3, v0
v_xor_b32 v18, v18, v23
v_lshl_add_u32 v18, v18, 4, v22
v_add_u32 v19, 17408, v18
v_add_u32 v20, 34816, v18
v_add_u32 v21, 52224, v18
v_and_b32 v22, 15, v0
v_lshlrev_b32 v22, 6, v22
v_lshrrev_b32 v23, 1, v0
v_and_b32 v23, 2, v23
v_lshrrev_b32 v5, 4, v0
v_xor_b32 v5, v5, v23
v_lshl_add_u32 v5, v5, 4, v22
v_add_u32 v6, 65536, v5
s_waitcnt vmcnt(36)
v_fma_mix_f32 v248, v152, v216, v224 op_sel_hi:[1,0,0]
v_fma_mix_f32 v249, v152, v217, v225 op_sel:[1,0,0] op_sel_hi:[1,0,0]
v_fma_mix_f32 v250, v153, v218, v226 op_sel_hi:[1,0,0]
v_fma_mix_f32 v251, v153, v219, v227 op_sel:[1,0,0] op_sel_hi:[1,0,0]
v_cvt_pk_bf16_f32 v200, v248, v249
v_cvt_pk_bf16_f32 v201, v250, v251
s_waitcnt vmcnt(35)
v_fma_mix_f32 v252, v154, v220, v228 op_sel_hi:[1,0,0]
v_fma_mix_f32 v253, v154, v221, v229 op_sel:[1,0,0] op_sel_hi:[1,0,0]
v_fma_mix_f32 v254, v155, v222, v230 op_sel_hi:[1,0,0]
v_fma_mix_f32 v255, v155, v223, v231 op_sel:[1,0,0] op_sel_hi:[1,0,0]
v_cvt_pk_bf16_f32 v202, v252, v253
v_cvt_pk_bf16_f32 v203, v254, v255
v_fma_mix_f32 v248, v156, v216, v224 op_sel_hi:[1,0,0]
v_fma_mix_f32 v249, v156, v217, v225 op_sel:[1,0,0] op_sel_hi:[1,0,0]
v_fma_mix_f32 v250, v157, v218, v226 op_sel_hi:[1,0,0]
v_fma_mix_f32 v251, v157, v219, v227 op_sel:[1,0,0] op_sel_hi:[1,0,0]
v_cvt_pk_bf16_f32 v204, v248, v249
v_cvt_pk_bf16_f32 v205, v250, v251
v_fma_mix_f32 v252, v158, v220, v228 op_sel_hi:[1,0,0]
v_fma_mix_f32 v253, v158, v221, v229 op_sel:[1,0,0] op_sel_hi:[1,0,0]
v_fma_mix_f32 v254, v159, v222, v230 op_sel_hi:[1,0,0]
v_fma_mix_f32 v255, v159, v223, v231 op_sel:[1,0,0] op_sel_hi:[1,0,0]
v_cvt_pk_bf16_f32 v206, v252, v253
v_cvt_pk_bf16_f32 v207, v254, v255
s_waitcnt vmcnt(22)
v_fma_mix_f32 v248, v160, v232, v240 op_sel_hi:[1,0,0]
v_fma_mix_f32 v249, v160, v233, v241 op_sel:[1,0,0] op_sel_hi:[1,0,0]
v_fma_mix_f32 v250, v161, v234, v242 op_sel_hi:[1,0,0]
v_fma_mix_f32 v251, v161, v235, v243 op_sel:[1,0,0] op_sel_hi:[1,0,0]
v_cvt_pk_bf16_f32 v208, v248, v249
v_cvt_pk_bf16_f32 v209, v250, v251
v_fma_mix_f32 v252, v162, v236, v244 op_sel_hi:[1,0,0]
v_fma_mix_f32 v253, v162, v237, v245 op_sel:[1,0,0] op_sel_hi:[1,0,0]
v_fma_mix_f32 v254, v163, v238, v246 op_sel_hi:[1,0,0]
v_fma_mix_f32 v255, v163, v239, v247 op_sel:[1,0,0] op_sel_hi:[1,0,0]
v_cvt_pk_bf16_f32 v210, v252, v253
v_cvt_pk_bf16_f32 v211, v254, v255
s_waitcnt vmcnt(21)
v_fma_mix_f32 v248, v164, v232, v240 op_sel_hi:[1,0,0]
v_fma_mix_f32 v249, v164, v233, v241 op_sel:[1,0,0] op_sel_hi:[1,0,0]
v_fma_mix_f32 v250, v165, v234, v242 op_sel_hi:[1,0,0]
v_fma_mix_f32 v251, v165, v235, v243 op_sel:[1,0,0] op_sel_hi:[1,0,0]
v_cvt_pk_bf16_f32 v212, v248, v249
v_cvt_pk_bf16_f32 v213, v250, v251
v_fma_mix_f32 v252, v166, v236, v244 op_sel_hi:[1,0,0]
v_fma_mix_f32 v253, v166, v237, v245 op_sel:[1,0,0] op_sel_hi:[1,0,0]
v_fma_mix_f32 v254, v167, v238, v246 op_sel_hi:[1,0,0]
v_fma_mix_f32 v255, v167, v239, v247 op_sel:[1,0,0] op_sel_hi:[1,0,0]
v_cvt_pk_bf16_f32 v214, v252, v253
v_cvt_pk_bf16_f32 v215, v254, v255
s_waitcnt vmcnt(17)
s_barrier
ds_read_b64_tr_b16 a[128:129], v1
ds_read_b64_tr_b16 a[130:131], v1 offset:8192
ds_read_b64_tr_b16 a[132:133], v2
ds_read_b64_tr_b16 a[134:135], v2 offset:8192
ds_read_b64_tr_b16 a[136:137], v1 offset:4096
ds_read_b64_tr_b16 a[138:139], v1 offset:12288
ds_read_b64_tr_b16 a[140:141], v2 offset:4096
ds_read_b64_tr_b16 a[142:143], v2 offset:12288
ds_read_b64_tr_b16 a[144:145], v1 offset:1024
ds_read_b64_tr_b16 a[146:147], v1 offset:9216
ds_read_b64_tr_b16 a[148:149], v2 offset:1024
ds_read_b64_tr_b16 a[150:151], v2 offset:9216
s_waitcnt lgkmcnt(8)
v_mfma_f32_16x16x32_bf16 v[24:27], a[128:131], v[200:203], 0
ds_read_b64_tr_b16 a[152:153], v1 offset:5120
s_add_u32 m0, s23, 65536
v_mfma_f32_16x16x32_bf16 v[28:31], a[128:131], v[204:207], 0
ds_read_b64_tr_b16 a[154:155], v1 offset:13312
s_add_u32 s30, s24, 1048576
v_mfma_f32_16x16x32_bf16 v[32:35], a[132:135], v[200:203], 0
buffer_load_dwordx4 v10, s[4:7], s30 offen lds
ds_read_b64_tr_b16 a[156:157], v2 offset:5120
v_mfma_f32_16x16x32_bf16 v[36:39], a[132:135], v[204:207], 0
ds_read_b64_tr_b16 a[158:159], v2 offset:13312
v_lshlrev_b32 v23, 6, v0
s_waitcnt lgkmcnt(8)
v_mfma_f32_16x16x32_bf16 v[40:43], a[136:139], v[200:203], 0
ds_read_b64_tr_b16 a[128:129], v1 offset:2048
buffer_load_dwordx4 v11, s[4:7], s30 offen offset:1024 lds
v_mfma_f32_16x16x32_bf16 v[44:47], a[136:139], v[204:207], 0
ds_read_b64_tr_b16 a[130:131], v1 offset:10240
buffer_load_dwordx4 v[152:155], v8, s[16:19], s33 offen offset:2048
v_mfma_f32_16x16x32_bf16 v[48:51], a[140:143], v[200:203], 0
ds_read_b64_tr_b16 a[132:133], v2 offset:2048
buffer_load_dwordx4 v12, s[4:7], s30 offen offset:2048 lds
v_mfma_f32_16x16x32_bf16 v[52:55], a[140:143], v[204:207], 0
ds_read_b64_tr_b16 a[134:135], v2 offset:10240
s_waitcnt lgkmcnt(8)
v_mfma_f32_16x16x32_bf16 v[56:59], a[144:147], v[200:203], 0
ds_read_b64_tr_b16 a[136:137], v1 offset:6144
buffer_load_dwordx4 v[156:159], v9, s[16:19], s33 offen offset:2048
v_mfma_f32_16x16x32_bf16 v[60:63], a[144:147], v[204:207], 0
ds_read_b64_tr_b16 a[138:139], v1 offset:14336
buffer_load_dwordx4 v13, s[4:7], s30 offen offset:3072 lds
v_mfma_f32_16x16x32_bf16 v[64:67], a[148:151], v[200:203], 0
ds_read_b64_tr_b16 a[140:141], v2 offset:6144
buffer_load_dwordx4 v[160:163], v8, s[16:19], s33 offen offset:3072
v_mfma_f32_16x16x32_bf16 v[68:71], a[148:151], v[204:207], 0
ds_read_b64_tr_b16 a[142:143], v2 offset:14336
s_waitcnt lgkmcnt(8)
v_mfma_f32_16x16x32_bf16 v[72:75], a[152:155], v[200:203], 0
ds_read_b64_tr_b16 a[144:145], v1 offset:3072
buffer_load_dwordx4 v[164:167], v9, s[16:19], s33 offen offset:3072
v_mfma_f32_16x16x32_bf16 v[76:79], a[152:155], v[204:207], 0
ds_read_b64_tr_b16 a[146:147], v1 offset:11264
s_add_u32 m0, s23, 69632
v_mfma_f32_16x16x32_bf16 v[80:83], a[156:159], v[200:203], 0
ds_read_b64_tr_b16 a[148:149], v2 offset:3072
s_add_u32 s31, s24, 1048832
v_mfma_f32_16x16x32_bf16 v[84:87], a[156:159], v[204:207], 0
ds_read_b64_tr_b16 a[150:151], v2 offset:11264
s_waitcnt lgkmcnt(8)
v_mfma_f32_16x16x32_bf16 v[88:91], a[128:131], v[200:203], 0
buffer_load_dwordx4 v10, s[4:7], s31 offen lds
ds_read_b64_tr_b16 a[152:153], v1 offset:7168
v_mfma_f32_16x16x32_bf16 v[92:95], a[128:131], v[204:207], 0
ds_read_b64_tr_b16 a[154:155], v1 offset:15360
buffer_load_dwordx4 v11, s[4:7], s31 offen offset:1024 lds
v_mfma_f32_16x16x32_bf16 v[96:99], a[132:135], v[200:203], 0
ds_read_b64_tr_b16 a[156:157], v2 offset:7168
v_mfma_f32_16x16x32_bf16 v[100:103], a[132:135], v[204:207], 0
ds_read_b64_tr_b16 a[158:159], v2 offset:15360
s_waitcnt lgkmcnt(8)
v_mfma_f32_16x16x32_bf16 v[104:107], a[136:139], v[200:203], 0
ds_read_b64_tr_b16 a[128:129], v1 offset:16384
buffer_load_dwordx4 v12, s[4:7], s31 offen offset:2048 lds
v_mfma_f32_16x16x32_bf16 v[108:111], a[136:139], v[204:207], 0
ds_read_b64_tr_b16 a[130:131], v1 offset:24576
v_mfma_f32_16x16x32_bf16 v[112:115], a[140:143], v[200:203], 0
ds_read_b64_tr_b16 a[132:133], v2 offset:16384
v_mfma_f32_16x16x32_bf16 v[116:119], a[140:143], v[204:207], 0
ds_read_b64_tr_b16 a[134:135], v2 offset:24576
s_waitcnt lgkmcnt(8)
v_mfma_f32_16x16x32_bf16 v[120:123], a[144:147], v[200:203], 0
ds_read_b64_tr_b16 a[136:137], v1 offset:20480
buffer_load_dwordx4 v13, s[4:7], s31 offen offset:3072 lds
v_mfma_f32_16x16x32_bf16 v[124:127], a[144:147], v[204:207], 0
ds_read_b64_tr_b16 a[138:139], v1 offset:28672
v_mfma_f32_16x16x32_bf16 v[128:131], a[148:151], v[200:203], 0
ds_read_b64_tr_b16 a[140:141], v2 offset:20480
v_mfma_f32_16x16x32_bf16 v[132:135], a[148:151], v[204:207], 0
ds_read_b64_tr_b16 a[142:143], v2 offset:28672
s_waitcnt lgkmcnt(8)
v_mfma_f32_16x16x32_bf16 v[136:139], a[152:155], v[200:203], 0
ds_read_b64_tr_b16 a[144:145], v1 offset:17408
v_mfma_f32_16x16x32_bf16 v[140:143], a[152:155], v[204:207], 0
ds_read_b64_tr_b16 a[146:147], v1 offset:25600
v_mfma_f32_16x16x32_bf16 v[144:147], a[156:159], v[200:203], 0
ds_read_b64_tr_b16 a[148:149], v2 offset:17408
ds_read_b128 v[216:219], v7 offset:2560
ds_read_b128 v[220:223], v7 offset:2624
ds_read_b128 v[224:227], v7 offset:256
ds_read_b128 v[228:231], v7 offset:320
v_mfma_f32_16x16x32_bf16 v[148:151], a[156:159], v[204:207], 0
ds_read_b64_tr_b16 a[150:151], v2 offset:25600
s_waitcnt lgkmcnt(12)
v_mfma_f32_16x16x32_bf16 v[24:27], a[128:131], v[208:211], v[24:27]
ds_read_b64_tr_b16 a[152:153], v1 offset:21504
s_waitcnt vmcnt(27) lgkmcnt(3)
v_fma_mix_f32 v248, v168, v216, v224 op_sel_hi:[1,0,0]
v_mfma_f32_16x16x32_bf16 v[28:31], a[128:131], v[212:215], v[28:31]
ds_read_b64_tr_b16 a[154:155], v1 offset:29696
s_add_u32 m0, s23, 98304
v_mfma_f32_16x16x32_bf16 v[32:35], a[132:135], v[208:211], v[32:35]
s_add_u32 s30, s24, 1572864
buffer_load_dwordx4 v10, s[4:7], s30 offen lds
ds_read_b64_tr_b16 a[156:157], v2 offset:21504
v_fma_mix_f32 v249, v168, v217, v225 op_sel:[1,0,0] op_sel_hi:[1,0,0]
v_mfma_f32_16x16x32_bf16 v[36:39], a[132:135], v[212:215], v[36:39]
ds_read_b64_tr_b16 a[158:159], v2 offset:29696
v_fma_mix_f32 v250, v169, v218, v226 op_sel_hi:[1,0,0]
v_mfma_f32_16x16x32_bf16 v[40:43], a[136:139], v[208:211], v[40:43]
ds_read_b64_tr_b16 a[128:129], v1 offset:18432
v_fma_mix_f32 v251, v169, v219, v227 op_sel:[1,0,0] op_sel_hi:[1,0,0]
v_mfma_f32_16x16x32_bf16 v[44:47], a[136:139], v[212:215], v[44:47]
ds_read_b64_tr_b16 a[130:131], v1 offset:26624
v_cvt_pk_bf16_f32 v200, v248, v249
v_mfma_f32_16x16x32_bf16 v[48:51], a[140:143], v[208:211], v[48:51]
ds_read_b64_tr_b16 a[132:133], v2 offset:18432
v_cvt_pk_bf16_f32 v201, v250, v251
v_mfma_f32_16x16x32_bf16 v[52:55], a[140:143], v[212:215], v[52:55]
ds_read_b64_tr_b16 a[134:135], v2 offset:26624
s_waitcnt lgkmcnt(8)
v_mfma_f32_16x16x32_bf16 v[56:59], a[144:147], v[208:211], v[56:59]
ds_read_b64_tr_b16 a[136:137], v1 offset:22528
v_fma_mix_f32 v252, v170, v220, v228 op_sel_hi:[1,0,0]
v_mfma_f32_16x16x32_bf16 v[60:63], a[144:147], v[212:215], v[60:63]
buffer_load_dwordx4 v11, s[4:7], s30 offen offset:1024 lds
ds_read_b64_tr_b16 a[138:139], v1 offset:30720
v_mfma_f32_16x16x32_bf16 v[64:67], a[148:151], v[208:211], v[64:67]
ds_read_b64_tr_b16 a[140:141], v2 offset:22528
s_lshl_b32 s100, s22, 13
v_fma_mix_f32 v253, v170, v221, v229 op_sel:[1,0,0] op_sel_hi:[1,0,0]
v_mfma_f32_16x16x32_bf16 v[68:71], a[148:151], v[212:215], v[68:71]
ds_read_b64_tr_b16 a[142:143], v2 offset:30720
v_fma_mix_f32 v254, v171, v222, v230 op_sel_hi:[1,0,0]
s_waitcnt lgkmcnt(8)
v_mfma_f32_16x16x32_bf16 v[72:75], a[152:155], v[208:211], v[72:75]
ds_read_b64_tr_b16 a[144:145], v1 offset:19456
s_lshl_b32 s35, s21, 19
v_fma_mix_f32 v255, v171, v223, v231 op_sel:[1,0,0] op_sel_hi:[1,0,0]
v_mfma_f32_16x16x32_bf16 v[76:79], a[152:155], v[212:215], v[76:79]
ds_read_b64_tr_b16 a[146:147], v1 offset:27648
v_cvt_pk_bf16_f32 v202, v252, v253
v_mfma_f32_16x16x32_bf16 v[80:83], a[156:159], v[208:211], v[80:83]
ds_read_b64_tr_b16 a[148:149], v2 offset:19456
s_add_u32 s100, s100, s35
v_mfma_f32_16x16x32_bf16 v[84:87], a[156:159], v[212:215], v[84:87]
ds_read_b64_tr_b16 a[150:151], v2 offset:27648
v_cvt_pk_bf16_f32 v203, v254, v255
s_waitcnt lgkmcnt(8)
v_mfma_f32_16x16x32_bf16 v[88:91], a[128:131], v[208:211], v[88:91]
buffer_load_dwordx4 v12, s[4:7], s30 offen offset:2048 lds
ds_read_b64_tr_b16 a[152:153], v1 offset:23552
s_and_b32 s35, s20, 1
s_waitcnt vmcnt(29)
v_fma_mix_f32 v248, v172, v216, v224 op_sel_hi:[1,0,0]
v_mfma_f32_16x16x32_bf16 v[92:95], a[128:131], v[212:215], v[92:95]
ds_read_b64_tr_b16 a[154:155], v1 offset:31744
v_fma_mix_f32 v249, v172, v217, v225 op_sel:[1,0,0] op_sel_hi:[1,0,0]
v_mfma_f32_16x16x32_bf16 v[96:99], a[132:135], v[208:211], v[96:99]
ds_read_b64_tr_b16 a[156:157], v2 offset:23552
s_lshl_b32 s35, s35, 12
v_mfma_f32_16x16x32_bf16 v[100:103], a[132:135], v[212:215], v[100:103]
ds_read_b64_tr_b16 a[158:159], v2 offset:31744
v_fma_mix_f32 v250, v173, v218, v226 op_sel_hi:[1,0,0]
s_waitcnt lgkmcnt(8)
v_mfma_f32_16x16x32_bf16 v[104:107], a[136:139], v[208:211], v[104:107]
s_waitcnt vmcnt(19)
s_barrier
ds_read_b64_tr_b16 a[128:129], v1 offset:32768
s_add_u32 s100, s100, s35
v_fma_mix_f32 v251, v173, v219, v227 op_sel:[1,0,0] op_sel_hi:[1,0,0]
v_mfma_f32_16x16x32_bf16 v[108:111], a[136:139], v[212:215], v[108:111]
ds_read_b64_tr_b16 a[130:131], v1 offset:40960
v_cvt_pk_bf16_f32 v204, v248, v249
v_mfma_f32_16x16x32_bf16 v[112:115], a[140:143], v[208:211], v[112:115]
ds_read_b64_tr_b16 a[132:133], v2 offset:32768
s_add_u32 s100, s100, 396288
v_cvt_pk_bf16_f32 v205, v250, v251
v_mfma_f32_16x16x32_bf16 v[116:119], a[140:143], v[212:215], v[116:119]
buffer_load_dwordx4 v13, s[4:7], s30 offen offset:3072 lds
ds_read_b64_tr_b16 a[134:135], v2 offset:40960
s_waitcnt lgkmcnt(8)
v_mfma_f32_16x16x32_bf16 v[120:123], a[144:147], v[208:211], v[120:123]
ds_read_b64_tr_b16 a[136:137], v1 offset:36864
buffer_load_dword a166, v23, s[8:11], s100 offen
v_fma_mix_f32 v252, v174, v220, v228 op_sel_hi:[1,0,0]
v_mfma_f32_16x16x32_bf16 v[124:127], a[144:147], v[212:215], v[124:127]
ds_read_b64_tr_b16 a[138:139], v1 offset:45056
v_fma_mix_f32 v253, v174, v221, v229 op_sel:[1,0,0] op_sel_hi:[1,0,0]
v_mfma_f32_16x16x32_bf16 v[128:131], a[148:151], v[208:211], v[128:131]
ds_read_b64_tr_b16 a[140:141], v2 offset:36864
v_fma_mix_f32 v254, v175, v222, v230 op_sel_hi:[1,0,0]
v_mfma_f32_16x16x32_bf16 v[132:135], a[148:151], v[212:215], v[132:135]
ds_read_b64_tr_b16 a[142:143], v2 offset:45056
s_waitcnt lgkmcnt(8)
v_mfma_f32_16x16x32_bf16 v[136:139], a[152:155], v[208:211], v[136:139]
ds_read_b64_tr_b16 a[144:145], v1 offset:33792
v_fma_mix_f32 v255, v175, v223, v231 op_sel:[1,0,0] op_sel_hi:[1,0,0]
v_mfma_f32_16x16x32_bf16 v[140:143], a[152:155], v[212:215], v[140:143]
ds_read_b64_tr_b16 a[146:147], v1 offset:41984
v_cvt_pk_bf16_f32 v206, v252, v253
v_cvt_pk_bf16_f32 v207, v254, v255
v_mfma_f32_16x16x32_bf16 v[144:147], a[156:159], v[208:211], v[144:147]
s_add_u32 m0, s23, 102400
s_add_u32 s31, s24, 1573120
buffer_load_dwordx4 v10, s[4:7], s31 offen lds
ds_read_b64_tr_b16 a[148:149], v2 offset:33792
ds_read_b128 v[232:235], v7 offset:2688
ds_read_b128 v[236:239], v7 offset:2752
ds_read_b128 v[240:243], v7 offset:384
ds_read_b128 v[244:247], v7 offset:448
v_mfma_f32_16x16x32_bf16 v[148:151], a[156:159], v[212:215], v[148:151]
ds_read_b64_tr_b16 a[150:151], v2 offset:41984
s_waitcnt lgkmcnt(12)
v_mfma_f32_16x16x32_bf16 v[24:27], a[128:131], v[200:203], v[24:27]
ds_read_b64_tr_b16 a[152:153], v1 offset:37888
s_waitcnt lgkmcnt(3)
v_fma_mix_f32 v248, v176, v232, v240 op_sel_hi:[1,0,0]
v_mfma_f32_16x16x32_bf16 v[28:31], a[128:131], v[204:207], v[28:31]
ds_read_b64_tr_b16 a[154:155], v1 offset:46080
v_fma_mix_f32 v249, v176, v233, v241 op_sel:[1,0,0] op_sel_hi:[1,0,0]
v_mfma_f32_16x16x32_bf16 v[32:35], a[132:135], v[200:203], v[32:35]
ds_read_b64_tr_b16 a[156:157], v2 offset:37888
v_fma_mix_f32 v250, v177, v234, v242 op_sel_hi:[1,0,0]
v_mfma_f32_16x16x32_bf16 v[36:39], a[132:135], v[204:207], v[36:39]
ds_read_b64_tr_b16 a[158:159], v2 offset:46080
v_mfma_f32_16x16x32_bf16 v[40:43], a[136:139], v[200:203], v[40:43]
ds_read_b64_tr_b16 a[128:129], v1 offset:34816
v_fma_mix_f32 v251, v177, v235, v243 op_sel:[1,0,0] op_sel_hi:[1,0,0]
v_mfma_f32_16x16x32_bf16 v[44:47], a[136:139], v[204:207], v[44:47]
buffer_load_dwordx4 v11, s[4:7], s31 offen offset:1024 lds
ds_read_b64_tr_b16 a[130:131], v1 offset:43008
v_mfma_f32_16x16x32_bf16 v[48:51], a[140:143], v[200:203], v[48:51]
ds_read_b64_tr_b16 a[132:133], v2 offset:34816
v_cvt_pk_bf16_f32 v208, v248, v249
v_mfma_f32_16x16x32_bf16 v[52:55], a[140:143], v[204:207], v[52:55]
ds_read_b64_tr_b16 a[134:135], v2 offset:43008
v_cvt_pk_bf16_f32 v209, v250, v251
s_waitcnt lgkmcnt(8)
v_mfma_f32_16x16x32_bf16 v[56:59], a[144:147], v[200:203], v[56:59]
ds_read_b64_tr_b16 a[136:137], v1 offset:38912
v_fma_mix_f32 v252, v178, v236, v244 op_sel_hi:[1,0,0]
v_mfma_f32_16x16x32_bf16 v[60:63], a[144:147], v[204:207], v[60:63]
ds_read_b64_tr_b16 a[138:139], v1 offset:47104
v_fma_mix_f32 v253, v178, v237, v245 op_sel:[1,0,0] op_sel_hi:[1,0,0]
v_mfma_f32_16x16x32_bf16 v[64:67], a[148:151], v[200:203], v[64:67]
ds_read_b64_tr_b16 a[140:141], v2 offset:38912
v_fma_mix_f32 v254, v179, v238, v246 op_sel_hi:[1,0,0]
v_mfma_f32_16x16x32_bf16 v[68:71], a[148:151], v[204:207], v[68:71]
ds_read_b64_tr_b16 a[142:143], v2 offset:47104
s_waitcnt lgkmcnt(8)
v_mfma_f32_16x16x32_bf16 v[72:75], a[152:155], v[200:203], v[72:75]
buffer_load_dwordx4 v12, s[4:7], s31 offen offset:2048 lds
ds_read_b64_tr_b16 a[144:145], v1 offset:35840
v_fma_mix_f32 v255, v179, v239, v247 op_sel:[1,0,0] op_sel_hi:[1,0,0]
v_mfma_f32_16x16x32_bf16 v[76:79], a[152:155], v[204:207], v[76:79]
ds_read_b64_tr_b16 a[146:147], v1 offset:44032
v_cvt_pk_bf16_f32 v210, v252, v253
v_mfma_f32_16x16x32_bf16 v[80:83], a[156:159], v[200:203], v[80:83]
ds_read_b64_tr_b16 a[148:149], v2 offset:35840
v_cvt_pk_bf16_f32 v211, v254, v255
v_mfma_f32_16x16x32_bf16 v[84:87], a[156:159], v[204:207], v[84:87]
ds_read_b64_tr_b16 a[150:151], v2 offset:44032
s_waitcnt lgkmcnt(8)
v_mfma_f32_16x16x32_bf16 v[88:91], a[128:131], v[200:203], v[88:91]
ds_read_b64_tr_b16 a[152:153], v1 offset:39936
v_fma_mix_f32 v248, v180, v232, v240 op_sel_hi:[1,0,0]
v_mfma_f32_16x16x32_bf16 v[92:95], a[128:131], v[204:207], v[92:95]
ds_read_b64_tr_b16 a[154:155], v1 offset:48128
v_fma_mix_f32 v249, v180, v233, v241 op_sel:[1,0,0] op_sel_hi:[1,0,0]
v_mfma_f32_16x16x32_bf16 v[96:99], a[132:135], v[200:203], v[96:99]
ds_read_b64_tr_b16 a[156:157], v2 offset:39936
buffer_load_dwordx4 v13, s[4:7], s31 offen offset:3072 lds
v_mfma_f32_16x16x32_bf16 v[100:103], a[132:135], v[204:207], v[100:103]
ds_read_b64_tr_b16 a[158:159], v2 offset:48128
v_fma_mix_f32 v250, v181, v234, v242 op_sel_hi:[1,0,0]
s_waitcnt lgkmcnt(8)
v_mfma_f32_16x16x32_bf16 v[104:107], a[136:139], v[200:203], v[104:107]
ds_read_b64_tr_b16 a[128:129], v1 offset:49152
v_fma_mix_f32 v251, v181, v235, v243 op_sel:[1,0,0] op_sel_hi:[1,0,0]
v_mfma_f32_16x16x32_bf16 v[108:111], a[136:139], v[204:207], v[108:111]
ds_read_b64_tr_b16 a[130:131], v1 offset:57344
v_cvt_pk_bf16_f32 v212, v248, v249
v_mfma_f32_16x16x32_bf16 v[112:115], a[140:143], v[200:203], v[112:115]
ds_read_b64_tr_b16 a[132:133], v2 offset:49152
v_cvt_pk_bf16_f32 v213, v250, v251
v_mfma_f32_16x16x32_bf16 v[116:119], a[140:143], v[204:207], v[116:119]
ds_read_b64_tr_b16 a[134:135], v2 offset:57344
s_add_u32 s33, s27, 8192
buffer_load_dwordx4 v[168:171], v8, s[16:19], s33 offen
buffer_load_dwordx4 v[172:175], v9, s[16:19], s33 offen
s_waitcnt lgkmcnt(8)
v_mfma_f32_16x16x32_bf16 v[120:123], a[144:147], v[200:203], v[120:123]
ds_read_b64_tr_b16 a[136:137], v1 offset:53248
v_fma_mix_f32 v252, v182, v236, v244 op_sel_hi:[1,0,0]
v_mfma_f32_16x16x32_bf16 v[124:127], a[144:147], v[204:207], v[124:127]
ds_read_b64_tr_b16 a[138:139], v1 offset:61440
v_fma_mix_f32 v253, v182, v237, v245 op_sel:[1,0,0] op_sel_hi:[1,0,0]
v_mfma_f32_16x16x32_bf16 v[128:131], a[148:151], v[200:203], v[128:131]
ds_read_b64_tr_b16 a[140:141], v2 offset:53248
v_fma_mix_f32 v254, v183, v238, v246 op_sel_hi:[1,0,0]
v_mfma_f32_16x16x32_bf16 v[132:135], a[148:151], v[204:207], v[132:135]
ds_read_b64_tr_b16 a[142:143], v2 offset:61440
s_waitcnt lgkmcnt(8)
v_mfma_f32_16x16x32_bf16 v[136:139], a[152:155], v[200:203], v[136:139]
ds_read_b64_tr_b16 a[144:145], v1 offset:50176
v_fma_mix_f32 v255, v183, v239, v247 op_sel:[1,0,0] op_sel_hi:[1,0,0]
v_mfma_f32_16x16x32_bf16 v[140:143], a[152:155], v[204:207], v[140:143]
ds_read_b64_tr_b16 a[146:147], v1 offset:58368
v_cvt_pk_bf16_f32 v214, v252, v253
v_cvt_pk_bf16_f32 v215, v254, v255
v_mfma_f32_16x16x32_bf16 v[144:147], a[156:159], v[200:203], v[144:147]
ds_read_b64_tr_b16 a[148:149], v2 offset:50176
ds_read_b128 v[216:219], v7 offset:2816
ds_read_b128 v[220:223], v7 offset:2880
ds_read_b128 v[224:227], v7 offset:512
ds_read_b128 v[228:231], v7 offset:576
v_mfma_f32_16x16x32_bf16 v[148:151], a[156:159], v[204:207], v[148:151]
ds_read_b64_tr_b16 a[150:151], v2 offset:58368
s_waitcnt lgkmcnt(12)
v_mfma_f32_16x16x32_bf16 v[24:27], a[128:131], v[208:211], v[24:27]
ds_read_b64_tr_b16 a[152:153], v1 offset:54272
s_waitcnt vmcnt(26) lgkmcnt(3)
v_fma_mix_f32 v248, v184, v216, v224 op_sel_hi:[1,0,0]
v_mfma_f32_16x16x32_bf16 v[28:31], a[128:131], v[212:215], v[28:31]
ds_read_b64_tr_b16 a[154:155], v1 offset:62464
v_fma_mix_f32 v249, v184, v217, v225 op_sel:[1,0,0] op_sel_hi:[1,0,0]
v_mfma_f32_16x16x32_bf16 v[32:35], a[132:135], v[208:211], v[32:35]
ds_read_b64_tr_b16 a[156:157], v2 offset:54272
v_fma_mix_f32 v250, v185, v218, v226 op_sel_hi:[1,0,0]
v_mfma_f32_16x16x32_bf16 v[36:39], a[132:135], v[212:215], v[36:39]
ds_read_b64_tr_b16 a[158:159], v2 offset:62464
v_mfma_f32_16x16x32_bf16 v[40:43], a[136:139], v[208:211], v[40:43]
ds_read_b64_tr_b16 a[128:129], v1 offset:51200
v_fma_mix_f32 v251, v185, v219, v227 op_sel:[1,0,0] op_sel_hi:[1,0,0]
v_mfma_f32_16x16x32_bf16 v[44:47], a[136:139], v[212:215], v[44:47]
ds_read_b64_tr_b16 a[130:131], v1 offset:59392
v_cvt_pk_bf16_f32 v200, v248, v249
v_mfma_f32_16x16x32_bf16 v[48:51], a[140:143], v[208:211], v[48:51]
ds_read_b64_tr_b16 a[132:133], v2 offset:51200
v_cvt_pk_bf16_f32 v201, v250, v251
v_mfma_f32_16x16x32_bf16 v[52:55], a[140:143], v[212:215], v[52:55]
ds_read_b64_tr_b16 a[134:135], v2 offset:59392
s_waitcnt lgkmcnt(8)
v_mfma_f32_16x16x32_bf16 v[56:59], a[144:147], v[208:211], v[56:59]
ds_read_b64_tr_b16 a[136:137], v1 offset:55296
v_fma_mix_f32 v252, v186, v220, v228 op_sel_hi:[1,0,0]
v_mfma_f32_16x16x32_bf16 v[60:63], a[144:147], v[212:215], v[60:63]
ds_read_b64_tr_b16 a[138:139], v1 offset:63488
v_fma_mix_f32 v253, v186, v221, v229 op_sel:[1,0,0] op_sel_hi:[1,0,0]
v_mfma_f32_16x16x32_bf16 v[64:67], a[148:151], v[208:211], v[64:67]
ds_read_b64_tr_b16 a[140:141], v2 offset:55296
v_fma_mix_f32 v254, v187, v222, v230 op_sel_hi:[1,0,0]
v_mfma_f32_16x16x32_bf16 v[68:71], a[148:151], v[212:215], v[68:71]
ds_read_b64_tr_b16 a[142:143], v2 offset:63488
s_waitcnt lgkmcnt(8)
v_mfma_f32_16x16x32_bf16 v[72:75], a[152:155], v[208:211], v[72:75]
ds_read_b64_tr_b16 a[144:145], v1 offset:52224
v_fma_mix_f32 v255, v187, v223, v231 op_sel:[1,0,0] op_sel_hi:[1,0,0]
v_mfma_f32_16x16x32_bf16 v[76:79], a[152:155], v[212:215], v[76:79]
ds_read_b64_tr_b16 a[146:147], v1 offset:60416
v_cvt_pk_bf16_f32 v202, v252, v253
v_mfma_f32_16x16x32_bf16 v[80:83], a[156:159], v[208:211], v[80:83]
ds_read_b64_tr_b16 a[148:149], v2 offset:52224
v_cvt_pk_bf16_f32 v203, v254, v255
v_mfma_f32_16x16x32_bf16 v[84:87], a[156:159], v[212:215], v[84:87]
ds_read_b64_tr_b16 a[150:151], v2 offset:60416
s_waitcnt lgkmcnt(8)
v_mfma_f32_16x16x32_bf16 v[88:91], a[128:131], v[208:211], v[88:91]
ds_read_b64_tr_b16 a[152:153], v1 offset:56320
s_waitcnt vmcnt(25)
v_fma_mix_f32 v248, v188, v216, v224 op_sel_hi:[1,0,0]
v_mfma_f32_16x16x32_bf16 v[92:95], a[128:131], v[212:215], v[92:95]
ds_read_b64_tr_b16 a[154:155], v1 offset:64512
v_fma_mix_f32 v249, v188, v217, v225 op_sel:[1,0,0] op_sel_hi:[1,0,0]
v_mfma_f32_16x16x32_bf16 v[96:99], a[132:135], v[208:211], v[96:99]
ds_read_b64_tr_b16 a[156:157], v2 offset:56320
v_fma_mix_f32 v250, v189, v218, v226 op_sel_hi:[1,0,0]
v_mfma_f32_16x16x32_bf16 v[100:103], a[132:135], v[212:215], v[100:103]
ds_read_b64_tr_b16 a[158:159], v2 offset:64512
s_waitcnt lgkmcnt(8)
v_mfma_f32_16x16x32_bf16 v[104:107], a[136:139], v[208:211], v[104:107]
s_waitcnt vmcnt(11)
s_barrier
ds_read_b64_tr_b16 a[128:129], v3
v_fma_mix_f32 v251, v189, v219, v227 op_sel:[1,0,0] op_sel_hi:[1,0,0]
v_mfma_f32_16x16x32_bf16 v[108:111], a[136:139], v[212:215], v[108:111]
ds_read_b64_tr_b16 a[130:131], v3 offset:8192
v_cvt_pk_bf16_f32 v204, v248, v249
v_mfma_f32_16x16x32_bf16 v[112:115], a[140:143], v[208:211], v[112:115]
ds_read_b64_tr_b16 a[132:133], v4
v_cvt_pk_bf16_f32 v205, v250, v251
v_mfma_f32_16x16x32_bf16 v[116:119], a[140:143], v[212:215], v[116:119]
ds_read_b64_tr_b16 a[134:135], v4 offset:8192
buffer_load_dwordx4 v[176:179], v8, s[16:19], s33 offen offset:1024
buffer_load_dwordx4 v[180:183], v9, s[16:19], s33 offen offset:1024
s_waitcnt lgkmcnt(8)
v_mfma_f32_16x16x32_bf16 v[120:123], a[144:147], v[208:211], v[120:123]
s_add_u32 m0, s23, 0
s_add_u32 s30, s24, 2097152
buffer_load_dwordx4 v10, s[4:7], s30 offen lds
ds_read_b64_tr_b16 a[136:137], v3 offset:4096
v_fma_mix_f32 v252, v190, v220, v228 op_sel_hi:[1,0,0]
v_mfma_f32_16x16x32_bf16 v[124:127], a[144:147], v[212:215], v[124:127]
ds_read_b64_tr_b16 a[138:139], v3 offset:12288
v_fma_mix_f32 v253, v190, v221, v229 op_sel:[1,0,0] op_sel_hi:[1,0,0]
v_mfma_f32_16x16x32_bf16 v[128:131], a[148:151], v[208:211], v[128:131]
ds_read_b64_tr_b16 a[140:141], v4 offset:4096
v_fma_mix_f32 v254, v191, v222, v230 op_sel_hi:[1,0,0]
v_mfma_f32_16x16x32_bf16 v[132:135], a[148:151], v[212:215], v[132:135]
ds_read_b64_tr_b16 a[142:143], v4 offset:12288
s_waitcnt lgkmcnt(8)
v_mfma_f32_16x16x32_bf16 v[136:139], a[152:155], v[208:211], v[136:139]
ds_read_b64_tr_b16 a[144:145], v3 offset:1024
v_fma_mix_f32 v255, v191, v223, v231 op_sel:[1,0,0] op_sel_hi:[1,0,0]
v_mfma_f32_16x16x32_bf16 v[140:143], a[152:155], v[212:215], v[140:143]
ds_read_b64_tr_b16 a[146:147], v3 offset:9216
v_cvt_pk_bf16_f32 v206, v252, v253
v_cvt_pk_bf16_f32 v207, v254, v255
v_mfma_f32_16x16x32_bf16 v[144:147], a[156:159], v[208:211], v[144:147]
ds_read_b64_tr_b16 a[148:149], v4 offset:1024
ds_read_b128 v[232:235], v7 offset:2944
ds_read_b128 v[236:239], v7 offset:3008
ds_read_b128 v[240:243], v7 offset:640
ds_read_b128 v[244:247], v7 offset:704
v_mfma_f32_16x16x32_bf16 v[148:151], a[156:159], v[212:215], v[148:151]
buffer_load_dwordx4 v11, s[4:7], s30 offen offset:1024 lds
ds_read_b64_tr_b16 a[150:151], v4 offset:9216
s_waitcnt lgkmcnt(12)
v_mfma_f32_16x16x32_bf16 v[24:27], a[128:131], v[200:203], v[24:27]
ds_read_b64_tr_b16 a[152:153], v3 offset:5120
s_waitcnt lgkmcnt(3)
v_fma_mix_f32 v248, v192, v232, v240 op_sel_hi:[1,0,0]
v_mfma_f32_16x16x32_bf16 v[28:31], a[128:131], v[204:207], v[28:31]
ds_read_b64_tr_b16 a[154:155], v3 offset:13312
v_fma_mix_f32 v249, v192, v233, v241 op_sel:[1,0,0] op_sel_hi:[1,0,0]
v_mfma_f32_16x16x32_bf16 v[32:35], a[132:135], v[200:203], v[32:35]
ds_read_b64_tr_b16 a[156:157], v4 offset:5120
v_fma_mix_f32 v250, v193, v234, v242 op_sel_hi:[1,0,0]
v_mfma_f32_16x16x32_bf16 v[36:39], a[132:135], v[204:207], v[36:39]
ds_read_b64_tr_b16 a[158:159], v4 offset:13312
v_mfma_f32_16x16x32_bf16 v[40:43], a[136:139], v[200:203], v[40:43]
ds_read_b64_tr_b16 a[128:129], v3 offset:2048
v_fma_mix_f32 v251, v193, v235, v243 op_sel:[1,0,0] op_sel_hi:[1,0,0]
v_mfma_f32_16x16x32_bf16 v[44:47], a[136:139], v[204:207], v[44:47]
ds_read_b64_tr_b16 a[130:131], v3 offset:10240
buffer_load_dwordx4 v12, s[4:7], s30 offen offset:2048 lds
v_mfma_f32_16x16x32_bf16 v[48:51], a[140:143], v[200:203], v[48:51]
ds_read_b64_tr_b16 a[132:133], v4 offset:2048
v_cvt_pk_bf16_f32 v208, v248, v249
v_mfma_f32_16x16x32_bf16 v[52:55], a[140:143], v[204:207], v[52:55]
ds_read_b64_tr_b16 a[134:135], v4 offset:10240
v_cvt_pk_bf16_f32 v209, v250, v251
s_waitcnt lgkmcnt(8)
v_mfma_f32_16x16x32_bf16 v[56:59], a[144:147], v[200:203], v[56:59]
ds_read_b64_tr_b16 a[136:137], v3 offset:6144
v_fma_mix_f32 v252, v194, v236, v244 op_sel_hi:[1,0,0]
v_mfma_f32_16x16x32_bf16 v[60:63], a[144:147], v[204:207], v[60:63]
ds_read_b64_tr_b16 a[138:139], v3 offset:14336
v_fma_mix_f32 v253, v194, v237, v245 op_sel:[1,0,0] op_sel_hi:[1,0,0]
v_mfma_f32_16x16x32_bf16 v[64:67], a[148:151], v[200:203], v[64:67]
ds_read_b64_tr_b16 a[140:141], v4 offset:6144
v_fma_mix_f32 v254, v195, v238, v246 op_sel_hi:[1,0,0]
v_mfma_f32_16x16x32_bf16 v[68:71], a[148:151], v[204:207], v[68:71]
ds_read_b64_tr_b16 a[142:143], v4 offset:14336
s_waitcnt lgkmcnt(8)
v_mfma_f32_16x16x32_bf16 v[72:75], a[152:155], v[200:203], v[72:75]
ds_read_b64_tr_b16 a[144:145], v3 offset:3072
v_fma_mix_f32 v255, v195, v239, v247 op_sel:[1,0,0] op_sel_hi:[1,0,0]
v_mfma_f32_16x16x32_bf16 v[76:79], a[152:155], v[204:207], v[76:79]
buffer_load_dwordx4 v13, s[4:7], s30 offen offset:3072 lds
ds_read_b64_tr_b16 a[146:147], v3 offset:11264
v_cvt_pk_bf16_f32 v210, v252, v253
v_mfma_f32_16x16x32_bf16 v[80:83], a[156:159], v[200:203], v[80:83]
ds_read_b64_tr_b16 a[148:149], v4 offset:3072
v_cvt_pk_bf16_f32 v211, v254, v255
v_mfma_f32_16x16x32_bf16 v[84:87], a[156:159], v[204:207], v[84:87]
ds_read_b64_tr_b16 a[150:151], v4 offset:11264
s_waitcnt lgkmcnt(8)
v_mfma_f32_16x16x32_bf16 v[88:91], a[128:131], v[200:203], v[88:91]
ds_read_b64_tr_b16 a[152:153], v3 offset:7168
v_fma_mix_f32 v248, v196, v232, v240 op_sel_hi:[1,0,0]
v_mfma_f32_16x16x32_bf16 v[92:95], a[128:131], v[204:207], v[92:95]
ds_read_b64_tr_b16 a[154:155], v3 offset:15360
v_fma_mix_f32 v249, v196, v233, v241 op_sel:[1,0,0] op_sel_hi:[1,0,0]
v_mfma_f32_16x16x32_bf16 v[96:99], a[132:135], v[200:203], v[96:99]
ds_read_b64_tr_b16 a[156:157], v4 offset:7168
v_fma_mix_f32 v250, v197, v234, v242 op_sel_hi:[1,0,0]
v_mfma_f32_16x16x32_bf16 v[100:103], a[132:135], v[204:207], v[100:103]
ds_read_b64_tr_b16 a[158:159], v4 offset:15360
s_waitcnt lgkmcnt(8)
v_mfma_f32_16x16x32_bf16 v[104:107], a[136:139], v[200:203], v[104:107]
s_add_u32 m0, s23, 4096
s_add_u32 s31, s24, 2097408
buffer_load_dwordx4 v10, s[4:7], s31 offen lds
ds_read_b64_tr_b16 a[128:129], v3 offset:16384
v_fma_mix_f32 v251, v197, v235, v243 op_sel:[1,0,0] op_sel_hi:[1,0,0]
v_mfma_f32_16x16x32_bf16 v[108:111], a[136:139], v[204:207], v[108:111]
ds_read_b64_tr_b16 a[130:131], v3 offset:24576
v_cvt_pk_bf16_f32 v212, v248, v249
v_mfma_f32_16x16x32_bf16 v[112:115], a[140:143], v[200:203], v[112:115]
ds_read_b64_tr_b16 a[132:133], v4 offset:16384
v_cvt_pk_bf16_f32 v213, v250, v251
v_mfma_f32_16x16x32_bf16 v[116:119], a[140:143], v[204:207], v[116:119]
ds_read_b64_tr_b16 a[134:135], v4 offset:24576
buffer_load_dwordx4 v[184:187], v8, s[16:19], s33 offen offset:2048
buffer_load_dwordx4 v[188:191], v9, s[16:19], s33 offen offset:2048
s_waitcnt lgkmcnt(8)
v_mfma_f32_16x16x32_bf16 v[120:123], a[144:147], v[200:203], v[120:123]
ds_read_b64_tr_b16 a[136:137], v3 offset:20480
v_fma_mix_f32 v252, v198, v236, v244 op_sel_hi:[1,0,0]
v_mfma_f32_16x16x32_bf16 v[124:127], a[144:147], v[204:207], v[124:127]
ds_read_b64_tr_b16 a[138:139], v3 offset:28672
v_fma_mix_f32 v253, v198, v237, v245 op_sel:[1,0,0] op_sel_hi:[1,0,0]
v_mfma_f32_16x16x32_bf16 v[128:131], a[148:151], v[200:203], v[128:131]
ds_read_b64_tr_b16 a[140:141], v4 offset:20480
v_fma_mix_f32 v254, v199, v238, v246 op_sel_hi:[1,0,0]
v_mfma_f32_16x16x32_bf16 v[132:135], a[148:151], v[204:207], v[132:135]
buffer_load_dwordx4 v11, s[4:7], s31 offen offset:1024 lds
ds_read_b64_tr_b16 a[142:143], v4 offset:28672
s_waitcnt lgkmcnt(8)
v_mfma_f32_16x16x32_bf16 v[136:139], a[152:155], v[200:203], v[136:139]
ds_read_b64_tr_b16 a[144:145], v3 offset:17408
v_fma_mix_f32 v255, v199, v239, v247 op_sel:[1,0,0] op_sel_hi:[1,0,0]
v_mfma_f32_16x16x32_bf16 v[140:143], a[152:155], v[204:207], v[140:143]
ds_read_b64_tr_b16 a[146:147], v3 offset:25600
v_cvt_pk_bf16_f32 v214, v252, v253
v_cvt_pk_bf16_f32 v215, v254, v255
v_mfma_f32_16x16x32_bf16 v[144:147], a[156:159], v[200:203], v[144:147]
ds_read_b64_tr_b16 a[148:149], v4 offset:17408
ds_read_b128 v[216:219], v7 offset:3072
ds_read_b128 v[220:223], v7 offset:3136
ds_read_b128 v[224:227], v7 offset:768
ds_read_b128 v[228:231], v7 offset:832
v_mfma_f32_16x16x32_bf16 v[148:151], a[156:159], v[204:207], v[148:151]
ds_read_b64_tr_b16 a[150:151], v4 offset:25600
s_waitcnt lgkmcnt(12)
v_mfma_f32_16x16x32_bf16 v[24:27], a[128:131], v[208:211], v[24:27]
ds_read_b64_tr_b16 a[152:153], v3 offset:21504
s_waitcnt lgkmcnt(3)
v_fma_mix_f32 v248, v152, v216, v224 op_sel_hi:[1,0,0]
v_mfma_f32_16x16x32_bf16 v[28:31], a[128:131], v[212:215], v[28:31]
ds_read_b64_tr_b16 a[154:155], v3 offset:29696
buffer_load_dwordx4 v12, s[4:7], s31 offen offset:2048 lds
v_mfma_f32_16x16x32_bf16 v[32:35], a[132:135], v[208:211], v[32:35]
ds_read_b64_tr_b16 a[156:157], v4 offset:21504
v_fma_mix_f32 v249, v152, v217, v225 op_sel:[1,0,0] op_sel_hi:[1,0,0]
v_mfma_f32_16x16x32_bf16 v[36:39], a[132:135], v[212:215], v[36:39]
ds_read_b64_tr_b16 a[158:159], v4 offset:29696
v_fma_mix_f32 v250, v153, v218, v226 op_sel_hi:[1,0,0]
v_mfma_f32_16x16x32_bf16 v[40:43], a[136:139], v[208:211], v[40:43]
ds_read_b64_tr_b16 a[128:129], v3 offset:18432
v_fma_mix_f32 v251, v153, v219, v227 op_sel:[1,0,0] op_sel_hi:[1,0,0]
v_mfma_f32_16x16x32_bf16 v[44:47], a[136:139], v[212:215], v[44:47]
ds_read_b64_tr_b16 a[130:131], v3 offset:26624
v_cvt_pk_bf16_f32 v200, v248, v249
v_mfma_f32_16x16x32_bf16 v[48:51], a[140:143], v[208:211], v[48:51]
ds_read_b64_tr_b16 a[132:133], v4 offset:18432
v_cvt_pk_bf16_f32 v201, v250, v251
v_mfma_f32_16x16x32_bf16 v[52:55], a[140:143], v[212:215], v[52:55]
ds_read_b64_tr_b16 a[134:135], v4 offset:26624
s_waitcnt lgkmcnt(8)
v_mfma_f32_16x16x32_bf16 v[56:59], a[144:147], v[208:211], v[56:59]
ds_read_b64_tr_b16 a[136:137], v3 offset:22528
v_fma_mix_f32 v252, v154, v220, v228 op_sel_hi:[1,0,0]
v_mfma_f32_16x16x32_bf16 v[60:63], a[144:147], v[212:215], v[60:63]
buffer_load_dwordx4 v13, s[4:7], s31 offen offset:3072 lds
ds_read_b64_tr_b16 a[138:139], v3 offset:30720
v_mfma_f32_16x16x32_bf16 v[64:67], a[148:151], v[208:211], v[64:67]
ds_read_b64_tr_b16 a[140:141], v4 offset:22528
v_fma_mix_f32 v253, v154, v221, v229 op_sel:[1,0,0] op_sel_hi:[1,0,0]
v_mfma_f32_16x16x32_bf16 v[68:71], a[148:151], v[212:215], v[68:71]
ds_read_b64_tr_b16 a[142:143], v4 offset:30720
v_fma_mix_f32 v254, v155, v222, v230 op_sel_hi:[1,0,0]
s_waitcnt lgkmcnt(8)
v_mfma_f32_16x16x32_bf16 v[72:75], a[152:155], v[208:211], v[72:75]
ds_read_b64_tr_b16 a[144:145], v3 offset:19456
v_fma_mix_f32 v255, v155, v223, v231 op_sel:[1,0,0] op_sel_hi:[1,0,0]
v_mfma_f32_16x16x32_bf16 v[76:79], a[152:155], v[212:215], v[76:79]
ds_read_b64_tr_b16 a[146:147], v3 offset:27648
v_cvt_pk_bf16_f32 v202, v252, v253
v_mfma_f32_16x16x32_bf16 v[80:83], a[156:159], v[208:211], v[80:83]
ds_read_b64_tr_b16 a[148:149], v4 offset:19456
v_cvt_pk_bf16_f32 v203, v254, v255
v_mfma_f32_16x16x32_bf16 v[84:87], a[156:159], v[212:215], v[84:87]
ds_read_b64_tr_b16 a[150:151], v4 offset:27648
s_waitcnt lgkmcnt(8)
v_mfma_f32_16x16x32_bf16 v[88:91], a[128:131], v[208:211], v[88:91]
ds_read_b64_tr_b16 a[152:153], v3 offset:23552
v_fma_mix_f32 v248, v156, v216, v224 op_sel_hi:[1,0,0]
v_mfma_f32_16x16x32_bf16 v[92:95], a[128:131], v[212:215], v[92:95]
ds_read_b64_tr_b16 a[154:155], v3 offset:31744
v_fma_mix_f32 v249, v156, v217, v225 op_sel:[1,0,0] op_sel_hi:[1,0,0]
v_mfma_f32_16x16x32_bf16 v[96:99], a[132:135], v[208:211], v[96:99]
ds_read_b64_tr_b16 a[156:157], v4 offset:23552
v_fma_mix_f32 v250, v157, v218, v226 op_sel_hi:[1,0,0]
v_mfma_f32_16x16x32_bf16 v[100:103], a[132:135], v[212:215], v[100:103]
ds_read_b64_tr_b16 a[158:159], v4 offset:31744
s_waitcnt lgkmcnt(8)
v_mfma_f32_16x16x32_bf16 v[104:107], a[136:139], v[208:211], v[104:107]
s_waitcnt vmcnt(14)
s_barrier
ds_read_b64_tr_b16 a[128:129], v3 offset:32768
v_fma_mix_f32 v251, v157, v219, v227 op_sel:[1,0,0] op_sel_hi:[1,0,0]
v_mfma_f32_16x16x32_bf16 v[108:111], a[136:139], v[212:215], v[108:111]
ds_read_b64_tr_b16 a[130:131], v3 offset:40960
v_cvt_pk_bf16_f32 v204, v248, v249
v_mfma_f32_16x16x32_bf16 v[112:115], a[140:143], v[208:211], v[112:115]
ds_read_b64_tr_b16 a[132:133], v4 offset:32768
v_cvt_pk_bf16_f32 v205, v250, v251
v_mfma_f32_16x16x32_bf16 v[116:119], a[140:143], v[212:215], v[116:119]
ds_read_b64_tr_b16 a[134:135], v4 offset:40960
buffer_load_dwordx4 v[192:195], v8, s[16:19], s33 offen offset:3072
buffer_load_dwordx4 v[196:199], v9, s[16:19], s33 offen offset:3072
s_waitcnt lgkmcnt(8)
v_mfma_f32_16x16x32_bf16 v[120:123], a[144:147], v[208:211], v[120:123]
s_add_u32 m0, s23, 32768
s_add_u32 s30, s24, 2621440
buffer_load_dwordx4 v10, s[4:7], s30 offen lds
ds_read_b64_tr_b16 a[136:137], v3 offset:36864
v_fma_mix_f32 v252, v158, v220, v228 op_sel_hi:[1,0,0]
v_mfma_f32_16x16x32_bf16 v[124:127], a[144:147], v[212:215], v[124:127]
ds_read_b64_tr_b16 a[138:139], v3 offset:45056
v_fma_mix_f32 v253, v158, v221, v229 op_sel:[1,0,0] op_sel_hi:[1,0,0]
v_mfma_f32_16x16x32_bf16 v[128:131], a[148:151], v[208:211], v[128:131]
ds_read_b64_tr_b16 a[140:141], v4 offset:36864
v_fma_mix_f32 v254, v159, v222, v230 op_sel_hi:[1,0,0]
v_mfma_f32_16x16x32_bf16 v[132:135], a[148:151], v[212:215], v[132:135]
ds_read_b64_tr_b16 a[142:143], v4 offset:45056
s_waitcnt lgkmcnt(8)
v_mfma_f32_16x16x32_bf16 v[136:139], a[152:155], v[208:211], v[136:139]
ds_read_b64_tr_b16 a[144:145], v3 offset:33792
v_fma_mix_f32 v255, v159, v223, v231 op_sel:[1,0,0] op_sel_hi:[1,0,0]
v_mfma_f32_16x16x32_bf16 v[140:143], a[152:155], v[212:215], v[140:143]
ds_read_b64_tr_b16 a[146:147], v3 offset:41984
v_cvt_pk_bf16_f32 v206, v252, v253
v_cvt_pk_bf16_f32 v207, v254, v255
v_mfma_f32_16x16x32_bf16 v[144:147], a[156:159], v[208:211], v[144:147]
ds_read_b64_tr_b16 a[148:149], v4 offset:33792
ds_read_b128 v[232:235], v7 offset:3200
ds_read_b128 v[236:239], v7 offset:3264
ds_read_b128 v[240:243], v7 offset:896
ds_read_b128 v[244:247], v7 offset:960
v_mfma_f32_16x16x32_bf16 v[148:151], a[156:159], v[212:215], v[148:151]
buffer_load_dwordx4 v11, s[4:7], s30 offen offset:1024 lds
ds_read_b64_tr_b16 a[150:151], v4 offset:41984
s_waitcnt lgkmcnt(12)
v_mfma_f32_16x16x32_bf16 v[24:27], a[128:131], v[200:203], v[24:27]
ds_read_b64_tr_b16 a[152:153], v3 offset:37888
s_waitcnt lgkmcnt(3)
v_fma_mix_f32 v248, v160, v232, v240 op_sel_hi:[1,0,0]
v_mfma_f32_16x16x32_bf16 v[28:31], a[128:131], v[204:207], v[28:31]
ds_read_b64_tr_b16 a[154:155], v3 offset:46080
v_fma_mix_f32 v249, v160, v233, v241 op_sel:[1,0,0] op_sel_hi:[1,0,0]
v_mfma_f32_16x16x32_bf16 v[32:35], a[132:135], v[200:203], v[32:35]
ds_read_b64_tr_b16 a[156:157], v4 offset:37888
v_fma_mix_f32 v250, v161, v234, v242 op_sel_hi:[1,0,0]
v_mfma_f32_16x16x32_bf16 v[36:39], a[132:135], v[204:207], v[36:39]
ds_read_b64_tr_b16 a[158:159], v4 offset:46080
v_mfma_f32_16x16x32_bf16 v[40:43], a[136:139], v[200:203], v[40:43]
ds_read_b64_tr_b16 a[128:129], v3 offset:34816
v_fma_mix_f32 v251, v161, v235, v243 op_sel:[1,0,0] op_sel_hi:[1,0,0]
v_mfma_f32_16x16x32_bf16 v[44:47], a[136:139], v[204:207], v[44:47]
ds_read_b64_tr_b16 a[130:131], v3 offset:43008
buffer_load_dwordx4 v12, s[4:7], s30 offen offset:2048 lds
v_mfma_f32_16x16x32_bf16 v[48:51], a[140:143], v[200:203], v[48:51]
ds_read_b64_tr_b16 a[132:133], v4 offset:34816
v_cvt_pk_bf16_f32 v208, v248, v249
v_mfma_f32_16x16x32_bf16 v[52:55], a[140:143], v[204:207], v[52:55]
ds_read_b64_tr_b16 a[134:135], v4 offset:43008
v_cvt_pk_bf16_f32 v209, v250, v251
s_waitcnt lgkmcnt(8)
v_mfma_f32_16x16x32_bf16 v[56:59], a[144:147], v[200:203], v[56:59]
ds_read_b64_tr_b16 a[136:137], v3 offset:38912
v_fma_mix_f32 v252, v162, v236, v244 op_sel_hi:[1,0,0]
v_mfma_f32_16x16x32_bf16 v[60:63], a[144:147], v[204:207], v[60:63]
ds_read_b64_tr_b16 a[138:139], v3 offset:47104
v_fma_mix_f32 v253, v162, v237, v245 op_sel:[1,0,0] op_sel_hi:[1,0,0]
v_mfma_f32_16x16x32_bf16 v[64:67], a[148:151], v[200:203], v[64:67]
ds_read_b64_tr_b16 a[140:141], v4 offset:38912
v_fma_mix_f32 v254, v163, v238, v246 op_sel_hi:[1,0,0]
v_mfma_f32_16x16x32_bf16 v[68:71], a[148:151], v[204:207], v[68:71]
ds_read_b64_tr_b16 a[142:143], v4 offset:47104
s_waitcnt lgkmcnt(8)
v_mfma_f32_16x16x32_bf16 v[72:75], a[152:155], v[200:203], v[72:75]
ds_read_b64_tr_b16 a[144:145], v3 offset:35840
v_fma_mix_f32 v255, v163, v239, v247 op_sel:[1,0,0] op_sel_hi:[1,0,0]
v_mfma_f32_16x16x32_bf16 v[76:79], a[152:155], v[204:207], v[76:79]
buffer_load_dwordx4 v13, s[4:7], s30 offen offset:3072 lds
ds_read_b64_tr_b16 a[146:147], v3 offset:44032
v_cvt_pk_bf16_f32 v210, v252, v253
v_mfma_f32_16x16x32_bf16 v[80:83], a[156:159], v[200:203], v[80:83]
ds_read_b64_tr_b16 a[148:149], v4 offset:35840
v_cvt_pk_bf16_f32 v211, v254, v255
v_mfma_f32_16x16x32_bf16 v[84:87], a[156:159], v[204:207], v[84:87]
ds_read_b64_tr_b16 a[150:151], v4 offset:44032
s_waitcnt lgkmcnt(8)
v_mfma_f32_16x16x32_bf16 v[88:91], a[128:131], v[200:203], v[88:91]
ds_read_b64_tr_b16 a[152:153], v3 offset:39936
v_fma_mix_f32 v248, v164, v232, v240 op_sel_hi:[1,0,0]
v_mfma_f32_16x16x32_bf16 v[92:95], a[128:131], v[204:207], v[92:95]
ds_read_b64_tr_b16 a[154:155], v3 offset:48128
v_fma_mix_f32 v249, v164, v233, v241 op_sel:[1,0,0] op_sel_hi:[1,0,0]
v_mfma_f32_16x16x32_bf16 v[96:99], a[132:135], v[200:203], v[96:99]
ds_read_b64_tr_b16 a[156:157], v4 offset:39936
v_fma_mix_f32 v250, v165, v234, v242 op_sel_hi:[1,0,0]
v_mfma_f32_16x16x32_bf16 v[100:103], a[132:135], v[204:207], v[100:103]
ds_read_b64_tr_b16 a[158:159], v4 offset:48128
s_waitcnt lgkmcnt(8)
v_mfma_f32_16x16x32_bf16 v[104:107], a[136:139], v[200:203], v[104:107]
s_add_u32 m0, s23, 36864
s_add_u32 s31, s24, 2621696
buffer_load_dwordx4 v10, s[4:7], s31 offen lds
ds_read_b64_tr_b16 a[128:129], v3 offset:49152
v_fma_mix_f32 v251, v165, v235, v243 op_sel:[1,0,0] op_sel_hi:[1,0,0]
v_mfma_f32_16x16x32_bf16 v[108:111], a[136:139], v[204:207], v[108:111]
ds_read_b64_tr_b16 a[130:131], v3 offset:57344
v_cvt_pk_bf16_f32 v212, v248, v249
v_mfma_f32_16x16x32_bf16 v[112:115], a[140:143], v[200:203], v[112:115]
ds_read_b64_tr_b16 a[132:133], v4 offset:49152
v_cvt_pk_bf16_f32 v213, v250, v251
v_mfma_f32_16x16x32_bf16 v[116:119], a[140:143], v[204:207], v[116:119]
ds_read_b64_tr_b16 a[134:135], v4 offset:57344
s_add_u32 s33, s27, 12288
buffer_load_dwordx4 v[152:155], v8, s[16:19], s33 offen
buffer_load_dwordx4 v[156:159], v9, s[16:19], s33 offen
s_waitcnt lgkmcnt(8)
v_mfma_f32_16x16x32_bf16 v[120:123], a[144:147], v[200:203], v[120:123]
ds_read_b64_tr_b16 a[136:137], v3 offset:53248
v_fma_mix_f32 v252, v166, v236, v244 op_sel_hi:[1,0,0]
v_mfma_f32_16x16x32_bf16 v[124:127], a[144:147], v[204:207], v[124:127]
ds_read_b64_tr_b16 a[138:139], v3 offset:61440
v_fma_mix_f32 v253, v166, v237, v245 op_sel:[1,0,0] op_sel_hi:[1,0,0]
v_mfma_f32_16x16x32_bf16 v[128:131], a[148:151], v[200:203], v[128:131]
ds_read_b64_tr_b16 a[140:141], v4 offset:53248
v_fma_mix_f32 v254, v167, v238, v246 op_sel_hi:[1,0,0]
v_mfma_f32_16x16x32_bf16 v[132:135], a[148:151], v[204:207], v[132:135]
buffer_load_dwordx4 v11, s[4:7], s31 offen offset:1024 lds
ds_read_b64_tr_b16 a[142:143], v4 offset:61440
s_waitcnt lgkmcnt(8)
v_mfma_f32_16x16x32_bf16 v[136:139], a[152:155], v[200:203], v[136:139]
ds_read_b64_tr_b16 a[144:145], v3 offset:50176
v_fma_mix_f32 v255, v167, v239, v247 op_sel:[1,0,0] op_sel_hi:[1,0,0]
v_mfma_f32_16x16x32_bf16 v[140:143], a[152:155], v[204:207], v[140:143]
ds_read_b64_tr_b16 a[146:147], v3 offset:58368
v_cvt_pk_bf16_f32 v214, v252, v253
v_cvt_pk_bf16_f32 v215, v254, v255
v_mfma_f32_16x16x32_bf16 v[144:147], a[156:159], v[200:203], v[144:147]
ds_read_b64_tr_b16 a[148:149], v4 offset:50176
ds_read_b128 v[216:219], v7 offset:3328
ds_read_b128 v[220:223], v7 offset:3392
ds_read_b128 v[224:227], v7 offset:1024
ds_read_b128 v[228:231], v7 offset:1088
v_mfma_f32_16x16x32_bf16 v[148:151], a[156:159], v[204:207], v[148:151]
ds_read_b64_tr_b16 a[150:151], v4 offset:58368
s_waitcnt lgkmcnt(12)
v_mfma_f32_16x16x32_bf16 v[24:27], a[128:131], v[208:211], v[24:27]
ds_read_b64_tr_b16 a[152:153], v3 offset:54272
s_waitcnt vmcnt(23) lgkmcnt(3)
v_fma_mix_f32 v248, v168, v216, v224 op_sel_hi:[1,0,0]
v_mfma_f32_16x16x32_bf16 v[28:31], a[128:131], v[212:215], v[28:31]
ds_read_b64_tr_b16 a[154:155], v3 offset:62464
buffer_load_dwordx4 v12, s[4:7], s31 offen offset:2048 lds
v_mfma_f32_16x16x32_bf16 v[32:35], a[132:135], v[208:211], v[32:35]
ds_read_b64_tr_b16 a[156:157], v4 offset:54272
v_fma_mix_f32 v249, v168, v217, v225 op_sel:[1,0,0] op_sel_hi:[1,0,0]
v_mfma_f32_16x16x32_bf16 v[36:39], a[132:135], v[212:215], v[36:39]
ds_read_b64_tr_b16 a[158:159], v4 offset:62464
v_fma_mix_f32 v250, v169, v218, v226 op_sel_hi:[1,0,0]
v_mfma_f32_16x16x32_bf16 v[40:43], a[136:139], v[208:211], v[40:43]
ds_read_b64_tr_b16 a[128:129], v3 offset:51200
v_fma_mix_f32 v251, v169, v219, v227 op_sel:[1,0,0] op_sel_hi:[1,0,0]
v_mfma_f32_16x16x32_bf16 v[44:47], a[136:139], v[212:215], v[44:47]
ds_read_b64_tr_b16 a[130:131], v3 offset:59392
v_cvt_pk_bf16_f32 v200, v248, v249
v_mfma_f32_16x16x32_bf16 v[48:51], a[140:143], v[208:211], v[48:51]
ds_read_b64_tr_b16 a[132:133], v4 offset:51200
v_cvt_pk_bf16_f32 v201, v250, v251
v_mfma_f32_16x16x32_bf16 v[52:55], a[140:143], v[212:215], v[52:55]
ds_read_b64_tr_b16 a[134:135], v4 offset:59392
s_waitcnt lgkmcnt(8)
v_mfma_f32_16x16x32_bf16 v[56:59], a[144:147], v[208:211], v[56:59]
ds_read_b64_tr_b16 a[136:137], v3 offset:55296
v_fma_mix_f32 v252, v170, v220, v228 op_sel_hi:[1,0,0]
v_mfma_f32_16x16x32_bf16 v[60:63], a[144:147], v[212:215], v[60:63]
buffer_load_dwordx4 v13, s[4:7], s31 offen offset:3072 lds
ds_read_b64_tr_b16 a[138:139], v3 offset:63488
v_mfma_f32_16x16x32_bf16 v[64:67], a[148:151], v[208:211], v[64:67]
ds_read_b64_tr_b16 a[140:141], v4 offset:55296
v_fma_mix_f32 v253, v170, v221, v229 op_sel:[1,0,0] op_sel_hi:[1,0,0]
v_mfma_f32_16x16x32_bf16 v[68:71], a[148:151], v[212:215], v[68:71]
ds_read_b64_tr_b16 a[142:143], v4 offset:63488
v_fma_mix_f32 v254, v171, v222, v230 op_sel_hi:[1,0,0]
s_waitcnt lgkmcnt(8)
v_mfma_f32_16x16x32_bf16 v[72:75], a[152:155], v[208:211], v[72:75]
ds_read_b64_tr_b16 a[144:145], v3 offset:52224
v_fma_mix_f32 v255, v171, v223, v231 op_sel:[1,0,0] op_sel_hi:[1,0,0]
v_mfma_f32_16x16x32_bf16 v[76:79], a[152:155], v[212:215], v[76:79]
ds_read_b64_tr_b16 a[146:147], v3 offset:60416
v_cvt_pk_bf16_f32 v202, v252, v253
v_mfma_f32_16x16x32_bf16 v[80:83], a[156:159], v[208:211], v[80:83]
ds_read_b64_tr_b16 a[148:149], v4 offset:52224
v_cvt_pk_bf16_f32 v203, v254, v255
v_mfma_f32_16x16x32_bf16 v[84:87], a[156:159], v[212:215], v[84:87]
ds_read_b64_tr_b16 a[150:151], v4 offset:60416
s_waitcnt lgkmcnt(8)
v_mfma_f32_16x16x32_bf16 v[88:91], a[128:131], v[208:211], v[88:91]
ds_read_b64_tr_b16 a[152:153], v3 offset:56320
s_waitcnt vmcnt(24)
v_fma_mix_f32 v248, v172, v216, v224 op_sel_hi:[1,0,0]
v_mfma_f32_16x16x32_bf16 v[92:95], a[128:131], v[212:215], v[92:95]
ds_read_b64_tr_b16 a[154:155], v3 offset:64512
v_fma_mix_f32 v249, v172, v217, v225 op_sel:[1,0,0] op_sel_hi:[1,0,0]
v_mfma_f32_16x16x32_bf16 v[96:99], a[132:135], v[208:211], v[96:99]
ds_read_b64_tr_b16 a[156:157], v4 offset:56320
v_fma_mix_f32 v250, v173, v218, v226 op_sel_hi:[1,0,0]
v_mfma_f32_16x16x32_bf16 v[100:103], a[132:135], v[212:215], v[100:103]
ds_read_b64_tr_b16 a[158:159], v4 offset:64512
s_waitcnt lgkmcnt(8)
v_mfma_f32_16x16x32_bf16 v[104:107], a[136:139], v[208:211], v[104:107]
s_waitcnt vmcnt(12)
s_barrier
ds_read_b64_tr_b16 a[128:129], v1
v_fma_mix_f32 v251, v173, v219, v227 op_sel:[1,0,0] op_sel_hi:[1,0,0]
v_mfma_f32_16x16x32_bf16 v[108:111], a[136:139], v[212:215], v[108:111]
ds_read_b64_tr_b16 a[130:131], v1 offset:8192
v_cvt_pk_bf16_f32 v204, v248, v249
v_mfma_f32_16x16x32_bf16 v[112:115], a[140:143], v[208:211], v[112:115]
ds_read_b64_tr_b16 a[132:133], v2
v_cvt_pk_bf16_f32 v205, v250, v251
v_mfma_f32_16x16x32_bf16 v[116:119], a[140:143], v[212:215], v[116:119]
ds_read_b64_tr_b16 a[134:135], v2 offset:8192
buffer_load_dwordx4 v[160:163], v8, s[16:19], s33 offen offset:1024
buffer_load_dwordx4 v[164:167], v9, s[16:19], s33 offen offset:1024
s_waitcnt lgkmcnt(8)
v_mfma_f32_16x16x32_bf16 v[120:123], a[144:147], v[208:211], v[120:123]
s_add_u32 m0, s23, 65536
s_add_u32 s30, s24, 3145728
buffer_load_dwordx4 v10, s[4:7], s30 offen lds
ds_read_b64_tr_b16 a[136:137], v1 offset:4096
v_fma_mix_f32 v252, v174, v220, v228 op_sel_hi:[1,0,0]
v_mfma_f32_16x16x32_bf16 v[124:127], a[144:147], v[212:215], v[124:127]
ds_read_b64_tr_b16 a[138:139], v1 offset:12288
v_fma_mix_f32 v253, v174, v221, v229 op_sel:[1,0,0] op_sel_hi:[1,0,0]
v_mfma_f32_16x16x32_bf16 v[128:131], a[148:151], v[208:211], v[128:131]
ds_read_b64_tr_b16 a[140:141], v2 offset:4096
v_fma_mix_f32 v254, v175, v222, v230 op_sel_hi:[1,0,0]
v_mfma_f32_16x16x32_bf16 v[132:135], a[148:151], v[212:215], v[132:135]
ds_read_b64_tr_b16 a[142:143], v2 offset:12288
s_waitcnt lgkmcnt(8)
v_mfma_f32_16x16x32_bf16 v[136:139], a[152:155], v[208:211], v[136:139]
ds_read_b64_tr_b16 a[144:145], v1 offset:1024
v_fma_mix_f32 v255, v175, v223, v231 op_sel:[1,0,0] op_sel_hi:[1,0,0]
v_mfma_f32_16x16x32_bf16 v[140:143], a[152:155], v[212:215], v[140:143]
ds_read_b64_tr_b16 a[146:147], v1 offset:9216
v_cvt_pk_bf16_f32 v206, v252, v253
v_cvt_pk_bf16_f32 v207, v254, v255
v_mfma_f32_16x16x32_bf16 v[144:147], a[156:159], v[208:211], v[144:147]
ds_read_b64_tr_b16 a[148:149], v2 offset:1024
ds_read_b128 v[232:235], v7 offset:3456
ds_read_b128 v[236:239], v7 offset:3520
ds_read_b128 v[240:243], v7 offset:1152
ds_read_b128 v[244:247], v7 offset:1216
v_mfma_f32_16x16x32_bf16 v[148:151], a[156:159], v[212:215], v[148:151]
buffer_load_dwordx4 v11, s[4:7], s30 offen offset:1024 lds
ds_read_b64_tr_b16 a[150:151], v2 offset:9216
s_waitcnt lgkmcnt(12)
v_mfma_f32_16x16x32_bf16 v[24:27], a[128:131], v[200:203], v[24:27]
ds_read_b64_tr_b16 a[152:153], v1 offset:5120
s_waitcnt lgkmcnt(3)
v_fma_mix_f32 v248, v176, v232, v240 op_sel_hi:[1,0,0]
v_mfma_f32_16x16x32_bf16 v[28:31], a[128:131], v[204:207], v[28:31]
ds_read_b64_tr_b16 a[154:155], v1 offset:13312
v_fma_mix_f32 v249, v176, v233, v241 op_sel:[1,0,0] op_sel_hi:[1,0,0]
v_mfma_f32_16x16x32_bf16 v[32:35], a[132:135], v[200:203], v[32:35]
ds_read_b64_tr_b16 a[156:157], v2 offset:5120
v_fma_mix_f32 v250, v177, v234, v242 op_sel_hi:[1,0,0]
v_mfma_f32_16x16x32_bf16 v[36:39], a[132:135], v[204:207], v[36:39]
ds_read_b64_tr_b16 a[158:159], v2 offset:13312
v_mfma_f32_16x16x32_bf16 v[40:43], a[136:139], v[200:203], v[40:43]
ds_read_b64_tr_b16 a[128:129], v1 offset:2048
v_fma_mix_f32 v251, v177, v235, v243 op_sel:[1,0,0] op_sel_hi:[1,0,0]
v_mfma_f32_16x16x32_bf16 v[44:47], a[136:139], v[204:207], v[44:47]
ds_read_b64_tr_b16 a[130:131], v1 offset:10240
buffer_load_dwordx4 v12, s[4:7], s30 offen offset:2048 lds
v_mfma_f32_16x16x32_bf16 v[48:51], a[140:143], v[200:203], v[48:51]
ds_read_b64_tr_b16 a[132:133], v2 offset:2048
v_cvt_pk_bf16_f32 v208, v248, v249
v_mfma_f32_16x16x32_bf16 v[52:55], a[140:143], v[204:207], v[52:55]
ds_read_b64_tr_b16 a[134:135], v2 offset:10240
v_cvt_pk_bf16_f32 v209, v250, v251
s_waitcnt lgkmcnt(8)
v_mfma_f32_16x16x32_bf16 v[56:59], a[144:147], v[200:203], v[56:59]
ds_read_b64_tr_b16 a[136:137], v1 offset:6144
v_fma_mix_f32 v252, v178, v236, v244 op_sel_hi:[1,0,0]
v_mfma_f32_16x16x32_bf16 v[60:63], a[144:147], v[204:207], v[60:63]
ds_read_b64_tr_b16 a[138:139], v1 offset:14336
v_fma_mix_f32 v253, v178, v237, v245 op_sel:[1,0,0] op_sel_hi:[1,0,0]
v_mfma_f32_16x16x32_bf16 v[64:67], a[148:151], v[200:203], v[64:67]
ds_read_b64_tr_b16 a[140:141], v2 offset:6144
v_fma_mix_f32 v254, v179, v238, v246 op_sel_hi:[1,0,0]
v_mfma_f32_16x16x32_bf16 v[68:71], a[148:151], v[204:207], v[68:71]
ds_read_b64_tr_b16 a[142:143], v2 offset:14336
s_waitcnt lgkmcnt(8)
v_mfma_f32_16x16x32_bf16 v[72:75], a[152:155], v[200:203], v[72:75]
ds_read_b64_tr_b16 a[144:145], v1 offset:3072
v_fma_mix_f32 v255, v179, v239, v247 op_sel:[1,0,0] op_sel_hi:[1,0,0]
v_mfma_f32_16x16x32_bf16 v[76:79], a[152:155], v[204:207], v[76:79]
buffer_load_dwordx4 v13, s[4:7], s30 offen offset:3072 lds
ds_read_b64_tr_b16 a[146:147], v1 offset:11264
v_cvt_pk_bf16_f32 v210, v252, v253
v_mfma_f32_16x16x32_bf16 v[80:83], a[156:159], v[200:203], v[80:83]
ds_read_b64_tr_b16 a[148:149], v2 offset:3072
v_cvt_pk_bf16_f32 v211, v254, v255
v_mfma_f32_16x16x32_bf16 v[84:87], a[156:159], v[204:207], v[84:87]
ds_read_b64_tr_b16 a[150:151], v2 offset:11264
s_waitcnt lgkmcnt(8)
v_mfma_f32_16x16x32_bf16 v[88:91], a[128:131], v[200:203], v[88:91]
ds_read_b64_tr_b16 a[152:153], v1 offset:7168
v_fma_mix_f32 v248, v180, v232, v240 op_sel_hi:[1,0,0]
v_mfma_f32_16x16x32_bf16 v[92:95], a[128:131], v[204:207], v[92:95]
ds_read_b64_tr_b16 a[154:155], v1 offset:15360
v_fma_mix_f32 v249, v180, v233, v241 op_sel:[1,0,0] op_sel_hi:[1,0,0]
v_mfma_f32_16x16x32_bf16 v[96:99], a[132:135], v[200:203], v[96:99]
ds_read_b64_tr_b16 a[156:157], v2 offset:7168
v_fma_mix_f32 v250, v181, v234, v242 op_sel_hi:[1,0,0]
v_mfma_f32_16x16x32_bf16 v[100:103], a[132:135], v[204:207], v[100:103]
ds_read_b64_tr_b16 a[158:159], v2 offset:15360
s_waitcnt lgkmcnt(8)
v_mfma_f32_16x16x32_bf16 v[104:107], a[136:139], v[200:203], v[104:107]
s_add_u32 m0, s23, 69632
s_add_u32 s31, s24, 3145984
buffer_load_dwordx4 v10, s[4:7], s31 offen lds
ds_read_b64_tr_b16 a[128:129], v1 offset:16384
v_fma_mix_f32 v251, v181, v235, v243 op_sel:[1,0,0] op_sel_hi:[1,0,0]
v_mfma_f32_16x16x32_bf16 v[108:111], a[136:139], v[204:207], v[108:111]
ds_read_b64_tr_b16 a[130:131], v1 offset:24576
v_cvt_pk_bf16_f32 v212, v248, v249
v_mfma_f32_16x16x32_bf16 v[112:115], a[140:143], v[200:203], v[112:115]
ds_read_b64_tr_b16 a[132:133], v2 offset:16384
v_cvt_pk_bf16_f32 v213, v250, v251
v_mfma_f32_16x16x32_bf16 v[116:119], a[140:143], v[204:207], v[116:119]
ds_read_b64_tr_b16 a[134:135], v2 offset:24576
buffer_load_dwordx4 v[168:171], v8, s[16:19], s33 offen offset:2048
buffer_load_dwordx4 v[172:175], v9, s[16:19], s33 offen offset:2048
s_waitcnt lgkmcnt(8)
v_mfma_f32_16x16x32_bf16 v[120:123], a[144:147], v[200:203], v[120:123]
ds_read_b64_tr_b16 a[136:137], v1 offset:20480
v_fma_mix_f32 v252, v182, v236, v244 op_sel_hi:[1,0,0]
v_mfma_f32_16x16x32_bf16 v[124:127], a[144:147], v[204:207], v[124:127]
ds_read_b64_tr_b16 a[138:139], v1 offset:28672
v_fma_mix_f32 v253, v182, v237, v245 op_sel:[1,0,0] op_sel_hi:[1,0,0]
v_mfma_f32_16x16x32_bf16 v[128:131], a[148:151], v[200:203], v[128:131]
ds_read_b64_tr_b16 a[140:141], v2 offset:20480
v_fma_mix_f32 v254, v183, v238, v246 op_sel_hi:[1,0,0]
v_mfma_f32_16x16x32_bf16 v[132:135], a[148:151], v[204:207], v[132:135]
buffer_load_dwordx4 v11, s[4:7], s31 offen offset:1024 lds
ds_read_b64_tr_b16 a[142:143], v2 offset:28672
s_waitcnt lgkmcnt(8)
v_mfma_f32_16x16x32_bf16 v[136:139], a[152:155], v[200:203], v[136:139]
ds_read_b64_tr_b16 a[144:145], v1 offset:17408
v_fma_mix_f32 v255, v183, v239, v247 op_sel:[1,0,0] op_sel_hi:[1,0,0]
v_mfma_f32_16x16x32_bf16 v[140:143], a[152:155], v[204:207], v[140:143]
ds_read_b64_tr_b16 a[146:147], v1 offset:25600
v_cvt_pk_bf16_f32 v214, v252, v253
v_cvt_pk_bf16_f32 v215, v254, v255
v_mfma_f32_16x16x32_bf16 v[144:147], a[156:159], v[200:203], v[144:147]
ds_read_b64_tr_b16 a[148:149], v2 offset:17408
ds_read_b128 v[216:219], v7 offset:3584
ds_read_b128 v[220:223], v7 offset:3648
ds_read_b128 v[224:227], v7 offset:1280
ds_read_b128 v[228:231], v7 offset:1344
v_mfma_f32_16x16x32_bf16 v[148:151], a[156:159], v[204:207], v[148:151]
ds_read_b64_tr_b16 a[150:151], v2 offset:25600
s_waitcnt lgkmcnt(12)
v_mfma_f32_16x16x32_bf16 v[24:27], a[128:131], v[208:211], v[24:27]
ds_read_b64_tr_b16 a[152:153], v1 offset:21504
s_waitcnt lgkmcnt(3)
v_fma_mix_f32 v248, v184, v216, v224 op_sel_hi:[1,0,0]
v_mfma_f32_16x16x32_bf16 v[28:31], a[128:131], v[212:215], v[28:31]
ds_read_b64_tr_b16 a[154:155], v1 offset:29696
buffer_load_dwordx4 v12, s[4:7], s31 offen offset:2048 lds
v_mfma_f32_16x16x32_bf16 v[32:35], a[132:135], v[208:211], v[32:35]
ds_read_b64_tr_b16 a[156:157], v2 offset:21504
v_fma_mix_f32 v249, v184, v217, v225 op_sel:[1,0,0] op_sel_hi:[1,0,0]
v_mfma_f32_16x16x32_bf16 v[36:39], a[132:135], v[212:215], v[36:39]
ds_read_b64_tr_b16 a[158:159], v2 offset:29696
v_fma_mix_f32 v250, v185, v218, v226 op_sel_hi:[1,0,0]
v_mfma_f32_16x16x32_bf16 v[40:43], a[136:139], v[208:211], v[40:43]
ds_read_b64_tr_b16 a[128:129], v1 offset:18432
v_fma_mix_f32 v251, v185, v219, v227 op_sel:[1,0,0] op_sel_hi:[1,0,0]
v_mfma_f32_16x16x32_bf16 v[44:47], a[136:139], v[212:215], v[44:47]
ds_read_b64_tr_b16 a[130:131], v1 offset:26624
v_cvt_pk_bf16_f32 v200, v248, v249
v_mfma_f32_16x16x32_bf16 v[48:51], a[140:143], v[208:211], v[48:51]
ds_read_b64_tr_b16 a[132:133], v2 offset:18432
v_cvt_pk_bf16_f32 v201, v250, v251
v_mfma_f32_16x16x32_bf16 v[52:55], a[140:143], v[212:215], v[52:55]
ds_read_b64_tr_b16 a[134:135], v2 offset:26624
s_waitcnt lgkmcnt(8)
v_mfma_f32_16x16x32_bf16 v[56:59], a[144:147], v[208:211], v[56:59]
ds_read_b64_tr_b16 a[136:137], v1 offset:22528
v_fma_mix_f32 v252, v186, v220, v228 op_sel_hi:[1,0,0]
v_mfma_f32_16x16x32_bf16 v[60:63], a[144:147], v[212:215], v[60:63]
buffer_load_dwordx4 v13, s[4:7], s31 offen offset:3072 lds
ds_read_b64_tr_b16 a[138:139], v1 offset:30720
v_mfma_f32_16x16x32_bf16 v[64:67], a[148:151], v[208:211], v[64:67]
ds_read_b64_tr_b16 a[140:141], v2 offset:22528
v_fma_mix_f32 v253, v186, v221, v229 op_sel:[1,0,0] op_sel_hi:[1,0,0]
v_mfma_f32_16x16x32_bf16 v[68:71], a[148:151], v[212:215], v[68:71]
ds_read_b64_tr_b16 a[142:143], v2 offset:30720
v_fma_mix_f32 v254, v187, v222, v230 op_sel_hi:[1,0,0]
s_waitcnt lgkmcnt(8)
v_mfma_f32_16x16x32_bf16 v[72:75], a[152:155], v[208:211], v[72:75]
ds_read_b64_tr_b16 a[144:145], v1 offset:19456
v_fma_mix_f32 v255, v187, v223, v231 op_sel:[1,0,0] op_sel_hi:[1,0,0]
v_mfma_f32_16x16x32_bf16 v[76:79], a[152:155], v[212:215], v[76:79]
ds_read_b64_tr_b16 a[146:147], v1 offset:27648
v_cvt_pk_bf16_f32 v202, v252, v253
v_mfma_f32_16x16x32_bf16 v[80:83], a[156:159], v[208:211], v[80:83]
ds_read_b64_tr_b16 a[148:149], v2 offset:19456
v_cvt_pk_bf16_f32 v203, v254, v255
v_mfma_f32_16x16x32_bf16 v[84:87], a[156:159], v[212:215], v[84:87]
ds_read_b64_tr_b16 a[150:151], v2 offset:27648
s_waitcnt lgkmcnt(8)
v_mfma_f32_16x16x32_bf16 v[88:91], a[128:131], v[208:211], v[88:91]
ds_read_b64_tr_b16 a[152:153], v1 offset:23552
v_fma_mix_f32 v248, v188, v216, v224 op_sel_hi:[1,0,0]
v_mfma_f32_16x16x32_bf16 v[92:95], a[128:131], v[212:215], v[92:95]
ds_read_b64_tr_b16 a[154:155], v1 offset:31744
v_fma_mix_f32 v249, v188, v217, v225 op_sel:[1,0,0] op_sel_hi:[1,0,0]
v_mfma_f32_16x16x32_bf16 v[96:99], a[132:135], v[208:211], v[96:99]
ds_read_b64_tr_b16 a[156:157], v2 offset:23552
v_fma_mix_f32 v250, v189, v218, v226 op_sel_hi:[1,0,0]
v_mfma_f32_16x16x32_bf16 v[100:103], a[132:135], v[212:215], v[100:103]
ds_read_b64_tr_b16 a[158:159], v2 offset:31744
s_waitcnt lgkmcnt(8)
v_mfma_f32_16x16x32_bf16 v[104:107], a[136:139], v[208:211], v[104:107]
s_waitcnt vmcnt(12)
s_barrier
ds_read_b64_tr_b16 a[128:129], v1 offset:32768
v_fma_mix_f32 v251, v189, v219, v227 op_sel:[1,0,0] op_sel_hi:[1,0,0]
v_mfma_f32_16x16x32_bf16 v[108:111], a[136:139], v[212:215], v[108:111]
ds_read_b64_tr_b16 a[130:131], v1 offset:40960
v_cvt_pk_bf16_f32 v204, v248, v249
v_mfma_f32_16x16x32_bf16 v[112:115], a[140:143], v[208:211], v[112:115]
ds_read_b64_tr_b16 a[132:133], v2 offset:32768
v_cvt_pk_bf16_f32 v205, v250, v251
v_mfma_f32_16x16x32_bf16 v[116:119], a[140:143], v[212:215], v[116:119]
ds_read_b64_tr_b16 a[134:135], v2 offset:40960
buffer_load_dwordx4 v[176:179], v8, s[16:19], s33 offen offset:3072
buffer_load_dwordx4 v[180:183], v9, s[16:19], s33 offen offset:3072
s_waitcnt lgkmcnt(8)
v_mfma_f32_16x16x32_bf16 v[120:123], a[144:147], v[208:211], v[120:123]
s_add_u32 m0, s23, 98304
s_add_u32 s30, s24, 3670016
buffer_load_dwordx4 v10, s[4:7], s30 offen lds
ds_read_b64_tr_b16 a[136:137], v1 offset:36864
v_fma_mix_f32 v252, v190, v220, v228 op_sel_hi:[1,0,0]
v_mfma_f32_16x16x32_bf16 v[124:127], a[144:147], v[212:215], v[124:127]
ds_read_b64_tr_b16 a[138:139], v1 offset:45056
v_fma_mix_f32 v253, v190, v221, v229 op_sel:[1,0,0] op_sel_hi:[1,0,0]
v_mfma_f32_16x16x32_bf16 v[128:131], a[148:151], v[208:211], v[128:131]
ds_read_b64_tr_b16 a[140:141], v2 offset:36864
v_fma_mix_f32 v254, v191, v222, v230 op_sel_hi:[1,0,0]
v_mfma_f32_16x16x32_bf16 v[132:135], a[148:151], v[212:215], v[132:135]
ds_read_b64_tr_b16 a[142:143], v2 offset:45056
s_waitcnt lgkmcnt(8)
v_mfma_f32_16x16x32_bf16 v[136:139], a[152:155], v[208:211], v[136:139]
ds_read_b64_tr_b16 a[144:145], v1 offset:33792
v_fma_mix_f32 v255, v191, v223, v231 op_sel:[1,0,0] op_sel_hi:[1,0,0]
v_mfma_f32_16x16x32_bf16 v[140:143], a[152:155], v[212:215], v[140:143]
ds_read_b64_tr_b16 a[146:147], v1 offset:41984
v_cvt_pk_bf16_f32 v206, v252, v253
v_cvt_pk_bf16_f32 v207, v254, v255
v_mfma_f32_16x16x32_bf16 v[144:147], a[156:159], v[208:211], v[144:147]
ds_read_b64_tr_b16 a[148:149], v2 offset:33792
ds_read_b128 v[232:235], v7 offset:3712
ds_read_b128 v[236:239], v7 offset:3776
ds_read_b128 v[240:243], v7 offset:1408
ds_read_b128 v[244:247], v7 offset:1472
v_mfma_f32_16x16x32_bf16 v[148:151], a[156:159], v[212:215], v[148:151]
buffer_load_dwordx4 v11, s[4:7], s30 offen offset:1024 lds
ds_read_b64_tr_b16 a[150:151], v2 offset:41984
s_waitcnt lgkmcnt(12)
v_mfma_f32_16x16x32_bf16 v[24:27], a[128:131], v[200:203], v[24:27]
ds_read_b64_tr_b16 a[152:153], v1 offset:37888
s_waitcnt lgkmcnt(3)
v_fma_mix_f32 v248, v192, v232, v240 op_sel_hi:[1,0,0]
v_mfma_f32_16x16x32_bf16 v[28:31], a[128:131], v[204:207], v[28:31]
ds_read_b64_tr_b16 a[154:155], v1 offset:46080
v_fma_mix_f32 v249, v192, v233, v241 op_sel:[1,0,0] op_sel_hi:[1,0,0]
v_mfma_f32_16x16x32_bf16 v[32:35], a[132:135], v[200:203], v[32:35]
ds_read_b64_tr_b16 a[156:157], v2 offset:37888
v_fma_mix_f32 v250, v193, v234, v242 op_sel_hi:[1,0,0]
v_mfma_f32_16x16x32_bf16 v[36:39], a[132:135], v[204:207], v[36:39]
ds_read_b64_tr_b16 a[158:159], v2 offset:46080
v_mfma_f32_16x16x32_bf16 v[40:43], a[136:139], v[200:203], v[40:43]
ds_read_b64_tr_b16 a[128:129], v1 offset:34816
v_fma_mix_f32 v251, v193, v235, v243 op_sel:[1,0,0] op_sel_hi:[1,0,0]
v_mfma_f32_16x16x32_bf16 v[44:47], a[136:139], v[204:207], v[44:47]
ds_read_b64_tr_b16 a[130:131], v1 offset:43008
buffer_load_dwordx4 v12, s[4:7], s30 offen offset:2048 lds
v_mfma_f32_16x16x32_bf16 v[48:51], a[140:143], v[200:203], v[48:51]
ds_read_b64_tr_b16 a[132:133], v2 offset:34816
v_cvt_pk_bf16_f32 v208, v248, v249
v_mfma_f32_16x16x32_bf16 v[52:55], a[140:143], v[204:207], v[52:55]
ds_read_b64_tr_b16 a[134:135], v2 offset:43008
v_cvt_pk_bf16_f32 v209, v250, v251
s_waitcnt lgkmcnt(8)
v_mfma_f32_16x16x32_bf16 v[56:59], a[144:147], v[200:203], v[56:59]
ds_read_b64_tr_b16 a[136:137], v1 offset:38912
v_fma_mix_f32 v252, v194, v236, v244 op_sel_hi:[1,0,0]
v_mfma_f32_16x16x32_bf16 v[60:63], a[144:147], v[204:207], v[60:63]
ds_read_b64_tr_b16 a[138:139], v1 offset:47104
v_fma_mix_f32 v253, v194, v237, v245 op_sel:[1,0,0] op_sel_hi:[1,0,0]
v_mfma_f32_16x16x32_bf16 v[64:67], a[148:151], v[200:203], v[64:67]
ds_read_b64_tr_b16 a[140:141], v2 offset:38912
v_fma_mix_f32 v254, v195, v238, v246 op_sel_hi:[1,0,0]
v_mfma_f32_16x16x32_bf16 v[68:71], a[148:151], v[204:207], v[68:71]
ds_read_b64_tr_b16 a[142:143], v2 offset:47104
s_waitcnt lgkmcnt(8)
v_mfma_f32_16x16x32_bf16 v[72:75], a[152:155], v[200:203], v[72:75]
ds_read_b64_tr_b16 a[144:145], v1 offset:35840
v_fma_mix_f32 v255, v195, v239, v247 op_sel:[1,0,0] op_sel_hi:[1,0,0]
v_mfma_f32_16x16x32_bf16 v[76:79], a[152:155], v[204:207], v[76:79]
buffer_load_dwordx4 v13, s[4:7], s30 offen offset:3072 lds
ds_read_b64_tr_b16 a[146:147], v1 offset:44032
v_cvt_pk_bf16_f32 v210, v252, v253
v_mfma_f32_16x16x32_bf16 v[80:83], a[156:159], v[200:203], v[80:83]
ds_read_b64_tr_b16 a[148:149], v2 offset:35840
v_cvt_pk_bf16_f32 v211, v254, v255
v_mfma_f32_16x16x32_bf16 v[84:87], a[156:159], v[204:207], v[84:87]
ds_read_b64_tr_b16 a[150:151], v2 offset:44032
s_waitcnt lgkmcnt(8)
v_mfma_f32_16x16x32_bf16 v[88:91], a[128:131], v[200:203], v[88:91]
ds_read_b64_tr_b16 a[152:153], v1 offset:39936
v_fma_mix_f32 v248, v196, v232, v240 op_sel_hi:[1,0,0]
v_mfma_f32_16x16x32_bf16 v[92:95], a[128:131], v[204:207], v[92:95]
ds_read_b64_tr_b16 a[154:155], v1 offset:48128
v_fma_mix_f32 v249, v196, v233, v241 op_sel:[1,0,0] op_sel_hi:[1,0,0]
v_mfma_f32_16x16x32_bf16 v[96:99], a[132:135], v[200:203], v[96:99]
ds_read_b64_tr_b16 a[156:157], v2 offset:39936
v_fma_mix_f32 v250, v197, v234, v242 op_sel_hi:[1,0,0]
v_mfma_f32_16x16x32_bf16 v[100:103], a[132:135], v[204:207], v[100:103]
ds_read_b64_tr_b16 a[158:159], v2 offset:48128
s_waitcnt lgkmcnt(8)
v_mfma_f32_16x16x32_bf16 v[104:107], a[136:139], v[200:203], v[104:107]
s_add_u32 m0, s23, 102400
s_add_u32 s31, s24, 3670272
buffer_load_dwordx4 v10, s[4:7], s31 offen lds
ds_read_b64_tr_b16 a[128:129], v1 offset:49152
v_fma_mix_f32 v251, v197, v235, v243 op_sel:[1,0,0] op_sel_hi:[1,0,0]
v_mfma_f32_16x16x32_bf16 v[108:111], a[136:139], v[204:207], v[108:111]
ds_read_b64_tr_b16 a[130:131], v1 offset:57344
v_cvt_pk_bf16_f32 v212, v248, v249
v_mfma_f32_16x16x32_bf16 v[112:115], a[140:143], v[200:203], v[112:115]
ds_read_b64_tr_b16 a[132:133], v2 offset:49152
v_cvt_pk_bf16_f32 v213, v250, v251
v_mfma_f32_16x16x32_bf16 v[116:119], a[140:143], v[204:207], v[116:119]
ds_read_b64_tr_b16 a[134:135], v2 offset:57344
s_add_u32 s33, s27, 16384
buffer_load_dwordx4 v[184:187], v8, s[16:19], s33 offen
buffer_load_dwordx4 v[188:191], v9, s[16:19], s33 offen
s_waitcnt lgkmcnt(8)
v_mfma_f32_16x16x32_bf16 v[120:123], a[144:147], v[200:203], v[120:123]
ds_read_b64_tr_b16 a[136:137], v1 offset:53248
v_fma_mix_f32 v252, v198, v236, v244 op_sel_hi:[1,0,0]
v_mfma_f32_16x16x32_bf16 v[124:127], a[144:147], v[204:207], v[124:127]
ds_read_b64_tr_b16 a[138:139], v1 offset:61440
v_fma_mix_f32 v253, v198, v237, v245 op_sel:[1,0,0] op_sel_hi:[1,0,0]
v_mfma_f32_16x16x32_bf16 v[128:131], a[148:151], v[200:203], v[128:131]
ds_read_b64_tr_b16 a[140:141], v2 offset:53248
v_fma_mix_f32 v254, v199, v238, v246 op_sel_hi:[1,0,0]
v_mfma_f32_16x16x32_bf16 v[132:135], a[148:151], v[204:207], v[132:135]
buffer_load_dwordx4 v11, s[4:7], s31 offen offset:1024 lds
ds_read_b64_tr_b16 a[142:143], v2 offset:61440
s_waitcnt lgkmcnt(8)
v_mfma_f32_16x16x32_bf16 v[136:139], a[152:155], v[200:203], v[136:139]
ds_read_b64_tr_b16 a[144:145], v1 offset:50176
v_fma_mix_f32 v255, v199, v239, v247 op_sel:[1,0,0] op_sel_hi:[1,0,0]
v_mfma_f32_16x16x32_bf16 v[140:143], a[152:155], v[204:207], v[140:143]
ds_read_b64_tr_b16 a[146:147], v1 offset:58368
v_cvt_pk_bf16_f32 v214, v252, v253
v_cvt_pk_bf16_f32 v215, v254, v255
v_mfma_f32_16x16x32_bf16 v[144:147], a[156:159], v[200:203], v[144:147]
ds_read_b64_tr_b16 a[148:149], v2 offset:50176
ds_read_b128 v[216:219], v7 offset:3840
ds_read_b128 v[220:223], v7 offset:3904
ds_read_b128 v[224:227], v7 offset:1536
ds_read_b128 v[228:231], v7 offset:1600
v_mfma_f32_16x16x32_bf16 v[148:151], a[156:159], v[204:207], v[148:151]
ds_read_b64_tr_b16 a[150:151], v2 offset:58368
s_waitcnt lgkmcnt(12)
v_mfma_f32_16x16x32_bf16 v[24:27], a[128:131], v[208:211], v[24:27]
ds_read_b64_tr_b16 a[152:153], v1 offset:54272
s_waitcnt lgkmcnt(3)
v_fma_mix_f32 v248, v152, v216, v224 op_sel_hi:[1,0,0]
v_mfma_f32_16x16x32_bf16 v[28:31], a[128:131], v[212:215], v[28:31]
ds_read_b64_tr_b16 a[154:155], v1 offset:62464
buffer_load_dwordx4 v12, s[4:7], s31 offen offset:2048 lds
v_mfma_f32_16x16x32_bf16 v[32:35], a[132:135], v[208:211], v[32:35]
ds_read_b64_tr_b16 a[156:157], v2 offset:54272
v_fma_mix_f32 v249, v152, v217, v225 op_sel:[1,0,0] op_sel_hi:[1,0,0]
v_mfma_f32_16x16x32_bf16 v[36:39], a[132:135], v[212:215], v[36:39]
ds_read_b64_tr_b16 a[158:159], v2 offset:62464
v_fma_mix_f32 v250, v153, v218, v226 op_sel_hi:[1,0,0]
v_mfma_f32_16x16x32_bf16 v[40:43], a[136:139], v[208:211], v[40:43]
ds_read_b64_tr_b16 a[128:129], v1 offset:51200
v_fma_mix_f32 v251, v153, v219, v227 op_sel:[1,0,0] op_sel_hi:[1,0,0]
v_mfma_f32_16x16x32_bf16 v[44:47], a[136:139], v[212:215], v[44:47]
ds_read_b64_tr_b16 a[130:131], v1 offset:59392
v_cvt_pk_bf16_f32 v200, v248, v249
v_mfma_f32_16x16x32_bf16 v[48:51], a[140:143], v[208:211], v[48:51]
ds_read_b64_tr_b16 a[132:133], v2 offset:51200
v_cvt_pk_bf16_f32 v201, v250, v251
v_mfma_f32_16x16x32_bf16 v[52:55], a[140:143], v[212:215], v[52:55]
ds_read_b64_tr_b16 a[134:135], v2 offset:59392
s_waitcnt lgkmcnt(8)
v_mfma_f32_16x16x32_bf16 v[56:59], a[144:147], v[208:211], v[56:59]
ds_read_b64_tr_b16 a[136:137], v1 offset:55296
v_fma_mix_f32 v252, v154, v220, v228 op_sel_hi:[1,0,0]
v_mfma_f32_16x16x32_bf16 v[60:63], a[144:147], v[212:215], v[60:63]
buffer_load_dwordx4 v13, s[4:7], s31 offen offset:3072 lds
ds_read_b64_tr_b16 a[138:139], v1 offset:63488
v_mfma_f32_16x16x32_bf16 v[64:67], a[148:151], v[208:211], v[64:67]
ds_read_b64_tr_b16 a[140:141], v2 offset:55296
v_fma_mix_f32 v253, v154, v221, v229 op_sel:[1,0,0] op_sel_hi:[1,0,0]
v_mfma_f32_16x16x32_bf16 v[68:71], a[148:151], v[212:215], v[68:71]
ds_read_b64_tr_b16 a[142:143], v2 offset:63488
v_fma_mix_f32 v254, v155, v222, v230 op_sel_hi:[1,0,0]
s_waitcnt lgkmcnt(8)
v_mfma_f32_16x16x32_bf16 v[72:75], a[152:155], v[208:211], v[72:75]
ds_read_b64_tr_b16 a[144:145], v1 offset:52224
v_fma_mix_f32 v255, v155, v223, v231 op_sel:[1,0,0] op_sel_hi:[1,0,0]
v_mfma_f32_16x16x32_bf16 v[76:79], a[152:155], v[212:215], v[76:79]
ds_read_b64_tr_b16 a[146:147], v1 offset:60416
v_cvt_pk_bf16_f32 v202, v252, v253
v_mfma_f32_16x16x32_bf16 v[80:83], a[156:159], v[208:211], v[80:83]
ds_read_b64_tr_b16 a[148:149], v2 offset:52224
v_cvt_pk_bf16_f32 v203, v254, v255
v_mfma_f32_16x16x32_bf16 v[84:87], a[156:159], v[212:215], v[84:87]
ds_read_b64_tr_b16 a[150:151], v2 offset:60416
s_waitcnt lgkmcnt(8)
v_mfma_f32_16x16x32_bf16 v[88:91], a[128:131], v[208:211], v[88:91]
ds_read_b64_tr_b16 a[152:153], v1 offset:56320
v_fma_mix_f32 v248, v156, v216, v224 op_sel_hi:[1,0,0]
v_mfma_f32_16x16x32_bf16 v[92:95], a[128:131], v[212:215], v[92:95]
ds_read_b64_tr_b16 a[154:155], v1 offset:64512
v_fma_mix_f32 v249, v156, v217, v225 op_sel:[1,0,0] op_sel_hi:[1,0,0]
v_mfma_f32_16x16x32_bf16 v[96:99], a[132:135], v[208:211], v[96:99]
ds_read_b64_tr_b16 a[156:157], v2 offset:56320
v_fma_mix_f32 v250, v157, v218, v226 op_sel_hi:[1,0,0]
v_mfma_f32_16x16x32_bf16 v[100:103], a[132:135], v[212:215], v[100:103]
ds_read_b64_tr_b16 a[158:159], v2 offset:64512
s_waitcnt lgkmcnt(8)
v_mfma_f32_16x16x32_bf16 v[104:107], a[136:139], v[208:211], v[104:107]
s_waitcnt vmcnt(12)
s_barrier
ds_read_b64_tr_b16 a[128:129], v3
v_fma_mix_f32 v251, v157, v219, v227 op_sel:[1,0,0] op_sel_hi:[1,0,0]
v_mfma_f32_16x16x32_bf16 v[108:111], a[136:139], v[212:215], v[108:111]
ds_read_b64_tr_b16 a[130:131], v3 offset:8192
v_cvt_pk_bf16_f32 v204, v248, v249
v_mfma_f32_16x16x32_bf16 v[112:115], a[140:143], v[208:211], v[112:115]
ds_read_b64_tr_b16 a[132:133], v4
v_cvt_pk_bf16_f32 v205, v250, v251
v_mfma_f32_16x16x32_bf16 v[116:119], a[140:143], v[212:215], v[116:119]
ds_read_b64_tr_b16 a[134:135], v4 offset:8192
buffer_load_dwordx4 v[192:195], v8, s[16:19], s33 offen offset:1024
buffer_load_dwordx4 v[196:199], v9, s[16:19], s33 offen offset:1024
s_waitcnt lgkmcnt(8)
v_mfma_f32_16x16x32_bf16 v[120:123], a[144:147], v[208:211], v[120:123]
s_add_u32 m0, s23, 0
s_add_u32 s30, s24, 4194304
buffer_load_dwordx4 v10, s[4:7], s30 offen lds
ds_read_b64_tr_b16 a[136:137], v3 offset:4096
v_fma_mix_f32 v252, v158, v220, v228 op_sel_hi:[1,0,0]
v_mfma_f32_16x16x32_bf16 v[124:127], a[144:147], v[212:215], v[124:127]
ds_read_b64_tr_b16 a[138:139], v3 offset:12288
v_fma_mix_f32 v253, v158, v221, v229 op_sel:[1,0,0] op_sel_hi:[1,0,0]
v_mfma_f32_16x16x32_bf16 v[128:131], a[148:151], v[208:211], v[128:131]
ds_read_b64_tr_b16 a[140:141], v4 offset:4096
v_fma_mix_f32 v254, v159, v222, v230 op_sel_hi:[1,0,0]
v_mfma_f32_16x16x32_bf16 v[132:135], a[148:151], v[212:215], v[132:135]
ds_read_b64_tr_b16 a[142:143], v4 offset:12288
s_waitcnt lgkmcnt(8)
v_mfma_f32_16x16x32_bf16 v[136:139], a[152:155], v[208:211], v[136:139]
ds_read_b64_tr_b16 a[144:145], v3 offset:1024
v_fma_mix_f32 v255, v159, v223, v231 op_sel:[1,0,0] op_sel_hi:[1,0,0]
v_mfma_f32_16x16x32_bf16 v[140:143], a[152:155], v[212:215], v[140:143]
ds_read_b64_tr_b16 a[146:147], v3 offset:9216
v_cvt_pk_bf16_f32 v206, v252, v253
v_cvt_pk_bf16_f32 v207, v254, v255
v_mfma_f32_16x16x32_bf16 v[144:147], a[156:159], v[208:211], v[144:147]
ds_read_b64_tr_b16 a[148:149], v4 offset:1024
ds_read_b128 v[232:235], v7 offset:3968
ds_read_b128 v[236:239], v7 offset:4032
ds_read_b128 v[240:243], v7 offset:1664
ds_read_b128 v[244:247], v7 offset:1728
v_mfma_f32_16x16x32_bf16 v[148:151], a[156:159], v[212:215], v[148:151]
buffer_load_dwordx4 v11, s[4:7], s30 offen offset:1024 lds
ds_read_b64_tr_b16 a[150:151], v4 offset:9216
s_waitcnt lgkmcnt(12)
v_mfma_f32_16x16x32_bf16 v[24:27], a[128:131], v[200:203], v[24:27]
ds_read_b64_tr_b16 a[152:153], v3 offset:5120
s_waitcnt lgkmcnt(3)
v_fma_mix_f32 v248, v160, v232, v240 op_sel_hi:[1,0,0]
v_mfma_f32_16x16x32_bf16 v[28:31], a[128:131], v[204:207], v[28:31]
ds_read_b64_tr_b16 a[154:155], v3 offset:13312
v_fma_mix_f32 v249, v160, v233, v241 op_sel:[1,0,0] op_sel_hi:[1,0,0]
v_mfma_f32_16x16x32_bf16 v[32:35], a[132:135], v[200:203], v[32:35]
ds_read_b64_tr_b16 a[156:157], v4 offset:5120
v_fma_mix_f32 v250, v161, v234, v242 op_sel_hi:[1,0,0]
v_mfma_f32_16x16x32_bf16 v[36:39], a[132:135], v[204:207], v[36:39]
ds_read_b64_tr_b16 a[158:159], v4 offset:13312
v_mfma_f32_16x16x32_bf16 v[40:43], a[136:139], v[200:203], v[40:43]
ds_read_b64_tr_b16 a[128:129], v3 offset:2048
v_fma_mix_f32 v251, v161, v235, v243 op_sel:[1,0,0] op_sel_hi:[1,0,0]
v_mfma_f32_16x16x32_bf16 v[44:47], a[136:139], v[204:207], v[44:47]
ds_read_b64_tr_b16 a[130:131], v3 offset:10240
buffer_load_dwordx4 v12, s[4:7], s30 offen offset:2048 lds
v_mfma_f32_16x16x32_bf16 v[48:51], a[140:143], v[200:203], v[48:51]
ds_read_b64_tr_b16 a[132:133], v4 offset:2048
v_cvt_pk_bf16_f32 v208, v248, v249
v_mfma_f32_16x16x32_bf16 v[52:55], a[140:143], v[204:207], v[52:55]
ds_read_b64_tr_b16 a[134:135], v4 offset:10240
v_cvt_pk_bf16_f32 v209, v250, v251
s_waitcnt lgkmcnt(8)
v_mfma_f32_16x16x32_bf16 v[56:59], a[144:147], v[200:203], v[56:59]
ds_read_b64_tr_b16 a[136:137], v3 offset:6144
v_fma_mix_f32 v252, v162, v236, v244 op_sel_hi:[1,0,0]
v_mfma_f32_16x16x32_bf16 v[60:63], a[144:147], v[204:207], v[60:63]
ds_read_b64_tr_b16 a[138:139], v3 offset:14336
v_fma_mix_f32 v253, v162, v237, v245 op_sel:[1,0,0] op_sel_hi:[1,0,0]
v_mfma_f32_16x16x32_bf16 v[64:67], a[148:151], v[200:203], v[64:67]
ds_read_b64_tr_b16 a[140:141], v4 offset:6144
v_fma_mix_f32 v254, v163, v238, v246 op_sel_hi:[1,0,0]
v_mfma_f32_16x16x32_bf16 v[68:71], a[148:151], v[204:207], v[68:71]
ds_read_b64_tr_b16 a[142:143], v4 offset:14336
s_waitcnt lgkmcnt(8)
v_mfma_f32_16x16x32_bf16 v[72:75], a[152:155], v[200:203], v[72:75]
ds_read_b64_tr_b16 a[144:145], v3 offset:3072
v_fma_mix_f32 v255, v163, v239, v247 op_sel:[1,0,0] op_sel_hi:[1,0,0]
v_mfma_f32_16x16x32_bf16 v[76:79], a[152:155], v[204:207], v[76:79]
buffer_load_dwordx4 v13, s[4:7], s30 offen offset:3072 lds
ds_read_b64_tr_b16 a[146:147], v3 offset:11264
v_cvt_pk_bf16_f32 v210, v252, v253
v_mfma_f32_16x16x32_bf16 v[80:83], a[156:159], v[200:203], v[80:83]
ds_read_b64_tr_b16 a[148:149], v4 offset:3072
v_cvt_pk_bf16_f32 v211, v254, v255
v_mfma_f32_16x16x32_bf16 v[84:87], a[156:159], v[204:207], v[84:87]
ds_read_b64_tr_b16 a[150:151], v4 offset:11264
s_waitcnt lgkmcnt(8)
v_mfma_f32_16x16x32_bf16 v[88:91], a[128:131], v[200:203], v[88:91]
ds_read_b64_tr_b16 a[152:153], v3 offset:7168
v_fma_mix_f32 v248, v164, v232, v240 op_sel_hi:[1,0,0]
v_mfma_f32_16x16x32_bf16 v[92:95], a[128:131], v[204:207], v[92:95]
ds_read_b64_tr_b16 a[154:155], v3 offset:15360
v_fma_mix_f32 v249, v164, v233, v241 op_sel:[1,0,0] op_sel_hi:[1,0,0]
v_mfma_f32_16x16x32_bf16 v[96:99], a[132:135], v[200:203], v[96:99]
ds_read_b64_tr_b16 a[156:157], v4 offset:7168
v_fma_mix_f32 v250, v165, v234, v242 op_sel_hi:[1,0,0]
v_mfma_f32_16x16x32_bf16 v[100:103], a[132:135], v[204:207], v[100:103]
ds_read_b64_tr_b16 a[158:159], v4 offset:15360
s_waitcnt lgkmcnt(8)
v_mfma_f32_16x16x32_bf16 v[104:107], a[136:139], v[200:203], v[104:107]
s_add_u32 m0, s23, 4096
s_add_u32 s31, s24, 4194560
buffer_load_dwordx4 v10, s[4:7], s31 offen lds
ds_read_b64_tr_b16 a[128:129], v3 offset:16384
v_fma_mix_f32 v251, v165, v235, v243 op_sel:[1,0,0] op_sel_hi:[1,0,0]
v_mfma_f32_16x16x32_bf16 v[108:111], a[136:139], v[204:207], v[108:111]
ds_read_b64_tr_b16 a[130:131], v3 offset:24576
v_cvt_pk_bf16_f32 v212, v248, v249
v_mfma_f32_16x16x32_bf16 v[112:115], a[140:143], v[200:203], v[112:115]
ds_read_b64_tr_b16 a[132:133], v4 offset:16384
v_cvt_pk_bf16_f32 v213, v250, v251
v_mfma_f32_16x16x32_bf16 v[116:119], a[140:143], v[204:207], v[116:119]
ds_read_b64_tr_b16 a[134:135], v4 offset:24576
s_waitcnt lgkmcnt(8)
v_mfma_f32_16x16x32_bf16 v[120:123], a[144:147], v[200:203], v[120:123]
ds_read_b64_tr_b16 a[136:137], v3 offset:20480
v_fma_mix_f32 v252, v166, v236, v244 op_sel_hi:[1,0,0]
v_mfma_f32_16x16x32_bf16 v[124:127], a[144:147], v[204:207], v[124:127]
ds_read_b64_tr_b16 a[138:139], v3 offset:28672
v_fma_mix_f32 v253, v166, v237, v245 op_sel:[1,0,0] op_sel_hi:[1,0,0]
v_mfma_f32_16x16x32_bf16 v[128:131], a[148:151], v[200:203], v[128:131]
ds_read_b64_tr_b16 a[140:141], v4 offset:20480
v_fma_mix_f32 v254, v167, v238, v246 op_sel_hi:[1,0,0]
v_mfma_f32_16x16x32_bf16 v[132:135], a[148:151], v[204:207], v[132:135]
buffer_load_dwordx4 v11, s[4:7], s31 offen offset:1024 lds
ds_read_b64_tr_b16 a[142:143], v4 offset:28672
s_waitcnt lgkmcnt(8)
v_mfma_f32_16x16x32_bf16 v[136:139], a[152:155], v[200:203], v[136:139]
ds_read_b64_tr_b16 a[144:145], v3 offset:17408
v_fma_mix_f32 v255, v167, v239, v247 op_sel:[1,0,0] op_sel_hi:[1,0,0]
v_mfma_f32_16x16x32_bf16 v[140:143], a[152:155], v[204:207], v[140:143]
ds_read_b64_tr_b16 a[146:147], v3 offset:25600
v_cvt_pk_bf16_f32 v214, v252, v253
v_cvt_pk_bf16_f32 v215, v254, v255
v_mfma_f32_16x16x32_bf16 v[144:147], a[156:159], v[200:203], v[144:147]
ds_read_b64_tr_b16 a[148:149], v4 offset:17408
ds_read_b128 v[216:219], v7 offset:4096
ds_read_b128 v[220:223], v7 offset:4160
ds_read_b128 v[224:227], v7 offset:1792
ds_read_b128 v[228:231], v7 offset:1856
v_mfma_f32_16x16x32_bf16 v[148:151], a[156:159], v[204:207], v[148:151]
ds_read_b64_tr_b16 a[150:151], v4 offset:25600
s_waitcnt lgkmcnt(12)
v_mfma_f32_16x16x32_bf16 v[24:27], a[128:131], v[208:211], v[24:27]
ds_read_b64_tr_b16 a[152:153], v3 offset:21504
s_waitcnt lgkmcnt(3)
v_fma_mix_f32 v248, v168, v216, v224 op_sel_hi:[1,0,0]
v_mfma_f32_16x16x32_bf16 v[28:31], a[128:131], v[212:215], v[28:31]
ds_read_b64_tr_b16 a[154:155], v3 offset:29696
buffer_load_dwordx4 v12, s[4:7], s31 offen offset:2048 lds
v_mfma_f32_16x16x32_bf16 v[32:35], a[132:135], v[208:211], v[32:35]
ds_read_b64_tr_b16 a[156:157], v4 offset:21504
v_fma_mix_f32 v249, v168, v217, v225 op_sel:[1,0,0] op_sel_hi:[1,0,0]
v_mfma_f32_16x16x32_bf16 v[36:39], a[132:135], v[212:215], v[36:39]
ds_read_b64_tr_b16 a[158:159], v4 offset:29696
v_fma_mix_f32 v250, v169, v218, v226 op_sel_hi:[1,0,0]
v_mfma_f32_16x16x32_bf16 v[40:43], a[136:139], v[208:211], v[40:43]
ds_read_b64_tr_b16 a[128:129], v3 offset:18432
v_fma_mix_f32 v251, v169, v219, v227 op_sel:[1,0,0] op_sel_hi:[1,0,0]
v_mfma_f32_16x16x32_bf16 v[44:47], a[136:139], v[212:215], v[44:47]
ds_read_b64_tr_b16 a[130:131], v3 offset:26624
v_cvt_pk_bf16_f32 v200, v248, v249
v_mfma_f32_16x16x32_bf16 v[48:51], a[140:143], v[208:211], v[48:51]
ds_read_b64_tr_b16 a[132:133], v4 offset:18432
v_cvt_pk_bf16_f32 v201, v250, v251
v_mfma_f32_16x16x32_bf16 v[52:55], a[140:143], v[212:215], v[52:55]
ds_read_b64_tr_b16 a[134:135], v4 offset:26624
s_waitcnt lgkmcnt(8)
v_mfma_f32_16x16x32_bf16 v[56:59], a[144:147], v[208:211], v[56:59]
ds_read_b64_tr_b16 a[136:137], v3 offset:22528
v_fma_mix_f32 v252, v170, v220, v228 op_sel_hi:[1,0,0]
v_mfma_f32_16x16x32_bf16 v[60:63], a[144:147], v[212:215], v[60:63]
buffer_load_dwordx4 v13, s[4:7], s31 offen offset:3072 lds
ds_read_b64_tr_b16 a[138:139], v3 offset:30720
v_mfma_f32_16x16x32_bf16 v[64:67], a[148:151], v[208:211], v[64:67]
ds_read_b64_tr_b16 a[140:141], v4 offset:22528
v_fma_mix_f32 v253, v170, v221, v229 op_sel:[1,0,0] op_sel_hi:[1,0,0]
v_mfma_f32_16x16x32_bf16 v[68:71], a[148:151], v[212:215], v[68:71]
ds_read_b64_tr_b16 a[142:143], v4 offset:30720
v_fma_mix_f32 v254, v171, v222, v230 op_sel_hi:[1,0,0]
s_waitcnt lgkmcnt(8)
v_mfma_f32_16x16x32_bf16 v[72:75], a[152:155], v[208:211], v[72:75]
ds_read_b64_tr_b16 a[144:145], v3 offset:19456
v_fma_mix_f32 v255, v171, v223, v231 op_sel:[1,0,0] op_sel_hi:[1,0,0]
v_mfma_f32_16x16x32_bf16 v[76:79], a[152:155], v[212:215], v[76:79]
ds_read_b64_tr_b16 a[146:147], v3 offset:27648
v_cvt_pk_bf16_f32 v202, v252, v253
v_mfma_f32_16x16x32_bf16 v[80:83], a[156:159], v[208:211], v[80:83]
ds_read_b64_tr_b16 a[148:149], v4 offset:19456
v_cvt_pk_bf16_f32 v203, v254, v255
v_mfma_f32_16x16x32_bf16 v[84:87], a[156:159], v[212:215], v[84:87]
ds_read_b64_tr_b16 a[150:151], v4 offset:27648
s_waitcnt lgkmcnt(8)
v_mfma_f32_16x16x32_bf16 v[88:91], a[128:131], v[208:211], v[88:91]
ds_read_b64_tr_b16 a[152:153], v3 offset:23552
v_fma_mix_f32 v248, v172, v216, v224 op_sel_hi:[1,0,0]
v_mfma_f32_16x16x32_bf16 v[92:95], a[128:131], v[212:215], v[92:95]
ds_read_b64_tr_b16 a[154:155], v3 offset:31744
v_fma_mix_f32 v249, v172, v217, v225 op_sel:[1,0,0] op_sel_hi:[1,0,0]
v_mfma_f32_16x16x32_bf16 v[96:99], a[132:135], v[208:211], v[96:99]
ds_read_b64_tr_b16 a[156:157], v4 offset:23552
v_fma_mix_f32 v250, v173, v218, v226 op_sel_hi:[1,0,0]
v_mfma_f32_16x16x32_bf16 v[100:103], a[132:135], v[212:215], v[100:103]
ds_read_b64_tr_b16 a[158:159], v4 offset:31744
s_waitcnt lgkmcnt(8)
v_mfma_f32_16x16x32_bf16 v[104:107], a[136:139], v[208:211], v[104:107]
s_waitcnt vmcnt(10)
s_barrier
ds_read_b64_tr_b16 a[128:129], v3 offset:32768
v_fma_mix_f32 v251, v173, v219, v227 op_sel:[1,0,0] op_sel_hi:[1,0,0]
v_mfma_f32_16x16x32_bf16 v[108:111], a[136:139], v[212:215], v[108:111]
ds_read_b64_tr_b16 a[130:131], v3 offset:40960
v_cvt_pk_bf16_f32 v204, v248, v249
v_mfma_f32_16x16x32_bf16 v[112:115], a[140:143], v[208:211], v[112:115]
ds_read_b64_tr_b16 a[132:133], v4 offset:32768
v_cvt_pk_bf16_f32 v205, v250, v251
v_mfma_f32_16x16x32_bf16 v[116:119], a[140:143], v[212:215], v[116:119]
ds_read_b64_tr_b16 a[134:135], v4 offset:40960
s_waitcnt lgkmcnt(8)
v_mfma_f32_16x16x32_bf16 v[120:123], a[144:147], v[208:211], v[120:123]
s_add_u32 m0, s23, 32768
s_add_u32 s30, s25, 0
buffer_load_dwordx4 v14, s[8:11], s30 offen lds
ds_read_b64_tr_b16 a[136:137], v3 offset:36864
v_fma_mix_f32 v252, v174, v220, v228 op_sel_hi:[1,0,0]
v_mfma_f32_16x16x32_bf16 v[124:127], a[144:147], v[212:215], v[124:127]
ds_read_b64_tr_b16 a[138:139], v3 offset:45056
v_fma_mix_f32 v253, v174, v221, v229 op_sel:[1,0,0] op_sel_hi:[1,0,0]
v_mfma_f32_16x16x32_bf16 v[128:131], a[148:151], v[208:211], v[128:131]
ds_read_b64_tr_b16 a[140:141], v4 offset:36864
v_fma_mix_f32 v254, v175, v222, v230 op_sel_hi:[1,0,0]
v_mfma_f32_16x16x32_bf16 v[132:135], a[148:151], v[212:215], v[132:135]
ds_read_b64_tr_b16 a[142:143], v4 offset:45056
s_waitcnt lgkmcnt(8)
v_mfma_f32_16x16x32_bf16 v[136:139], a[152:155], v[208:211], v[136:139]
ds_read_b64_tr_b16 a[144:145], v3 offset:33792
v_fma_mix_f32 v255, v175, v223, v231 op_sel:[1,0,0] op_sel_hi:[1,0,0]
v_mfma_f32_16x16x32_bf16 v[140:143], a[152:155], v[212:215], v[140:143]
ds_read_b64_tr_b16 a[146:147], v3 offset:41984
v_cvt_pk_bf16_f32 v206, v252, v253
v_cvt_pk_bf16_f32 v207, v254, v255
v_mfma_f32_16x16x32_bf16 v[144:147], a[156:159], v[208:211], v[144:147]
ds_read_b64_tr_b16 a[148:149], v4 offset:33792
ds_read_b128 v[232:235], v7 offset:4224
ds_read_b128 v[236:239], v7 offset:4288
ds_read_b128 v[240:243], v7 offset:1920
ds_read_b128 v[244:247], v7 offset:1984
v_mfma_f32_16x16x32_bf16 v[148:151], a[156:159], v[212:215], v[148:151]
buffer_load_dwordx4 v15, s[8:11], s30 offen offset:1024 lds
ds_read_b64_tr_b16 a[150:151], v4 offset:41984
s_waitcnt lgkmcnt(12)
v_mfma_f32_16x16x32_bf16 v[24:27], a[128:131], v[200:203], v[24:27]
ds_read_b64_tr_b16 a[152:153], v3 offset:37888
s_waitcnt lgkmcnt(3)
v_fma_mix_f32 v248, v176, v232, v240 op_sel_hi:[1,0,0]
v_mfma_f32_16x16x32_bf16 v[28:31], a[128:131], v[204:207], v[28:31]
ds_read_b64_tr_b16 a[154:155], v3 offset:46080
v_fma_mix_f32 v249, v176, v233, v241 op_sel:[1,0,0] op_sel_hi:[1,0,0]
v_mfma_f32_16x16x32_bf16 v[32:35], a[132:135], v[200:203], v[32:35]
ds_read_b64_tr_b16 a[156:157], v4 offset:37888
v_fma_mix_f32 v250, v177, v234, v242 op_sel_hi:[1,0,0]
v_mfma_f32_16x16x32_bf16 v[36:39], a[132:135], v[204:207], v[36:39]
ds_read_b64_tr_b16 a[158:159], v4 offset:46080
v_mfma_f32_16x16x32_bf16 v[40:43], a[136:139], v[200:203], v[40:43]
ds_read_b64_tr_b16 a[128:129], v3 offset:34816
v_fma_mix_f32 v251, v177, v235, v243 op_sel:[1,0,0] op_sel_hi:[1,0,0]
v_mfma_f32_16x16x32_bf16 v[44:47], a[136:139], v[204:207], v[44:47]
ds_read_b64_tr_b16 a[130:131], v3 offset:43008
buffer_load_dwordx4 v16, s[8:11], s30 offen offset:2048 lds
v_mfma_f32_16x16x32_bf16 v[48:51], a[140:143], v[200:203], v[48:51]
ds_read_b64_tr_b16 a[132:133], v4 offset:34816
v_cvt_pk_bf16_f32 v208, v248, v249
v_mfma_f32_16x16x32_bf16 v[52:55], a[140:143], v[204:207], v[52:55]
ds_read_b64_tr_b16 a[134:135], v4 offset:43008
v_cvt_pk_bf16_f32 v209, v250, v251
s_waitcnt lgkmcnt(8)
v_mfma_f32_16x16x32_bf16 v[56:59], a[144:147], v[200:203], v[56:59]
ds_read_b64_tr_b16 a[136:137], v3 offset:38912
v_fma_mix_f32 v252, v178, v236, v244 op_sel_hi:[1,0,0]
v_mfma_f32_16x16x32_bf16 v[60:63], a[144:147], v[204:207], v[60:63]
ds_read_b64_tr_b16 a[138:139], v3 offset:47104
v_fma_mix_f32 v253, v178, v237, v245 op_sel:[1,0,0] op_sel_hi:[1,0,0]
v_mfma_f32_16x16x32_bf16 v[64:67], a[148:151], v[200:203], v[64:67]
ds_read_b64_tr_b16 a[140:141], v4 offset:38912
v_fma_mix_f32 v254, v179, v238, v246 op_sel_hi:[1,0,0]
v_mfma_f32_16x16x32_bf16 v[68:71], a[148:151], v[204:207], v[68:71]
ds_read_b64_tr_b16 a[142:143], v4 offset:47104
s_waitcnt lgkmcnt(8)
v_mfma_f32_16x16x32_bf16 v[72:75], a[152:155], v[200:203], v[72:75]
ds_read_b64_tr_b16 a[144:145], v3 offset:35840
v_fma_mix_f32 v255, v179, v239, v247 op_sel:[1,0,0] op_sel_hi:[1,0,0]
v_mfma_f32_16x16x32_bf16 v[76:79], a[152:155], v[204:207], v[76:79]
buffer_load_dwordx4 v17, s[8:11], s30 offen offset:3072 lds
ds_read_b64_tr_b16 a[146:147], v3 offset:44032
v_cvt_pk_bf16_f32 v210, v252, v253
v_mfma_f32_16x16x32_bf16 v[80:83], a[156:159], v[200:203], v[80:83]
ds_read_b64_tr_b16 a[148:149], v4 offset:35840
v_cvt_pk_bf16_f32 v211, v254, v255
v_mfma_f32_16x16x32_bf16 v[84:87], a[156:159], v[204:207], v[84:87]
ds_read_b64_tr_b16 a[150:151], v4 offset:44032
s_waitcnt lgkmcnt(8)
v_mfma_f32_16x16x32_bf16 v[88:91], a[128:131], v[200:203], v[88:91]
ds_read_b64_tr_b16 a[152:153], v3 offset:39936
v_fma_mix_f32 v248, v180, v232, v240 op_sel_hi:[1,0,0]
v_mfma_f32_16x16x32_bf16 v[92:95], a[128:131], v[204:207], v[92:95]
ds_read_b64_tr_b16 a[154:155], v3 offset:48128
v_fma_mix_f32 v249, v180, v233, v241 op_sel:[1,0,0] op_sel_hi:[1,0,0]
v_mfma_f32_16x16x32_bf16 v[96:99], a[132:135], v[200:203], v[96:99]
ds_read_b64_tr_b16 a[156:157], v4 offset:39936
v_fma_mix_f32 v250, v181, v234, v242 op_sel_hi:[1,0,0]
v_mfma_f32_16x16x32_bf16 v[100:103], a[132:135], v[204:207], v[100:103]
ds_read_b64_tr_b16 a[158:159], v4 offset:48128
s_waitcnt lgkmcnt(8)
v_mfma_f32_16x16x32_bf16 v[104:107], a[136:139], v[200:203], v[104:107]
s_add_u32 m0, s23, 36864
s_add_u32 s31, s25, 4096
buffer_load_dwordx4 v14, s[8:11], s31 offen lds
ds_read_b64_tr_b16 a[128:129], v3 offset:49152
v_fma_mix_f32 v251, v181, v235, v243 op_sel:[1,0,0] op_sel_hi:[1,0,0]
v_mfma_f32_16x16x32_bf16 v[108:111], a[136:139], v[204:207], v[108:111]
ds_read_b64_tr_b16 a[130:131], v3 offset:57344
v_cvt_pk_bf16_f32 v212, v248, v249
v_mfma_f32_16x16x32_bf16 v[112:115], a[140:143], v[200:203], v[112:115]
ds_read_b64_tr_b16 a[132:133], v4 offset:49152
v_cvt_pk_bf16_f32 v213, v250, v251
v_mfma_f32_16x16x32_bf16 v[116:119], a[140:143], v[204:207], v[116:119]
ds_read_b64_tr_b16 a[134:135], v4 offset:57344
s_waitcnt lgkmcnt(8)
v_mfma_f32_16x16x32_bf16 v[120:123], a[144:147], v[200:203], v[120:123]
ds_read_b64_tr_b16 a[136:137], v3 offset:53248
v_fma_mix_f32 v252, v182, v236, v244 op_sel_hi:[1,0,0]
v_mfma_f32_16x16x32_bf16 v[124:127], a[144:147], v[204:207], v[124:127]
ds_read_b64_tr_b16 a[138:139], v3 offset:61440
v_fma_mix_f32 v253, v182, v237, v245 op_sel:[1,0,0] op_sel_hi:[1,0,0]
v_mfma_f32_16x16x32_bf16 v[128:131], a[148:151], v[200:203], v[128:131]
ds_read_b64_tr_b16 a[140:141], v4 offset:53248
v_fma_mix_f32 v254, v183, v238, v246 op_sel_hi:[1,0,0]
v_mfma_f32_16x16x32_bf16 v[132:135], a[148:151], v[204:207], v[132:135]
buffer_load_dwordx4 v15, s[8:11], s31 offen offset:1024 lds
ds_read_b64_tr_b16 a[142:143], v4 offset:61440
s_waitcnt lgkmcnt(8)
v_mfma_f32_16x16x32_bf16 v[136:139], a[152:155], v[200:203], v[136:139]
ds_read_b64_tr_b16 a[144:145], v3 offset:50176
v_fma_mix_f32 v255, v183, v239, v247 op_sel:[1,0,0] op_sel_hi:[1,0,0]
v_mfma_f32_16x16x32_bf16 v[140:143], a[152:155], v[204:207], v[140:143]
ds_read_b64_tr_b16 a[146:147], v3 offset:58368
v_cvt_pk_bf16_f32 v214, v252, v253
v_cvt_pk_bf16_f32 v215, v254, v255
v_mfma_f32_16x16x32_bf16 v[144:147], a[156:159], v[200:203], v[144:147]
ds_read_b64_tr_b16 a[148:149], v4 offset:50176
ds_read_b128 v[216:219], v7 offset:4352
ds_read_b128 v[220:223], v7 offset:4416
ds_read_b128 v[224:227], v7 offset:2048
ds_read_b128 v[228:231], v7 offset:2112
v_mfma_f32_16x16x32_bf16 v[148:151], a[156:159], v[204:207], v[148:151]
ds_read_b64_tr_b16 a[150:151], v4 offset:58368
s_waitcnt lgkmcnt(12)
v_mfma_f32_16x16x32_bf16 v[24:27], a[128:131], v[208:211], v[24:27]
ds_read_b64_tr_b16 a[152:153], v3 offset:54272
s_waitcnt lgkmcnt(3)
v_fma_mix_f32 v248, v184, v216, v224 op_sel_hi:[1,0,0]
v_mfma_f32_16x16x32_bf16 v[28:31], a[128:131], v[212:215], v[28:31]
ds_read_b64_tr_b16 a[154:155], v3 offset:62464
buffer_load_dwordx4 v16, s[8:11], s31 offen offset:2048 lds
v_mfma_f32_16x16x32_bf16 v[32:35], a[132:135], v[208:211], v[32:35]
ds_read_b64_tr_b16 a[156:157], v4 offset:54272
v_fma_mix_f32 v249, v184, v217, v225 op_sel:[1,0,0] op_sel_hi:[1,0,0]
v_mfma_f32_16x16x32_bf16 v[36:39], a[132:135], v[212:215], v[36:39]
ds_read_b64_tr_b16 a[158:159], v4 offset:62464
v_fma_mix_f32 v250, v185, v218, v226 op_sel_hi:[1,0,0]
v_mfma_f32_16x16x32_bf16 v[40:43], a[136:139], v[208:211], v[40:43]
ds_read_b64_tr_b16 a[128:129], v3 offset:51200
v_fma_mix_f32 v251, v185, v219, v227 op_sel:[1,0,0] op_sel_hi:[1,0,0]
v_mfma_f32_16x16x32_bf16 v[44:47], a[136:139], v[212:215], v[44:47]
ds_read_b64_tr_b16 a[130:131], v3 offset:59392
v_cvt_pk_bf16_f32 v200, v248, v249
v_mfma_f32_16x16x32_bf16 v[48:51], a[140:143], v[208:211], v[48:51]
ds_read_b64_tr_b16 a[132:133], v4 offset:51200
v_cvt_pk_bf16_f32 v201, v250, v251
v_mfma_f32_16x16x32_bf16 v[52:55], a[140:143], v[212:215], v[52:55]
ds_read_b64_tr_b16 a[134:135], v4 offset:59392
s_waitcnt lgkmcnt(8)
v_mfma_f32_16x16x32_bf16 v[56:59], a[144:147], v[208:211], v[56:59]
ds_read_b64_tr_b16 a[136:137], v3 offset:55296
v_fma_mix_f32 v252, v186, v220, v228 op_sel_hi:[1,0,0]
v_mfma_f32_16x16x32_bf16 v[60:63], a[144:147], v[212:215], v[60:63]
buffer_load_dwordx4 v17, s[8:11], s31 offen offset:3072 lds
ds_read_b64_tr_b16 a[138:139], v3 offset:63488
v_mfma_f32_16x16x32_bf16 v[64:67], a[148:151], v[208:211], v[64:67]
ds_read_b64_tr_b16 a[140:141], v4 offset:55296
v_fma_mix_f32 v253, v186, v221, v229 op_sel:[1,0,0] op_sel_hi:[1,0,0]
v_mfma_f32_16x16x32_bf16 v[68:71], a[148:151], v[212:215], v[68:71]
ds_read_b64_tr_b16 a[142:143], v4 offset:63488
v_fma_mix_f32 v254, v187, v222, v230 op_sel_hi:[1,0,0]
s_waitcnt lgkmcnt(8)
v_mfma_f32_16x16x32_bf16 v[72:75], a[152:155], v[208:211], v[72:75]
ds_read_b64_tr_b16 a[144:145], v3 offset:52224
v_fma_mix_f32 v255, v187, v223, v231 op_sel:[1,0,0] op_sel_hi:[1,0,0]
v_mfma_f32_16x16x32_bf16 v[76:79], a[152:155], v[212:215], v[76:79]
ds_read_b64_tr_b16 a[146:147], v3 offset:60416
v_cvt_pk_bf16_f32 v202, v252, v253
v_mfma_f32_16x16x32_bf16 v[80:83], a[156:159], v[208:211], v[80:83]
ds_read_b64_tr_b16 a[148:149], v4 offset:52224
v_cvt_pk_bf16_f32 v203, v254, v255
v_mfma_f32_16x16x32_bf16 v[84:87], a[156:159], v[212:215], v[84:87]
ds_read_b64_tr_b16 a[150:151], v4 offset:60416
s_waitcnt lgkmcnt(8)
v_mfma_f32_16x16x32_bf16 v[88:91], a[128:131], v[208:211], v[88:91]
ds_read_b64_tr_b16 a[152:153], v3 offset:56320
v_fma_mix_f32 v248, v188, v216, v224 op_sel_hi:[1,0,0]
v_mfma_f32_16x16x32_bf16 v[92:95], a[128:131], v[212:215], v[92:95]
ds_read_b64_tr_b16 a[154:155], v3 offset:64512
v_fma_mix_f32 v249, v188, v217, v225 op_sel:[1,0,0] op_sel_hi:[1,0,0]
v_mfma_f32_16x16x32_bf16 v[96:99], a[132:135], v[208:211], v[96:99]
ds_read_b64_tr_b16 a[156:157], v4 offset:56320
v_fma_mix_f32 v250, v189, v218, v226 op_sel_hi:[1,0,0]
v_mfma_f32_16x16x32_bf16 v[100:103], a[132:135], v[212:215], v[100:103]
ds_read_b64_tr_b16 a[158:159], v4 offset:64512
s_waitcnt lgkmcnt(8)
v_mfma_f32_16x16x32_bf16 v[104:107], a[136:139], v[208:211], v[104:107]
s_waitcnt vmcnt(8)
s_barrier
ds_read_b64_tr_b16 a[128:129], v1
v_fma_mix_f32 v251, v189, v219, v227 op_sel:[1,0,0] op_sel_hi:[1,0,0]
v_mfma_f32_16x16x32_bf16 v[108:111], a[136:139], v[212:215], v[108:111]
ds_read_b64_tr_b16 a[130:131], v1 offset:8192
v_cvt_pk_bf16_f32 v204, v248, v249
v_mfma_f32_16x16x32_bf16 v[112:115], a[140:143], v[208:211], v[112:115]
ds_read_b64_tr_b16 a[132:133], v2
v_cvt_pk_bf16_f32 v205, v250, v251
v_mfma_f32_16x16x32_bf16 v[116:119], a[140:143], v[212:215], v[116:119]
ds_read_b64_tr_b16 a[134:135], v2 offset:8192
s_waitcnt lgkmcnt(8)
v_mfma_f32_16x16x32_bf16 v[120:123], a[144:147], v[208:211], v[120:123]
s_add_u32 m0, s23, 65536
s_add_u32 s30, s25, 16384
buffer_load_dwordx4 v14, s[8:11], s30 offen lds
ds_read_b64_tr_b16 a[136:137], v1 offset:4096
v_fma_mix_f32 v252, v190, v220, v228 op_sel_hi:[1,0,0]
v_mfma_f32_16x16x32_bf16 v[124:127], a[144:147], v[212:215], v[124:127]
ds_read_b64_tr_b16 a[138:139], v1 offset:12288
v_fma_mix_f32 v253, v190, v221, v229 op_sel:[1,0,0] op_sel_hi:[1,0,0]
v_mfma_f32_16x16x32_bf16 v[128:131], a[148:151], v[208:211], v[128:131]
ds_read_b64_tr_b16 a[140:141], v2 offset:4096
v_fma_mix_f32 v254, v191, v222, v230 op_sel_hi:[1,0,0]
v_mfma_f32_16x16x32_bf16 v[132:135], a[148:151], v[212:215], v[132:135]
ds_read_b64_tr_b16 a[142:143], v2 offset:12288
s_waitcnt lgkmcnt(8)
v_mfma_f32_16x16x32_bf16 v[136:139], a[152:155], v[208:211], v[136:139]
ds_read_b64_tr_b16 a[144:145], v1 offset:1024
v_fma_mix_f32 v255, v191, v223, v231 op_sel:[1,0,0] op_sel_hi:[1,0,0]
v_mfma_f32_16x16x32_bf16 v[140:143], a[152:155], v[212:215], v[140:143]
ds_read_b64_tr_b16 a[146:147], v1 offset:9216
v_cvt_pk_bf16_f32 v206, v252, v253
v_cvt_pk_bf16_f32 v207, v254, v255
v_mfma_f32_16x16x32_bf16 v[144:147], a[156:159], v[208:211], v[144:147]
ds_read_b64_tr_b16 a[148:149], v2 offset:1024
ds_read_b128 v[232:235], v7 offset:4480
ds_read_b128 v[236:239], v7 offset:4544
ds_read_b128 v[240:243], v7 offset:2176
ds_read_b128 v[244:247], v7 offset:2240
v_mfma_f32_16x16x32_bf16 v[148:151], a[156:159], v[212:215], v[148:151]
buffer_load_dwordx4 v15, s[8:11], s30 offen offset:1024 lds
ds_read_b64_tr_b16 a[150:151], v2 offset:9216
s_waitcnt lgkmcnt(12)
v_mfma_f32_16x16x32_bf16 v[24:27], a[128:131], v[200:203], v[24:27]
ds_read_b64_tr_b16 a[152:153], v1 offset:5120
s_waitcnt lgkmcnt(3)
v_fma_mix_f32 v248, v192, v232, v240 op_sel_hi:[1,0,0]
v_mfma_f32_16x16x32_bf16 v[28:31], a[128:131], v[204:207], v[28:31]
ds_read_b64_tr_b16 a[154:155], v1 offset:13312
v_fma_mix_f32 v249, v192, v233, v241 op_sel:[1,0,0] op_sel_hi:[1,0,0]
v_mfma_f32_16x16x32_bf16 v[32:35], a[132:135], v[200:203], v[32:35]
ds_read_b64_tr_b16 a[156:157], v2 offset:5120
v_fma_mix_f32 v250, v193, v234, v242 op_sel_hi:[1,0,0]
v_mfma_f32_16x16x32_bf16 v[36:39], a[132:135], v[204:207], v[36:39]
ds_read_b64_tr_b16 a[158:159], v2 offset:13312
v_mfma_f32_16x16x32_bf16 v[40:43], a[136:139], v[200:203], v[40:43]
ds_read_b64_tr_b16 a[128:129], v1 offset:2048
v_fma_mix_f32 v251, v193, v235, v243 op_sel:[1,0,0] op_sel_hi:[1,0,0]
v_mfma_f32_16x16x32_bf16 v[44:47], a[136:139], v[204:207], v[44:47]
ds_read_b64_tr_b16 a[130:131], v1 offset:10240
buffer_load_dwordx4 v16, s[8:11], s30 offen offset:2048 lds
v_mfma_f32_16x16x32_bf16 v[48:51], a[140:143], v[200:203], v[48:51]
ds_read_b64_tr_b16 a[132:133], v2 offset:2048
v_cvt_pk_bf16_f32 v208, v248, v249
v_mfma_f32_16x16x32_bf16 v[52:55], a[140:143], v[204:207], v[52:55]
ds_read_b64_tr_b16 a[134:135], v2 offset:10240
v_cvt_pk_bf16_f32 v209, v250, v251
s_waitcnt lgkmcnt(8)
v_mfma_f32_16x16x32_bf16 v[56:59], a[144:147], v[200:203], v[56:59]
ds_read_b64_tr_b16 a[136:137], v1 offset:6144
v_fma_mix_f32 v252, v194, v236, v244 op_sel_hi:[1,0,0]
v_mfma_f32_16x16x32_bf16 v[60:63], a[144:147], v[204:207], v[60:63]
ds_read_b64_tr_b16 a[138:139], v1 offset:14336
v_fma_mix_f32 v253, v194, v237, v245 op_sel:[1,0,0] op_sel_hi:[1,0,0]
v_mfma_f32_16x16x32_bf16 v[64:67], a[148:151], v[200:203], v[64:67]
ds_read_b64_tr_b16 a[140:141], v2 offset:6144
v_fma_mix_f32 v254, v195, v238, v246 op_sel_hi:[1,0,0]
v_mfma_f32_16x16x32_bf16 v[68:71], a[148:151], v[204:207], v[68:71]
ds_read_b64_tr_b16 a[142:143], v2 offset:14336
s_waitcnt lgkmcnt(8)
v_mfma_f32_16x16x32_bf16 v[72:75], a[152:155], v[200:203], v[72:75]
ds_read_b64_tr_b16 a[144:145], v1 offset:3072
v_fma_mix_f32 v255, v195, v239, v247 op_sel:[1,0,0] op_sel_hi:[1,0,0]
v_mfma_f32_16x16x32_bf16 v[76:79], a[152:155], v[204:207], v[76:79]
buffer_load_dwordx4 v17, s[8:11], s30 offen offset:3072 lds
ds_read_b64_tr_b16 a[146:147], v1 offset:11264
v_cvt_pk_bf16_f32 v210, v252, v253
v_mfma_f32_16x16x32_bf16 v[80:83], a[156:159], v[200:203], v[80:83]
ds_read_b64_tr_b16 a[148:149], v2 offset:3072
v_cvt_pk_bf16_f32 v211, v254, v255
v_mfma_f32_16x16x32_bf16 v[84:87], a[156:159], v[204:207], v[84:87]
ds_read_b64_tr_b16 a[150:151], v2 offset:11264
s_waitcnt lgkmcnt(8)
v_mfma_f32_16x16x32_bf16 v[88:91], a[128:131], v[200:203], v[88:91]
ds_read_b64_tr_b16 a[152:153], v1 offset:7168
v_fma_mix_f32 v248, v196, v232, v240 op_sel_hi:[1,0,0]
v_mfma_f32_16x16x32_bf16 v[92:95], a[128:131], v[204:207], v[92:95]
ds_read_b64_tr_b16 a[154:155], v1 offset:15360
v_fma_mix_f32 v249, v196, v233, v241 op_sel:[1,0,0] op_sel_hi:[1,0,0]
v_mfma_f32_16x16x32_bf16 v[96:99], a[132:135], v[200:203], v[96:99]
ds_read_b64_tr_b16 a[156:157], v2 offset:7168
v_fma_mix_f32 v250, v197, v234, v242 op_sel_hi:[1,0,0]
v_mfma_f32_16x16x32_bf16 v[100:103], a[132:135], v[204:207], v[100:103]
ds_read_b64_tr_b16 a[158:159], v2 offset:15360
s_waitcnt lgkmcnt(8)
v_mfma_f32_16x16x32_bf16 v[104:107], a[136:139], v[200:203], v[104:107]
s_add_u32 m0, s23, 69632
s_add_u32 s31, s25, 20480
buffer_load_dwordx4 v14, s[8:11], s31 offen lds
ds_read_b64_tr_b16 a[128:129], v1 offset:16384
v_fma_mix_f32 v251, v197, v235, v243 op_sel:[1,0,0] op_sel_hi:[1,0,0]
v_mfma_f32_16x16x32_bf16 v[108:111], a[136:139], v[204:207], v[108:111]
ds_read_b64_tr_b16 a[130:131], v1 offset:24576
v_cvt_pk_bf16_f32 v212, v248, v249
v_mfma_f32_16x16x32_bf16 v[112:115], a[140:143], v[200:203], v[112:115]
ds_read_b64_tr_b16 a[132:133], v2 offset:16384
v_cvt_pk_bf16_f32 v213, v250, v251
v_mfma_f32_16x16x32_bf16 v[116:119], a[140:143], v[204:207], v[116:119]
ds_read_b64_tr_b16 a[134:135], v2 offset:24576
s_waitcnt lgkmcnt(8)
v_mfma_f32_16x16x32_bf16 v[120:123], a[144:147], v[200:203], v[120:123]
ds_read_b64_tr_b16 a[136:137], v1 offset:20480
v_fma_mix_f32 v252, v198, v236, v244 op_sel_hi:[1,0,0]
v_mfma_f32_16x16x32_bf16 v[124:127], a[144:147], v[204:207], v[124:127]
ds_read_b64_tr_b16 a[138:139], v1 offset:28672
v_fma_mix_f32 v253, v198, v237, v245 op_sel:[1,0,0] op_sel_hi:[1,0,0]
v_mfma_f32_16x16x32_bf16 v[128:131], a[148:151], v[200:203], v[128:131]
ds_read_b64_tr_b16 a[140:141], v2 offset:20480
v_fma_mix_f32 v254, v199, v238, v246 op_sel_hi:[1,0,0]
v_mfma_f32_16x16x32_bf16 v[132:135], a[148:151], v[204:207], v[132:135]
buffer_load_dwordx4 v15, s[8:11], s31 offen offset:1024 lds
ds_read_b64_tr_b16 a[142:143], v2 offset:28672
s_waitcnt lgkmcnt(8)
v_mfma_f32_16x16x32_bf16 v[136:139], a[152:155], v[200:203], v[136:139]
ds_read_b64_tr_b16 a[144:145], v1 offset:17408
v_fma_mix_f32 v255, v199, v239, v247 op_sel:[1,0,0] op_sel_hi:[1,0,0]
v_mfma_f32_16x16x32_bf16 v[140:143], a[152:155], v[204:207], v[140:143]
ds_read_b64_tr_b16 a[146:147], v1 offset:25600
v_cvt_pk_bf16_f32 v214, v252, v253
v_cvt_pk_bf16_f32 v215, v254, v255
v_mfma_f32_16x16x32_bf16 v[144:147], a[156:159], v[200:203], v[144:147]
ds_read_b64_tr_b16 a[148:149], v2 offset:17408
v_mfma_f32_16x16x32_bf16 v[148:151], a[156:159], v[204:207], v[148:151]
ds_read_b64_tr_b16 a[150:151], v2 offset:25600
s_waitcnt lgkmcnt(8)
v_mfma_f32_16x16x32_bf16 v[24:27], a[128:131], v[208:211], v[24:27]
ds_read_b64_tr_b16 a[152:153], v1 offset:21504
buffer_load_dwordx4 v16, s[8:11], s31 offen offset:2048 lds
v_mfma_f32_16x16x32_bf16 v[28:31], a[128:131], v[212:215], v[28:31]
ds_read_b64_tr_b16 a[154:155], v1 offset:29696
v_mfma_f32_16x16x32_bf16 v[32:35], a[132:135], v[208:211], v[32:35]
ds_read_b64_tr_b16 a[156:157], v2 offset:21504
v_mfma_f32_16x16x32_bf16 v[36:39], a[132:135], v[212:215], v[36:39]
ds_read_b64_tr_b16 a[158:159], v2 offset:29696
s_waitcnt lgkmcnt(8)
v_mfma_f32_16x16x32_bf16 v[40:43], a[136:139], v[208:211], v[40:43]
ds_read_b64_tr_b16 a[128:129], v1 offset:18432
v_mfma_f32_16x16x32_bf16 v[44:47], a[136:139], v[212:215], v[44:47]
ds_read_b64_tr_b16 a[130:131], v1 offset:26624
v_cvt_pk_bf16_f32 v152, v24, v25
v_mfma_f32_16x16x32_bf16 v[48:51], a[140:143], v[208:211], v[48:51]
ds_read_b64_tr_b16 a[132:133], v2 offset:18432
buffer_load_dwordx4 v17, s[8:11], s31 offen offset:3072 lds
v_mfma_f32_16x16x32_bf16 v[52:55], a[140:143], v[212:215], v[52:55]
ds_read_b64_tr_b16 a[134:135], v2 offset:26624
s_waitcnt lgkmcnt(8)
v_mfma_f32_16x16x32_bf16 v[56:59], a[144:147], v[208:211], v[56:59]
ds_read_b64_tr_b16 a[136:137], v1 offset:22528
v_cvt_pk_bf16_f32 v153, v26, v27
v_mfma_f32_16x16x32_bf16 v[60:63], a[144:147], v[212:215], v[60:63]
ds_read_b64_tr_b16 a[138:139], v1 offset:30720
v_cvt_pk_bf16_f32 v154, v32, v33
v_mfma_f32_16x16x32_bf16 v[64:67], a[148:151], v[208:211], v[64:67]
ds_read_b64_tr_b16 a[140:141], v2 offset:22528
v_cvt_pk_bf16_f32 v155, v34, v35
v_mfma_f32_16x16x32_bf16 v[68:71], a[148:151], v[212:215], v[68:71]
ds_read_b64_tr_b16 a[142:143], v2 offset:30720
s_waitcnt lgkmcnt(8)
v_mfma_f32_16x16x32_bf16 v[72:75], a[152:155], v[208:211], v[72:75]
ds_read_b64_tr_b16 a[144:145], v1 offset:19456
v_permlane32_swap_b32 v152, v154
v_mfma_f32_16x16x32_bf16 v[76:79], a[152:155], v[212:215], v[76:79]
ds_read_b64_tr_b16 a[146:147], v1 offset:27648
v_permlane32_swap_b32 v153, v155
v_mfma_f32_16x16x32_bf16 v[80:83], a[156:159], v[208:211], v[80:83]
ds_read_b64_tr_b16 a[148:149], v2 offset:19456
v_permlane16_swap_b32 v152, v154
v_mfma_f32_16x16x32_bf16 v[84:87], a[156:159], v[212:215], v[84:87]
ds_read_b64_tr_b16 a[150:151], v2 offset:27648
s_waitcnt lgkmcnt(8)
v_mfma_f32_16x16x32_bf16 v[88:91], a[128:131], v[208:211], v[88:91]
ds_read_b64_tr_b16 a[152:153], v1 offset:23552
v_permlane16_swap_b32 v153, v155
v_mfma_f32_16x16x32_bf16 v[92:95], a[128:131], v[212:215], v[92:95]
ds_read_b64_tr_b16 a[154:155], v1 offset:31744
v_cvt_pk_bf16_f32 v168, v28, v29
v_mfma_f32_16x16x32_bf16 v[96:99], a[132:135], v[208:211], v[96:99]
ds_read_b64_tr_b16 a[156:157], v2 offset:23552
v_cvt_pk_bf16_f32 v169, v30, v31
v_mfma_f32_16x16x32_bf16 v[100:103], a[132:135], v[212:215], v[100:103]
ds_read_b64_tr_b16 a[158:159], v2 offset:31744
s_waitcnt lgkmcnt(8)
v_mfma_f32_16x16x32_bf16 v[104:107], a[136:139], v[208:211], v[104:107]
s_waitcnt vmcnt(8)
s_barrier
ds_read_b128 a[128:131], v5 offset:32768
v_mfma_f32_16x16x32_bf16 v[108:111], a[136:139], v[212:215], v[108:111]
s_add_u32 m0, s23, 98304
s_add_u32 s30, s25, 32768
v_mfma_f32_16x16x32_bf16 v[112:115], a[140:143], v[208:211], v[112:115]
buffer_load_dwordx4 v14, s[8:11], s30 offen lds
v_cvt_pk_bf16_f32 v170, v36, v37
v_mfma_f32_16x16x32_bf16 v[116:119], a[140:143], v[212:215], v[116:119]
v_cvt_pk_bf16_f32 v171, v38, v39
s_waitcnt lgkmcnt(5)
v_mfma_f32_16x16x32_bf16 v[120:123], a[144:147], v[208:211], v[120:123]
ds_read_b128 a[132:135], v5 offset:33792
v_permlane32_swap_b32 v168, v170
v_mfma_f32_16x16x32_bf16 v[124:127], a[144:147], v[212:215], v[124:127]
v_permlane32_swap_b32 v169, v171
v_permlane16_swap_b32 v168, v170
v_mfma_f32_16x16x32_bf16 v[128:131], a[148:151], v[208:211], v[128:131]
v_permlane16_swap_b32 v169, v171
v_cvt_pk_bf16_f32 v184, v40, v41
v_mfma_f32_16x16x32_bf16 v[132:135], a[148:151], v[212:215], v[132:135]
v_cvt_pk_bf16_f32 v185, v42, v43
s_waitcnt lgkmcnt(2)
v_mfma_f32_16x16x32_bf16 v[136:139], a[152:155], v[208:211], v[136:139]
ds_read_b128 a[136:139], v5 offset:34816
v_cvt_pk_bf16_f32 v186, v48, v49
v_mfma_f32_16x16x32_bf16 v[140:143], a[152:155], v[212:215], v[140:143]
v_cvt_pk_bf16_f32 v187, v50, v51
v_permlane32_swap_b32 v184, v186
v_mfma_f32_16x16x32_bf16 v[144:147], a[156:159], v[208:211], v[144:147]
v_permlane32_swap_b32 v185, v187
v_permlane16_swap_b32 v184, v186
v_mfma_f32_16x16x32_bf16 v[148:151], a[156:159], v[212:215], v[148:151]
v_permlane16_swap_b32 v185, v187
s_waitcnt lgkmcnt(2)
v_mfma_f32_16x16x32_bf16 v[24:27], a[128:131], v[152:155], 0
ds_read_b128 a[140:143], v5 offset:35840
v_cvt_pk_bf16_f32 v216, v44, v45
v_mfma_f32_16x16x32_bf16 v[32:35], a[128:131], v[168:171], 0
v_cvt_pk_bf16_f32 v217, v46, v47
v_cvt_pk_bf16_f32 v218, v52, v53
v_cvt_pk_bf16_f32 v219, v54, v55
s_nop 0
v_permlane32_swap_b32 v216, v218
v_permlane32_swap_b32 v217, v219
s_nop 0
v_permlane16_swap_b32 v216, v218
v_permlane16_swap_b32 v217, v219
v_mfma_f32_16x16x32_bf16 v[40:43], a[128:131], v[184:187], 0
v_cvt_pk_bf16_f32 v156, v56, v57
v_cvt_pk_bf16_f32 v157, v58, v59
v_cvt_pk_bf16_f32 v158, v64, v65
v_cvt_pk_bf16_f32 v159, v66, v67
s_nop 0
v_permlane32_swap_b32 v156, v158
v_permlane32_swap_b32 v157, v159
s_nop 0
v_permlane16_swap_b32 v156, v158
v_permlane16_swap_b32 v157, v159
v_mfma_f32_16x16x32_bf16 v[48:51], a[128:131], v[216:219], 0
buffer_load_dwordx4 v15, s[8:11], s30 offen offset:1024 lds
v_cvt_pk_bf16_f32 v172, v60, v61
v_cvt_pk_bf16_f32 v173, v62, v63
v_cvt_pk_bf16_f32 v174, v68, v69
v_cvt_pk_bf16_f32 v175, v70, v71
s_nop 0
v_permlane32_swap_b32 v172, v174
v_permlane32_swap_b32 v173, v175
s_nop 0
v_permlane16_swap_b32 v172, v174
v_permlane16_swap_b32 v173, v175
s_waitcnt lgkmcnt(2)
v_mfma_f32_16x16x32_bf16 v[24:27], a[132:135], v[156:159], v[24:27]
ds_read_b128 a[144:147], v5 offset:36864
v_cvt_pk_bf16_f32 v188, v72, v73
v_cvt_pk_bf16_f32 v189, v74, v75
v_cvt_pk_bf16_f32 v190, v80, v81
v_cvt_pk_bf16_f32 v191, v82, v83
s_nop 0
v_permlane32_swap_b32 v188, v190
v_permlane32_swap_b32 v189, v191
s_nop 0
v_permlane16_swap_b32 v188, v190
v_permlane16_swap_b32 v189, v191
v_mfma_f32_16x16x32_bf16 v[32:35], a[132:135], v[172:175], v[32:35]
v_cvt_pk_bf16_f32 v220, v76, v77
v_cvt_pk_bf16_f32 v221, v78, v79
v_cvt_pk_bf16_f32 v222, v84, v85
v_cvt_pk_bf16_f32 v223, v86, v87
s_nop 0
v_permlane32_swap_b32 v220, v222
v_permlane32_swap_b32 v221, v223
s_nop 0
v_permlane16_swap_b32 v220, v222
v_permlane16_swap_b32 v221, v223
v_mfma_f32_16x16x32_bf16 v[40:43], a[132:135], v[188:191], v[40:43]
v_cvt_pk_bf16_f32 v160, v88, v89
v_cvt_pk_bf16_f32 v161, v90, v91
v_cvt_pk_bf16_f32 v162, v96, v97
v_cvt_pk_bf16_f32 v163, v98, v99
s_nop 0
v_permlane32_swap_b32 v160, v162
v_permlane32_swap_b32 v161, v163
s_nop 0
v_permlane16_swap_b32 v160, v162
v_permlane16_swap_b32 v161, v163
v_mfma_f32_16x16x32_bf16 v[48:51], a[132:135], v[220:223], v[48:51]
v_cvt_pk_bf16_f32 v176, v92, v93
v_cvt_pk_bf16_f32 v177, v94, v95
v_cvt_pk_bf16_f32 v178, v100, v101
v_cvt_pk_bf16_f32 v179, v102, v103
s_nop 0
v_permlane32_swap_b32 v176, v178
v_permlane32_swap_b32 v177, v179
s_nop 0
v_permlane16_swap_b32 v176, v178
v_permlane16_swap_b32 v177, v179
s_waitcnt lgkmcnt(2)
v_mfma_f32_16x16x32_bf16 v[24:27], a[136:139], v[160:163], v[24:27]
ds_read_b128 a[148:151], v5 offset:37888
v_cvt_pk_bf16_f32 v192, v104, v105
v_cvt_pk_bf16_f32 v193, v106, v107
v_cvt_pk_bf16_f32 v194, v112, v113
v_cvt_pk_bf16_f32 v195, v114, v115
s_nop 0
v_permlane32_swap_b32 v192, v194
v_permlane32_swap_b32 v193, v195
s_nop 0
v_permlane16_swap_b32 v192, v194
v_permlane16_swap_b32 v193, v195
v_mfma_f32_16x16x32_bf16 v[32:35], a[136:139], v[176:179], v[32:35]
v_cvt_pk_bf16_f32 v224, v108, v109
v_cvt_pk_bf16_f32 v225, v110, v111
v_cvt_pk_bf16_f32 v226, v116, v117
v_cvt_pk_bf16_f32 v227, v118, v119
s_nop 0
v_permlane32_swap_b32 v224, v226
v_permlane32_swap_b32 v225, v227
s_nop 0
v_permlane16_swap_b32 v224, v226
v_permlane16_swap_b32 v225, v227
v_mfma_f32_16x16x32_bf16 v[40:43], a[136:139], v[192:195], v[40:43]
v_cvt_pk_bf16_f32 v164, v120, v121
v_cvt_pk_bf16_f32 v165, v122, v123
v_cvt_pk_bf16_f32 v166, v128, v129
v_cvt_pk_bf16_f32 v167, v130, v131
s_nop 0
v_permlane32_swap_b32 v164, v166
v_permlane32_swap_b32 v165, v167
s_nop 0
v_permlane16_swap_b32 v164, v166
v_permlane16_swap_b32 v165, v167
v_mfma_f32_16x16x32_bf16 v[48:51], a[136:139], v[224:227], v[48:51]
v_cvt_pk_bf16_f32 v180, v124, v125
v_cvt_pk_bf16_f32 v181, v126, v127
v_cvt_pk_bf16_f32 v182, v132, v133
v_cvt_pk_bf16_f32 v183, v134, v135
s_nop 0
v_permlane32_swap_b32 v180, v182
v_permlane32_swap_b32 v181, v183
s_nop 0
v_permlane16_swap_b32 v180, v182
v_permlane16_swap_b32 v181, v183
s_waitcnt lgkmcnt(2)
v_mfma_f32_16x16x32_bf16 v[24:27], a[140:143], v[164:167], v[24:27]
ds_read_b128 a[152:155], v5 offset:38912
v_cvt_pk_bf16_f32 v196, v136, v137
v_cvt_pk_bf16_f32 v197, v138, v139
v_cvt_pk_bf16_f32 v198, v144, v145
v_cvt_pk_bf16_f32 v199, v146, v147
s_nop 0
v_permlane32_swap_b32 v196, v198
v_permlane32_swap_b32 v197, v199
s_nop 0
v_permlane16_swap_b32 v196, v198
v_permlane16_swap_b32 v197, v199
v_mfma_f32_16x16x32_bf16 v[32:35], a[140:143], v[180:183], v[32:35]
v_cvt_pk_bf16_f32 v228, v140, v141
v_cvt_pk_bf16_f32 v229, v142, v143
v_cvt_pk_bf16_f32 v230, v148, v149
v_cvt_pk_bf16_f32 v231, v150, v151
s_nop 0
v_permlane32_swap_b32 v228, v230
v_permlane32_swap_b32 v229, v231
s_nop 0
v_permlane16_swap_b32 v228, v230
v_permlane16_swap_b32 v229, v231
v_mfma_f32_16x16x32_bf16 v[40:43], a[140:143], v[196:199], v[40:43]
buffer_load_dwordx4 v16, s[8:11], s30 offen offset:2048 lds
v_mfma_f32_16x16x32_bf16 v[48:51], a[140:143], v[228:231], v[48:51]
v_max3_f32 v144, v24, v25, v26
s_waitcnt lgkmcnt(2)
v_mfma_f32_16x16x32_bf16 v[28:31], a[144:147], v[152:155], 0
ds_read_b128 a[156:159], v5 offset:39936
v_max_f32 v144, v144, v27
v_mfma_f32_16x16x32_bf16 v[36:39], a[144:147], v[168:171], 0
v_max3_f32 v145, v32, v33, v34
v_max_f32 v145, v145, v35
v_mfma_f32_16x16x32_bf16 v[44:47], a[144:147], v[184:187], 0
v_max3_f32 v146, v40, v41, v42
v_max_f32 v146, v146, v43
v_mfma_f32_16x16x32_bf16 v[52:55], a[144:147], v[216:219], 0
v_max3_f32 v147, v48, v49, v50
v_max_f32 v147, v147, v51
v_mov_b32 v148, v144
s_waitcnt lgkmcnt(2)
v_mfma_f32_16x16x32_bf16 v[28:31], a[148:151], v[156:159], v[28:31]
ds_read_b128 a[128:131], v5 offset:40960
v_mov_b32 v149, v145
v_mov_b32 v150, v146
v_mov_b32 v151, v147
v_mfma_f32_16x16x32_bf16 v[36:39], a[148:151], v[172:175], v[36:39]
v_permlane16_swap_b32 v144, v148
v_permlane16_swap_b32 v145, v149
v_permlane16_swap_b32 v146, v150
v_mfma_f32_16x16x32_bf16 v[44:47], a[148:151], v[188:191], v[44:47]
v_permlane16_swap_b32 v147, v151
v_max_f32 v144, v144, v148
v_max_f32 v145, v145, v149
v_mfma_f32_16x16x32_bf16 v[52:55], a[148:151], v[220:223], v[52:55]
v_max_f32 v146, v146, v150
v_max_f32 v147, v147, v151
v_mov_b32 v148, v144
s_waitcnt lgkmcnt(2)
v_mfma_f32_16x16x32_bf16 v[28:31], a[152:155], v[160:163], v[28:31]
ds_read_b128 a[132:135], v5 offset:41984
v_mov_b32 v149, v145
v_mov_b32 v150, v146
v_mov_b32 v151, v147
v_mfma_f32_16x16x32_bf16 v[36:39], a[152:155], v[176:179], v[36:39]
buffer_load_dwordx4 v17, s[8:11], s30 offen offset:3072 lds
v_permlane32_swap_b32 v144, v148
v_permlane32_swap_b32 v145, v149
v_permlane32_swap_b32 v146, v150
v_mfma_f32_16x16x32_bf16 v[44:47], a[152:155], v[192:195], v[44:47]
s_lshl_b32 s100, s21, 4
v_permlane32_swap_b32 v147, v151
v_max_f32 v144, v144, v148
v_max_f32 v145, v145, v149
v_mfma_f32_16x16x32_bf16 v[52:55], a[152:155], v[224:227], v[52:55]
v_max_f32 v146, v146, v150
v_max_f32 v147, v147, v151
v_sub_f32 v120, 0, v144
s_waitcnt lgkmcnt(2)
v_mfma_f32_16x16x32_bf16 v[28:31], a[156:159], v[164:167], v[28:31]
ds_read_b128 a[136:139], v5 offset:43008
s_add_u32 s100, s100, s22
v_sub_f32 v121, 0, v144
v_sub_f32 v122, 0, v144
v_sub_f32 v123, 0, v144
v_mfma_f32_16x16x32_bf16 v[36:39], a[156:159], v[180:183], v[36:39]
v_sub_f32 v124, 0, v145
v_sub_f32 v125, 0, v145
v_sub_f32 v126, 0, v145
v_mfma_f32_16x16x32_bf16 v[44:47], a[156:159], v[196:199], v[44:47]
s_lshl_b32 s100, s100, 2
v_sub_f32 v127, 0, v145
v_sub_f32 v128, 0, v146
v_sub_f32 v129, 0, v146
v_sub_f32 v130, 0, v146
v_sub_f32 v131, 0, v146
v_sub_f32 v132, 0, v147
v_sub_f32 v133, 0, v147
v_sub_f32 v134, 0, v147
v_sub_f32 v135, 0, v147
v_mfma_f32_16x16x32_bf16 v[52:55], a[156:159], v[228:231], v[52:55]
s_add_u32 s100, s100, s20
s_waitcnt lgkmcnt(2)
v_mfma_f32_16x16x32_bf16 v[56:59], a[128:131], v[152:155], v[120:123]
ds_read_b128 a[140:143], v5 offset:44032
v_add_f32 v24, v24, v120
v_mfma_f32_16x16x32_bf16 v[64:67], a[128:131], v[168:171], v[124:127]
v_add_f32 v25, v25, v120
v_add_f32 v26, v26, v120
v_add_f32 v27, v27, v120
v_exp_f32 v144, v24
v_mfma_f32_16x16x32_bf16 v[72:75], a[128:131], v[184:187], v[128:131]
s_mul_i32 s100, s100, 4608
v_exp_f32 v145, v25
v_exp_f32 v146, v26
v_mfma_f32_16x16x32_bf16 v[80:83], a[128:131], v[216:219], v[132:135]
v_exp_f32 v147, v27
v_add_f32 v140, v144, v145
v_cvt_pk_bf16_f32 v88, v144, v145
s_waitcnt lgkmcnt(2)
v_mfma_f32_16x16x32_bf16 v[56:59], a[132:135], v[156:159], v[56:59]
s_add_u32 m0, s23, 102400
s_add_u32 s31, s25, 36864
buffer_load_dwordx4 v14, s[8:11], s31 offen lds
ds_read_b128 a[144:147], v5 offset:45056
buffer_load_dword a166, v23, s[12:15], s100 offen
v_add_f32 v140, v140, v146
v_add_f32 v140, v140, v147
v_cvt_pk_bf16_f32 v89, v146, v147
v_add_f32 v32, v32, v124
v_mfma_f32_16x16x32_bf16 v[64:67], a[132:135], v[172:175], v[64:67]
v_add_f32 v33, v33, v124
v_add_f32 v34, v34, v124
v_add_f32 v35, v35, v124
v_exp_f32 v144, v32
v_mfma_f32_16x16x32_bf16 v[72:75], a[132:135], v[188:191], v[72:75]
v_exp_f32 v145, v33
v_exp_f32 v146, v34
v_mfma_f32_16x16x32_bf16 v[80:83], a[132:135], v[220:223], v[80:83]
v_exp_f32 v147, v35
v_add_f32 v141, v144, v145
v_cvt_pk_bf16_f32 v92, v144, v145
v_add_f32 v141, v141, v146
s_waitcnt lgkmcnt(2)
v_mfma_f32_16x16x32_bf16 v[56:59], a[136:139], v[160:163], v[56:59]
ds_read_b128 a[148:151], v5 offset:46080
v_add_f32 v141, v141, v147
v_cvt_pk_bf16_f32 v93, v146, v147
v_add_f32 v40, v40, v128
v_add_f32 v41, v41, v128
v_mfma_f32_16x16x32_bf16 v[64:67], a[136:139], v[176:179], v[64:67]
v_add_f32 v42, v42, v128
v_add_f32 v43, v43, v128
v_exp_f32 v144, v40
v_exp_f32 v145, v41
v_mfma_f32_16x16x32_bf16 v[72:75], a[136:139], v[192:195], v[72:75]
v_exp_f32 v146, v42
v_exp_f32 v147, v43
v_mfma_f32_16x16x32_bf16 v[80:83], a[136:139], v[224:227], v[80:83]
v_add_f32 v142, v144, v145
v_cvt_pk_bf16_f32 v96, v144, v145
v_add_f32 v142, v142, v146
v_add_f32 v142, v142, v147
s_waitcnt lgkmcnt(2)
v_mfma_f32_16x16x32_bf16 v[56:59], a[140:143], v[164:167], v[56:59]
ds_read_b128 a[152:155], v5 offset:47104
v_cvt_pk_bf16_f32 v97, v146, v147
v_add_f32 v48, v48, v132
v_add_f32 v49, v49, v132
v_add_f32 v50, v50, v132
v_mfma_f32_16x16x32_bf16 v[64:67], a[140:143], v[180:183], v[64:67]
v_add_f32 v51, v51, v132
v_exp_f32 v144, v48
v_exp_f32 v145, v49
v_mfma_f32_16x16x32_bf16 v[72:75], a[140:143], v[196:199], v[72:75]
v_exp_f32 v146, v50
v_exp_f32 v147, v51
v_mfma_f32_16x16x32_bf16 v[80:83], a[140:143], v[228:231], v[80:83]
buffer_load_dwordx4 v15, s[8:11], s31 offen offset:1024 lds
v_add_f32 v143, v144, v145
v_cvt_pk_bf16_f32 v100, v144, v145
v_add_f32 v143, v143, v146
v_add_f32 v143, v143, v147
v_cvt_pk_bf16_f32 v101, v146, v147
s_waitcnt lgkmcnt(2)
v_mfma_f32_16x16x32_bf16 v[60:63], a[144:147], v[152:155], v[120:123]
ds_read_b128 a[156:159], v5 offset:48128
v_add_f32 v28, v28, v120
v_add_f32 v29, v29, v120
v_add_f32 v30, v30, v120
v_add_f32 v31, v31, v120
v_mfma_f32_16x16x32_bf16 v[68:71], a[144:147], v[168:171], v[124:127]
v_exp_f32 v148, v28
v_exp_f32 v149, v29
v_mfma_f32_16x16x32_bf16 v[76:79], a[144:147], v[184:187], v[128:131]
v_exp_f32 v150, v30
v_exp_f32 v151, v31
v_add_f32 v140, v140, v148
v_mfma_f32_16x16x32_bf16 v[84:87], a[144:147], v[216:219], v[132:135]
v_add_f32 v140, v140, v149
v_cvt_pk_bf16_f32 v90, v148, v149
v_add_f32 v140, v140, v150
v_add_f32 v140, v140, v151
s_waitcnt lgkmcnt(2)
v_mfma_f32_16x16x32_bf16 v[60:63], a[148:151], v[156:159], v[60:63]
ds_read_b64_tr_b16 a[128:129], v1 offset:49152
v_cvt_pk_bf16_f32 v91, v150, v151
v_add_f32 v36, v36, v124
v_add_f32 v37, v37, v124
v_add_f32 v38, v38, v124
v_add_f32 v39, v39, v124
v_mfma_f32_16x16x32_bf16 v[68:71], a[148:151], v[172:175], v[68:71]
ds_read_b64_tr_b16 a[130:131], v1 offset:53248
v_exp_f32 v148, v36
v_exp_f32 v149, v37
v_mfma_f32_16x16x32_bf16 v[76:79], a[148:151], v[188:191], v[76:79]
v_exp_f32 v150, v38
v_exp_f32 v151, v39
v_add_f32 v141, v141, v148
v_mfma_f32_16x16x32_bf16 v[84:87], a[148:151], v[220:223], v[84:87]
v_add_f32 v141, v141, v149
v_cvt_pk_bf16_f32 v94, v148, v149
v_add_f32 v141, v141, v150
v_add_f32 v141, v141, v151
s_waitcnt lgkmcnt(3)
v_mfma_f32_16x16x32_bf16 v[60:63], a[152:155], v[160:163], v[60:63]
ds_read_b64_tr_b16 a[132:133], v2 offset:49152
v_cvt_pk_bf16_f32 v95, v150, v151
v_add_f32 v44, v44, v128
v_add_f32 v45, v45, v128
v_add_f32 v46, v46, v128
v_add_f32 v47, v47, v128
v_mfma_f32_16x16x32_bf16 v[68:71], a[152:155], v[176:179], v[68:71]
ds_read_b64_tr_b16 a[134:135], v2 offset:53248
v_exp_f32 v148, v44
v_exp_f32 v149, v45
v_mfma_f32_16x16x32_bf16 v[76:79], a[152:155], v[192:195], v[76:79]
buffer_load_dwordx4 v16, s[8:11], s31 offen offset:2048 lds
v_exp_f32 v150, v46
v_exp_f32 v151, v47
v_add_f32 v142, v142, v148
v_mfma_f32_16x16x32_bf16 v[84:87], a[152:155], v[224:227], v[84:87]
v_add_f32 v142, v142, v149
v_cvt_pk_bf16_f32 v98, v148, v149
v_add_f32 v142, v142, v150
v_add_f32 v142, v142, v151
s_waitcnt lgkmcnt(4)
v_mfma_f32_16x16x32_bf16 v[60:63], a[156:159], v[164:167], v[60:63]
ds_read_b64_tr_b16 a[136:137], v1 offset:50176
v_cvt_pk_bf16_f32 v99, v150, v151
v_add_f32 v52, v52, v132
v_add_f32 v53, v53, v132
v_add_f32 v54, v54, v132
v_add_f32 v55, v55, v132
v_mfma_f32_16x16x32_bf16 v[68:71], a[156:159], v[180:183], v[68:71]
ds_read_b64_tr_b16 a[138:139], v1 offset:54272
v_exp_f32 v148, v52
v_exp_f32 v149, v53
v_mfma_f32_16x16x32_bf16 v[76:79], a[156:159], v[196:199], v[76:79]
v_exp_f32 v150, v54
v_exp_f32 v151, v55
v_add_f32 v143, v143, v148
v_add_f32 v143, v143, v149
v_cvt_pk_bf16_f32 v102, v148, v149
v_add_f32 v143, v143, v150
v_add_f32 v143, v143, v151
v_cvt_pk_bf16_f32 v103, v150, v151
v_max3_f32 v144, v140, v141, v142
v_max_f32 v144, v144, v143
v_cmp_lt_f32 vcc, s29, v144
v_mfma_f32_16x16x32_bf16 v[84:87], a[156:159], v[228:231], v[84:87]
s_nop 0
s_cbranch_vccnz K1_STUB0
K1_BACK0:
s_waitcnt lgkmcnt(4)
v_mfma_f32_16x16x32_bf16 a[0:3], a[128:131], v[88:91], 0
ds_read_b64_tr_b16 a[140:141], v2 offset:50176
v_mov_b32 v136, v140
v_mfma_f32_16x16x32_bf16 a[32:35], a[128:131], v[92:95], 0
ds_read_b64_tr_b16 a[142:143], v2 offset:54272
v_mov_b32 v137, v141
v_mfma_f32_16x16x32_bf16 a[64:67], a[128:131], v[96:99], 0
v_mov_b32 v138, v142
v_mov_b32 v139, v143
v_mfma_f32_16x16x32_bf16 a[96:99], a[128:131], v[100:103], 0
v_exp_f32 v144, v56
s_waitcnt lgkmcnt(4)
v_mfma_f32_16x16x32_bf16 a[4:7], a[132:135], v[88:91], 0
ds_read_b64_tr_b16 a[144:145], v1 offset:51200
v_exp_f32 v145, v57
v_mfma_f32_16x16x32_bf16 a[36:39], a[132:135], v[92:95], 0
buffer_load_dwordx4 v17, s[8:11], s31 offen offset:3072 lds
ds_read_b64_tr_b16 a[146:147], v1 offset:55296
v_exp_f32 v146, v58
v_mfma_f32_16x16x32_bf16 a[68:71], a[132:135], v[96:99], 0
v_exp_f32 v147, v59
v_mfma_f32_16x16x32_bf16 a[100:103], a[132:135], v[100:103], 0
v_add_f32 v140, v144, v145
s_waitcnt lgkmcnt(4)
v_mfma_f32_16x16x32_bf16 a[8:11], a[136:139], v[88:91], 0
ds_read_b64_tr_b16 a[148:149], v2 offset:51200
v_cvt_pk_bf16_f32 v104, v144, v145
v_add_f32 v140, v140, v146
v_mfma_f32_16x16x32_bf16 a[40:43], a[136:139], v[92:95], 0
ds_read_b64_tr_b16 a[150:151], v2 offset:55296
v_add_f32 v140, v140, v147
v_cvt_pk_bf16_f32 v105, v146, v147
v_mfma_f32_16x16x32_bf16 a[72:75], a[136:139], v[96:99], 0
v_exp_f32 v144, v64
v_mfma_f32_16x16x32_bf16 a[104:107], a[136:139], v[100:103], 0
v_exp_f32 v145, v65
s_waitcnt lgkmcnt(4)
v_mfma_f32_16x16x32_bf16 a[12:15], a[140:143], v[88:91], 0
ds_read_b64_tr_b16 a[152:153], v1 offset:52224
v_exp_f32 v146, v66
v_mfma_f32_16x16x32_bf16 a[44:47], a[140:143], v[92:95], 0
ds_read_b64_tr_b16 a[154:155], v1 offset:56320
v_exp_f32 v147, v67
v_mfma_f32_16x16x32_bf16 a[76:79], a[140:143], v[96:99], 0
v_add_f32 v141, v144, v145
v_cvt_pk_bf16_f32 v108, v144, v145
v_mfma_f32_16x16x32_bf16 a[108:111], a[140:143], v[100:103], 0
v_add_f32 v141, v141, v146
s_waitcnt lgkmcnt(4)
v_mfma_f32_16x16x32_bf16 a[16:19], a[144:147], v[88:91], 0
ds_read_b64_tr_b16 a[156:157], v2 offset:52224
v_add_f32 v141, v141, v147
v_mfma_f32_16x16x32_bf16 a[48:51], a[144:147], v[92:95], 0
ds_read_b64_tr_b16 a[158:159], v2 offset:56320
v_cvt_pk_bf16_f32 v109, v146, v147
v_exp_f32 v144, v72
v_mfma_f32_16x16x32_bf16 a[80:83], a[144:147], v[96:99], 0
v_exp_f32 v145, v73
v_mfma_f32_16x16x32_bf16 a[112:115], a[144:147], v[100:103], 0
v_exp_f32 v146, v74
s_waitcnt lgkmcnt(4)
v_mfma_f32_16x16x32_bf16 a[20:23], a[148:151], v[88:91], 0
s_waitcnt vmcnt(9)
s_barrier
ds_read_b128 a[128:131], v6
v_mfma_f32_16x16x32_bf16 a[52:55], a[148:151], v[92:95], 0
v_exp_f32 v147, v75
v_mfma_f32_16x16x32_bf16 a[84:87], a[148:151], v[96:99], 0
v_add_f32 v142, v144, v145
v_cvt_pk_bf16_f32 v112, v144, v145
v_mfma_f32_16x16x32_bf16 a[116:119], a[148:151], v[100:103], 0
v_add_f32 v142, v142, v146
v_add_f32 v142, v142, v147
s_waitcnt lgkmcnt(3)
v_mfma_f32_16x16x32_bf16 a[24:27], a[152:155], v[88:91], 0
s_add_u32 m0, s23, 0
s_add_u32 s30, s25, 49152
buffer_load_dwordx4 v14, s[8:11], s30 offen lds
ds_read_b128 a[132:135], v6 offset:1024
v_cvt_pk_bf16_f32 v113, v146, v147
v_exp_f32 v144, v80
v_mfma_f32_16x16x32_bf16 a[56:59], a[152:155], v[92:95], 0
buffer_load_dword a166, v23, s[12:15], s100 offen offset:512
v_mfma_f32_16x16x32_bf16 a[88:91], a[152:155], v[96:99], 0
v_exp_f32 v145, v81
v_mfma_f32_16x16x32_bf16 a[120:123], a[152:155], v[100:103], 0
v_exp_f32 v146, v82
s_waitcnt lgkmcnt(2)
v_mfma_f32_16x16x32_bf16 a[28:31], a[156:159], v[88:91], 0
ds_read_b128 a[136:139], v6 offset:2048
v_exp_f32 v147, v83
v_mfma_f32_16x16x32_bf16 a[60:63], a[156:159], v[92:95], 0
v_add_f32 v143, v144, v145
v_cvt_pk_bf16_f32 v116, v144, v145
v_mfma_f32_16x16x32_bf16 a[92:95], a[156:159], v[96:99], 0
v_add_f32 v143, v143, v146
v_add_f32 v143, v143, v147
v_mfma_f32_16x16x32_bf16 a[124:127], a[156:159], v[100:103], 0
v_cvt_pk_bf16_f32 v117, v146, v147
s_waitcnt lgkmcnt(2)
v_mfma_f32_16x16x32_bf16 v[24:27], a[128:131], v[152:155], v[120:123]
ds_read_b128 a[140:143], v6 offset:3072
v_exp_f32 v148, v60
v_mfma_f32_16x16x32_bf16 v[32:35], a[128:131], v[168:171], v[124:127]
v_exp_f32 v149, v61
v_mfma_f32_16x16x32_bf16 v[40:43], a[128:131], v[184:187], v[128:131]
v_exp_f32 v150, v62
v_mfma_f32_16x16x32_bf16 v[48:51], a[128:131], v[216:219], v[132:135]
v_exp_f32 v151, v63
s_waitcnt lgkmcnt(2)
v_mfma_f32_16x16x32_bf16 v[24:27], a[132:135], v[156:159], v[24:27]
buffer_load_dwordx4 v15, s[8:11], s30 offen offset:1024 lds
ds_read_b128 a[144:147], v6 offset:4096
v_add_f32 v140, v140, v148
v_mfma_f32_16x16x32_bf16 v[32:35], a[132:135], v[172:175], v[32:35]
v_add_f32 v140, v140, v149
v_cvt_pk_bf16_f32 v106, v148, v149
v_mfma_f32_16x16x32_bf16 v[40:43], a[132:135], v[188:191], v[40:43]
v_add_f32 v140, v140, v150
v_add_f32 v140, v140, v151
v_mfma_f32_16x16x32_bf16 v[48:51], a[132:135], v[220:223], v[48:51]
v_cvt_pk_bf16_f32 v107, v150, v151
v_exp_f32 v148, v68
s_waitcnt lgkmcnt(2)
v_mfma_f32_16x16x32_bf16 v[24:27], a[136:139], v[160:163], v[24:27]
ds_read_b128 a[148:151], v6 offset:5120
v_mfma_f32_16x16x32_bf16 v[32:35], a[136:139], v[176:179], v[32:35]
v_exp_f32 v149, v69
v_mfma_f32_16x16x32_bf16 v[40:43], a[136:139], v[192:195], v[40:43]
v_exp_f32 v150, v70
v_mfma_f32_16x16x32_bf16 v[48:51], a[136:139], v[224:227], v[48:51]
v_exp_f32 v151, v71
s_waitcnt lgkmcnt(2)
v_mfma_f32_16x16x32_bf16 v[24:27], a[140:143], v[164:167], v[24:27]
ds_read_b128 a[152:155], v6 offset:6144
v_add_f32 v141, v141, v148
v_add_f32 v141, v141, v149
v_mfma_f32_16x16x32_bf16 v[32:35], a[140:143], v[180:183], v[32:35]
v_cvt_pk_bf16_f32 v110, v148, v149
v_add_f32 v141, v141, v150
v_mfma_f32_16x16x32_bf16 v[40:43], a[140:143], v[196:199], v[40:43]
v_add_f32 v141, v141, v151
v_cvt_pk_bf16_f32 v111, v150, v151
v_mfma_f32_16x16x32_bf16 v[48:51], a[140:143], v[228:231], v[48:51]
v_exp_f32 v148, v76
s_waitcnt lgkmcnt(2)
v_mfma_f32_16x16x32_bf16 v[28:31], a[144:147], v[152:155], v[120:123]
ds_read_b128 a[156:159], v6 offset:7168
v_exp_f32 v149, v77
v_mfma_f32_16x16x32_bf16 v[36:39], a[144:147], v[168:171], v[124:127]
buffer_load_dwordx4 v16, s[8:11], s30 offen offset:2048 lds
v_exp_f32 v150, v78
v_mfma_f32_16x16x32_bf16 v[44:47], a[144:147], v[184:187], v[128:131]
v_exp_f32 v151, v79
v_mfma_f32_16x16x32_bf16 v[52:55], a[144:147], v[216:219], v[132:135]
v_add_f32 v142, v142, v148
s_waitcnt lgkmcnt(2)
v_mfma_f32_16x16x32_bf16 v[28:31], a[148:151], v[156:159], v[28:31]
ds_read_b64_tr_b16 a[128:129], v1 offset:57344
v_add_f32 v142, v142, v149
v_mfma_f32_16x16x32_bf16 v[36:39], a[148:151], v[172:175], v[36:39]
ds_read_b64_tr_b16 a[130:131], v1 offset:61440
v_cvt_pk_bf16_f32 v114, v148, v149
v_add_f32 v142, v142, v150
v_mfma_f32_16x16x32_bf16 v[44:47], a[148:151], v[188:191], v[44:47]
v_add_f32 v142, v142, v151
v_cvt_pk_bf16_f32 v115, v150, v151
v_mfma_f32_16x16x32_bf16 v[52:55], a[148:151], v[220:223], v[52:55]
v_exp_f32 v148, v84
s_waitcnt lgkmcnt(3)
v_mfma_f32_16x16x32_bf16 v[28:31], a[152:155], v[160:163], v[28:31]
ds_read_b64_tr_b16 a[132:133], v2 offset:57344
v_exp_f32 v149, v85
v_mfma_f32_16x16x32_bf16 v[36:39], a[152:155], v[176:179], v[36:39]
ds_read_b64_tr_b16 a[134:135], v2 offset:61440
v_exp_f32 v150, v86
v_mfma_f32_16x16x32_bf16 v[44:47], a[152:155], v[192:195], v[44:47]
v_exp_f32 v151, v87
v_mfma_f32_16x16x32_bf16 v[52:55], a[152:155], v[224:227], v[52:55]
v_add_f32 v143, v143, v148
s_waitcnt lgkmcnt(4)
v_mfma_f32_16x16x32_bf16 v[28:31], a[156:159], v[164:167], v[28:31]
ds_read_b64_tr_b16 a[136:137], v1 offset:58368
v_add_f32 v143, v143, v149
v_mfma_f32_16x16x32_bf16 v[36:39], a[156:159], v[180:183], v[36:39]
buffer_load_dwordx4 v17, s[8:11], s30 offen offset:3072 lds
ds_read_b64_tr_b16 a[138:139], v1 offset:62464
v_cvt_pk_bf16_f32 v118, v148, v149
v_add_f32 v143, v143, v150
v_mfma_f32_16x16x32_bf16 v[44:47], a[156:159], v[196:199], v[44:47]
v_add_f32 v143, v143, v151
v_cvt_pk_bf16_f32 v119, v150, v151
v_max3_f32 v144, v140, v141, v142
v_max_f32 v144, v144, v143
v_cmp_lt_f32 vcc, s29, v144
v_mfma_f32_16x16x32_bf16 v[52:55], a[156:159], v[228:231], v[52:55]
s_nop 0
s_cbranch_vccnz K1_STUB1
K1_BACK1:
s_waitcnt lgkmcnt(4)
v_mfma_f32_16x16x32_bf16 a[0:3], a[128:131], v[104:107], a[0:3]
ds_read_b64_tr_b16 a[140:141], v2 offset:58368
v_add_f32 v136, v136, v140
v_mfma_f32_16x16x32_bf16 a[32:35], a[128:131], v[108:111], a[32:35]
ds_read_b64_tr_b16 a[142:143], v2 offset:62464
v_add_f32 v137, v137, v141
v_mfma_f32_16x16x32_bf16 a[64:67], a[128:131], v[112:115], a[64:67]
v_add_f32 v138, v138, v142
v_add_f32 v139, v139, v143
v_mfma_f32_16x16x32_bf16 a[96:99], a[128:131], v[116:119], a[96:99]
v_exp_f32 v144, v24
s_waitcnt lgkmcnt(4)
v_mfma_f32_16x16x32_bf16 a[4:7], a[132:135], v[104:107], a[4:7]
ds_read_b64_tr_b16 a[144:145], v1 offset:59392
v_exp_f32 v145, v25
v_mfma_f32_16x16x32_bf16 a[36:39], a[132:135], v[108:111], a[36:39]
ds_read_b64_tr_b16 a[146:147], v1 offset:63488
v_exp_f32 v146, v26
v_mfma_f32_16x16x32_bf16 a[68:71], a[132:135], v[112:115], a[68:71]
v_exp_f32 v147, v27
v_mfma_f32_16x16x32_bf16 a[100:103], a[132:135], v[116:119], a[100:103]
v_add_f32 v140, v144, v145
s_waitcnt lgkmcnt(4)
v_mfma_f32_16x16x32_bf16 a[8:11], a[136:139], v[104:107], a[8:11]
ds_read_b64_tr_b16 a[148:149], v2 offset:59392
v_cvt_pk_bf16_f32 v88, v144, v145
v_add_f32 v140, v140, v146
v_mfma_f32_16x16x32_bf16 a[40:43], a[136:139], v[108:111], a[40:43]
ds_read_b64_tr_b16 a[150:151], v2 offset:63488
v_add_f32 v140, v140, v147
v_cvt_pk_bf16_f32 v89, v146, v147
v_mfma_f32_16x16x32_bf16 a[72:75], a[136:139], v[112:115], a[72:75]
s_add_u32 m0, s23, 4096
s_add_u32 s31, s25, 53248
buffer_load_dwordx4 v14, s[8:11], s31 offen lds
v_exp_f32 v144, v32
v_mfma_f32_16x16x32_bf16 a[104:107], a[136:139], v[116:119], a[104:107]
v_exp_f32 v145, v33
s_waitcnt lgkmcnt(4)
v_mfma_f32_16x16x32_bf16 a[12:15], a[140:143], v[104:107], a[12:15]
ds_read_b64_tr_b16 a[152:153], v1 offset:60416
v_exp_f32 v146, v34
v_mfma_f32_16x16x32_bf16 a[44:47], a[140:143], v[108:111], a[44:47]
ds_read_b64_tr_b16 a[154:155], v1 offset:64512
v_exp_f32 v147, v35
v_mfma_f32_16x16x32_bf16 a[76:79], a[140:143], v[112:115], a[76:79]
v_add_f32 v141, v144, v145
v_cvt_pk_bf16_f32 v92, v144, v145
v_mfma_f32_16x16x32_bf16 a[108:111], a[140:143], v[116:119], a[108:111]
v_add_f32 v141, v141, v146
s_waitcnt lgkmcnt(4)
v_mfma_f32_16x16x32_bf16 a[16:19], a[144:147], v[104:107], a[16:19]
ds_read_b64_tr_b16 a[156:157], v2 offset:60416
v_add_f32 v141, v141, v147
v_mfma_f32_16x16x32_bf16 a[48:51], a[144:147], v[108:111], a[48:51]
ds_read_b64_tr_b16 a[158:159], v2 offset:64512
v_cvt_pk_bf16_f32 v93, v146, v147
v_exp_f32 v144, v40
v_mfma_f32_16x16x32_bf16 a[80:83], a[144:147], v[112:115], a[80:83]
v_exp_f32 v145, v41
v_mfma_f32_16x16x32_bf16 a[112:115], a[144:147], v[116:119], a[112:115]
v_exp_f32 v146, v42
s_waitcnt lgkmcnt(4)
v_mfma_f32_16x16x32_bf16 a[20:23], a[148:151], v[104:107], a[20:23]
ds_read_b128 a[128:131], v6 offset:8192
v_mfma_f32_16x16x32_bf16 a[52:55], a[148:151], v[108:111], a[52:55]
v_exp_f32 v147, v43
v_mfma_f32_16x16x32_bf16 a[84:87], a[148:151], v[112:115], a[84:87]
buffer_load_dwordx4 v15, s[8:11], s31 offen offset:1024 lds
v_add_f32 v142, v144, v145
v_cvt_pk_bf16_f32 v96, v144, v145
v_mfma_f32_16x16x32_bf16 a[116:119], a[148:151], v[116:119], a[116:119]
v_add_f32 v142, v142, v146
v_add_f32 v142, v142, v147
s_waitcnt lgkmcnt(3)
v_mfma_f32_16x16x32_bf16 a[24:27], a[152:155], v[104:107], a[24:27]
ds_read_b128 a[132:135], v6 offset:9216
v_cvt_pk_bf16_f32 v97, v146, v147
v_exp_f32 v144, v48
v_mfma_f32_16x16x32_bf16 a[56:59], a[152:155], v[108:111], a[56:59]
v_exp_f32 v145, v49
v_mfma_f32_16x16x32_bf16 a[88:91], a[152:155], v[112:115], a[88:91]
v_exp_f32 v146, v50
v_mfma_f32_16x16x32_bf16 a[120:123], a[152:155], v[116:119], a[120:123]
s_waitcnt lgkmcnt(2)
v_mfma_f32_16x16x32_bf16 a[28:31], a[156:159], v[104:107], a[28:31]
ds_read_b128 a[136:139], v6 offset:10240
v_exp_f32 v147, v51
v_mfma_f32_16x16x32_bf16 a[60:63], a[156:159], v[108:111], a[60:63]
v_add_f32 v143, v144, v145
v_cvt_pk_bf16_f32 v100, v144, v145
v_mfma_f32_16x16x32_bf16 a[92:95], a[156:159], v[112:115], a[92:95]
v_add_f32 v143, v143, v146
v_add_f32 v143, v143, v147
v_mfma_f32_16x16x32_bf16 a[124:127], a[156:159], v[116:119], a[124:127]
v_cvt_pk_bf16_f32 v101, v146, v147
s_waitcnt lgkmcnt(2)
v_mfma_f32_16x16x32_bf16 v[56:59], a[128:131], v[152:155], v[120:123]
ds_read_b128 a[140:143], v6 offset:11264
v_exp_f32 v148, v28
v_mfma_f32_16x16x32_bf16 v[64:67], a[128:131], v[168:171], v[124:127]
v_exp_f32 v149, v29
v_mfma_f32_16x16x32_bf16 v[72:75], a[128:131], v[184:187], v[128:131]
v_exp_f32 v150, v30
v_mfma_f32_16x16x32_bf16 v[80:83], a[128:131], v[216:219], v[132:135]
buffer_load_dwordx4 v16, s[8:11], s31 offen offset:2048 lds
v_exp_f32 v151, v31
s_waitcnt lgkmcnt(2)
v_mfma_f32_16x16x32_bf16 v[56:59], a[132:135], v[156:159], v[56:59]
ds_read_b128 a[144:147], v6 offset:12288
v_add_f32 v140, v140, v148
v_mfma_f32_16x16x32_bf16 v[64:67], a[132:135], v[172:175], v[64:67]
v_add_f32 v140, v140, v149
v_cvt_pk_bf16_f32 v90, v148, v149
v_mfma_f32_16x16x32_bf16 v[72:75], a[132:135], v[188:191], v[72:75]
v_add_f32 v140, v140, v150
v_add_f32 v140, v140, v151
v_mfma_f32_16x16x32_bf16 v[80:83], a[132:135], v[220:223], v[80:83]
v_cvt_pk_bf16_f32 v91, v150, v151
v_exp_f32 v148, v36
s_waitcnt lgkmcnt(2)
v_mfma_f32_16x16x32_bf16 v[56:59], a[136:139], v[160:163], v[56:59]
ds_read_b128 a[148:151], v6 offset:13312
v_mfma_f32_16x16x32_bf16 v[64:67], a[136:139], v[176:179], v[64:67]
v_exp_f32 v149, v37
v_mfma_f32_16x16x32_bf16 v[72:75], a[136:139], v[192:195], v[72:75]
v_exp_f32 v150, v38
v_mfma_f32_16x16x32_bf16 v[80:83], a[136:139], v[224:227], v[80:83]
v_exp_f32 v151, v39
s_waitcnt lgkmcnt(2)
v_mfma_f32_16x16x32_bf16 v[56:59], a[140:143], v[164:167], v[56:59]
ds_read_b128 a[152:155], v6 offset:14336
v_add_f32 v141, v141, v148
v_add_f32 v141, v141, v149
v_mfma_f32_16x16x32_bf16 v[64:67], a[140:143], v[180:183], v[64:67]
v_cvt_pk_bf16_f32 v94, v148, v149
v_add_f32 v141, v141, v150
v_mfma_f32_16x16x32_bf16 v[72:75], a[140:143], v[196:199], v[72:75]
v_add_f32 v141, v141, v151
buffer_load_dwordx4 v17, s[8:11], s31 offen offset:3072 lds
v_mfma_f32_16x16x32_bf16 v[80:83], a[140:143], v[228:231], v[80:83]
v_cvt_pk_bf16_f32 v95, v150, v151
v_exp_f32 v148, v44
s_waitcnt lgkmcnt(2)
v_mfma_f32_16x16x32_bf16 v[60:63], a[144:147], v[152:155], v[120:123]
ds_read_b128 a[156:159], v6 offset:15360
v_exp_f32 v149, v45
v_mfma_f32_16x16x32_bf16 v[68:71], a[144:147], v[168:171], v[124:127]
v_exp_f32 v150, v46
v_mfma_f32_16x16x32_bf16 v[76:79], a[144:147], v[184:187], v[128:131]
v_exp_f32 v151, v47
v_mfma_f32_16x16x32_bf16 v[84:87], a[144:147], v[216:219], v[132:135]
v_add_f32 v142, v142, v148
s_waitcnt lgkmcnt(2)
v_mfma_f32_16x16x32_bf16 v[60:63], a[148:151], v[156:159], v[60:63]
ds_read_b64_tr_b16 a[128:129], v3 offset:16384
v_add_f32 v142, v142, v149
v_mfma_f32_16x16x32_bf16 v[68:71], a[148:151], v[172:175], v[68:71]
ds_read_b64_tr_b16 a[130:131], v3 offset:20480
v_cvt_pk_bf16_f32 v98, v148, v149
v_add_f32 v142, v142, v150
v_mfma_f32_16x16x32_bf16 v[76:79], a[148:151], v[188:191], v[76:79]
v_add_f32 v142, v142, v151
v_cvt_pk_bf16_f32 v99, v150, v151
v_mfma_f32_16x16x32_bf16 v[84:87], a[148:151], v[220:223], v[84:87]
v_exp_f32 v148, v52
s_waitcnt lgkmcnt(3)
v_mfma_f32_16x16x32_bf16 v[60:63], a[152:155], v[160:163], v[60:63]
ds_read_b64_tr_b16 a[132:133], v4 offset:16384
v_exp_f32 v149, v53
v_mfma_f32_16x16x32_bf16 v[68:71], a[152:155], v[176:179], v[68:71]
ds_read_b64_tr_b16 a[134:135], v4 offset:20480
v_exp_f32 v150, v54
v_mfma_f32_16x16x32_bf16 v[76:79], a[152:155], v[192:195], v[76:79]
v_exp_f32 v151, v55
v_mfma_f32_16x16x32_bf16 v[84:87], a[152:155], v[224:227], v[84:87]
v_add_f32 v143, v143, v148
s_waitcnt lgkmcnt(4)
v_mfma_f32_16x16x32_bf16 v[60:63], a[156:159], v[164:167], v[60:63]
ds_read_b64_tr_b16 a[136:137], v3 offset:17408
v_add_f32 v143, v143, v149
v_mfma_f32_16x16x32_bf16 v[68:71], a[156:159], v[180:183], v[68:71]
ds_read_b64_tr_b16 a[138:139], v3 offset:21504
v_cvt_pk_bf16_f32 v102, v148, v149
v_add_f32 v143, v143, v150
v_mfma_f32_16x16x32_bf16 v[76:79], a[156:159], v[196:199], v[76:79]
v_add_f32 v143, v143, v151
v_cvt_pk_bf16_f32 v103, v150, v151
v_max3_f32 v144, v140, v141, v142
v_max_f32 v144, v144, v143
v_cmp_lt_f32 vcc, s29, v144
v_mfma_f32_16x16x32_bf16 v[84:87], a[156:159], v[228:231], v[84:87]
s_nop 0
s_cbranch_vccnz K1_STUB2
K1_BACK2:
s_waitcnt lgkmcnt(4)
v_mfma_f32_16x16x32_bf16 a[0:3], a[128:131], v[88:91], a[0:3]
ds_read_b64_tr_b16 a[140:141], v4 offset:17408
v_add_f32 v136, v136, v140
v_mfma_f32_16x16x32_bf16 a[32:35], a[128:131], v[92:95], a[32:35]
ds_read_b64_tr_b16 a[142:143], v4 offset:21504
v_add_f32 v137, v137, v141
v_mfma_f32_16x16x32_bf16 a[64:67], a[128:131], v[96:99], a[64:67]
v_add_f32 v138, v138, v142
v_add_f32 v139, v139, v143
v_mfma_f32_16x16x32_bf16 a[96:99], a[128:131], v[100:103], a[96:99]
v_exp_f32 v144, v56
s_waitcnt lgkmcnt(4)
v_mfma_f32_16x16x32_bf16 a[4:7], a[132:135], v[88:91], a[4:7]
ds_read_b64_tr_b16 a[144:145], v3 offset:18432
v_exp_f32 v145, v57
v_mfma_f32_16x16x32_bf16 a[36:39], a[132:135], v[92:95], a[36:39]
ds_read_b64_tr_b16 a[146:147], v3 offset:22528
v_exp_f32 v146, v58
v_mfma_f32_16x16x32_bf16 a[68:71], a[132:135], v[96:99], a[68:71]
v_exp_f32 v147, v59
v_mfma_f32_16x16x32_bf16 a[100:103], a[132:135], v[100:103], a[100:103]
v_add_f32 v140, v144, v145
s_waitcnt lgkmcnt(4)
v_mfma_f32_16x16x32_bf16 a[8:11], a[136:139], v[88:91], a[8:11]
ds_read_b64_tr_b16 a[148:149], v4 offset:18432
v_cvt_pk_bf16_f32 v104, v144, v145
v_add_f32 v140, v140, v146
v_mfma_f32_16x16x32_bf16 a[40:43], a[136:139], v[92:95], a[40:43]
ds_read_b64_tr_b16 a[150:151], v4 offset:22528
v_add_f32 v140, v140, v147
v_cvt_pk_bf16_f32 v105, v146, v147
v_mfma_f32_16x16x32_bf16 a[72:75], a[136:139], v[96:99], a[72:75]
v_exp_f32 v144, v64
v_mfma_f32_16x16x32_bf16 a[104:107], a[136:139], v[100:103], a[104:107]
v_exp_f32 v145, v65
s_waitcnt lgkmcnt(4)
v_mfma_f32_16x16x32_bf16 a[12:15], a[140:143], v[88:91], a[12:15]
ds_read_b64_tr_b16 a[152:153], v3 offset:19456
v_exp_f32 v146, v66
v_mfma_f32_16x16x32_bf16 a[44:47], a[140:143], v[92:95], a[44:47]
ds_read_b64_tr_b16 a[154:155], v3 offset:23552
v_exp_f32 v147, v67
v_mfma_f32_16x16x32_bf16 a[76:79], a[140:143], v[96:99], a[76:79]
v_add_f32 v141, v144, v145
v_cvt_pk_bf16_f32 v108, v144, v145
v_mfma_f32_16x16x32_bf16 a[108:111], a[140:143], v[100:103], a[108:111]
v_add_f32 v141, v141, v146
s_waitcnt lgkmcnt(4)
v_mfma_f32_16x16x32_bf16 a[16:19], a[144:147], v[88:91], a[16:19]
ds_read_b64_tr_b16 a[156:157], v4 offset:19456
v_add_f32 v141, v141, v147
v_mfma_f32_16x16x32_bf16 a[48:51], a[144:147], v[92:95], a[48:51]
ds_read_b64_tr_b16 a[158:159], v4 offset:23552
v_cvt_pk_bf16_f32 v109, v146, v147
v_exp_f32 v144, v72
v_mfma_f32_16x16x32_bf16 a[80:83], a[144:147], v[96:99], a[80:83]
v_exp_f32 v145, v73
v_mfma_f32_16x16x32_bf16 a[112:115], a[144:147], v[100:103], a[112:115]
v_exp_f32 v146, v74
s_waitcnt lgkmcnt(4)
v_mfma_f32_16x16x32_bf16 a[20:23], a[148:151], v[88:91], a[20:23]
s_waitcnt vmcnt(9)
s_barrier
ds_read_b128 a[128:131], v6 offset:32768
v_mfma_f32_16x16x32_bf16 a[52:55], a[148:151], v[92:95], a[52:55]
v_exp_f32 v147, v75
v_mfma_f32_16x16x32_bf16 a[84:87], a[148:151], v[96:99], a[84:87]
v_add_f32 v142, v144, v145
v_cvt_pk_bf16_f32 v112, v144, v145
v_mfma_f32_16x16x32_bf16 a[116:119], a[148:151], v[100:103], a[116:119]
v_add_f32 v142, v142, v146
v_add_f32 v142, v142, v147
s_waitcnt lgkmcnt(3)
v_mfma_f32_16x16x32_bf16 a[24:27], a[152:155], v[88:91], a[24:27]
s_add_u32 m0, s23, 32768
s_add_u32 s30, s25, 65536
buffer_load_dwordx4 v14, s[8:11], s30 offen lds
ds_read_b128 a[132:135], v6 offset:33792
v_cvt_pk_bf16_f32 v113, v146, v147
v_exp_f32 v144, v80
v_mfma_f32_16x16x32_bf16 a[56:59], a[152:155], v[92:95], a[56:59]
v_exp_f32 v145, v81
v_mfma_f32_16x16x32_bf16 a[88:91], a[152:155], v[96:99], a[88:91]
v_exp_f32 v146, v82
v_mfma_f32_16x16x32_bf16 a[120:123], a[152:155], v[100:103], a[120:123]
s_waitcnt lgkmcnt(2)
v_mfma_f32_16x16x32_bf16 a[28:31], a[156:159], v[88:91], a[28:31]
ds_read_b128 a[136:139], v6 offset:34816
v_exp_f32 v147, v83
v_mfma_f32_16x16x32_bf16 a[60:63], a[156:159], v[92:95], a[60:63]
v_add_f32 v143, v144, v145
v_cvt_pk_bf16_f32 v116, v144, v145
v_mfma_f32_16x16x32_bf16 a[92:95], a[156:159], v[96:99], a[92:95]
v_add_f32 v143, v143, v146
v_add_f32 v143, v143, v147
v_mfma_f32_16x16x32_bf16 a[124:127], a[156:159], v[100:103], a[124:127]
s_load_dwordx4 s[88:91], s[0:1], 48
s_load_dwordx2 s[92:93], s[0:1], 64
s_waitcnt lgkmcnt(0)
s_mul_i32 s100, s2, 20736
s_mul_i32 s35, s20, 5184
s_add_u32 s100, s100, s35
v_cvt_pk_bf16_f32 v117, v146, v147
v_mfma_f32_16x16x32_bf16 v[24:27], a[128:131], v[152:155], v[120:123]
ds_read_b128 a[140:143], v6 offset:35840
v_exp_f32 v148, v60
v_mfma_f32_16x16x32_bf16 v[32:35], a[128:131], v[168:171], v[124:127]
v_exp_f32 v149, v61
v_mfma_f32_16x16x32_bf16 v[40:43], a[128:131], v[184:187], v[128:131]
v_exp_f32 v150, v62
v_mfma_f32_16x16x32_bf16 v[48:51], a[128:131], v[216:219], v[132:135]
v_exp_f32 v151, v63
v_mfma_f32_16x16x32_bf16 v[24:27], a[132:135], v[156:159], v[24:27]
buffer_load_dwordx4 v15, s[8:11], s30 offen offset:1024 lds
ds_read_b128 a[144:147], v6 offset:36864
v_add_f32 v140, v140, v148
v_mfma_f32_16x16x32_bf16 v[32:35], a[132:135], v[172:175], v[32:35]
v_add_f32 v140, v140, v149
v_cvt_pk_bf16_f32 v106, v148, v149
v_mfma_f32_16x16x32_bf16 v[40:43], a[132:135], v[188:191], v[40:43]
v_add_f32 v140, v140, v150
v_add_f32 v140, v140, v151
v_mfma_f32_16x16x32_bf16 v[48:51], a[132:135], v[220:223], v[48:51]
v_cvt_pk_bf16_f32 v107, v150, v151
v_exp_f32 v148, v68
v_mfma_f32_16x16x32_bf16 v[24:27], a[136:139], v[160:163], v[24:27]
ds_read_b128 a[148:151], v6 offset:37888
v_mfma_f32_16x16x32_bf16 v[32:35], a[136:139], v[176:179], v[32:35]
v_exp_f32 v149, v69
v_mfma_f32_16x16x32_bf16 v[40:43], a[136:139], v[192:195], v[40:43]
s_mov_b32 s96, s88
v_exp_f32 v150, v70
v_mfma_f32_16x16x32_bf16 v[48:51], a[136:139], v[224:227], v[48:51]
v_exp_f32 v151, v71
s_waitcnt lgkmcnt(2)
v_mfma_f32_16x16x32_bf16 v[24:27], a[140:143], v[164:167], v[24:27]
ds_read_b128 a[152:155], v6 offset:38912
s_mov_b32 s97, s89
v_add_f32 v141, v141, v148
v_add_f32 v141, v141, v149
v_mfma_f32_16x16x32_bf16 v[32:35], a[140:143], v[180:183], v[32:35]
v_cvt_pk_bf16_f32 v110, v148, v149
s_mov_b32 s98, 0x510000
v_mfma_f32_16x16x32_bf16 v[40:43], a[140:143], v[196:199], v[40:43]
v_add_f32 v141, v141, v150
v_add_f32 v141, v141, v151
v_mfma_f32_16x16x32_bf16 v[48:51], a[140:143], v[228:231], v[48:51]
v_cvt_pk_bf16_f32 v111, v150, v151
v_exp_f32 v148, v76
s_waitcnt lgkmcnt(2)
v_mfma_f32_16x16x32_bf16 v[28:31], a[144:147], v[152:155], v[120:123]
ds_read_b128 a[156:159], v6 offset:39936
s_mov_b32 s99, 0x20000
v_exp_f32 v149, v77
v_mfma_f32_16x16x32_bf16 v[36:39], a[144:147], v[168:171], v[124:127]
buffer_load_dwordx4 v16, s[8:11], s30 offen offset:2048 lds
v_exp_f32 v150, v78
v_mfma_f32_16x16x32_bf16 v[44:47], a[144:147], v[184:187], v[128:131]
buffer_load_dword a166, v23, s[96:99], s100 offen
v_mfma_f32_16x16x32_bf16 v[52:55], a[144:147], v[216:219], v[132:135]
v_exp_f32 v151, v79
s_waitcnt lgkmcnt(2)
v_mfma_f32_16x16x32_bf16 v[28:31], a[148:151], v[156:159], v[28:31]
ds_read_b64_tr_b16 a[128:129], v3 offset:24576
v_add_f32 v142, v142, v148
v_add_f32 v142, v142, v149
v_mfma_f32_16x16x32_bf16 v[36:39], a[148:151], v[172:175], v[36:39]
ds_read_b64_tr_b16 a[130:131], v3 offset:28672
v_cvt_pk_bf16_f32 v114, v148, v149
v_add_f32 v142, v142, v150
v_mfma_f32_16x16x32_bf16 v[44:47], a[148:151], v[188:191], v[44:47]
v_add_f32 v142, v142, v151
v_cvt_pk_bf16_f32 v115, v150, v151
v_mfma_f32_16x16x32_bf16 v[52:55], a[148:151], v[220:223], v[52:55]
v_exp_f32 v148, v84
s_waitcnt lgkmcnt(3)
v_mfma_f32_16x16x32_bf16 v[28:31], a[152:155], v[160:163], v[28:31]
ds_read_b64_tr_b16 a[132:133], v4 offset:24576
v_exp_f32 v149, v85
v_mfma_f32_16x16x32_bf16 v[36:39], a[152:155], v[176:179], v[36:39]
ds_read_b64_tr_b16 a[134:135], v4 offset:28672
v_exp_f32 v150, v86
v_mfma_f32_16x16x32_bf16 v[44:47], a[152:155], v[192:195], v[44:47]
v_exp_f32 v151, v87
v_mfma_f32_16x16x32_bf16 v[52:55], a[152:155], v[224:227], v[52:55]
v_add_f32 v143, v143, v148
s_waitcnt lgkmcnt(4)
v_mfma_f32_16x16x32_bf16 v[28:31], a[156:159], v[164:167], v[28:31]
ds_read_b64_tr_b16 a[136:137], v3 offset:25600
v_add_f32 v143, v143, v149
v_mfma_f32_16x16x32_bf16 v[36:39], a[156:159], v[180:183], v[36:39]
buffer_load_dwordx4 v17, s[8:11], s30 offen offset:3072 lds
ds_read_b64_tr_b16 a[138:139], v3 offset:29696
v_cvt_pk_bf16_f32 v118, v148, v149
v_add_f32 v143, v143, v150
v_mfma_f32_16x16x32_bf16 v[44:47], a[156:159], v[196:199], v[44:47]
v_add_f32 v143, v143, v151
v_cvt_pk_bf16_f32 v119, v150, v151
v_max3_f32 v144, v140, v141, v142
v_max_f32 v144, v144, v143
v_cmp_lt_f32 vcc, s29, v144
v_mfma_f32_16x16x32_bf16 v[52:55], a[156:159], v[228:231], v[52:55]
s_nop 0
s_cbranch_vccnz K1_STUB3
K1_BACK3:
s_waitcnt lgkmcnt(4)
v_mfma_f32_16x16x32_bf16 a[0:3], a[128:131], v[104:107], a[0:3]
ds_read_b64_tr_b16 a[140:141], v4 offset:25600
v_add_f32 v136, v136, v140
v_mfma_f32_16x16x32_bf16 a[32:35], a[128:131], v[108:111], a[32:35]
ds_read_b64_tr_b16 a[142:143], v4 offset:29696
v_add_f32 v137, v137, v141
v_mfma_f32_16x16x32_bf16 a[64:67], a[128:131], v[112:115], a[64:67]
v_add_f32 v138, v138, v142
v_add_f32 v139, v139, v143
v_mfma_f32_16x16x32_bf16 a[96:99], a[128:131], v[116:119], a[96:99]
v_exp_f32 v144, v24
s_waitcnt lgkmcnt(4)
v_mfma_f32_16x16x32_bf16 a[4:7], a[132:135], v[104:107], a[4:7]
ds_read_b64_tr_b16 a[144:145], v3 offset:26624
v_exp_f32 v145, v25
v_mfma_f32_16x16x32_bf16 a[36:39], a[132:135], v[108:111], a[36:39]
ds_read_b64_tr_b16 a[146:147], v3 offset:30720
v_exp_f32 v146, v26
v_mfma_f32_16x16x32_bf16 a[68:71], a[132:135], v[112:115], a[68:71]
v_exp_f32 v147, v27
v_mfma_f32_16x16x32_bf16 a[100:103], a[132:135], v[116:119], a[100:103]
v_add_f32 v140, v144, v145
s_waitcnt lgkmcnt(4)
v_mfma_f32_16x16x32_bf16 a[8:11], a[136:139], v[104:107], a[8:11]
ds_read_b64_tr_b16 a[148:149], v4 offset:26624
v_cvt_pk_bf16_f32 v88, v144, v145
v_add_f32 v140, v140, v146
v_mfma_f32_16x16x32_bf16 a[40:43], a[136:139], v[108:111], a[40:43]
ds_read_b64_tr_b16 a[150:151], v4 offset:30720
v_add_f32 v140, v140, v147
v_cvt_pk_bf16_f32 v89, v146, v147
v_mfma_f32_16x16x32_bf16 a[72:75], a[136:139], v[112:115], a[72:75]
s_add_u32 m0, s23, 36864
s_add_u32 s31, s25, 69632
buffer_load_dwordx4 v14, s[8:11], s31 offen lds
v_exp_f32 v144, v32
v_mfma_f32_16x16x32_bf16 a[104:107], a[136:139], v[116:119], a[104:107]
v_exp_f32 v145, v33
s_waitcnt lgkmcnt(4)
v_mfma_f32_16x16x32_bf16 a[12:15], a[140:143], v[104:107], a[12:15]
ds_read_b64_tr_b16 a[152:153], v3 offset:27648
v_exp_f32 v146, v34
v_mfma_f32_16x16x32_bf16 a[44:47], a[140:143], v[108:111], a[44:47]
ds_read_b64_tr_b16 a[154:155], v3 offset:31744
v_exp_f32 v147, v35
v_mfma_f32_16x16x32_bf16 a[76:79], a[140:143], v[112:115], a[76:79]
v_add_f32 v141, v144, v145
v_cvt_pk_bf16_f32 v92, v144, v145
v_mfma_f32_16x16x32_bf16 a[108:111], a[140:143], v[116:119], a[108:111]
v_add_f32 v141, v141, v146
s_waitcnt lgkmcnt(4)
v_mfma_f32_16x16x32_bf16 a[16:19], a[144:147], v[104:107], a[16:19]
ds_read_b64_tr_b16 a[156:157], v4 offset:27648
v_add_f32 v141, v141, v147
v_mfma_f32_16x16x32_bf16 a[48:51], a[144:147], v[108:111], a[48:51]
ds_read_b64_tr_b16 a[158:159], v4 offset:31744
v_cvt_pk_bf16_f32 v93, v146, v147
v_exp_f32 v144, v40
v_mfma_f32_16x16x32_bf16 a[80:83], a[144:147], v[112:115], a[80:83]
v_exp_f32 v145, v41
v_mfma_f32_16x16x32_bf16 a[112:115], a[144:147], v[116:119], a[112:115]
v_exp_f32 v146, v42
s_waitcnt lgkmcnt(4)
v_mfma_f32_16x16x32_bf16 a[20:23], a[148:151], v[104:107], a[20:23]
ds_read_b128 a[128:131], v6 offset:40960
v_mfma_f32_16x16x32_bf16 a[52:55], a[148:151], v[108:111], a[52:55]
v_exp_f32 v147, v43
v_mfma_f32_16x16x32_bf16 a[84:87], a[148:151], v[112:115], a[84:87]
buffer_load_dwordx4 v15, s[8:11], s31 offen offset:1024 lds
v_add_f32 v142, v144, v145
v_cvt_pk_bf16_f32 v96, v144, v145
v_mfma_f32_16x16x32_bf16 a[116:119], a[148:151], v[116:119], a[116:119]
v_add_f32 v142, v142, v146
v_add_f32 v142, v142, v147
s_waitcnt lgkmcnt(3)
v_mfma_f32_16x16x32_bf16 a[24:27], a[152:155], v[104:107], a[24:27]
ds_read_b128 a[132:135], v6 offset:41984
v_cvt_pk_bf16_f32 v97, v146, v147
v_exp_f32 v144, v48
v_mfma_f32_16x16x32_bf16 a[56:59], a[152:155], v[108:111], a[56:59]
v_exp_f32 v145, v49
v_mfma_f32_16x16x32_bf16 a[88:91], a[152:155], v[112:115], a[88:91]
v_exp_f32 v146, v50
v_mfma_f32_16x16x32_bf16 a[120:123], a[152:155], v[116:119], a[120:123]
s_waitcnt lgkmcnt(2)
v_mfma_f32_16x16x32_bf16 a[28:31], a[156:159], v[104:107], a[28:31]
ds_read_b128 a[136:139], v6 offset:43008
v_exp_f32 v147, v51
v_mfma_f32_16x16x32_bf16 a[60:63], a[156:159], v[108:111], a[60:63]
v_add_f32 v143, v144, v145
v_cvt_pk_bf16_f32 v100, v144, v145
v_mfma_f32_16x16x32_bf16 a[92:95], a[156:159], v[112:115], a[92:95]
v_add_f32 v143, v143, v146
v_add_f32 v143, v143, v147
v_mfma_f32_16x16x32_bf16 a[124:127], a[156:159], v[116:119], a[124:127]
v_cvt_pk_bf16_f32 v101, v146, v147
s_waitcnt lgkmcnt(2)
v_mfma_f32_16x16x32_bf16 v[56:59], a[128:131], v[152:155], v[120:123]
ds_read_b128 a[140:143], v6 offset:44032
v_exp_f32 v148, v28
v_mfma_f32_16x16x32_bf16 v[64:67], a[128:131], v[168:171], v[124:127]
v_exp_f32 v149, v29
v_mfma_f32_16x16x32_bf16 v[72:75], a[128:131], v[184:187], v[128:131]
v_exp_f32 v150, v30
v_mfma_f32_16x16x32_bf16 v[80:83], a[128:131], v[216:219], v[132:135]
buffer_load_dwordx4 v16, s[8:11], s31 offen offset:2048 lds
v_exp_f32 v151, v31
s_waitcnt lgkmcnt(2)
v_mfma_f32_16x16x32_bf16 v[56:59], a[132:135], v[156:159], v[56:59]
ds_read_b128 a[144:147], v6 offset:45056
v_add_f32 v140, v140, v148
v_mfma_f32_16x16x32_bf16 v[64:67], a[132:135], v[172:175], v[64:67]
v_add_f32 v140, v140, v149
v_cvt_pk_bf16_f32 v90, v148, v149
v_mfma_f32_16x16x32_bf16 v[72:75], a[132:135], v[188:191], v[72:75]
v_add_f32 v140, v140, v150
v_add_f32 v140, v140, v151
v_mfma_f32_16x16x32_bf16 v[80:83], a[132:135], v[220:223], v[80:83]
v_cvt_pk_bf16_f32 v91, v150, v151
v_exp_f32 v148, v36
s_waitcnt lgkmcnt(2)
v_mfma_f32_16x16x32_bf16 v[56:59], a[136:139], v[160:163], v[56:59]
ds_read_b128 a[148:151], v6 offset:46080
v_mfma_f32_16x16x32_bf16 v[64:67], a[136:139], v[176:179], v[64:67]
v_exp_f32 v149, v37
v_mfma_f32_16x16x32_bf16 v[72:75], a[136:139], v[192:195], v[72:75]
v_exp_f32 v150, v38
v_mfma_f32_16x16x32_bf16 v[80:83], a[136:139], v[224:227], v[80:83]
v_exp_f32 v151, v39
s_waitcnt lgkmcnt(2)
v_mfma_f32_16x16x32_bf16 v[56:59], a[140:143], v[164:167], v[56:59]
ds_read_b128 a[152:155], v6 offset:47104
v_add_f32 v141, v141, v148
v_add_f32 v141, v141, v149
v_mfma_f32_16x16x32_bf16 v[64:67], a[140:143], v[180:183], v[64:67]
v_cvt_pk_bf16_f32 v94, v148, v149
v_add_f32 v141, v141, v150
v_mfma_f32_16x16x32_bf16 v[72:75], a[140:143], v[196:199], v[72:75]
v_add_f32 v141, v141, v151
buffer_load_dwordx4 v17, s[8:11], s31 offen offset:3072 lds
v_mfma_f32_16x16x32_bf16 v[80:83], a[140:143], v[228:231], v[80:83]
v_cvt_pk_bf16_f32 v95, v150, v151
v_exp_f32 v148, v44
s_waitcnt lgkmcnt(2)
v_mfma_f32_16x16x32_bf16 v[60:63], a[144:147], v[152:155], v[120:123]
ds_read_b128 a[156:159], v6 offset:48128
v_exp_f32 v149, v45
v_mfma_f32_16x16x32_bf16 v[68:71], a[144:147], v[168:171], v[124:127]
v_exp_f32 v150, v46
v_mfma_f32_16x16x32_bf16 v[76:79], a[144:147], v[184:187], v[128:131]
v_exp_f32 v151, v47
v_mfma_f32_16x16x32_bf16 v[84:87], a[144:147], v[216:219], v[132:135]
v_add_f32 v142, v142, v148
s_waitcnt lgkmcnt(2)
v_mfma_f32_16x16x32_bf16 v[60:63], a[148:151], v[156:159], v[60:63]
ds_read_b64_tr_b16 a[128:129], v3 offset:49152
v_add_f32 v142, v142, v149
v_mfma_f32_16x16x32_bf16 v[68:71], a[148:151], v[172:175], v[68:71]
ds_read_b64_tr_b16 a[130:131], v3 offset:53248
v_cvt_pk_bf16_f32 v98, v148, v149
v_add_f32 v142, v142, v150
v_mfma_f32_16x16x32_bf16 v[76:79], a[148:151], v[188:191], v[76:79]
v_add_f32 v142, v142, v151
v_cvt_pk_bf16_f32 v99, v150, v151
v_mfma_f32_16x16x32_bf16 v[84:87], a[148:151], v[220:223], v[84:87]
v_exp_f32 v148, v52
s_waitcnt lgkmcnt(3)
v_mfma_f32_16x16x32_bf16 v[60:63], a[152:155], v[160:163], v[60:63]
ds_read_b64_tr_b16 a[132:133], v4 offset:49152
v_exp_f32 v149, v53
v_mfma_f32_16x16x32_bf16 v[68:71], a[152:155], v[176:179], v[68:71]
ds_read_b64_tr_b16 a[134:135], v4 offset:53248
v_exp_f32 v150, v54
v_mfma_f32_16x16x32_bf16 v[76:79], a[152:155], v[192:195], v[76:79]
v_exp_f32 v151, v55
v_mfma_f32_16x16x32_bf16 v[84:87], a[152:155], v[224:227], v[84:87]
v_add_f32 v143, v143, v148
s_waitcnt lgkmcnt(4)
v_mfma_f32_16x16x32_bf16 v[60:63], a[156:159], v[164:167], v[60:63]
ds_read_b64_tr_b16 a[136:137], v3 offset:50176
v_add_f32 v143, v143, v149
v_mfma_f32_16x16x32_bf16 v[68:71], a[156:159], v[180:183], v[68:71]
ds_read_b64_tr_b16 a[138:139], v3 offset:54272
v_cvt_pk_bf16_f32 v102, v148, v149
v_add_f32 v143, v143, v150
v_mfma_f32_16x16x32_bf16 v[76:79], a[156:159], v[196:199], v[76:79]
v_add_f32 v143, v143, v151
v_cvt_pk_bf16_f32 v103, v150, v151
v_max3_f32 v144, v140, v141, v142
v_max_f32 v144, v144, v143
v_cmp_lt_f32 vcc, s29, v144
v_mfma_f32_16x16x32_bf16 v[84:87], a[156:159], v[228:231], v[84:87]
s_nop 0
s_cbranch_vccnz K1_STUB4
K1_BACK4:
s_waitcnt lgkmcnt(4)
v_mfma_f32_16x16x32_bf16 a[0:3], a[128:131], v[88:91], a[0:3]
ds_read_b64_tr_b16 a[140:141], v4 offset:50176
v_add_f32 v136, v136, v140
v_mfma_f32_16x16x32_bf16 a[32:35], a[128:131], v[92:95], a[32:35]
ds_read_b64_tr_b16 a[142:143], v4 offset:54272
v_add_f32 v137, v137, v141
v_mfma_f32_16x16x32_bf16 a[64:67], a[128:131], v[96:99], a[64:67]
v_add_f32 v138, v138, v142
v_add_f32 v139, v139, v143
v_mfma_f32_16x16x32_bf16 a[96:99], a[128:131], v[100:103], a[96:99]
v_exp_f32 v144, v56
s_waitcnt lgkmcnt(4)
v_mfma_f32_16x16x32_bf16 a[4:7], a[132:135], v[88:91], a[4:7]
ds_read_b64_tr_b16 a[144:145], v3 offset:51200
v_exp_f32 v145, v57
v_mfma_f32_16x16x32_bf16 a[36:39], a[132:135], v[92:95], a[36:39]
ds_read_b64_tr_b16 a[146:147], v3 offset:55296
v_exp_f32 v146, v58
v_mfma_f32_16x16x32_bf16 a[68:71], a[132:135], v[96:99], a[68:71]
v_exp_f32 v147, v59
v_mfma_f32_16x16x32_bf16 a[100:103], a[132:135], v[100:103], a[100:103]
v_add_f32 v140, v144, v145
s_waitcnt lgkmcnt(4)
v_mfma_f32_16x16x32_bf16 a[8:11], a[136:139], v[88:91], a[8:11]
ds_read_b64_tr_b16 a[148:149], v4 offset:51200
v_cvt_pk_bf16_f32 v104, v144, v145
v_add_f32 v140, v140, v146
v_mfma_f32_16x16x32_bf16 a[40:43], a[136:139], v[92:95], a[40:43]
ds_read_b64_tr_b16 a[150:151], v4 offset:55296
v_add_f32 v140, v140, v147
v_cvt_pk_bf16_f32 v105, v146, v147
v_mfma_f32_16x16x32_bf16 a[72:75], a[136:139], v[96:99], a[72:75]
v_exp_f32 v144, v64
v_mfma_f32_16x16x32_bf16 a[104:107], a[136:139], v[100:103], a[104:107]
v_exp_f32 v145, v65
s_waitcnt lgkmcnt(4)
v_mfma_f32_16x16x32_bf16 a[12:15], a[140:143], v[88:91], a[12:15]
ds_read_b64_tr_b16 a[152:153], v3 offset:52224
v_exp_f32 v146, v66
v_mfma_f32_16x16x32_bf16 a[44:47], a[140:143], v[92:95], a[44:47]
ds_read_b64_tr_b16 a[154:155], v3 offset:56320
v_exp_f32 v147, v67
v_mfma_f32_16x16x32_bf16 a[76:79], a[140:143], v[96:99], a[76:79]
buffer_load_dword a166, v23, s[96:99], s100 offen offset:1088
v_add_f32 v141, v144, v145
v_mfma_f32_16x16x32_bf16 a[108:111], a[140:143], v[100:103], a[108:111]
v_cvt_pk_bf16_f32 v108, v144, v145
s_waitcnt lgkmcnt(4)
v_mfma_f32_16x16x32_bf16 a[16:19], a[144:147], v[88:91], a[16:19]
ds_read_b64_tr_b16 a[156:157], v4 offset:52224
v_add_f32 v141, v141, v146
v_add_f32 v141, v141, v147
v_mfma_f32_16x16x32_bf16 a[48:51], a[144:147], v[92:95], a[48:51]
ds_read_b64_tr_b16 a[158:159], v4 offset:56320
v_cvt_pk_bf16_f32 v109, v146, v147
v_exp_f32 v144, v72
v_mfma_f32_16x16x32_bf16 a[80:83], a[144:147], v[96:99], a[80:83]
v_exp_f32 v145, v73
v_mfma_f32_16x16x32_bf16 a[112:115], a[144:147], v[100:103], a[112:115]
v_exp_f32 v146, v74
s_waitcnt lgkmcnt(4)
v_mfma_f32_16x16x32_bf16 a[20:23], a[148:151], v[88:91], a[20:23]
s_waitcnt vmcnt(10)
s_barrier
ds_read_b128 a[128:131], v5
v_mfma_f32_16x16x32_bf16 a[52:55], a[148:151], v[92:95], a[52:55]
v_exp_f32 v147, v75
v_mfma_f32_16x16x32_bf16 a[84:87], a[148:151], v[96:99], a[84:87]
v_add_f32 v142, v144, v145
v_cvt_pk_bf16_f32 v112, v144, v145
v_mfma_f32_16x16x32_bf16 a[116:119], a[148:151], v[100:103], a[116:119]
v_add_f32 v142, v142, v146
v_add_f32 v142, v142, v147
s_waitcnt lgkmcnt(3)
v_mfma_f32_16x16x32_bf16 a[24:27], a[152:155], v[88:91], a[24:27]
s_add_u32 m0, s23, 65536
s_add_u32 s30, s25, 81920
buffer_load_dwordx4 v14, s[8:11], s30 offen lds
ds_read_b128 a[132:135], v5 offset:1024
v_cvt_pk_bf16_f32 v113, v146, v147
v_exp_f32 v144, v80
v_mfma_f32_16x16x32_bf16 a[56:59], a[152:155], v[92:95], a[56:59]
v_exp_f32 v145, v81
v_mfma_f32_16x16x32_bf16 a[88:91], a[152:155], v[96:99], a[88:91]
v_exp_f32 v146, v82
v_mfma_f32_16x16x32_bf16 a[120:123], a[152:155], v[100:103], a[120:123]
s_waitcnt lgkmcnt(2)
v_mfma_f32_16x16x32_bf16 a[28:31], a[156:159], v[88:91], a[28:31]
ds_read_b128 a[136:139], v5 offset:2048
v_exp_f32 v147, v83
v_mfma_f32_16x16x32_bf16 a[60:63], a[156:159], v[92:95], a[60:63]
v_add_f32 v143, v144, v145
v_cvt_pk_bf16_f32 v116, v144, v145
v_mfma_f32_16x16x32_bf16 a[92:95], a[156:159], v[96:99], a[92:95]
v_add_f32 v143, v143, v146
v_add_f32 v143, v143, v147
v_mfma_f32_16x16x32_bf16 a[124:127], a[156:159], v[100:103], a[124:127]
v_cvt_pk_bf16_f32 v117, v146, v147
s_waitcnt lgkmcnt(2)
v_mfma_f32_16x16x32_bf16 v[24:27], a[128:131], v[152:155], v[120:123]
ds_read_b128 a[140:143], v5 offset:3072
v_exp_f32 v148, v60
v_mfma_f32_16x16x32_bf16 v[32:35], a[128:131], v[168:171], v[124:127]
v_exp_f32 v149, v61
v_mfma_f32_16x16x32_bf16 v[40:43], a[128:131], v[184:187], v[128:131]
v_exp_f32 v150, v62
v_mfma_f32_16x16x32_bf16 v[48:51], a[128:131], v[216:219], v[132:135]
v_exp_f32 v151, v63
s_waitcnt lgkmcnt(2)
v_mfma_f32_16x16x32_bf16 v[24:27], a[132:135], v[156:159], v[24:27]
buffer_load_dwordx4 v15, s[8:11], s30 offen offset:1024 lds
ds_read_b128 a[144:147], v5 offset:4096
v_add_f32 v140, v140, v148
v_mfma_f32_16x16x32_bf16 v[32:35], a[132:135], v[172:175], v[32:35]
v_add_f32 v140, v140, v149
v_cvt_pk_bf16_f32 v106, v148, v149
v_mfma_f32_16x16x32_bf16 v[40:43], a[132:135], v[188:191], v[40:43]
v_add_f32 v140, v140, v150
v_add_f32 v140, v140, v151
v_mfma_f32_16x16x32_bf16 v[48:51], a[132:135], v[220:223], v[48:51]
v_cvt_pk_bf16_f32 v107, v150, v151
v_exp_f32 v148, v68
s_waitcnt lgkmcnt(2)
v_mfma_f32_16x16x32_bf16 v[24:27], a[136:139], v[160:163], v[24:27]
ds_read_b128 a[148:151], v5 offset:5120
v_mfma_f32_16x16x32_bf16 v[32:35], a[136:139], v[176:179], v[32:35]
v_exp_f32 v149, v69
v_mfma_f32_16x16x32_bf16 v[40:43], a[136:139], v[192:195], v[40:43]
v_exp_f32 v150, v70
v_mfma_f32_16x16x32_bf16 v[48:51], a[136:139], v[224:227], v[48:51]
v_exp_f32 v151, v71
s_waitcnt lgkmcnt(2)
v_mfma_f32_16x16x32_bf16 v[24:27], a[140:143], v[164:167], v[24:27]
ds_read_b128 a[152:155], v5 offset:6144
v_add_f32 v141, v141, v148
v_add_f32 v141, v141, v149
v_mfma_f32_16x16x32_bf16 v[32:35], a[140:143], v[180:183], v[32:35]
v_cvt_pk_bf16_f32 v110, v148, v149
v_add_f32 v141, v141, v150
v_mfma_f32_16x16x32_bf16 v[40:43], a[140:143], v[196:199], v[40:43]
v_add_f32 v141, v141, v151
v_cvt_pk_bf16_f32 v111, v150, v151
v_mfma_f32_16x16x32_bf16 v[48:51], a[140:143], v[228:231], v[48:51]
v_exp_f32 v148, v76
s_waitcnt lgkmcnt(2)
v_mfma_f32_16x16x32_bf16 v[28:31], a[144:147], v[152:155], v[120:123]
ds_read_b128 a[156:159], v5 offset:7168
v_exp_f32 v149, v77
v_mfma_f32_16x16x32_bf16 v[36:39], a[144:147], v[168:171], v[124:127]
buffer_load_dwordx4 v16, s[8:11], s30 offen offset:2048 lds
v_exp_f32 v150, v78
v_mfma_f32_16x16x32_bf16 v[44:47], a[144:147], v[184:187], v[128:131]
v_exp_f32 v151, v79
v_mfma_f32_16x16x32_bf16 v[52:55], a[144:147], v[216:219], v[132:135]
v_add_f32 v142, v142, v148
s_waitcnt lgkmcnt(2)
v_mfma_f32_16x16x32_bf16 v[28:31], a[148:151], v[156:159], v[28:31]
ds_read_b64_tr_b16 a[128:129], v3 offset:57344
v_add_f32 v142, v142, v149
v_mfma_f32_16x16x32_bf16 v[36:39], a[148:151], v[172:175], v[36:39]
ds_read_b64_tr_b16 a[130:131], v3 offset:61440
v_cvt_pk_bf16_f32 v114, v148, v149
v_add_f32 v142, v142, v150
v_mfma_f32_16x16x32_bf16 v[44:47], a[148:151], v[188:191], v[44:47]
v_add_f32 v142, v142, v151
v_cvt_pk_bf16_f32 v115, v150, v151
v_mfma_f32_16x16x32_bf16 v[52:55], a[148:151], v[220:223], v[52:55]
v_exp_f32 v148, v84
s_waitcnt lgkmcnt(3)
v_mfma_f32_16x16x32_bf16 v[28:31], a[152:155], v[160:163], v[28:31]
ds_read_b64_tr_b16 a[132:133], v4 offset:57344
v_exp_f32 v149, v85
v_mfma_f32_16x16x32_bf16 v[36:39], a[152:155], v[176:179], v[36:39]
ds_read_b64_tr_b16 a[134:135], v4 offset:61440
v_exp_f32 v150, v86
v_mfma_f32_16x16x32_bf16 v[44:47], a[152:155], v[192:195], v[44:47]
v_exp_f32 v151, v87
v_mfma_f32_16x16x32_bf16 v[52:55], a[152:155], v[224:227], v[52:55]
v_add_f32 v143, v143, v148
s_waitcnt lgkmcnt(4)
v_mfma_f32_16x16x32_bf16 v[28:31], a[156:159], v[164:167], v[28:31]
ds_read_b64_tr_b16 a[136:137], v3 offset:58368
v_add_f32 v143, v143, v149
v_mfma_f32_16x16x32_bf16 v[36:39], a[156:159], v[180:183], v[36:39]
buffer_load_dwordx4 v17, s[8:11], s30 offen offset:3072 lds
ds_read_b64_tr_b16 a[138:139], v3 offset:62464
v_cvt_pk_bf16_f32 v118, v148, v149
v_add_f32 v143, v143, v150
v_mfma_f32_16x16x32_bf16 v[44:47], a[156:159], v[196:199], v[44:47]
v_add_f32 v143, v143, v151
v_cvt_pk_bf16_f32 v119, v150, v151
v_max3_f32 v144, v140, v141, v142
v_max_f32 v144, v144, v143
v_cmp_lt_f32 vcc, s29, v144
v_mfma_f32_16x16x32_bf16 v[52:55], a[156:159], v[228:231], v[52:55]
s_nop 0
s_cbranch_vccnz K1_STUB5
K1_BACK5:
s_waitcnt lgkmcnt(4)
v_mfma_f32_16x16x32_bf16 a[0:3], a[128:131], v[104:107], a[0:3]
ds_read_b64_tr_b16 a[140:141], v4 offset:58368
v_add_f32 v136, v136, v140
v_mfma_f32_16x16x32_bf16 a[32:35], a[128:131], v[108:111], a[32:35]
ds_read_b64_tr_b16 a[142:143], v4 offset:62464
v_add_f32 v137, v137, v141
v_mfma_f32_16x16x32_bf16 a[64:67], a[128:131], v[112:115], a[64:67]
v_add_f32 v138, v138, v142
v_add_f32 v139, v139, v143
v_mfma_f32_16x16x32_bf16 a[96:99], a[128:131], v[116:119], a[96:99]
v_exp_f32 v144, v24
s_waitcnt lgkmcnt(4)
v_mfma_f32_16x16x32_bf16 a[4:7], a[132:135], v[104:107], a[4:7]
ds_read_b64_tr_b16 a[144:145], v3 offset:59392
v_exp_f32 v145, v25
v_mfma_f32_16x16x32_bf16 a[36:39], a[132:135], v[108:111], a[36:39]
ds_read_b64_tr_b16 a[146:147], v3 offset:63488
v_exp_f32 v146, v26
v_mfma_f32_16x16x32_bf16 a[68:71], a[132:135], v[112:115], a[68:71]
v_exp_f32 v147, v27
v_mfma_f32_16x16x32_bf16 a[100:103], a[132:135], v[116:119], a[100:103]
v_add_f32 v140, v144, v145
s_waitcnt lgkmcnt(4)
v_mfma_f32_16x16x32_bf16 a[8:11], a[136:139], v[104:107], a[8:11]
ds_read_b64_tr_b16 a[148:149], v4 offset:59392
v_cvt_pk_bf16_f32 v88, v144, v145
v_add_f32 v140, v140, v146
v_mfma_f32_16x16x32_bf16 a[40:43], a[136:139], v[108:111], a[40:43]
ds_read_b64_tr_b16 a[150:151], v4 offset:63488
v_add_f32 v140, v140, v147
v_cvt_pk_bf16_f32 v89, v146, v147
v_mfma_f32_16x16x32_bf16 a[72:75], a[136:139], v[112:115], a[72:75]
s_add_u32 m0, s23, 69632
s_add_u32 s31, s25, 86016
buffer_load_dwordx4 v14, s[8:11], s31 offen lds
v_exp_f32 v144, v32
v_mfma_f32_16x16x32_bf16 a[104:107], a[136:139], v[116:119], a[104:107]
v_exp_f32 v145, v33
s_waitcnt lgkmcnt(4)
v_mfma_f32_16x16x32_bf16 a[12:15], a[140:143], v[104:107], a[12:15]
ds_read_b64_tr_b16 a[152:153], v3 offset:60416
v_exp_f32 v146, v34
v_mfma_f32_16x16x32_bf16 a[44:47], a[140:143], v[108:111], a[44:47]
ds_read_b64_tr_b16 a[154:155], v3 offset:64512
v_exp_f32 v147, v35
v_mfma_f32_16x16x32_bf16 a[76:79], a[140:143], v[112:115], a[76:79]
v_add_f32 v141, v144, v145
v_cvt_pk_bf16_f32 v92, v144, v145
v_mfma_f32_16x16x32_bf16 a[108:111], a[140:143], v[116:119], a[108:111]
v_add_f32 v141, v141, v146
s_waitcnt lgkmcnt(4)
v_mfma_f32_16x16x32_bf16 a[16:19], a[144:147], v[104:107], a[16:19]
ds_read_b64_tr_b16 a[156:157], v4 offset:60416
v_add_f32 v141, v141, v147
v_mfma_f32_16x16x32_bf16 a[48:51], a[144:147], v[108:111], a[48:51]
ds_read_b64_tr_b16 a[158:159], v4 offset:64512
v_cvt_pk_bf16_f32 v93, v146, v147
v_exp_f32 v144, v40
v_mfma_f32_16x16x32_bf16 a[80:83], a[144:147], v[112:115], a[80:83]
v_exp_f32 v145, v41
v_mfma_f32_16x16x32_bf16 a[112:115], a[144:147], v[116:119], a[112:115]
v_exp_f32 v146, v42
s_waitcnt lgkmcnt(4)
v_mfma_f32_16x16x32_bf16 a[20:23], a[148:151], v[104:107], a[20:23]
ds_read_b128 a[128:131], v5 offset:8192
v_mfma_f32_16x16x32_bf16 a[52:55], a[148:151], v[108:111], a[52:55]
v_exp_f32 v147, v43
v_mfma_f32_16x16x32_bf16 a[84:87], a[148:151], v[112:115], a[84:87]
buffer_load_dwordx4 v15, s[8:11], s31 offen offset:1024 lds
v_add_f32 v142, v144, v145
v_cvt_pk_bf16_f32 v96, v144, v145
v_mfma_f32_16x16x32_bf16 a[116:119], a[148:151], v[116:119], a[116:119]
v_add_f32 v142, v142, v146
v_add_f32 v142, v142, v147
s_waitcnt lgkmcnt(3)
v_mfma_f32_16x16x32_bf16 a[24:27], a[152:155], v[104:107], a[24:27]
ds_read_b128 a[132:135], v5 offset:9216
v_cvt_pk_bf16_f32 v97, v146, v147
v_exp_f32 v144, v48
v_mfma_f32_16x16x32_bf16 a[56:59], a[152:155], v[108:111], a[56:59]
v_exp_f32 v145, v49
v_mfma_f32_16x16x32_bf16 a[88:91], a[152:155], v[112:115], a[88:91]
v_exp_f32 v146, v50
v_mfma_f32_16x16x32_bf16 a[120:123], a[152:155], v[116:119], a[120:123]
s_waitcnt lgkmcnt(2)
v_mfma_f32_16x16x32_bf16 a[28:31], a[156:159], v[104:107], a[28:31]
ds_read_b128 a[136:139], v5 offset:10240
v_exp_f32 v147, v51
v_mfma_f32_16x16x32_bf16 a[60:63], a[156:159], v[108:111], a[60:63]
v_add_f32 v143, v144, v145
v_cvt_pk_bf16_f32 v100, v144, v145
v_mfma_f32_16x16x32_bf16 a[92:95], a[156:159], v[112:115], a[92:95]
v_add_f32 v143, v143, v146
v_add_f32 v143, v143, v147
v_mfma_f32_16x16x32_bf16 a[124:127], a[156:159], v[116:119], a[124:127]
v_cvt_pk_bf16_f32 v101, v146, v147
s_waitcnt lgkmcnt(2)
v_mfma_f32_16x16x32_bf16 v[56:59], a[128:131], v[152:155], v[120:123]
ds_read_b128 a[140:143], v5 offset:11264
v_exp_f32 v148, v28
v_mfma_f32_16x16x32_bf16 v[64:67], a[128:131], v[168:171], v[124:127]
v_exp_f32 v149, v29
v_mfma_f32_16x16x32_bf16 v[72:75], a[128:131], v[184:187], v[128:131]
v_exp_f32 v150, v30
v_mfma_f32_16x16x32_bf16 v[80:83], a[128:131], v[216:219], v[132:135]
buffer_load_dwordx4 v16, s[8:11], s31 offen offset:2048 lds
v_exp_f32 v151, v31
s_waitcnt lgkmcnt(2)
v_mfma_f32_16x16x32_bf16 v[56:59], a[132:135], v[156:159], v[56:59]
ds_read_b128 a[144:147], v5 offset:12288
v_add_f32 v140, v140, v148
v_mfma_f32_16x16x32_bf16 v[64:67], a[132:135], v[172:175], v[64:67]
v_add_f32 v140, v140, v149
v_cvt_pk_bf16_f32 v90, v148, v149
v_mfma_f32_16x16x32_bf16 v[72:75], a[132:135], v[188:191], v[72:75]
v_add_f32 v140, v140, v150
v_add_f32 v140, v140, v151
v_mfma_f32_16x16x32_bf16 v[80:83], a[132:135], v[220:223], v[80:83]
v_cvt_pk_bf16_f32 v91, v150, v151
v_exp_f32 v148, v36
s_waitcnt lgkmcnt(2)
v_mfma_f32_16x16x32_bf16 v[56:59], a[136:139], v[160:163], v[56:59]
ds_read_b128 a[148:151], v5 offset:13312
v_mfma_f32_16x16x32_bf16 v[64:67], a[136:139], v[176:179], v[64:67]
v_exp_f32 v149, v37
v_mfma_f32_16x16x32_bf16 v[72:75], a[136:139], v[192:195], v[72:75]
v_exp_f32 v150, v38
v_mfma_f32_16x16x32_bf16 v[80:83], a[136:139], v[224:227], v[80:83]
v_exp_f32 v151, v39
s_waitcnt lgkmcnt(2)
v_mfma_f32_16x16x32_bf16 v[56:59], a[140:143], v[164:167], v[56:59]
ds_read_b128 a[152:155], v5 offset:14336
v_add_f32 v141, v141, v148
v_add_f32 v141, v141, v149
v_mfma_f32_16x16x32_bf16 v[64:67], a[140:143], v[180:183], v[64:67]
v_cvt_pk_bf16_f32 v94, v148, v149
v_add_f32 v141, v141, v150
v_mfma_f32_16x16x32_bf16 v[72:75], a[140:143], v[196:199], v[72:75]
v_add_f32 v141, v141, v151
buffer_load_dwordx4 v17, s[8:11], s31 offen offset:3072 lds
v_mfma_f32_16x16x32_bf16 v[80:83], a[140:143], v[228:231], v[80:83]
v_cvt_pk_bf16_f32 v95, v150, v151
v_exp_f32 v148, v44
s_waitcnt lgkmcnt(2)
v_mfma_f32_16x16x32_bf16 v[60:63], a[144:147], v[152:155], v[120:123]
ds_read_b128 a[156:159], v5 offset:15360
v_exp_f32 v149, v45
v_mfma_f32_16x16x32_bf16 v[68:71], a[144:147], v[168:171], v[124:127]
v_exp_f32 v150, v46
v_mfma_f32_16x16x32_bf16 v[76:79], a[144:147], v[184:187], v[128:131]
s_mov_b32 s96, s90
v_mfma_f32_16x16x32_bf16 v[84:87], a[144:147], v[216:219], v[132:135]
v_exp_f32 v151, v47
s_waitcnt lgkmcnt(2)
v_mfma_f32_16x16x32_bf16 v[60:63], a[148:151], v[156:159], v[60:63]
ds_read_b64_tr_b16 a[128:129], v1 offset:16384
s_mov_b32 s97, s91
v_add_f32 v142, v142, v148
v_add_f32 v142, v142, v149
v_mfma_f32_16x16x32_bf16 v[68:71], a[148:151], v[172:175], v[68:71]
ds_read_b64_tr_b16 a[130:131], v1 offset:20480
v_cvt_pk_bf16_f32 v98, v148, v149
v_add_f32 v142, v142, v150
v_mfma_f32_16x16x32_bf16 v[76:79], a[148:151], v[188:191], v[76:79]
s_mov_b32 s98, 0x510000
v_add_f32 v142, v142, v151
v_cvt_pk_bf16_f32 v99, v150, v151
v_mfma_f32_16x16x32_bf16 v[84:87], a[148:151], v[220:223], v[84:87]
v_exp_f32 v148, v52
s_waitcnt lgkmcnt(3)
v_mfma_f32_16x16x32_bf16 v[60:63], a[152:155], v[160:163], v[60:63]
ds_read_b64_tr_b16 a[132:133], v2 offset:16384
s_mov_b32 s99, 0x20000
v_exp_f32 v149, v53
v_mfma_f32_16x16x32_bf16 v[68:71], a[152:155], v[176:179], v[68:71]
ds_read_b64_tr_b16 a[134:135], v2 offset:20480
v_exp_f32 v150, v54
v_mfma_f32_16x16x32_bf16 v[76:79], a[152:155], v[192:195], v[76:79]
buffer_load_dword a166, v23, s[96:99], s100 offen
v_exp_f32 v151, v55
v_mfma_f32_16x16x32_bf16 v[84:87], a[152:155], v[224:227], v[84:87]
v_add_f32 v143, v143, v148
s_waitcnt lgkmcnt(4)
v_mfma_f32_16x16x32_bf16 v[60:63], a[156:159], v[164:167], v[60:63]
ds_read_b64_tr_b16 a[136:137], v1 offset:17408
v_add_f32 v143, v143, v149
v_mfma_f32_16x16x32_bf16 v[68:71], a[156:159], v[180:183], v[68:71]
ds_read_b64_tr_b16 a[138:139], v1 offset:21504
v_cvt_pk_bf16_f32 v102, v148, v149
v_add_f32 v143, v143, v150
v_mfma_f32_16x16x32_bf16 v[76:79], a[156:159], v[196:199], v[76:79]
v_add_f32 v143, v143, v151
v_cvt_pk_bf16_f32 v103, v150, v151
v_max3_f32 v144, v140, v141, v142
v_max_f32 v144, v144, v143
v_cmp_lt_f32 vcc, s29, v144
v_mfma_f32_16x16x32_bf16 v[84:87], a[156:159], v[228:231], v[84:87]
s_nop 0
s_cbranch_vccnz K1_STUB6
K1_BACK6:
s_waitcnt lgkmcnt(4)
v_mfma_f32_16x16x32_bf16 a[0:3], a[128:131], v[88:91], a[0:3]
ds_read_b64_tr_b16 a[140:141], v2 offset:17408
v_add_f32 v136, v136, v140
v_mfma_f32_16x16x32_bf16 a[32:35], a[128:131], v[92:95], a[32:35]
ds_read_b64_tr_b16 a[142:143], v2 offset:21504
v_add_f32 v137, v137, v141
v_mfma_f32_16x16x32_bf16 a[64:67], a[128:131], v[96:99], a[64:67]
v_add_f32 v138, v138, v142
v_add_f32 v139, v139, v143
v_mfma_f32_16x16x32_bf16 a[96:99], a[128:131], v[100:103], a[96:99]
v_exp_f32 v144, v56
s_waitcnt lgkmcnt(4)
v_mfma_f32_16x16x32_bf16 a[4:7], a[132:135], v[88:91], a[4:7]
ds_read_b64_tr_b16 a[144:145], v1 offset:18432
v_exp_f32 v145, v57
v_mfma_f32_16x16x32_bf16 a[36:39], a[132:135], v[92:95], a[36:39]
ds_read_b64_tr_b16 a[146:147], v1 offset:22528
v_exp_f32 v146, v58
v_mfma_f32_16x16x32_bf16 a[68:71], a[132:135], v[96:99], a[68:71]
v_exp_f32 v147, v59
v_mfma_f32_16x16x32_bf16 a[100:103], a[132:135], v[100:103], a[100:103]
v_add_f32 v140, v144, v145
s_waitcnt lgkmcnt(4)
v_mfma_f32_16x16x32_bf16 a[8:11], a[136:139], v[88:91], a[8:11]
ds_read_b64_tr_b16 a[148:149], v2 offset:18432
v_cvt_pk_bf16_f32 v104, v144, v145
v_add_f32 v140, v140, v146
v_mfma_f32_16x16x32_bf16 a[40:43], a[136:139], v[92:95], a[40:43]
ds_read_b64_tr_b16 a[150:151], v2 offset:22528
v_add_f32 v140, v140, v147
v_cvt_pk_bf16_f32 v105, v146, v147
v_mfma_f32_16x16x32_bf16 a[72:75], a[136:139], v[96:99], a[72:75]
v_exp_f32 v144, v64
v_mfma_f32_16x16x32_bf16 a[104:107], a[136:139], v[100:103], a[104:107]
v_exp_f32 v145, v65
s_waitcnt lgkmcnt(4)
v_mfma_f32_16x16x32_bf16 a[12:15], a[140:143], v[88:91], a[12:15]
ds_read_b64_tr_b16 a[152:153], v1 offset:19456
v_exp_f32 v146, v66
v_mfma_f32_16x16x32_bf16 a[44:47], a[140:143], v[92:95], a[44:47]
ds_read_b64_tr_b16 a[154:155], v1 offset:23552
v_exp_f32 v147, v67
v_mfma_f32_16x16x32_bf16 a[76:79], a[140:143], v[96:99], a[76:79]
v_add_f32 v141, v144, v145
v_cvt_pk_bf16_f32 v108, v144, v145
v_mfma_f32_16x16x32_bf16 a[108:111], a[140:143], v[100:103], a[108:111]
v_add_f32 v141, v141, v146
s_waitcnt lgkmcnt(4)
v_mfma_f32_16x16x32_bf16 a[16:19], a[144:147], v[88:91], a[16:19]
ds_read_b64_tr_b16 a[156:157], v2 offset:19456
v_add_f32 v141, v141, v147
v_mfma_f32_16x16x32_bf16 a[48:51], a[144:147], v[92:95], a[48:51]
ds_read_b64_tr_b16 a[158:159], v2 offset:23552
v_cvt_pk_bf16_f32 v109, v146, v147
v_exp_f32 v144, v72
v_mfma_f32_16x16x32_bf16 a[80:83], a[144:147], v[96:99], a[80:83]
v_exp_f32 v145, v73
v_mfma_f32_16x16x32_bf16 a[112:115], a[144:147], v[100:103], a[112:115]
v_exp_f32 v146, v74
s_waitcnt lgkmcnt(4)
v_mfma_f32_16x16x32_bf16 a[20:23], a[148:151], v[88:91], a[20:23]
s_waitcnt vmcnt(10)
s_barrier
ds_read_b128 a[128:131], v5 offset:32768
v_mfma_f32_16x16x32_bf16 a[52:55], a[148:151], v[92:95], a[52:55]
v_exp_f32 v147, v75
v_mfma_f32_16x16x32_bf16 a[84:87], a[148:151], v[96:99], a[84:87]
v_add_f32 v142, v144, v145
v_cvt_pk_bf16_f32 v112, v144, v145
v_mfma_f32_16x16x32_bf16 a[116:119], a[148:151], v[100:103], a[116:119]
v_add_f32 v142, v142, v146
v_add_f32 v142, v142, v147
s_waitcnt lgkmcnt(3)
v_mfma_f32_16x16x32_bf16 a[24:27], a[152:155], v[88:91], a[24:27]
s_add_u32 m0, s23, 98304
s_add_u32 s30, s25, 98304
buffer_load_dwordx4 v14, s[8:11], s30 offen lds
ds_read_b128 a[132:135], v5 offset:33792
v_cvt_pk_bf16_f32 v113, v146, v147
v_exp_f32 v144, v80
v_mfma_f32_16x16x32_bf16 a[56:59], a[152:155], v[92:95], a[56:59]
v_exp_f32 v145, v81
v_mfma_f32_16x16x32_bf16 a[88:91], a[152:155], v[96:99], a[88:91]
v_exp_f32 v146, v82
v_mfma_f32_16x16x32_bf16 a[120:123], a[152:155], v[100:103], a[120:123]
s_waitcnt lgkmcnt(2)
v_mfma_f32_16x16x32_bf16 a[28:31], a[156:159], v[88:91], a[28:31]
ds_read_b128 a[136:139], v5 offset:34816
v_exp_f32 v147, v83
v_mfma_f32_16x16x32_bf16 a[60:63], a[156:159], v[92:95], a[60:63]
v_add_f32 v143, v144, v145
v_cvt_pk_bf16_f32 v116, v144, v145
v_mfma_f32_16x16x32_bf16 a[92:95], a[156:159], v[96:99], a[92:95]
v_add_f32 v143, v143, v146
v_add_f32 v143, v143, v147
v_mfma_f32_16x16x32_bf16 a[124:127], a[156:159], v[100:103], a[124:127]
v_cvt_pk_bf16_f32 v117, v146, v147
s_waitcnt lgkmcnt(2)
v_mfma_f32_16x16x32_bf16 v[24:27], a[128:131], v[152:155], v[120:123]
ds_read_b128 a[140:143], v5 offset:35840
v_exp_f32 v148, v60
v_mfma_f32_16x16x32_bf16 v[32:35], a[128:131], v[168:171], v[124:127]
v_exp_f32 v149, v61
v_mfma_f32_16x16x32_bf16 v[40:43], a[128:131], v[184:187], v[128:131]
v_exp_f32 v150, v62
v_mfma_f32_16x16x32_bf16 v[48:51], a[128:131], v[216:219], v[132:135]
v_exp_f32 v151, v63
s_waitcnt lgkmcnt(2)
v_mfma_f32_16x16x32_bf16 v[24:27], a[132:135], v[156:159], v[24:27]
buffer_load_dwordx4 v15, s[8:11], s30 offen offset:1024 lds
ds_read_b128 a[144:147], v5 offset:36864
v_add_f32 v140, v140, v148
v_mfma_f32_16x16x32_bf16 v[32:35], a[132:135], v[172:175], v[32:35]
v_add_f32 v140, v140, v149
v_cvt_pk_bf16_f32 v106, v148, v149
v_mfma_f32_16x16x32_bf16 v[40:43], a[132:135], v[188:191], v[40:43]
v_add_f32 v140, v140, v150
v_add_f32 v140, v140, v151
v_mfma_f32_16x16x32_bf16 v[48:51], a[132:135], v[220:223], v[48:51]
v_cvt_pk_bf16_f32 v107, v150, v151
v_exp_f32 v148, v68
s_waitcnt lgkmcnt(2)
v_mfma_f32_16x16x32_bf16 v[24:27], a[136:139], v[160:163], v[24:27]
ds_read_b128 a[148:151], v5 offset:37888
v_mfma_f32_16x16x32_bf16 v[32:35], a[136:139], v[176:179], v[32:35]
v_exp_f32 v149, v69
v_mfma_f32_16x16x32_bf16 v[40:43], a[136:139], v[192:195], v[40:43]
v_exp_f32 v150, v70
v_mfma_f32_16x16x32_bf16 v[48:51], a[136:139], v[224:227], v[48:51]
v_exp_f32 v151, v71
s_waitcnt lgkmcnt(2)
v_mfma_f32_16x16x32_bf16 v[24:27], a[140:143], v[164:167], v[24:27]
ds_read_b128 a[152:155], v5 offset:38912
v_add_f32 v141, v141, v148
v_add_f32 v141, v141, v149
v_mfma_f32_16x16x32_bf16 v[32:35], a[140:143], v[180:183], v[32:35]
v_cvt_pk_bf16_f32 v110, v148, v149
v_add_f32 v141, v141, v150
v_mfma_f32_16x16x32_bf16 v[40:43], a[140:143], v[196:199], v[40:43]
v_add_f32 v141, v141, v151
v_cvt_pk_bf16_f32 v111, v150, v151
v_mfma_f32_16x16x32_bf16 v[48:51], a[140:143], v[228:231], v[48:51]
v_exp_f32 v148, v76
s_waitcnt lgkmcnt(2)
v_mfma_f32_16x16x32_bf16 v[28:31], a[144:147], v[152:155], v[120:123]
ds_read_b128 a[156:159], v5 offset:39936
v_exp_f32 v149, v77
v_mfma_f32_16x16x32_bf16 v[36:39], a[144:147], v[168:171], v[124:127]
buffer_load_dwordx4 v16, s[8:11], s30 offen offset:2048 lds
v_exp_f32 v150, v78
v_mfma_f32_16x16x32_bf16 v[44:47], a[144:147], v[184:187], v[128:131]
v_exp_f32 v151, v79
v_mfma_f32_16x16x32_bf16 v[52:55], a[144:147], v[216:219], v[132:135]
v_add_f32 v142, v142, v148
s_waitcnt lgkmcnt(2)
v_mfma_f32_16x16x32_bf16 v[28:31], a[148:151], v[156:159], v[28:31]
ds_read_b64_tr_b16 a[128:129], v1 offset:24576
v_add_f32 v142, v142, v149
v_mfma_f32_16x16x32_bf16 v[36:39], a[148:151], v[172:175], v[36:39]
ds_read_b64_tr_b16 a[130:131], v1 offset:28672
v_cvt_pk_bf16_f32 v114, v148, v149
v_add_f32 v142, v142, v150
v_mfma_f32_16x16x32_bf16 v[44:47], a[148:151], v[188:191], v[44:47]
v_add_f32 v142, v142, v151
v_cvt_pk_bf16_f32 v115, v150, v151
v_mfma_f32_16x16x32_bf16 v[52:55], a[148:151], v[220:223], v[52:55]
v_exp_f32 v148, v84
s_waitcnt lgkmcnt(3)
v_mfma_f32_16x16x32_bf16 v[28:31], a[152:155], v[160:163], v[28:31]
ds_read_b64_tr_b16 a[132:133], v2 offset:24576
v_exp_f32 v149, v85
v_mfma_f32_16x16x32_bf16 v[36:39], a[152:155], v[176:179], v[36:39]
ds_read_b64_tr_b16 a[134:135], v2 offset:28672
v_exp_f32 v150, v86
v_mfma_f32_16x16x32_bf16 v[44:47], a[152:155], v[192:195], v[44:47]
v_exp_f32 v151, v87
v_mfma_f32_16x16x32_bf16 v[52:55], a[152:155], v[224:227], v[52:55]
v_add_f32 v143, v143, v148
s_waitcnt lgkmcnt(4)
v_mfma_f32_16x16x32_bf16 v[28:31], a[156:159], v[164:167], v[28:31]
ds_read_b64_tr_b16 a[136:137], v1 offset:25600
v_add_f32 v143, v143, v149
v_mfma_f32_16x16x32_bf16 v[36:39], a[156:159], v[180:183], v[36:39]
buffer_load_dwordx4 v17, s[8:11], s30 offen offset:3072 lds
ds_read_b64_tr_b16 a[138:139], v1 offset:29696
v_cvt_pk_bf16_f32 v118, v148, v149
v_add_f32 v143, v143, v150
v_mfma_f32_16x16x32_bf16 v[44:47], a[156:159], v[196:199], v[44:47]
v_add_f32 v143, v143, v151
v_cvt_pk_bf16_f32 v119, v150, v151
v_max3_f32 v144, v140, v141, v142
v_max_f32 v144, v144, v143
v_cmp_lt_f32 vcc, s29, v144
v_mfma_f32_16x16x32_bf16 v[52:55], a[156:159], v[228:231], v[52:55]
s_nop 0
s_cbranch_vccnz K1_STUB7
K1_BACK7:
s_waitcnt lgkmcnt(4)
v_mfma_f32_16x16x32_bf16 a[0:3], a[128:131], v[104:107], a[0:3]
ds_read_b64_tr_b16 a[140:141], v2 offset:25600
v_add_f32 v136, v136, v140
v_mfma_f32_16x16x32_bf16 a[32:35], a[128:131], v[108:111], a[32:35]
ds_read_b64_tr_b16 a[142:143], v2 offset:29696
v_add_f32 v137, v137, v141
v_mfma_f32_16x16x32_bf16 a[64:67], a[128:131], v[112:115], a[64:67]
v_add_f32 v138, v138, v142
v_add_f32 v139, v139, v143
v_mfma_f32_16x16x32_bf16 a[96:99], a[128:131], v[116:119], a[96:99]
v_exp_f32 v144, v24
s_waitcnt lgkmcnt(4)
v_mfma_f32_16x16x32_bf16 a[4:7], a[132:135], v[104:107], a[4:7]
ds_read_b64_tr_b16 a[144:145], v1 offset:26624
v_exp_f32 v145, v25
v_mfma_f32_16x16x32_bf16 a[36:39], a[132:135], v[108:111], a[36:39]
ds_read_b64_tr_b16 a[146:147], v1 offset:30720
v_exp_f32 v146, v26
v_mfma_f32_16x16x32_bf16 a[68:71], a[132:135], v[112:115], a[68:71]
v_exp_f32 v147, v27
v_mfma_f32_16x16x32_bf16 a[100:103], a[132:135], v[116:119], a[100:103]
v_add_f32 v140, v144, v145
s_waitcnt lgkmcnt(4)
v_mfma_f32_16x16x32_bf16 a[8:11], a[136:139], v[104:107], a[8:11]
ds_read_b64_tr_b16 a[148:149], v2 offset:26624
v_cvt_pk_bf16_f32 v88, v144, v145
v_add_f32 v140, v140, v146
v_mfma_f32_16x16x32_bf16 a[40:43], a[136:139], v[108:111], a[40:43]
ds_read_b64_tr_b16 a[150:151], v2 offset:30720
v_add_f32 v140, v140, v147
v_cvt_pk_bf16_f32 v89, v146, v147
v_mfma_f32_16x16x32_bf16 a[72:75], a[136:139], v[112:115], a[72:75]
s_add_u32 m0, s23, 102400
s_add_u32 s31, s25, 102400
buffer_load_dwordx4 v14, s[8:11], s31 offen lds
v_exp_f32 v144, v32
v_mfma_f32_16x16x32_bf16 a[104:107], a[136:139], v[116:119], a[104:107]
v_exp_f32 v145, v33
s_waitcnt lgkmcnt(4)
v_mfma_f32_16x16x32_bf16 a[12:15], a[140:143], v[104:107], a[12:15]
ds_read_b64_tr_b16 a[152:153], v1 offset:27648
v_exp_f32 v146, v34
v_mfma_f32_16x16x32_bf16 a[44:47], a[140:143], v[108:111], a[44:47]
ds_read_b64_tr_b16 a[154:155], v1 offset:31744
v_exp_f32 v147, v35
v_mfma_f32_16x16x32_bf16 a[76:79], a[140:143], v[112:115], a[76:79]
v_add_f32 v141, v144, v145
v_cvt_pk_bf16_f32 v92, v144, v145
v_mfma_f32_16x16x32_bf16 a[108:111], a[140:143], v[116:119], a[108:111]
v_add_f32 v141, v141, v146
s_waitcnt lgkmcnt(4)
v_mfma_f32_16x16x32_bf16 a[16:19], a[144:147], v[104:107], a[16:19]
ds_read_b64_tr_b16 a[156:157], v2 offset:27648
v_add_f32 v141, v141, v147
v_mfma_f32_16x16x32_bf16 a[48:51], a[144:147], v[108:111], a[48:51]
ds_read_b64_tr_b16 a[158:159], v2 offset:31744
v_cvt_pk_bf16_f32 v93, v146, v147
v_exp_f32 v144, v40
v_mfma_f32_16x16x32_bf16 a[80:83], a[144:147], v[112:115], a[80:83]
v_exp_f32 v145, v41
v_mfma_f32_16x16x32_bf16 a[112:115], a[144:147], v[116:119], a[112:115]
v_exp_f32 v146, v42
s_waitcnt lgkmcnt(4)
v_mfma_f32_16x16x32_bf16 a[20:23], a[148:151], v[104:107], a[20:23]
ds_read_b128 a[128:131], v5 offset:40960
v_mfma_f32_16x16x32_bf16 a[52:55], a[148:151], v[108:111], a[52:55]
v_exp_f32 v147, v43
v_mfma_f32_16x16x32_bf16 a[84:87], a[148:151], v[112:115], a[84:87]
buffer_load_dwordx4 v15, s[8:11], s31 offen offset:1024 lds
buffer_load_dword a166, v23, s[96:99], s100 offen offset:1088
v_add_f32 v142, v144, v145
v_cvt_pk_bf16_f32 v96, v144, v145
v_mfma_f32_16x16x32_bf16 a[116:119], a[148:151], v[116:119], a[116:119]
v_add_f32 v142, v142, v146
v_add_f32 v142, v142, v147
s_waitcnt lgkmcnt(3)
v_mfma_f32_16x16x32_bf16 a[24:27], a[152:155], v[104:107], a[24:27]
ds_read_b128 a[132:135], v5 offset:41984
v_cvt_pk_bf16_f32 v97, v146, v147
v_exp_f32 v144, v48
v_mfma_f32_16x16x32_bf16 a[56:59], a[152:155], v[108:111], a[56:59]
v_exp_f32 v145, v49
v_mfma_f32_16x16x32_bf16 a[88:91], a[152:155], v[112:115], a[88:91]
v_exp_f32 v146, v50
v_mfma_f32_16x16x32_bf16 a[120:123], a[152:155], v[116:119], a[120:123]
s_waitcnt lgkmcnt(2)
v_mfma_f32_16x16x32_bf16 a[28:31], a[156:159], v[104:107], a[28:31]
ds_read_b128 a[136:139], v5 offset:43008
v_exp_f32 v147, v51
v_mfma_f32_16x16x32_bf16 a[60:63], a[156:159], v[108:111], a[60:63]
v_add_f32 v143, v144, v145
v_cvt_pk_bf16_f32 v100, v144, v145
v_mfma_f32_16x16x32_bf16 a[92:95], a[156:159], v[112:115], a[92:95]
v_add_f32 v143, v143, v146
v_add_f32 v143, v143, v147
v_mfma_f32_16x16x32_bf16 a[124:127], a[156:159], v[116:119], a[124:127]
v_cvt_pk_bf16_f32 v101, v146, v147
s_waitcnt lgkmcnt(2)
v_mfma_f32_16x16x32_bf16 v[56:59], a[128:131], v[152:155], v[120:123]
ds_read_b128 a[140:143], v5 offset:44032
v_exp_f32 v148, v28
v_mfma_f32_16x16x32_bf16 v[64:67], a[128:131], v[168:171], v[124:127]
v_exp_f32 v149, v29
v_mfma_f32_16x16x32_bf16 v[72:75], a[128:131], v[184:187], v[128:131]
v_exp_f32 v150, v30
v_mfma_f32_16x16x32_bf16 v[80:83], a[128:131], v[216:219], v[132:135]
buffer_load_dwordx4 v16, s[8:11], s31 offen offset:2048 lds
v_exp_f32 v151, v31
s_waitcnt lgkmcnt(2)
v_mfma_f32_16x16x32_bf16 v[56:59], a[132:135], v[156:159], v[56:59]
ds_read_b128 a[144:147], v5 offset:45056
v_add_f32 v140, v140, v148
v_mfma_f32_16x16x32_bf16 v[64:67], a[132:135], v[172:175], v[64:67]
v_add_f32 v140, v140, v149
v_cvt_pk_bf16_f32 v90, v148, v149
v_mfma_f32_16x16x32_bf16 v[72:75], a[132:135], v[188:191], v[72:75]
v_add_f32 v140, v140, v150
v_add_f32 v140, v140, v151
v_mfma_f32_16x16x32_bf16 v[80:83], a[132:135], v[220:223], v[80:83]
v_cvt_pk_bf16_f32 v91, v150, v151
v_exp_f32 v148, v36
s_waitcnt lgkmcnt(2)
v_mfma_f32_16x16x32_bf16 v[56:59], a[136:139], v[160:163], v[56:59]
ds_read_b128 a[148:151], v5 offset:46080
v_mfma_f32_16x16x32_bf16 v[64:67], a[136:139], v[176:179], v[64:67]
v_exp_f32 v149, v37
v_mfma_f32_16x16x32_bf16 v[72:75], a[136:139], v[192:195], v[72:75]
v_exp_f32 v150, v38
v_mfma_f32_16x16x32_bf16 v[80:83], a[136:139], v[224:227], v[80:83]
v_exp_f32 v151, v39
s_waitcnt lgkmcnt(2)
v_mfma_f32_16x16x32_bf16 v[56:59], a[140:143], v[164:167], v[56:59]
ds_read_b128 a[152:155], v5 offset:47104
v_add_f32 v141, v141, v148
v_add_f32 v141, v141, v149
v_mfma_f32_16x16x32_bf16 v[64:67], a[140:143], v[180:183], v[64:67]
v_cvt_pk_bf16_f32 v94, v148, v149
v_add_f32 v141, v141, v150
v_mfma_f32_16x16x32_bf16 v[72:75], a[140:143], v[196:199], v[72:75]
v_add_f32 v141, v141, v151
buffer_load_dwordx4 v17, s[8:11], s31 offen offset:3072 lds
v_mfma_f32_16x16x32_bf16 v[80:83], a[140:143], v[228:231], v[80:83]
v_cvt_pk_bf16_f32 v95, v150, v151
v_exp_f32 v148, v44
s_waitcnt lgkmcnt(2)
v_mfma_f32_16x16x32_bf16 v[60:63], a[144:147], v[152:155], v[120:123]
ds_read_b128 a[156:159], v5 offset:48128
v_exp_f32 v149, v45
v_mfma_f32_16x16x32_bf16 v[68:71], a[144:147], v[168:171], v[124:127]
v_exp_f32 v150, v46
v_mfma_f32_16x16x32_bf16 v[76:79], a[144:147], v[184:187], v[128:131]
v_exp_f32 v151, v47
v_mfma_f32_16x16x32_bf16 v[84:87], a[144:147], v[216:219], v[132:135]
v_add_f32 v142, v142, v148
s_waitcnt lgkmcnt(2)
v_mfma_f32_16x16x32_bf16 v[60:63], a[148:151], v[156:159], v[60:63]
ds_read_b64_tr_b16 a[128:129], v1 offset:49152
v_add_f32 v142, v142, v149
v_mfma_f32_16x16x32_bf16 v[68:71], a[148:151], v[172:175], v[68:71]
ds_read_b64_tr_b16 a[130:131], v1 offset:53248
v_cvt_pk_bf16_f32 v98, v148, v149
v_add_f32 v142, v142, v150
v_mfma_f32_16x16x32_bf16 v[76:79], a[148:151], v[188:191], v[76:79]
v_add_f32 v142, v142, v151
v_cvt_pk_bf16_f32 v99, v150, v151
v_mfma_f32_16x16x32_bf16 v[84:87], a[148:151], v[220:223], v[84:87]
v_exp_f32 v148, v52
s_waitcnt lgkmcnt(3)
v_mfma_f32_16x16x32_bf16 v[60:63], a[152:155], v[160:163], v[60:63]
ds_read_b64_tr_b16 a[132:133], v2 offset:49152
v_exp_f32 v149, v53
v_mfma_f32_16x16x32_bf16 v[68:71], a[152:155], v[176:179], v[68:71]
ds_read_b64_tr_b16 a[134:135], v2 offset:53248
v_exp_f32 v150, v54
v_mfma_f32_16x16x32_bf16 v[76:79], a[152:155], v[192:195], v[76:79]
v_exp_f32 v151, v55
v_mfma_f32_16x16x32_bf16 v[84:87], a[152:155], v[224:227], v[84:87]
v_add_f32 v143, v143, v148
s_waitcnt lgkmcnt(4)
v_mfma_f32_16x16x32_bf16 v[60:63], a[156:159], v[164:167], v[60:63]
ds_read_b64_tr_b16 a[136:137], v1 offset:50176
v_add_f32 v143, v143, v149
v_mfma_f32_16x16x32_bf16 v[68:71], a[156:159], v[180:183], v[68:71]
ds_read_b64_tr_b16 a[138:139], v1 offset:54272
v_cvt_pk_bf16_f32 v102, v148, v149
v_add_f32 v143, v143, v150
v_mfma_f32_16x16x32_bf16 v[76:79], a[156:159], v[196:199], v[76:79]
v_add_f32 v143, v143, v151
v_cvt_pk_bf16_f32 v103, v150, v151
v_max3_f32 v144, v140, v141, v142
v_max_f32 v144, v144, v143
v_cmp_lt_f32 vcc, s29, v144
v_mfma_f32_16x16x32_bf16 v[84:87], a[156:159], v[228:231], v[84:87]
s_nop 0
s_cbranch_vccnz K1_STUB8
K1_BACK8:
s_waitcnt lgkmcnt(4)
v_mfma_f32_16x16x32_bf16 a[0:3], a[128:131], v[88:91], a[0:3]
ds_read_b64_tr_b16 a[140:141], v2 offset:50176
v_add_f32 v136, v136, v140
v_mfma_f32_16x16x32_bf16 a[32:35], a[128:131], v[92:95], a[32:35]
ds_read_b64_tr_b16 a[142:143], v2 offset:54272
v_add_f32 v137, v137, v141
v_mfma_f32_16x16x32_bf16 a[64:67], a[128:131], v[96:99], a[64:67]
v_add_f32 v138, v138, v142
v_add_f32 v139, v139, v143
v_mfma_f32_16x16x32_bf16 a[96:99], a[128:131], v[100:103], a[96:99]
v_exp_f32 v144, v56
s_waitcnt lgkmcnt(4)
v_mfma_f32_16x16x32_bf16 a[4:7], a[132:135], v[88:91], a[4:7]
ds_read_b64_tr_b16 a[144:145], v1 offset:51200
v_exp_f32 v145, v57
v_mfma_f32_16x16x32_bf16 a[36:39], a[132:135], v[92:95], a[36:39]
ds_read_b64_tr_b16 a[146:147], v1 offset:55296
v_exp_f32 v146, v58
v_mfma_f32_16x16x32_bf16 a[68:71], a[132:135], v[96:99], a[68:71]
v_exp_f32 v147, v59
v_mfma_f32_16x16x32_bf16 a[100:103], a[132:135], v[100:103], a[100:103]
v_add_f32 v140, v144, v145
s_waitcnt lgkmcnt(4)
v_mfma_f32_16x16x32_bf16 a[8:11], a[136:139], v[88:91], a[8:11]
ds_read_b64_tr_b16 a[148:149], v2 offset:51200
v_cvt_pk_bf16_f32 v104, v144, v145
v_add_f32 v140, v140, v146
v_mfma_f32_16x16x32_bf16 a[40:43], a[136:139], v[92:95], a[40:43]
ds_read_b64_tr_b16 a[150:151], v2 offset:55296
v_add_f32 v140, v140, v147
v_cvt_pk_bf16_f32 v105, v146, v147
v_mfma_f32_16x16x32_bf16 a[72:75], a[136:139], v[96:99], a[72:75]
v_exp_f32 v144, v64
v_mfma_f32_16x16x32_bf16 a[104:107], a[136:139], v[100:103], a[104:107]
v_exp_f32 v145, v65
s_waitcnt lgkmcnt(4)
v_mfma_f32_16x16x32_bf16 a[12:15], a[140:143], v[88:91], a[12:15]
ds_read_b64_tr_b16 a[152:153], v1 offset:52224
v_exp_f32 v146, v66
v_mfma_f32_16x16x32_bf16 a[44:47], a[140:143], v[92:95], a[44:47]
ds_read_b64_tr_b16 a[154:155], v1 offset:56320
v_exp_f32 v147, v67
v_mfma_f32_16x16x32_bf16 a[76:79], a[140:143], v[96:99], a[76:79]
v_add_f32 v141, v144, v145
v_cvt_pk_bf16_f32 v108, v144, v145
v_mfma_f32_16x16x32_bf16 a[108:111], a[140:143], v[100:103], a[108:111]
v_add_f32 v141, v141, v146
s_waitcnt lgkmcnt(4)
v_mfma_f32_16x16x32_bf16 a[16:19], a[144:147], v[88:91], a[16:19]
ds_read_b64_tr_b16 a[156:157], v2 offset:52224
v_add_f32 v141, v141, v147
v_mfma_f32_16x16x32_bf16 a[48:51], a[144:147], v[92:95], a[48:51]
ds_read_b64_tr_b16 a[158:159], v2 offset:56320
v_cvt_pk_bf16_f32 v109, v146, v147
v_exp_f32 v144, v72
v_mfma_f32_16x16x32_bf16 a[80:83], a[144:147], v[96:99], a[80:83]
v_exp_f32 v145, v73
v_mfma_f32_16x16x32_bf16 a[112:115], a[144:147], v[100:103], a[112:115]
v_exp_f32 v146, v74
s_waitcnt lgkmcnt(4)
v_mfma_f32_16x16x32_bf16 a[20:23], a[148:151], v[88:91], a[20:23]
s_waitcnt vmcnt(10)
s_barrier
ds_read_b128 a[128:131], v6
v_mfma_f32_16x16x32_bf16 a[52:55], a[148:151], v[92:95], a[52:55]
v_exp_f32 v147, v75
v_mfma_f32_16x16x32_bf16 a[84:87], a[148:151], v[96:99], a[84:87]
v_add_f32 v142, v144, v145
v_cvt_pk_bf16_f32 v112, v144, v145
v_mfma_f32_16x16x32_bf16 a[116:119], a[148:151], v[100:103], a[116:119]
v_add_f32 v142, v142, v146
v_add_f32 v142, v142, v147
s_waitcnt lgkmcnt(3)
v_mfma_f32_16x16x32_bf16 a[24:27], a[152:155], v[88:91], a[24:27]
s_add_u32 m0, s23, 0
s_add_u32 s30, s25, 114688
buffer_load_dwordx4 v14, s[8:11], s30 offen lds
ds_read_b128 a[132:135], v6 offset:1024
v_cvt_pk_bf16_f32 v113, v146, v147
v_exp_f32 v144, v80
v_mfma_f32_16x16x32_bf16 a[56:59], a[152:155], v[92:95], a[56:59]
v_exp_f32 v145, v81
v_mfma_f32_16x16x32_bf16 a[88:91], a[152:155], v[96:99], a[88:91]
v_exp_f32 v146, v82
v_mfma_f32_16x16x32_bf16 a[120:123], a[152:155], v[100:103], a[120:123]
s_waitcnt lgkmcnt(2)
v_mfma_f32_16x16x32_bf16 a[28:31], a[156:159], v[88:91], a[28:31]
ds_read_b128 a[136:139], v6 offset:2048
v_exp_f32 v147, v83
v_mfma_f32_16x16x32_bf16 a[60:63], a[156:159], v[92:95], a[60:63]
v_add_f32 v143, v144, v145
v_cvt_pk_bf16_f32 v116, v144, v145
v_mfma_f32_16x16x32_bf16 a[92:95], a[156:159], v[96:99], a[92:95]
v_add_f32 v143, v143, v146
v_add_f32 v143, v143, v147
v_mfma_f32_16x16x32_bf16 a[124:127], a[156:159], v[100:103], a[124:127]
v_cvt_pk_bf16_f32 v117, v146, v147
s_waitcnt lgkmcnt(2)
v_mfma_f32_16x16x32_bf16 v[24:27], a[128:131], v[152:155], v[120:123]
ds_read_b128 a[140:143], v6 offset:3072
v_exp_f32 v148, v60
v_mfma_f32_16x16x32_bf16 v[32:35], a[128:131], v[168:171], v[124:127]
v_exp_f32 v149, v61
v_mfma_f32_16x16x32_bf16 v[40:43], a[128:131], v[184:187], v[128:131]
v_exp_f32 v150, v62
v_mfma_f32_16x16x32_bf16 v[48:51], a[128:131], v[216:219], v[132:135]
v_exp_f32 v151, v63
s_waitcnt lgkmcnt(2)
v_mfma_f32_16x16x32_bf16 v[24:27], a[132:135], v[156:159], v[24:27]
buffer_load_dwordx4 v15, s[8:11], s30 offen offset:1024 lds
ds_read_b128 a[144:147], v6 offset:4096
v_add_f32 v140, v140, v148
v_mfma_f32_16x16x32_bf16 v[32:35], a[132:135], v[172:175], v[32:35]
v_add_f32 v140, v140, v149
v_cvt_pk_bf16_f32 v106, v148, v149
v_mfma_f32_16x16x32_bf16 v[40:43], a[132:135], v[188:191], v[40:43]
v_add_f32 v140, v140, v150
v_add_f32 v140, v140, v151
v_mfma_f32_16x16x32_bf16 v[48:51], a[132:135], v[220:223], v[48:51]
v_cvt_pk_bf16_f32 v107, v150, v151
v_exp_f32 v148, v68
s_waitcnt lgkmcnt(2)
v_mfma_f32_16x16x32_bf16 v[24:27], a[136:139], v[160:163], v[24:27]
ds_read_b128 a[148:151], v6 offset:5120
v_mfma_f32_16x16x32_bf16 v[32:35], a[136:139], v[176:179], v[32:35]
v_exp_f32 v149, v69
v_mfma_f32_16x16x32_bf16 v[40:43], a[136:139], v[192:195], v[40:43]
v_exp_f32 v150, v70
v_mfma_f32_16x16x32_bf16 v[48:51], a[136:139], v[224:227], v[48:51]
v_exp_f32 v151, v71
s_waitcnt lgkmcnt(2)
v_mfma_f32_16x16x32_bf16 v[24:27], a[140:143], v[164:167], v[24:27]
ds_read_b128 a[152:155], v6 offset:6144
v_add_f32 v141, v141, v148
v_add_f32 v141, v141, v149
v_mfma_f32_16x16x32_bf16 v[32:35], a[140:143], v[180:183], v[32:35]
v_cvt_pk_bf16_f32 v110, v148, v149
v_add_f32 v141, v141, v150
v_mfma_f32_16x16x32_bf16 v[40:43], a[140:143], v[196:199], v[40:43]
v_add_f32 v141, v141, v151
v_cvt_pk_bf16_f32 v111, v150, v151
v_mfma_f32_16x16x32_bf16 v[48:51], a[140:143], v[228:231], v[48:51]
v_exp_f32 v148, v76
s_waitcnt lgkmcnt(2)
v_mfma_f32_16x16x32_bf16 v[28:31], a[144:147], v[152:155], v[120:123]
ds_read_b128 a[156:159], v6 offset:7168
v_exp_f32 v149, v77
v_mfma_f32_16x16x32_bf16 v[36:39], a[144:147], v[168:171], v[124:127]
buffer_load_dwordx4 v16, s[8:11], s30 offen offset:2048 lds
v_exp_f32 v150, v78
v_mfma_f32_16x16x32_bf16 v[44:47], a[144:147], v[184:187], v[128:131]
v_exp_f32 v151, v79
v_mfma_f32_16x16x32_bf16 v[52:55], a[144:147], v[216:219], v[132:135]
v_add_f32 v142, v142, v148
s_waitcnt lgkmcnt(2)
v_mfma_f32_16x16x32_bf16 v[28:31], a[148:151], v[156:159], v[28:31]
ds_read_b64_tr_b16 a[128:129], v1 offset:57344
v_add_f32 v142, v142, v149
v_mfma_f32_16x16x32_bf16 v[36:39], a[148:151], v[172:175], v[36:39]
ds_read_b64_tr_b16 a[130:131], v1 offset:61440
v_cvt_pk_bf16_f32 v114, v148, v149
v_add_f32 v142, v142, v150
v_mfma_f32_16x16x32_bf16 v[44:47], a[148:151], v[188:191], v[44:47]
v_add_f32 v142, v142, v151
v_cvt_pk_bf16_f32 v115, v150, v151
v_mfma_f32_16x16x32_bf16 v[52:55], a[148:151], v[220:223], v[52:55]
v_exp_f32 v148, v84
s_waitcnt lgkmcnt(3)
v_mfma_f32_16x16x32_bf16 v[28:31], a[152:155], v[160:163], v[28:31]
ds_read_b64_tr_b16 a[132:133], v2 offset:57344
v_exp_f32 v149, v85
v_mfma_f32_16x16x32_bf16 v[36:39], a[152:155], v[176:179], v[36:39]
ds_read_b64_tr_b16 a[134:135], v2 offset:61440
v_exp_f32 v150, v86
v_mfma_f32_16x16x32_bf16 v[44:47], a[152:155], v[192:195], v[44:47]
s_mov_b32 s96, s92
v_exp_f32 v151, v87
v_mfma_f32_16x16x32_bf16 v[52:55], a[152:155], v[224:227], v[52:55]
v_add_f32 v143, v143, v148
s_waitcnt lgkmcnt(4)
v_mfma_f32_16x16x32_bf16 v[28:31], a[156:159], v[164:167], v[28:31]
ds_read_b64_tr_b16 a[136:137], v1 offset:58368
s_mov_b32 s97, s93
v_add_f32 v143, v143, v149
v_mfma_f32_16x16x32_bf16 v[36:39], a[156:159], v[180:183], v[36:39]
buffer_load_dwordx4 v17, s[8:11], s30 offen offset:3072 lds
ds_read_b64_tr_b16 a[138:139], v1 offset:62464
v_cvt_pk_bf16_f32 v118, v148, v149
v_add_f32 v143, v143, v150
v_mfma_f32_16x16x32_bf16 v[44:47], a[156:159], v[196:199], v[44:47]
s_mov_b32 s98, 0x510000
v_add_f32 v143, v143, v151
v_cvt_pk_bf16_f32 v119, v150, v151
v_max3_f32 v144, v140, v141, v142
v_max_f32 v144, v144, v143
v_cmp_lt_f32 vcc, s29, v144
v_mfma_f32_16x16x32_bf16 v[52:55], a[156:159], v[228:231], v[52:55]
s_nop 0
s_cbranch_vccnz K1_STUB9
K1_BACK9:
s_waitcnt lgkmcnt(4)
v_mfma_f32_16x16x32_bf16 a[0:3], a[128:131], v[104:107], a[0:3]
ds_read_b64_tr_b16 a[140:141], v2 offset:58368
s_mov_b32 s99, 0x20000
v_mfma_f32_16x16x32_bf16 a[32:35], a[128:131], v[108:111], a[32:35]
ds_read_b64_tr_b16 a[142:143], v2 offset:62464
v_add_f32 v136, v136, v140
v_add_f32 v137, v137, v141
v_mfma_f32_16x16x32_bf16 a[64:67], a[128:131], v[112:115], a[64:67]
buffer_load_dword a166, v23, s[96:99], s100 offen
v_add_f32 v138, v138, v142
v_add_f32 v139, v139, v143
v_mfma_f32_16x16x32_bf16 a[96:99], a[128:131], v[116:119], a[96:99]
v_exp_f32 v144, v24
s_waitcnt lgkmcnt(4)
v_mfma_f32_16x16x32_bf16 a[4:7], a[132:135], v[104:107], a[4:7]
ds_read_b64_tr_b16 a[144:145], v1 offset:59392
v_exp_f32 v145, v25
v_mfma_f32_16x16x32_bf16 a[36:39], a[132:135], v[108:111], a[36:39]
ds_read_b64_tr_b16 a[146:147], v1 offset:63488
v_exp_f32 v146, v26
v_mfma_f32_16x16x32_bf16 a[68:71], a[132:135], v[112:115], a[68:71]
v_exp_f32 v147, v27
v_mfma_f32_16x16x32_bf16 a[100:103], a[132:135], v[116:119], a[100:103]
v_add_f32 v140, v144, v145
s_waitcnt lgkmcnt(4)
v_mfma_f32_16x16x32_bf16 a[8:11], a[136:139], v[104:107], a[8:11]
ds_read_b64_tr_b16 a[148:149], v2 offset:59392
v_cvt_pk_bf16_f32 v88, v144, v145
v_add_f32 v140, v140, v146
v_mfma_f32_16x16x32_bf16 a[40:43], a[136:139], v[108:111], a[40:43]
ds_read_b64_tr_b16 a[150:151], v2 offset:63488
v_add_f32 v140, v140, v147
v_cvt_pk_bf16_f32 v89, v146, v147
v_mfma_f32_16x16x32_bf16 a[72:75], a[136:139], v[112:115], a[72:75]
s_add_u32 m0, s23, 4096
s_add_u32 s31, s25, 118784
buffer_load_dwordx4 v14, s[8:11], s31 offen lds
v_exp_f32 v144, v32
v_mfma_f32_16x16x32_bf16 a[104:107], a[136:139], v[116:119], a[104:107]
v_exp_f32 v145, v33
s_waitcnt lgkmcnt(4)
v_mfma_f32_16x16x32_bf16 a[12:15], a[140:143], v[104:107], a[12:15]
ds_read_b64_tr_b16 a[152:153], v1 offset:60416
v_exp_f32 v146, v34
v_mfma_f32_16x16x32_bf16 a[44:47], a[140:143], v[108:111], a[44:47]
ds_read_b64_tr_b16 a[154:155], v1 offset:64512
v_exp_f32 v147, v35
v_mfma_f32_16x16x32_bf16 a[76:79], a[140:143], v[112:115], a[76:79]
v_add_f32 v141, v144, v145
v_cvt_pk_bf16_f32 v92, v144, v145
v_mfma_f32_16x16x32_bf16 a[108:111], a[140:143], v[116:119], a[108:111]
v_add_f32 v141, v141, v146
s_waitcnt lgkmcnt(4)
v_mfma_f32_16x16x32_bf16 a[16:19], a[144:147], v[104:107], a[16:19]
ds_read_b64_tr_b16 a[156:157], v2 offset:60416
v_add_f32 v141, v141, v147
v_mfma_f32_16x16x32_bf16 a[48:51], a[144:147], v[108:111], a[48:51]
ds_read_b64_tr_b16 a[158:159], v2 offset:64512
v_cvt_pk_bf16_f32 v93, v146, v147
v_exp_f32 v144, v40
v_mfma_f32_16x16x32_bf16 a[80:83], a[144:147], v[112:115], a[80:83]
v_exp_f32 v145, v41
v_mfma_f32_16x16x32_bf16 a[112:115], a[144:147], v[116:119], a[112:115]
v_exp_f32 v146, v42
s_waitcnt lgkmcnt(4)
v_mfma_f32_16x16x32_bf16 a[20:23], a[148:151], v[104:107], a[20:23]
ds_read_b128 a[128:131], v6 offset:8192
v_mfma_f32_16x16x32_bf16 a[52:55], a[148:151], v[108:111], a[52:55]
v_exp_f32 v147, v43
v_mfma_f32_16x16x32_bf16 a[84:87], a[148:151], v[112:115], a[84:87]
buffer_load_dwordx4 v15, s[8:11], s31 offen offset:1024 lds
v_add_f32 v142, v144, v145
v_cvt_pk_bf16_f32 v96, v144, v145
v_mfma_f32_16x16x32_bf16 a[116:119], a[148:151], v[116:119], a[116:119]
v_add_f32 v142, v142, v146
v_add_f32 v142, v142, v147
s_waitcnt lgkmcnt(3)
v_mfma_f32_16x16x32_bf16 a[24:27], a[152:155], v[104:107], a[24:27]
ds_read_b128 a[132:135], v6 offset:9216
v_cvt_pk_bf16_f32 v97, v146, v147
v_exp_f32 v144, v48
v_mfma_f32_16x16x32_bf16 a[56:59], a[152:155], v[108:111], a[56:59]
v_exp_f32 v145, v49
v_mfma_f32_16x16x32_bf16 a[88:91], a[152:155], v[112:115], a[88:91]
v_exp_f32 v146, v50
v_mfma_f32_16x16x32_bf16 a[120:123], a[152:155], v[116:119], a[120:123]
s_waitcnt lgkmcnt(2)
v_mfma_f32_16x16x32_bf16 a[28:31], a[156:159], v[104:107], a[28:31]
ds_read_b128 a[136:139], v6 offset:10240
v_exp_f32 v147, v51
v_mfma_f32_16x16x32_bf16 a[60:63], a[156:159], v[108:111], a[60:63]
v_add_f32 v143, v144, v145
v_cvt_pk_bf16_f32 v100, v144, v145
v_mfma_f32_16x16x32_bf16 a[92:95], a[156:159], v[112:115], a[92:95]
v_add_f32 v143, v143, v146
v_add_f32 v143, v143, v147
v_mfma_f32_16x16x32_bf16 a[124:127], a[156:159], v[116:119], a[124:127]
v_cvt_pk_bf16_f32 v101, v146, v147
s_waitcnt lgkmcnt(2)
v_mfma_f32_16x16x32_bf16 v[56:59], a[128:131], v[152:155], v[120:123]
ds_read_b128 a[140:143], v6 offset:11264
v_exp_f32 v148, v28
v_mfma_f32_16x16x32_bf16 v[64:67], a[128:131], v[168:171], v[124:127]
v_exp_f32 v149, v29
v_mfma_f32_16x16x32_bf16 v[72:75], a[128:131], v[184:187], v[128:131]
v_exp_f32 v150, v30
v_mfma_f32_16x16x32_bf16 v[80:83], a[128:131], v[216:219], v[132:135]
buffer_load_dwordx4 v16, s[8:11], s31 offen offset:2048 lds
v_exp_f32 v151, v31
s_waitcnt lgkmcnt(2)
v_mfma_f32_16x16x32_bf16 v[56:59], a[132:135], v[156:159], v[56:59]
ds_read_b128 a[144:147], v6 offset:12288
v_add_f32 v140, v140, v148
v_mfma_f32_16x16x32_bf16 v[64:67], a[132:135], v[172:175], v[64:67]
v_add_f32 v140, v140, v149
v_cvt_pk_bf16_f32 v90, v148, v149
v_mfma_f32_16x16x32_bf16 v[72:75], a[132:135], v[188:191], v[72:75]
v_add_f32 v140, v140, v150
v_add_f32 v140, v140, v151
v_mfma_f32_16x16x32_bf16 v[80:83], a[132:135], v[220:223], v[80:83]
v_cvt_pk_bf16_f32 v91, v150, v151
v_exp_f32 v148, v36
s_waitcnt lgkmcnt(2)
v_mfma_f32_16x16x32_bf16 v[56:59], a[136:139], v[160:163], v[56:59]
ds_read_b128 a[148:151], v6 offset:13312
v_mfma_f32_16x16x32_bf16 v[64:67], a[136:139], v[176:179], v[64:67]
v_exp_f32 v149, v37
v_mfma_f32_16x16x32_bf16 v[72:75], a[136:139], v[192:195], v[72:75]
v_exp_f32 v150, v38
v_mfma_f32_16x16x32_bf16 v[80:83], a[136:139], v[224:227], v[80:83]
v_exp_f32 v151, v39
s_waitcnt lgkmcnt(2)
v_mfma_f32_16x16x32_bf16 v[56:59], a[140:143], v[164:167], v[56:59]
ds_read_b128 a[152:155], v6 offset:14336
v_add_f32 v141, v141, v148
v_add_f32 v141, v141, v149
v_mfma_f32_16x16x32_bf16 v[64:67], a[140:143], v[180:183], v[64:67]
v_cvt_pk_bf16_f32 v94, v148, v149
v_add_f32 v141, v141, v150
v_mfma_f32_16x16x32_bf16 v[72:75], a[140:143], v[196:199], v[72:75]
v_add_f32 v141, v141, v151
buffer_load_dwordx4 v17, s[8:11], s31 offen offset:3072 lds
v_mfma_f32_16x16x32_bf16 v[80:83], a[140:143], v[228:231], v[80:83]
v_cvt_pk_bf16_f32 v95, v150, v151
v_exp_f32 v148, v44
s_waitcnt lgkmcnt(2)
v_mfma_f32_16x16x32_bf16 v[60:63], a[144:147], v[152:155], v[120:123]
ds_read_b128 a[156:159], v6 offset:15360
v_exp_f32 v149, v45
v_mfma_f32_16x16x32_bf16 v[68:71], a[144:147], v[168:171], v[124:127]
v_exp_f32 v150, v46
v_mfma_f32_16x16x32_bf16 v[76:79], a[144:147], v[184:187], v[128:131]
v_exp_f32 v151, v47
v_mfma_f32_16x16x32_bf16 v[84:87], a[144:147], v[216:219], v[132:135]
v_add_f32 v142, v142, v148
s_waitcnt lgkmcnt(2)
v_mfma_f32_16x16x32_bf16 v[60:63], a[148:151], v[156:159], v[60:63]
ds_read_b64_tr_b16 a[128:129], v3 offset:16384
v_add_f32 v142, v142, v149
v_mfma_f32_16x16x32_bf16 v[68:71], a[148:151], v[172:175], v[68:71]
ds_read_b64_tr_b16 a[130:131], v3 offset:20480
v_cvt_pk_bf16_f32 v98, v148, v149
v_add_f32 v142, v142, v150
v_mfma_f32_16x16x32_bf16 v[76:79], a[148:151], v[188:191], v[76:79]
v_add_f32 v142, v142, v151
v_cvt_pk_bf16_f32 v99, v150, v151
v_mfma_f32_16x16x32_bf16 v[84:87], a[148:151], v[220:223], v[84:87]
v_exp_f32 v148, v52
s_waitcnt lgkmcnt(3)
v_mfma_f32_16x16x32_bf16 v[60:63], a[152:155], v[160:163], v[60:63]
ds_read_b64_tr_b16 a[132:133], v4 offset:16384
v_exp_f32 v149, v53
v_mfma_f32_16x16x32_bf16 v[68:71], a[152:155], v[176:179], v[68:71]
ds_read_b64_tr_b16 a[134:135], v4 offset:20480
v_exp_f32 v150, v54
v_mfma_f32_16x16x32_bf16 v[76:79], a[152:155], v[192:195], v[76:79]
v_exp_f32 v151, v55
v_mfma_f32_16x16x32_bf16 v[84:87], a[152:155], v[224:227], v[84:87]
v_add_f32 v143, v143, v148
s_waitcnt lgkmcnt(4)
v_mfma_f32_16x16x32_bf16 v[60:63], a[156:159], v[164:167], v[60:63]
ds_read_b64_tr_b16 a[136:137], v3 offset:17408
v_add_f32 v143, v143, v149
v_mfma_f32_16x16x32_bf16 v[68:71], a[156:159], v[180:183], v[68:71]
ds_read_b64_tr_b16 a[138:139], v3 offset:21504
v_cvt_pk_bf16_f32 v102, v148, v149
v_add_f32 v143, v143, v150
v_mfma_f32_16x16x32_bf16 v[76:79], a[156:159], v[196:199], v[76:79]
v_add_f32 v143, v143, v151
v_cvt_pk_bf16_f32 v103, v150, v151
v_max3_f32 v144, v140, v141, v142
v_max_f32 v144, v144, v143
v_cmp_lt_f32 vcc, s29, v144
v_mfma_f32_16x16x32_bf16 v[84:87], a[156:159], v[228:231], v[84:87]
s_nop 0
s_cbranch_vccnz K1_STUB10
K1_BACK10:
s_waitcnt lgkmcnt(4)
v_mfma_f32_16x16x32_bf16 a[0:3], a[128:131], v[88:91], a[0:3]
ds_read_b64_tr_b16 a[140:141], v4 offset:17408
v_add_f32 v136, v136, v140
v_mfma_f32_16x16x32_bf16 a[32:35], a[128:131], v[92:95], a[32:35]
ds_read_b64_tr_b16 a[142:143], v4 offset:21504
v_add_f32 v137, v137, v141
v_mfma_f32_16x16x32_bf16 a[64:67], a[128:131], v[96:99], a[64:67]
v_add_f32 v138, v138, v142
v_add_f32 v139, v139, v143
v_mfma_f32_16x16x32_bf16 a[96:99], a[128:131], v[100:103], a[96:99]
v_exp_f32 v144, v56
s_waitcnt lgkmcnt(4)
v_mfma_f32_16x16x32_bf16 a[4:7], a[132:135], v[88:91], a[4:7]
ds_read_b64_tr_b16 a[144:145], v3 offset:18432
v_exp_f32 v145, v57
v_mfma_f32_16x16x32_bf16 a[36:39], a[132:135], v[92:95], a[36:39]
ds_read_b64_tr_b16 a[146:147], v3 offset:22528
v_exp_f32 v146, v58
v_mfma_f32_16x16x32_bf16 a[68:71], a[132:135], v[96:99], a[68:71]
v_exp_f32 v147, v59
v_mfma_f32_16x16x32_bf16 a[100:103], a[132:135], v[100:103], a[100:103]
v_add_f32 v140, v144, v145
s_waitcnt lgkmcnt(4)
v_mfma_f32_16x16x32_bf16 a[8:11], a[136:139], v[88:91], a[8:11]
ds_read_b64_tr_b16 a[148:149], v4 offset:18432
v_cvt_pk_bf16_f32 v104, v144, v145
v_add_f32 v140, v140, v146
v_mfma_f32_16x16x32_bf16 a[40:43], a[136:139], v[92:95], a[40:43]
ds_read_b64_tr_b16 a[150:151], v4 offset:22528
v_add_f32 v140, v140, v147
v_cvt_pk_bf16_f32 v105, v146, v147
v_mfma_f32_16x16x32_bf16 a[72:75], a[136:139], v[96:99], a[72:75]
v_exp_f32 v144, v64
v_mfma_f32_16x16x32_bf16 a[104:107], a[136:139], v[100:103], a[104:107]
v_exp_f32 v145, v65
s_waitcnt lgkmcnt(4)
v_mfma_f32_16x16x32_bf16 a[12:15], a[140:143], v[88:91], a[12:15]
ds_read_b64_tr_b16 a[152:153], v3 offset:19456
v_exp_f32 v146, v66
v_mfma_f32_16x16x32_bf16 a[44:47], a[140:143], v[92:95], a[44:47]
ds_read_b64_tr_b16 a[154:155], v3 offset:23552
v_exp_f32 v147, v67
v_mfma_f32_16x16x32_bf16 a[76:79], a[140:143], v[96:99], a[76:79]
v_add_f32 v141, v144, v145
v_cvt_pk_bf16_f32 v108, v144, v145
v_mfma_f32_16x16x32_bf16 a[108:111], a[140:143], v[100:103], a[108:111]
v_add_f32 v141, v141, v146
s_waitcnt lgkmcnt(4)
v_mfma_f32_16x16x32_bf16 a[16:19], a[144:147], v[88:91], a[16:19]
ds_read_b64_tr_b16 a[156:157], v4 offset:19456
v_add_f32 v141, v141, v147
v_mfma_f32_16x16x32_bf16 a[48:51], a[144:147], v[92:95], a[48:51]
ds_read_b64_tr_b16 a[158:159], v4 offset:23552
v_cvt_pk_bf16_f32 v109, v146, v147
v_exp_f32 v144, v72
v_mfma_f32_16x16x32_bf16 a[80:83], a[144:147], v[96:99], a[80:83]
v_exp_f32 v145, v73
v_mfma_f32_16x16x32_bf16 a[112:115], a[144:147], v[100:103], a[112:115]
v_exp_f32 v146, v74
s_waitcnt lgkmcnt(4)
v_mfma_f32_16x16x32_bf16 a[20:23], a[148:151], v[88:91], a[20:23]
s_waitcnt vmcnt(9)
s_barrier
ds_read_b128 a[128:131], v6 offset:32768
v_mfma_f32_16x16x32_bf16 a[52:55], a[148:151], v[92:95], a[52:55]
v_exp_f32 v147, v75
v_mfma_f32_16x16x32_bf16 a[84:87], a[148:151], v[96:99], a[84:87]
v_add_f32 v142, v144, v145
v_cvt_pk_bf16_f32 v112, v144, v145
v_mfma_f32_16x16x32_bf16 a[116:119], a[148:151], v[100:103], a[116:119]
v_add_f32 v142, v142, v146
v_add_f32 v142, v142, v147
s_waitcnt lgkmcnt(3)
v_mfma_f32_16x16x32_bf16 a[24:27], a[152:155], v[88:91], a[24:27]
s_add_u32 m0, s23, 32768
s_add_u32 s30, s26, 0
buffer_load_dwordx4 v18, s[12:15], s30 offen lds
ds_read_b128 a[132:135], v6 offset:33792
v_cvt_pk_bf16_f32 v113, v146, v147
v_exp_f32 v144, v80
v_mfma_f32_16x16x32_bf16 a[56:59], a[152:155], v[92:95], a[56:59]
v_exp_f32 v145, v81
v_mfma_f32_16x16x32_bf16 a[88:91], a[152:155], v[96:99], a[88:91]
v_exp_f32 v146, v82
v_mfma_f32_16x16x32_bf16 a[120:123], a[152:155], v[100:103], a[120:123]
s_waitcnt lgkmcnt(2)
v_mfma_f32_16x16x32_bf16 a[28:31], a[156:159], v[88:91], a[28:31]
ds_read_b128 a[136:139], v6 offset:34816
v_exp_f32 v147, v83
v_mfma_f32_16x16x32_bf16 a[60:63], a[156:159], v[92:95], a[60:63]
v_add_f32 v143, v144, v145
v_cvt_pk_bf16_f32 v116, v144, v145
v_mfma_f32_16x16x32_bf16 a[92:95], a[156:159], v[96:99], a[92:95]
buffer_load_dword a166, v23, s[96:99], s100 offen offset:1088
v_add_f32 v143, v143, v146
v_mfma_f32_16x16x32_bf16 a[124:127], a[156:159], v[100:103], a[124:127]
v_add_f32 v143, v143, v147
v_cvt_pk_bf16_f32 v117, v146, v147
s_waitcnt lgkmcnt(2)
v_mfma_f32_16x16x32_bf16 v[24:27], a[128:131], v[152:155], v[120:123]
ds_read_b128 a[140:143], v6 offset:35840
v_exp_f32 v148, v60
v_mfma_f32_16x16x32_bf16 v[32:35], a[128:131], v[168:171], v[124:127]
v_exp_f32 v149, v61
v_mfma_f32_16x16x32_bf16 v[40:43], a[128:131], v[184:187], v[128:131]
v_exp_f32 v150, v62
v_mfma_f32_16x16x32_bf16 v[48:51], a[128:131], v[216:219], v[132:135]
v_exp_f32 v151, v63
s_waitcnt lgkmcnt(2)
v_mfma_f32_16x16x32_bf16 v[24:27], a[132:135], v[156:159], v[24:27]
buffer_load_dwordx4 v19, s[12:15], s30 offen offset:1024 lds
ds_read_b128 a[144:147], v6 offset:36864
v_add_f32 v140, v140, v148
v_mfma_f32_16x16x32_bf16 v[32:35], a[132:135], v[172:175], v[32:35]
v_add_f32 v140, v140, v149
v_cvt_pk_bf16_f32 v106, v148, v149
v_mfma_f32_16x16x32_bf16 v[40:43], a[132:135], v[188:191], v[40:43]
v_add_f32 v140, v140, v150
v_add_f32 v140, v140, v151
v_mfma_f32_16x16x32_bf16 v[48:51], a[132:135], v[220:223], v[48:51]
v_cvt_pk_bf16_f32 v107, v150, v151
v_exp_f32 v148, v68
s_waitcnt lgkmcnt(2)
v_mfma_f32_16x16x32_bf16 v[24:27], a[136:139], v[160:163], v[24:27]
ds_read_b128 a[148:151], v6 offset:37888
v_mfma_f32_16x16x32_bf16 v[32:35], a[136:139], v[176:179], v[32:35]
v_exp_f32 v149, v69
v_mfma_f32_16x16x32_bf16 v[40:43], a[136:139], v[192:195], v[40:43]
v_exp_f32 v150, v70
v_mfma_f32_16x16x32_bf16 v[48:51], a[136:139], v[224:227], v[48:51]
v_exp_f32 v151, v71
s_waitcnt lgkmcnt(2)
v_mfma_f32_16x16x32_bf16 v[24:27], a[140:143], v[164:167], v[24:27]
ds_read_b128 a[152:155], v6 offset:38912
v_add_f32 v141, v141, v148
v_add_f32 v141, v141, v149
v_mfma_f32_16x16x32_bf16 v[32:35], a[140:143], v[180:183], v[32:35]
v_cvt_pk_bf16_f32 v110, v148, v149
v_add_f32 v141, v141, v150
v_mfma_f32_16x16x32_bf16 v[40:43], a[140:143], v[196:199], v[40:43]
v_add_f32 v141, v141, v151
v_cvt_pk_bf16_f32 v111, v150, v151
v_mfma_f32_16x16x32_bf16 v[48:51], a[140:143], v[228:231], v[48:51]
v_exp_f32 v148, v76
s_waitcnt lgkmcnt(2)
v_mfma_f32_16x16x32_bf16 v[28:31], a[144:147], v[152:155], v[120:123]
ds_read_b128 a[156:159], v6 offset:39936
v_exp_f32 v149, v77
v_mfma_f32_16x16x32_bf16 v[36:39], a[144:147], v[168:171], v[124:127]
buffer_load_dwordx4 v20, s[12:15], s30 offen offset:2048 lds
v_exp_f32 v150, v78
v_mfma_f32_16x16x32_bf16 v[44:47], a[144:147], v[184:187], v[128:131]
v_exp_f32 v151, v79
v_mfma_f32_16x16x32_bf16 v[52:55], a[144:147], v[216:219], v[132:135]
v_add_f32 v142, v142, v148
s_waitcnt lgkmcnt(2)
v_mfma_f32_16x16x32_bf16 v[28:31], a[148:151], v[156:159], v[28:31]
ds_read_b64_tr_b16 a[128:129], v3 offset:24576
v_add_f32 v142, v142, v149
v_mfma_f32_16x16x32_bf16 v[36:39], a[148:151], v[172:175], v[36:39]
ds_read_b64_tr_b16 a[130:131], v3 offset:28672
v_cvt_pk_bf16_f32 v114, v148, v149
v_add_f32 v142, v142, v150
v_mfma_f32_16x16x32_bf16 v[44:47], a[148:151], v[188:191], v[44:47]
v_add_f32 v142, v142, v151
v_cvt_pk_bf16_f32 v115, v150, v151
v_mfma_f32_16x16x32_bf16 v[52:55], a[148:151], v[220:223], v[52:55]
v_exp_f32 v148, v84
s_waitcnt lgkmcnt(3)
v_mfma_f32_16x16x32_bf16 v[28:31], a[152:155], v[160:163], v[28:31]
ds_read_b64_tr_b16 a[132:133], v4 offset:24576
v_exp_f32 v149, v85
v_mfma_f32_16x16x32_bf16 v[36:39], a[152:155], v[176:179], v[36:39]
ds_read_b64_tr_b16 a[134:135], v4 offset:28672
v_exp_f32 v150, v86
v_mfma_f32_16x16x32_bf16 v[44:47], a[152:155], v[192:195], v[44:47]
v_exp_f32 v151, v87
v_mfma_f32_16x16x32_bf16 v[52:55], a[152:155], v[224:227], v[52:55]
v_add_f32 v143, v143, v148
s_waitcnt lgkmcnt(4)
v_mfma_f32_16x16x32_bf16 v[28:31], a[156:159], v[164:167], v[28:31]
ds_read_b64_tr_b16 a[136:137], v3 offset:25600
v_add_f32 v143, v143, v149
v_mfma_f32_16x16x32_bf16 v[36:39], a[156:159], v[180:183], v[36:39]
buffer_load_dwordx4 v21, s[12:15], s30 offen offset:3072 lds
ds_read_b64_tr_b16 a[138:139], v3 offset:29696
v_cvt_pk_bf16_f32 v118, v148, v149
v_add_f32 v143, v143, v150
v_mfma_f32_16x16x32_bf16 v[44:47], a[156:159], v[196:199], v[44:47]
v_add_f32 v143, v143, v151
v_cvt_pk_bf16_f32 v119, v150, v151
v_max3_f32 v144, v140, v141, v142
v_max_f32 v144, v144, v143
v_cmp_lt_f32 vcc, s29, v144
v_mfma_f32_16x16x32_bf16 v[52:55], a[156:159], v[228:231], v[52:55]
s_nop 0
s_cbranch_vccnz K1_STUB11
K1_BACK11:
s_waitcnt lgkmcnt(4)
v_mfma_f32_16x16x32_bf16 a[0:3], a[128:131], v[104:107], a[0:3]
ds_read_b64_tr_b16 a[140:141], v4 offset:25600
v_add_f32 v136, v136, v140
v_mfma_f32_16x16x32_bf16 a[32:35], a[128:131], v[108:111], a[32:35]
ds_read_b64_tr_b16 a[142:143], v4 offset:29696
v_add_f32 v137, v137, v141
v_mfma_f32_16x16x32_bf16 a[64:67], a[128:131], v[112:115], a[64:67]
v_add_f32 v138, v138, v142
v_add_f32 v139, v139, v143
v_mfma_f32_16x16x32_bf16 a[96:99], a[128:131], v[116:119], a[96:99]
v_exp_f32 v144, v24
s_waitcnt lgkmcnt(4)
v_mfma_f32_16x16x32_bf16 a[4:7], a[132:135], v[104:107], a[4:7]
ds_read_b64_tr_b16 a[144:145], v3 offset:26624
v_exp_f32 v145, v25
v_mfma_f32_16x16x32_bf16 a[36:39], a[132:135], v[108:111], a[36:39]
ds_read_b64_tr_b16 a[146:147], v3 offset:30720
v_exp_f32 v146, v26
v_mfma_f32_16x16x32_bf16 a[68:71], a[132:135], v[112:115], a[68:71]
v_exp_f32 v147, v27
v_mfma_f32_16x16x32_bf16 a[100:103], a[132:135], v[116:119], a[100:103]
v_add_f32 v140, v144, v145
s_waitcnt lgkmcnt(4)
v_mfma_f32_16x16x32_bf16 a[8:11], a[136:139], v[104:107], a[8:11]
ds_read_b64_tr_b16 a[148:149], v4 offset:26624
v_cvt_pk_bf16_f32 v88, v144, v145
v_add_f32 v140, v140, v146
v_mfma_f32_16x16x32_bf16 a[40:43], a[136:139], v[108:111], a[40:43]
ds_read_b64_tr_b16 a[150:151], v4 offset:30720
v_add_f32 v140, v140, v147
v_cvt_pk_bf16_f32 v89, v146, v147
v_mfma_f32_16x16x32_bf16 a[72:75], a[136:139], v[112:115], a[72:75]
s_add_u32 m0, s23, 36864
s_add_u32 s31, s26, 73728
buffer_load_dwordx4 v18, s[12:15], s31 offen lds
v_exp_f32 v144, v32
v_mfma_f32_16x16x32_bf16 a[104:107], a[136:139], v[116:119], a[104:107]
v_exp_f32 v145, v33
s_waitcnt lgkmcnt(4)
v_mfma_f32_16x16x32_bf16 a[12:15], a[140:143], v[104:107], a[12:15]
ds_read_b64_tr_b16 a[152:153], v3 offset:27648
v_exp_f32 v146, v34
v_mfma_f32_16x16x32_bf16 a[44:47], a[140:143], v[108:111], a[44:47]
ds_read_b64_tr_b16 a[154:155], v3 offset:31744
v_exp_f32 v147, v35
v_mfma_f32_16x16x32_bf16 a[76:79], a[140:143], v[112:115], a[76:79]
v_add_f32 v141, v144, v145
v_cvt_pk_bf16_f32 v92, v144, v145
v_mfma_f32_16x16x32_bf16 a[108:111], a[140:143], v[116:119], a[108:111]
v_add_f32 v141, v141, v146
s_waitcnt lgkmcnt(4)
v_mfma_f32_16x16x32_bf16 a[16:19], a[144:147], v[104:107], a[16:19]
ds_read_b64_tr_b16 a[156:157], v4 offset:27648
v_add_f32 v141, v141, v147
v_mfma_f32_16x16x32_bf16 a[48:51], a[144:147], v[108:111], a[48:51]
ds_read_b64_tr_b16 a[158:159], v4 offset:31744
v_cvt_pk_bf16_f32 v93, v146, v147
v_exp_f32 v144, v40
v_mfma_f32_16x16x32_bf16 a[80:83], a[144:147], v[112:115], a[80:83]
v_exp_f32 v145, v41
v_mfma_f32_16x16x32_bf16 a[112:115], a[144:147], v[116:119], a[112:115]
v_exp_f32 v146, v42
s_waitcnt lgkmcnt(4)
v_mfma_f32_16x16x32_bf16 a[20:23], a[148:151], v[104:107], a[20:23]
ds_read_b128 a[128:131], v6 offset:40960
v_mfma_f32_16x16x32_bf16 a[52:55], a[148:151], v[108:111], a[52:55]
v_exp_f32 v147, v43
v_mfma_f32_16x16x32_bf16 a[84:87], a[148:151], v[112:115], a[84:87]
buffer_load_dwordx4 v19, s[12:15], s31 offen offset:1024 lds
v_add_f32 v142, v144, v145
v_cvt_pk_bf16_f32 v96, v144, v145
v_mfma_f32_16x16x32_bf16 a[116:119], a[148:151], v[116:119], a[116:119]
v_add_f32 v142, v142, v146
v_add_f32 v142, v142, v147
s_waitcnt lgkmcnt(3)
v_mfma_f32_16x16x32_bf16 a[24:27], a[152:155], v[104:107], a[24:27]
ds_read_b128 a[132:135], v6 offset:41984
v_cvt_pk_bf16_f32 v97, v146, v147
v_exp_f32 v144, v48
v_mfma_f32_16x16x32_bf16 a[56:59], a[152:155], v[108:111], a[56:59]
v_exp_f32 v145, v49
v_mfma_f32_16x16x32_bf16 a[88:91], a[152:155], v[112:115], a[88:91]
v_exp_f32 v146, v50
v_mfma_f32_16x16x32_bf16 a[120:123], a[152:155], v[116:119], a[120:123]
s_waitcnt lgkmcnt(2)
v_mfma_f32_16x16x32_bf16 a[28:31], a[156:159], v[104:107], a[28:31]
ds_read_b128 a[136:139], v6 offset:43008
v_exp_f32 v147, v51
v_mfma_f32_16x16x32_bf16 a[60:63], a[156:159], v[108:111], a[60:63]
v_add_f32 v143, v144, v145
v_cvt_pk_bf16_f32 v100, v144, v145
v_mfma_f32_16x16x32_bf16 a[92:95], a[156:159], v[112:115], a[92:95]
v_add_f32 v143, v143, v146
v_add_f32 v143, v143, v147
v_mfma_f32_16x16x32_bf16 a[124:127], a[156:159], v[116:119], a[124:127]
v_cvt_pk_bf16_f32 v101, v146, v147
s_waitcnt lgkmcnt(2)
v_mfma_f32_16x16x32_bf16 v[56:59], a[128:131], v[152:155], v[120:123]
ds_read_b128 a[140:143], v6 offset:44032
v_exp_f32 v148, v28
v_mfma_f32_16x16x32_bf16 v[64:67], a[128:131], v[168:171], v[124:127]
v_exp_f32 v149, v29
v_mfma_f32_16x16x32_bf16 v[72:75], a[128:131], v[184:187], v[128:131]
v_exp_f32 v150, v30
v_mfma_f32_16x16x32_bf16 v[80:83], a[128:131], v[216:219], v[132:135]
buffer_load_dwordx4 v20, s[12:15], s31 offen offset:2048 lds
v_exp_f32 v151, v31
s_waitcnt lgkmcnt(2)
v_mfma_f32_16x16x32_bf16 v[56:59], a[132:135], v[156:159], v[56:59]
ds_read_b128 a[144:147], v6 offset:45056
v_add_f32 v140, v140, v148
v_mfma_f32_16x16x32_bf16 v[64:67], a[132:135], v[172:175], v[64:67]
v_add_f32 v140, v140, v149
v_cvt_pk_bf16_f32 v90, v148, v149
v_mfma_f32_16x16x32_bf16 v[72:75], a[132:135], v[188:191], v[72:75]
v_add_f32 v140, v140, v150
v_add_f32 v140, v140, v151
v_mfma_f32_16x16x32_bf16 v[80:83], a[132:135], v[220:223], v[80:83]
v_cvt_pk_bf16_f32 v91, v150, v151
v_exp_f32 v148, v36
s_waitcnt lgkmcnt(2)
v_mfma_f32_16x16x32_bf16 v[56:59], a[136:139], v[160:163], v[56:59]
ds_read_b128 a[148:151], v6 offset:46080
v_mfma_f32_16x16x32_bf16 v[64:67], a[136:139], v[176:179], v[64:67]
v_exp_f32 v149, v37
v_mfma_f32_16x16x32_bf16 v[72:75], a[136:139], v[192:195], v[72:75]
v_exp_f32 v150, v38
v_mfma_f32_16x16x32_bf16 v[80:83], a[136:139], v[224:227], v[80:83]
v_exp_f32 v151, v39
s_waitcnt lgkmcnt(2)
v_mfma_f32_16x16x32_bf16 v[56:59], a[140:143], v[164:167], v[56:59]
ds_read_b128 a[152:155], v6 offset:47104
v_add_f32 v141, v141, v148
v_add_f32 v141, v141, v149
v_mfma_f32_16x16x32_bf16 v[64:67], a[140:143], v[180:183], v[64:67]
v_cvt_pk_bf16_f32 v94, v148, v149
v_add_f32 v141, v141, v150
v_mfma_f32_16x16x32_bf16 v[72:75], a[140:143], v[196:199], v[72:75]
v_add_f32 v141, v141, v151
buffer_load_dwordx4 v21, s[12:15], s31 offen offset:3072 lds
v_mfma_f32_16x16x32_bf16 v[80:83], a[140:143], v[228:231], v[80:83]
v_cvt_pk_bf16_f32 v95, v150, v151
v_exp_f32 v148, v44
s_waitcnt lgkmcnt(2)
v_mfma_f32_16x16x32_bf16 v[60:63], a[144:147], v[152:155], v[120:123]
ds_read_b128 a[156:159], v6 offset:48128
v_exp_f32 v149, v45
v_mfma_f32_16x16x32_bf16 v[68:71], a[144:147], v[168:171], v[124:127]
v_exp_f32 v150, v46
v_mfma_f32_16x16x32_bf16 v[76:79], a[144:147], v[184:187], v[128:131]
v_exp_f32 v151, v47
v_mfma_f32_16x16x32_bf16 v[84:87], a[144:147], v[216:219], v[132:135]
v_add_f32 v142, v142, v148
s_waitcnt lgkmcnt(2)
v_mfma_f32_16x16x32_bf16 v[60:63], a[148:151], v[156:159], v[60:63]
ds_read_b64_tr_b16 a[128:129], v3 offset:49152
v_add_f32 v142, v142, v149
v_mfma_f32_16x16x32_bf16 v[68:71], a[148:151], v[172:175], v[68:71]
ds_read_b64_tr_b16 a[130:131], v3 offset:53248
v_cvt_pk_bf16_f32 v98, v148, v149
v_add_f32 v142, v142, v150
v_mfma_f32_16x16x32_bf16 v[76:79], a[148:151], v[188:191], v[76:79]
v_add_f32 v142, v142, v151
v_cvt_pk_bf16_f32 v99, v150, v151
v_mfma_f32_16x16x32_bf16 v[84:87], a[148:151], v[220:223], v[84:87]
v_exp_f32 v148, v52
s_waitcnt lgkmcnt(3)
v_mfma_f32_16x16x32_bf16 v[60:63], a[152:155], v[160:163], v[60:63]
ds_read_b64_tr_b16 a[132:133], v4 offset:49152
v_exp_f32 v149, v53
v_mfma_f32_16x16x32_bf16 v[68:71], a[152:155], v[176:179], v[68:71]
ds_read_b64_tr_b16 a[134:135], v4 offset:53248
v_exp_f32 v150, v54
v_mfma_f32_16x16x32_bf16 v[76:79], a[152:155], v[192:195], v[76:79]
v_exp_f32 v151, v55
v_mfma_f32_16x16x32_bf16 v[84:87], a[152:155], v[224:227], v[84:87]
v_add_f32 v143, v143, v148
s_waitcnt lgkmcnt(4)
v_mfma_f32_16x16x32_bf16 v[60:63], a[156:159], v[164:167], v[60:63]
ds_read_b64_tr_b16 a[136:137], v3 offset:50176
v_add_f32 v143, v143, v149
v_mfma_f32_16x16x32_bf16 v[68:71], a[156:159], v[180:183], v[68:71]
ds_read_b64_tr_b16 a[138:139], v3 offset:54272
v_cvt_pk_bf16_f32 v102, v148, v149
v_add_f32 v143, v143, v150
v_mfma_f32_16x16x32_bf16 v[76:79], a[156:159], v[196:199], v[76:79]
v_add_f32 v143, v143, v151
v_cvt_pk_bf16_f32 v103, v150, v151
v_max3_f32 v144, v140, v141, v142
v_max_f32 v144, v144, v143
v_cmp_lt_f32 vcc, s29, v144
v_mfma_f32_16x16x32_bf16 v[84:87], a[156:159], v[228:231], v[84:87]
s_nop 0
s_cbranch_vccnz K1_STUB12
K1_BACK12:
s_waitcnt lgkmcnt(4)
v_mfma_f32_16x16x32_bf16 a[0:3], a[128:131], v[88:91], a[0:3]
ds_read_b64_tr_b16 a[140:141], v4 offset:50176
v_add_f32 v136, v136, v140
v_mfma_f32_16x16x32_bf16 a[32:35], a[128:131], v[92:95], a[32:35]
ds_read_b64_tr_b16 a[142:143], v4 offset:54272
v_add_f32 v137, v137, v141
v_mfma_f32_16x16x32_bf16 a[64:67], a[128:131], v[96:99], a[64:67]
v_add_f32 v138, v138, v142
v_add_f32 v139, v139, v143
v_mfma_f32_16x16x32_bf16 a[96:99], a[128:131], v[100:103], a[96:99]
v_exp_f32 v144, v56
s_waitcnt lgkmcnt(4)
v_mfma_f32_16x16x32_bf16 a[4:7], a[132:135], v[88:91], a[4:7]
ds_read_b64_tr_b16 a[144:145], v3 offset:51200
v_exp_f32 v145, v57
v_mfma_f32_16x16x32_bf16 a[36:39], a[132:135], v[92:95], a[36:39]
ds_read_b64_tr_b16 a[146:147], v3 offset:55296
v_exp_f32 v146, v58
v_mfma_f32_16x16x32_bf16 a[68:71], a[132:135], v[96:99], a[68:71]
v_exp_f32 v147, v59
v_mfma_f32_16x16x32_bf16 a[100:103], a[132:135], v[100:103], a[100:103]
v_add_f32 v140, v144, v145
s_waitcnt lgkmcnt(4)
v_mfma_f32_16x16x32_bf16 a[8:11], a[136:139], v[88:91], a[8:11]
ds_read_b64_tr_b16 a[148:149], v4 offset:51200
v_cvt_pk_bf16_f32 v104, v144, v145
v_add_f32 v140, v140, v146
v_mfma_f32_16x16x32_bf16 a[40:43], a[136:139], v[92:95], a[40:43]
ds_read_b64_tr_b16 a[150:151], v4 offset:55296
v_add_f32 v140, v140, v147
v_cvt_pk_bf16_f32 v105, v146, v147
v_mfma_f32_16x16x32_bf16 a[72:75], a[136:139], v[96:99], a[72:75]
v_exp_f32 v144, v64
v_mfma_f32_16x16x32_bf16 a[104:107], a[136:139], v[100:103], a[104:107]
v_exp_f32 v145, v65
s_waitcnt lgkmcnt(4)
v_mfma_f32_16x16x32_bf16 a[12:15], a[140:143], v[88:91], a[12:15]
ds_read_b64_tr_b16 a[152:153], v3 offset:52224
v_exp_f32 v146, v66
v_mfma_f32_16x16x32_bf16 a[44:47], a[140:143], v[92:95], a[44:47]
ds_read_b64_tr_b16 a[154:155], v3 offset:56320
v_exp_f32 v147, v67
v_mfma_f32_16x16x32_bf16 a[76:79], a[140:143], v[96:99], a[76:79]
v_add_f32 v141, v144, v145
v_cvt_pk_bf16_f32 v108, v144, v145
v_mfma_f32_16x16x32_bf16 a[108:111], a[140:143], v[100:103], a[108:111]
v_add_f32 v141, v141, v146
s_waitcnt lgkmcnt(4)
v_mfma_f32_16x16x32_bf16 a[16:19], a[144:147], v[88:91], a[16:19]
ds_read_b64_tr_b16 a[156:157], v4 offset:52224
v_add_f32 v141, v141, v147
v_mfma_f32_16x16x32_bf16 a[48:51], a[144:147], v[92:95], a[48:51]
ds_read_b64_tr_b16 a[158:159], v4 offset:56320
v_cvt_pk_bf16_f32 v109, v146, v147
v_exp_f32 v144, v72
v_mfma_f32_16x16x32_bf16 a[80:83], a[144:147], v[96:99], a[80:83]
v_exp_f32 v145, v73
v_mfma_f32_16x16x32_bf16 a[112:115], a[144:147], v[100:103], a[112:115]
v_exp_f32 v146, v74
s_waitcnt lgkmcnt(4)
v_mfma_f32_16x16x32_bf16 a[20:23], a[148:151], v[88:91], a[20:23]
s_waitcnt vmcnt(9)
s_barrier
ds_read_b128 a[128:131], v5
v_mfma_f32_16x16x32_bf16 a[52:55], a[148:151], v[92:95], a[52:55]
v_exp_f32 v147, v75
v_mfma_f32_16x16x32_bf16 a[84:87], a[148:151], v[96:99], a[84:87]
v_add_f32 v142, v144, v145
v_cvt_pk_bf16_f32 v112, v144, v145
v_mfma_f32_16x16x32_bf16 a[116:119], a[148:151], v[100:103], a[116:119]
v_add_f32 v142, v142, v146
v_add_f32 v142, v142, v147
s_waitcnt lgkmcnt(3)
v_mfma_f32_16x16x32_bf16 a[24:27], a[152:155], v[88:91], a[24:27]
s_add_u32 m0, s23, 65536
s_add_u32 s30, s26, 128
buffer_load_dwordx4 v18, s[12:15], s30 offen lds
ds_read_b128 a[132:135], v5 offset:1024
v_cvt_pk_bf16_f32 v113, v146, v147
v_exp_f32 v144, v80
v_mfma_f32_16x16x32_bf16 a[56:59], a[152:155], v[92:95], a[56:59]
v_exp_f32 v145, v81
v_mfma_f32_16x16x32_bf16 a[88:91], a[152:155], v[96:99], a[88:91]
v_exp_f32 v146, v82
v_mfma_f32_16x16x32_bf16 a[120:123], a[152:155], v[100:103], a[120:123]
s_waitcnt lgkmcnt(2)
v_mfma_f32_16x16x32_bf16 a[28:31], a[156:159], v[88:91], a[28:31]
ds_read_b128 a[136:139], v5 offset:2048
v_exp_f32 v147, v83
v_mfma_f32_16x16x32_bf16 a[60:63], a[156:159], v[92:95], a[60:63]
v_add_f32 v143, v144, v145
v_cvt_pk_bf16_f32 v116, v144, v145
v_mfma_f32_16x16x32_bf16 a[92:95], a[156:159], v[96:99], a[92:95]
v_add_f32 v143, v143, v146
v_add_f32 v143, v143, v147
v_mfma_f32_16x16x32_bf16 a[124:127], a[156:159], v[100:103], a[124:127]
v_cvt_pk_bf16_f32 v117, v146, v147
s_waitcnt lgkmcnt(2)
v_mfma_f32_16x16x32_bf16 v[24:27], a[128:131], v[152:155], v[120:123]
ds_read_b128 a[140:143], v5 offset:3072
v_exp_f32 v148, v60
v_mfma_f32_16x16x32_bf16 v[32:35], a[128:131], v[168:171], v[124:127]
v_exp_f32 v149, v61
v_mfma_f32_16x16x32_bf16 v[40:43], a[128:131], v[184:187], v[128:131]
v_exp_f32 v150, v62
v_mfma_f32_16x16x32_bf16 v[48:51], a[128:131], v[216:219], v[132:135]
v_exp_f32 v151, v63
s_waitcnt lgkmcnt(2)
v_mfma_f32_16x16x32_bf16 v[24:27], a[132:135], v[156:159], v[24:27]
buffer_load_dwordx4 v19, s[12:15], s30 offen offset:1024 lds
ds_read_b128 a[144:147], v5 offset:4096
v_add_f32 v140, v140, v148
v_mfma_f32_16x16x32_bf16 v[32:35], a[132:135], v[172:175], v[32:35]
v_add_f32 v140, v140, v149
v_cvt_pk_bf16_f32 v106, v148, v149
v_mfma_f32_16x16x32_bf16 v[40:43], a[132:135], v[188:191], v[40:43]
v_add_f32 v140, v140, v150
v_add_f32 v140, v140, v151
v_mfma_f32_16x16x32_bf16 v[48:51], a[132:135], v[220:223], v[48:51]
v_cvt_pk_bf16_f32 v107, v150, v151
v_exp_f32 v148, v68
s_waitcnt lgkmcnt(2)
v_mfma_f32_16x16x32_bf16 v[24:27], a[136:139], v[160:163], v[24:27]
ds_read_b128 a[148:151], v5 offset:5120
v_mfma_f32_16x16x32_bf16 v[32:35], a[136:139], v[176:179], v[32:35]
v_exp_f32 v149, v69
v_mfma_f32_16x16x32_bf16 v[40:43], a[136:139], v[192:195], v[40:43]
v_exp_f32 v150, v70
v_mfma_f32_16x16x32_bf16 v[48:51], a[136:139], v[224:227], v[48:51]
v_exp_f32 v151, v71
s_waitcnt lgkmcnt(2)
v_mfma_f32_16x16x32_bf16 v[24:27], a[140:143], v[164:167], v[24:27]
ds_read_b128 a[152:155], v5 offset:6144
v_add_f32 v141, v141, v148
v_add_f32 v141, v141, v149
v_mfma_f32_16x16x32_bf16 v[32:35], a[140:143], v[180:183], v[32:35]
v_cvt_pk_bf16_f32 v110, v148, v149
v_add_f32 v141, v141, v150
v_mfma_f32_16x16x32_bf16 v[40:43], a[140:143], v[196:199], v[40:43]
v_add_f32 v141, v141, v151
v_cvt_pk_bf16_f32 v111, v150, v151
v_mfma_f32_16x16x32_bf16 v[48:51], a[140:143], v[228:231], v[48:51]
v_exp_f32 v148, v76
s_waitcnt lgkmcnt(2)
v_mfma_f32_16x16x32_bf16 v[28:31], a[144:147], v[152:155], v[120:123]
ds_read_b128 a[156:159], v5 offset:7168
v_exp_f32 v149, v77
v_mfma_f32_16x16x32_bf16 v[36:39], a[144:147], v[168:171], v[124:127]
buffer_load_dwordx4 v20, s[12:15], s30 offen offset:2048 lds
v_exp_f32 v150, v78
v_mfma_f32_16x16x32_bf16 v[44:47], a[144:147], v[184:187], v[128:131]
v_exp_f32 v151, v79
v_mfma_f32_16x16x32_bf16 v[52:55], a[144:147], v[216:219], v[132:135]
v_add_f32 v142, v142, v148
s_waitcnt lgkmcnt(2)
v_mfma_f32_16x16x32_bf16 v[28:31], a[148:151], v[156:159], v[28:31]
ds_read_b64_tr_b16 a[128:129], v3 offset:57344
v_add_f32 v142, v142, v149
v_mfma_f32_16x16x32_bf16 v[36:39], a[148:151], v[172:175], v[36:39]
ds_read_b64_tr_b16 a[130:131], v3 offset:61440
v_cvt_pk_bf16_f32 v114, v148, v149
v_add_f32 v142, v142, v150
v_mfma_f32_16x16x32_bf16 v[44:47], a[148:151], v[188:191], v[44:47]
v_add_f32 v142, v142, v151
v_cvt_pk_bf16_f32 v115, v150, v151
v_mfma_f32_16x16x32_bf16 v[52:55], a[148:151], v[220:223], v[52:55]
v_exp_f32 v148, v84
s_waitcnt lgkmcnt(3)
v_mfma_f32_16x16x32_bf16 v[28:31], a[152:155], v[160:163], v[28:31]
ds_read_b64_tr_b16 a[132:133], v4 offset:57344
v_exp_f32 v149, v85
v_mfma_f32_16x16x32_bf16 v[36:39], a[152:155], v[176:179], v[36:39]
ds_read_b64_tr_b16 a[134:135], v4 offset:61440
v_exp_f32 v150, v86
v_mfma_f32_16x16x32_bf16 v[44:47], a[152:155], v[192:195], v[44:47]
v_exp_f32 v151, v87
v_mfma_f32_16x16x32_bf16 v[52:55], a[152:155], v[224:227], v[52:55]
v_add_f32 v143, v143, v148
s_waitcnt lgkmcnt(4)
v_mfma_f32_16x16x32_bf16 v[28:31], a[156:159], v[164:167], v[28:31]
ds_read_b64_tr_b16 a[136:137], v3 offset:58368
v_add_f32 v143, v143, v149
v_mfma_f32_16x16x32_bf16 v[36:39], a[156:159], v[180:183], v[36:39]
buffer_load_dwordx4 v21, s[12:15], s30 offen offset:3072 lds
ds_read_b64_tr_b16 a[138:139], v3 offset:62464
v_cvt_pk_bf16_f32 v118, v148, v149
v_add_f32 v143, v143, v150
v_mfma_f32_16x16x32_bf16 v[44:47], a[156:159], v[196:199], v[44:47]
v_add_f32 v143, v143, v151
v_cvt_pk_bf16_f32 v119, v150, v151
v_max3_f32 v144, v140, v141, v142
v_max_f32 v144, v144, v143
v_cmp_lt_f32 vcc, s29, v144
v_mfma_f32_16x16x32_bf16 v[52:55], a[156:159], v[228:231], v[52:55]
s_nop 0
s_cbranch_vccnz K1_STUB13
K1_BACK13:
s_waitcnt lgkmcnt(4)
v_mfma_f32_16x16x32_bf16 a[0:3], a[128:131], v[104:107], a[0:3]
ds_read_b64_tr_b16 a[140:141], v4 offset:58368
v_add_f32 v136, v136, v140
v_mfma_f32_16x16x32_bf16 a[32:35], a[128:131], v[108:111], a[32:35]
ds_read_b64_tr_b16 a[142:143], v4 offset:62464
v_add_f32 v137, v137, v141
v_mfma_f32_16x16x32_bf16 a[64:67], a[128:131], v[112:115], a[64:67]
v_add_f32 v138, v138, v142
v_add_f32 v139, v139, v143
v_mfma_f32_16x16x32_bf16 a[96:99], a[128:131], v[116:119], a[96:99]
v_exp_f32 v144, v24
s_waitcnt lgkmcnt(4)
v_mfma_f32_16x16x32_bf16 a[4:7], a[132:135], v[104:107], a[4:7]
ds_read_b64_tr_b16 a[144:145], v3 offset:59392
v_exp_f32 v145, v25
v_mfma_f32_16x16x32_bf16 a[36:39], a[132:135], v[108:111], a[36:39]
ds_read_b64_tr_b16 a[146:147], v3 offset:63488
v_exp_f32 v146, v26
v_mfma_f32_16x16x32_bf16 a[68:71], a[132:135], v[112:115], a[68:71]
v_exp_f32 v147, v27
v_mfma_f32_16x16x32_bf16 a[100:103], a[132:135], v[116:119], a[100:103]
v_add_f32 v140, v144, v145
s_waitcnt lgkmcnt(4)
v_mfma_f32_16x16x32_bf16 a[8:11], a[136:139], v[104:107], a[8:11]
ds_read_b64_tr_b16 a[148:149], v4 offset:59392
v_cvt_pk_bf16_f32 v88, v144, v145
v_add_f32 v140, v140, v146
v_mfma_f32_16x16x32_bf16 a[40:43], a[136:139], v[108:111], a[40:43]
ds_read_b64_tr_b16 a[150:151], v4 offset:63488
v_add_f32 v140, v140, v147
v_cvt_pk_bf16_f32 v89, v146, v147
v_mfma_f32_16x16x32_bf16 a[72:75], a[136:139], v[112:115], a[72:75]
s_add_u32 m0, s23, 69632
s_add_u32 s31, s26, 73856
buffer_load_dwordx4 v18, s[12:15], s31 offen lds
v_exp_f32 v144, v32
v_mfma_f32_16x16x32_bf16 a[104:107], a[136:139], v[116:119], a[104:107]
v_exp_f32 v145, v33
s_waitcnt lgkmcnt(4)
v_mfma_f32_16x16x32_bf16 a[12:15], a[140:143], v[104:107], a[12:15]
ds_read_b64_tr_b16 a[152:153], v3 offset:60416
v_exp_f32 v146, v34
v_mfma_f32_16x16x32_bf16 a[44:47], a[140:143], v[108:111], a[44:47]
ds_read_b64_tr_b16 a[154:155], v3 offset:64512
v_exp_f32 v147, v35
v_mfma_f32_16x16x32_bf16 a[76:79], a[140:143], v[112:115], a[76:79]
v_add_f32 v141, v144, v145
v_cvt_pk_bf16_f32 v92, v144, v145
v_mfma_f32_16x16x32_bf16 a[108:111], a[140:143], v[116:119], a[108:111]
v_add_f32 v141, v141, v146
s_waitcnt lgkmcnt(4)
v_mfma_f32_16x16x32_bf16 a[16:19], a[144:147], v[104:107], a[16:19]
ds_read_b64_tr_b16 a[156:157], v4 offset:60416
v_add_f32 v141, v141, v147
v_mfma_f32_16x16x32_bf16 a[48:51], a[144:147], v[108:111], a[48:51]
ds_read_b64_tr_b16 a[158:159], v4 offset:64512
v_cvt_pk_bf16_f32 v93, v146, v147
v_exp_f32 v144, v40
v_mfma_f32_16x16x32_bf16 a[80:83], a[144:147], v[112:115], a[80:83]
v_exp_f32 v145, v41
v_mfma_f32_16x16x32_bf16 a[112:115], a[144:147], v[116:119], a[112:115]
v_exp_f32 v146, v42
s_waitcnt lgkmcnt(4)
v_mfma_f32_16x16x32_bf16 a[20:23], a[148:151], v[104:107], a[20:23]
ds_read_b128 a[128:131], v5 offset:8192
v_mfma_f32_16x16x32_bf16 a[52:55], a[148:151], v[108:111], a[52:55]
v_exp_f32 v147, v43
v_mfma_f32_16x16x32_bf16 a[84:87], a[148:151], v[112:115], a[84:87]
buffer_load_dwordx4 v19, s[12:15], s31 offen offset:1024 lds
v_add_f32 v142, v144, v145
v_cvt_pk_bf16_f32 v96, v144, v145
v_mfma_f32_16x16x32_bf16 a[116:119], a[148:151], v[116:119], a[116:119]
v_add_f32 v142, v142, v146
v_add_f32 v142, v142, v147
s_waitcnt lgkmcnt(3)
v_mfma_f32_16x16x32_bf16 a[24:27], a[152:155], v[104:107], a[24:27]
ds_read_b128 a[132:135], v5 offset:9216
v_cvt_pk_bf16_f32 v97, v146, v147
v_exp_f32 v144, v48
v_mfma_f32_16x16x32_bf16 a[56:59], a[152:155], v[108:111], a[56:59]
v_exp_f32 v145, v49
v_mfma_f32_16x16x32_bf16 a[88:91], a[152:155], v[112:115], a[88:91]
v_exp_f32 v146, v50
v_mfma_f32_16x16x32_bf16 a[120:123], a[152:155], v[116:119], a[120:123]
s_waitcnt lgkmcnt(2)
v_mfma_f32_16x16x32_bf16 a[28:31], a[156:159], v[104:107], a[28:31]
ds_read_b128 a[136:139], v5 offset:10240
v_exp_f32 v147, v51
v_mfma_f32_16x16x32_bf16 a[60:63], a[156:159], v[108:111], a[60:63]
v_add_f32 v143, v144, v145
v_cvt_pk_bf16_f32 v100, v144, v145
v_mfma_f32_16x16x32_bf16 a[92:95], a[156:159], v[112:115], a[92:95]
v_add_f32 v143, v143, v146
v_add_f32 v143, v143, v147
v_mfma_f32_16x16x32_bf16 a[124:127], a[156:159], v[116:119], a[124:127]
v_cvt_pk_bf16_f32 v101, v146, v147
s_waitcnt lgkmcnt(2)
v_mfma_f32_16x16x32_bf16 v[56:59], a[128:131], v[152:155], v[120:123]
ds_read_b128 a[140:143], v5 offset:11264
v_exp_f32 v148, v28
v_mfma_f32_16x16x32_bf16 v[64:67], a[128:131], v[168:171], v[124:127]
v_exp_f32 v149, v29
v_mfma_f32_16x16x32_bf16 v[72:75], a[128:131], v[184:187], v[128:131]
v_exp_f32 v150, v30
v_mfma_f32_16x16x32_bf16 v[80:83], a[128:131], v[216:219], v[132:135]
buffer_load_dwordx4 v20, s[12:15], s31 offen offset:2048 lds
v_exp_f32 v151, v31
s_waitcnt lgkmcnt(2)
v_mfma_f32_16x16x32_bf16 v[56:59], a[132:135], v[156:159], v[56:59]
ds_read_b128 a[144:147], v5 offset:12288
v_add_f32 v140, v140, v148
v_mfma_f32_16x16x32_bf16 v[64:67], a[132:135], v[172:175], v[64:67]
v_add_f32 v140, v140, v149
v_cvt_pk_bf16_f32 v90, v148, v149
v_mfma_f32_16x16x32_bf16 v[72:75], a[132:135], v[188:191], v[72:75]
v_add_f32 v140, v140, v150
v_add_f32 v140, v140, v151
v_mfma_f32_16x16x32_bf16 v[80:83], a[132:135], v[220:223], v[80:83]
v_cvt_pk_bf16_f32 v91, v150, v151
v_exp_f32 v148, v36
s_waitcnt lgkmcnt(2)
v_mfma_f32_16x16x32_bf16 v[56:59], a[136:139], v[160:163], v[56:59]
ds_read_b128 a[148:151], v5 offset:13312
v_mfma_f32_16x16x32_bf16 v[64:67], a[136:139], v[176:179], v[64:67]
v_exp_f32 v149, v37
v_mfma_f32_16x16x32_bf16 v[72:75], a[136:139], v[192:195], v[72:75]
v_exp_f32 v150, v38
v_mfma_f32_16x16x32_bf16 v[80:83], a[136:139], v[224:227], v[80:83]
v_exp_f32 v151, v39
s_waitcnt lgkmcnt(2)
v_mfma_f32_16x16x32_bf16 v[56:59], a[140:143], v[164:167], v[56:59]
ds_read_b128 a[152:155], v5 offset:14336
v_add_f32 v141, v141, v148
v_add_f32 v141, v141, v149
v_mfma_f32_16x16x32_bf16 v[64:67], a[140:143], v[180:183], v[64:67]
v_cvt_pk_bf16_f32 v94, v148, v149
v_add_f32 v141, v141, v150
v_mfma_f32_16x16x32_bf16 v[72:75], a[140:143], v[196:199], v[72:75]
v_add_f32 v141, v141, v151
buffer_load_dwordx4 v21, s[12:15], s31 offen offset:3072 lds
v_mfma_f32_16x16x32_bf16 v[80:83], a[140:143], v[228:231], v[80:83]
v_cvt_pk_bf16_f32 v95, v150, v151
v_exp_f32 v148, v44
s_waitcnt lgkmcnt(2)
v_mfma_f32_16x16x32_bf16 v[60:63], a[144:147], v[152:155], v[120:123]
ds_read_b128 a[156:159], v5 offset:15360
v_exp_f32 v149, v45
v_mfma_f32_16x16x32_bf16 v[68:71], a[144:147], v[168:171], v[124:127]
v_exp_f32 v150, v46
v_mfma_f32_16x16x32_bf16 v[76:79], a[144:147], v[184:187], v[128:131]
v_exp_f32 v151, v47
v_mfma_f32_16x16x32_bf16 v[84:87], a[144:147], v[216:219], v[132:135]
v_add_f32 v142, v142, v148
s_waitcnt lgkmcnt(2)
v_mfma_f32_16x16x32_bf16 v[60:63], a[148:151], v[156:159], v[60:63]
ds_read_b64_tr_b16 a[128:129], v1 offset:16384
v_add_f32 v142, v142, v149
v_mfma_f32_16x16x32_bf16 v[68:71], a[148:151], v[172:175], v[68:71]
ds_read_b64_tr_b16 a[130:131], v1 offset:20480
v_cvt_pk_bf16_f32 v98, v148, v149
v_add_f32 v142, v142, v150
v_mfma_f32_16x16x32_bf16 v[76:79], a[148:151], v[188:191], v[76:79]
v_add_f32 v142, v142, v151
v_cvt_pk_bf16_f32 v99, v150, v151
v_mfma_f32_16x16x32_bf16 v[84:87], a[148:151], v[220:223], v[84:87]
v_exp_f32 v148, v52
s_waitcnt lgkmcnt(3)
v_mfma_f32_16x16x32_bf16 v[60:63], a[152:155], v[160:163], v[60:63]
ds_read_b64_tr_b16 a[132:133], v2 offset:16384
v_exp_f32 v149, v53
v_mfma_f32_16x16x32_bf16 v[68:71], a[152:155], v[176:179], v[68:71]
ds_read_b64_tr_b16 a[134:135], v2 offset:20480
v_exp_f32 v150, v54
v_mfma_f32_16x16x32_bf16 v[76:79], a[152:155], v[192:195], v[76:79]
v_exp_f32 v151, v55
v_mfma_f32_16x16x32_bf16 v[84:87], a[152:155], v[224:227], v[84:87]
v_add_f32 v143, v143, v148
s_waitcnt lgkmcnt(4)
v_mfma_f32_16x16x32_bf16 v[60:63], a[156:159], v[164:167], v[60:63]
ds_read_b64_tr_b16 a[136:137], v1 offset:17408
v_add_f32 v143, v143, v149
v_mfma_f32_16x16x32_bf16 v[68:71], a[156:159], v[180:183], v[68:71]
ds_read_b64_tr_b16 a[138:139], v1 offset:21504
v_cvt_pk_bf16_f32 v102, v148, v149
v_add_f32 v143, v143, v150
v_mfma_f32_16x16x32_bf16 v[76:79], a[156:159], v[196:199], v[76:79]
v_add_f32 v143, v143, v151
v_cvt_pk_bf16_f32 v103, v150, v151
v_max3_f32 v144, v140, v141, v142
v_max_f32 v144, v144, v143
v_cmp_lt_f32 vcc, s29, v144
v_mfma_f32_16x16x32_bf16 v[84:87], a[156:159], v[228:231], v[84:87]
s_nop 0
s_cbranch_vccnz K1_STUB14
K1_BACK14:
s_waitcnt lgkmcnt(4)
v_mfma_f32_16x16x32_bf16 a[0:3], a[128:131], v[88:91], a[0:3]
ds_read_b64_tr_b16 a[140:141], v2 offset:17408
v_add_f32 v136, v136, v140
v_mfma_f32_16x16x32_bf16 a[32:35], a[128:131], v[92:95], a[32:35]
ds_read_b64_tr_b16 a[142:143], v2 offset:21504
v_add_f32 v137, v137, v141
v_add_f32 v138, v138, v142
v_add_f32 v139, v139, v143
v_mfma_f32_16x16x32_bf16 a[64:67], a[128:131], v[96:99], a[64:67]
v_exp_f32 v144, v56
v_exp_f32 v145, v57
v_mfma_f32_16x16x32_bf16 a[96:99], a[128:131], v[100:103], a[96:99]
v_exp_f32 v146, v58
v_exp_f32 v147, v59
s_waitcnt lgkmcnt(4)
v_mfma_f32_16x16x32_bf16 a[4:7], a[132:135], v[88:91], a[4:7]
ds_read_b64_tr_b16 a[144:145], v1 offset:18432
v_add_f32 v140, v144, v145
v_cvt_pk_bf16_f32 v104, v144, v145
v_add_f32 v140, v140, v146
v_mfma_f32_16x16x32_bf16 a[36:39], a[132:135], v[92:95], a[36:39]
ds_read_b64_tr_b16 a[146:147], v1 offset:22528
v_add_f32 v140, v140, v147
v_cvt_pk_bf16_f32 v105, v146, v147
v_exp_f32 v144, v64
v_mfma_f32_16x16x32_bf16 a[68:71], a[132:135], v[96:99], a[68:71]
v_exp_f32 v145, v65
v_exp_f32 v146, v66
v_mfma_f32_16x16x32_bf16 a[100:103], a[132:135], v[100:103], a[100:103]
v_exp_f32 v147, v67
v_add_f32 v141, v144, v145
s_waitcnt lgkmcnt(4)
v_mfma_f32_16x16x32_bf16 a[8:11], a[136:139], v[88:91], a[8:11]
ds_read_b64_tr_b16 a[148:149], v2 offset:18432
v_cvt_pk_bf16_f32 v108, v144, v145
v_add_f32 v141, v141, v146
v_add_f32 v141, v141, v147
v_mfma_f32_16x16x32_bf16 a[40:43], a[136:139], v[92:95], a[40:43]
ds_read_b64_tr_b16 a[150:151], v2 offset:22528
v_cvt_pk_bf16_f32 v109, v146, v147
v_exp_f32 v144, v72
v_exp_f32 v145, v73
v_mfma_f32_16x16x32_bf16 a[72:75], a[136:139], v[96:99], a[72:75]
v_exp_f32 v146, v74
v_mfma_f32_16x16x32_bf16 a[104:107], a[136:139], v[100:103], a[104:107]
v_exp_f32 v147, v75
v_add_f32 v142, v144, v145
v_cvt_pk_bf16_f32 v112, v144, v145
s_waitcnt lgkmcnt(4)
v_mfma_f32_16x16x32_bf16 a[12:15], a[140:143], v[88:91], a[12:15]
ds_read_b64_tr_b16 a[152:153], v1 offset:19456
v_add_f32 v142, v142, v146
v_add_f32 v142, v142, v147
v_cvt_pk_bf16_f32 v113, v146, v147
v_exp_f32 v144, v80
v_mfma_f32_16x16x32_bf16 a[44:47], a[140:143], v[92:95], a[44:47]
ds_read_b64_tr_b16 a[154:155], v1 offset:23552
v_exp_f32 v145, v81
v_mfma_f32_16x16x32_bf16 a[76:79], a[140:143], v[96:99], a[76:79]
v_exp_f32 v146, v82
v_exp_f32 v147, v83
v_mfma_f32_16x16x32_bf16 a[108:111], a[140:143], v[100:103], a[108:111]
v_add_f32 v143, v144, v145
v_cvt_pk_bf16_f32 v116, v144, v145
v_add_f32 v143, v143, v146
s_waitcnt lgkmcnt(4)
v_mfma_f32_16x16x32_bf16 a[16:19], a[144:147], v[88:91], a[16:19]
ds_read_b64_tr_b16 a[156:157], v2 offset:19456
v_add_f32 v143, v143, v147
v_cvt_pk_bf16_f32 v117, v146, v147
v_exp_f32 v148, v60
v_mfma_f32_16x16x32_bf16 a[48:51], a[144:147], v[92:95], a[48:51]
ds_read_b64_tr_b16 a[158:159], v2 offset:23552
v_exp_f32 v149, v61
v_exp_f32 v150, v62
v_mfma_f32_16x16x32_bf16 a[80:83], a[144:147], v[96:99], a[80:83]
v_exp_f32 v151, v63
v_add_f32 v140, v140, v148
v_mfma_f32_16x16x32_bf16 a[112:115], a[144:147], v[100:103], a[112:115]
v_add_f32 v140, v140, v149
v_cvt_pk_bf16_f32 v106, v148, v149
v_add_f32 v140, v140, v150
v_add_f32 v140, v140, v151
s_waitcnt lgkmcnt(4)
v_mfma_f32_16x16x32_bf16 a[20:23], a[148:151], v[88:91], a[20:23]
ds_read_b64_tr_b16 a[128:129], v1 offset:24576
v_cvt_pk_bf16_f32 v107, v150, v151
v_exp_f32 v148, v68
v_mfma_f32_16x16x32_bf16 a[52:55], a[148:151], v[92:95], a[52:55]
ds_read_b64_tr_b16 a[130:131], v1 offset:28672
v_exp_f32 v149, v69
v_exp_f32 v150, v70
v_mfma_f32_16x16x32_bf16 a[84:87], a[148:151], v[96:99], a[84:87]
v_exp_f32 v151, v71
v_add_f32 v141, v141, v148
v_add_f32 v141, v141, v149
v_mfma_f32_16x16x32_bf16 a[116:119], a[148:151], v[100:103], a[116:119]
v_cvt_pk_bf16_f32 v110, v148, v149
v_add_f32 v141, v141, v150
v_add_f32 v141, v141, v151
s_waitcnt lgkmcnt(4)
v_mfma_f32_16x16x32_bf16 a[24:27], a[152:155], v[88:91], a[24:27]
ds_read_b64_tr_b16 a[132:133], v2 offset:24576
v_cvt_pk_bf16_f32 v111, v150, v151
v_exp_f32 v148, v76
v_exp_f32 v149, v77
v_mfma_f32_16x16x32_bf16 a[56:59], a[152:155], v[92:95], a[56:59]
ds_read_b64_tr_b16 a[134:135], v2 offset:28672
v_exp_f32 v150, v78
v_mfma_f32_16x16x32_bf16 a[88:91], a[152:155], v[96:99], a[88:91]
v_exp_f32 v151, v79
v_add_f32 v142, v142, v148
v_add_f32 v142, v142, v149
v_mfma_f32_16x16x32_bf16 a[120:123], a[152:155], v[100:103], a[120:123]
v_cvt_pk_bf16_f32 v114, v148, v149
v_add_f32 v142, v142, v150
v_add_f32 v142, v142, v151
v_cvt_pk_bf16_f32 v115, v150, v151
s_waitcnt lgkmcnt(4)
v_mfma_f32_16x16x32_bf16 a[28:31], a[156:159], v[88:91], a[28:31]
ds_read_b64_tr_b16 a[136:137], v1 offset:25600
v_exp_f32 v148, v84
v_exp_f32 v149, v85
v_mfma_f32_16x16x32_bf16 a[60:63], a[156:159], v[92:95], a[60:63]
ds_read_b64_tr_b16 a[138:139], v1 offset:29696
v_exp_f32 v150, v86
v_exp_f32 v151, v87
v_mfma_f32_16x16x32_bf16 a[92:95], a[156:159], v[96:99], a[92:95]
v_add_f32 v143, v143, v148
v_add_f32 v143, v143, v149
v_cvt_pk_bf16_f32 v118, v148, v149
v_add_f32 v143, v143, v150
v_add_f32 v143, v143, v151
v_cvt_pk_bf16_f32 v119, v150, v151
v_max3_f32 v144, v140, v141, v142
v_max_f32 v144, v144, v143
v_cmp_lt_f32 vcc, s29, v144
v_mfma_f32_16x16x32_bf16 a[124:127], a[156:159], v[100:103], a[124:127]
s_nop 0
s_cbranch_vccnz K1_STUB15
K1_BACK15:
s_waitcnt lgkmcnt(4)
v_mfma_f32_16x16x32_bf16 a[0:3], a[128:131], v[104:107], a[0:3]
ds_read_b64_tr_b16 a[140:141], v2 offset:25600
v_add_f32 v136, v136, v140
v_mfma_f32_16x16x32_bf16 a[32:35], a[128:131], v[108:111], a[32:35]
ds_read_b64_tr_b16 a[142:143], v2 offset:29696
v_add_f32 v137, v137, v141
v_add_f32 v138, v138, v142
v_add_f32 v139, v139, v143
v_mfma_f32_16x16x32_bf16 a[64:67], a[128:131], v[112:115], a[64:67]
v_mov_b32 v144, v136
s_nop 1
v_permlane16_swap_b32 v136, v144
v_mfma_f32_16x16x32_bf16 a[96:99], a[128:131], v[116:119], a[96:99]
v_add_f32 v136, v136, v144
s_waitcnt lgkmcnt(4)
v_mfma_f32_16x16x32_bf16 a[4:7], a[132:135], v[104:107], a[4:7]
ds_read_b64_tr_b16 a[144:145], v1 offset:26624
v_mov_b32 v144, v136
v_mfma_f32_16x16x32_bf16 a[36:39], a[132:135], v[108:111], a[36:39]
ds_read_b64_tr_b16 a[146:147], v1 offset:30720
v_permlane32_swap_b32 v136, v144
v_mfma_f32_16x16x32_bf16 a[68:71], a[132:135], v[112:115], a[68:71]
v_add_f32 v136, v136, v144
v_mfma_f32_16x16x32_bf16 a[100:103], a[132:135], v[116:119], a[100:103]
s_waitcnt lgkmcnt(4)
v_mfma_f32_16x16x32_bf16 a[8:11], a[136:139], v[104:107], a[8:11]
ds_read_b64_tr_b16 a[148:149], v2 offset:26624
v_mfma_f32_16x16x32_bf16 a[40:43], a[136:139], v[108:111], a[40:43]
ds_read_b64_tr_b16 a[150:151], v2 offset:30720
v_mfma_f32_16x16x32_bf16 a[72:75], a[136:139], v[112:115], a[72:75]
v_rcp_f32 v136, v136
v_mfma_f32_16x16x32_bf16 a[104:107], a[136:139], v[116:119], a[104:107]
v_mov_b32 v145, v137
s_waitcnt lgkmcnt(4)
v_mfma_f32_16x16x32_bf16 a[12:15], a[140:143], v[104:107], a[12:15]
ds_read_b64_tr_b16 a[152:153], v1 offset:27648
v_permlane16_swap_b32 v137, v145
v_mfma_f32_16x16x32_bf16 a[44:47], a[140:143], v[108:111], a[44:47]
ds_read_b64_tr_b16 a[154:155], v1 offset:31744
v_add_f32 v137, v137, v145
v_mfma_f32_16x16x32_bf16 a[76:79], a[140:143], v[112:115], a[76:79]
v_mov_b32 v145, v137
s_nop 1
v_permlane32_swap_b32 v137, v145
v_mfma_f32_16x16x32_bf16 a[108:111], a[140:143], v[116:119], a[108:111]
v_add_f32 v137, v137, v145
s_waitcnt lgkmcnt(4)
v_mfma_f32_16x16x32_bf16 a[16:19], a[144:147], v[104:107], a[16:19]
ds_read_b64_tr_b16 a[156:157], v2 offset:27648
v_mfma_f32_16x16x32_bf16 a[48:51], a[144:147], v[108:111], a[48:51]
ds_read_b64_tr_b16 a[158:159], v2 offset:31744
v_mfma_f32_16x16x32_bf16 a[80:83], a[144:147], v[112:115], a[80:83]
v_rcp_f32 v137, v137
v_mfma_f32_16x16x32_bf16 a[112:115], a[144:147], v[116:119], a[112:115]
v_mov_b32 v146, v138
s_waitcnt lgkmcnt(4)
v_mfma_f32_16x16x32_bf16 a[20:23], a[148:151], v[104:107], a[20:23]
s_waitcnt vmcnt(8)
s_barrier
ds_read_b64_tr_b16 a[128:129], v1 offset:32768
v_mfma_f32_16x16x32_bf16 a[52:55], a[148:151], v[108:111], a[52:55]
ds_read_b64_tr_b16 a[130:131], v1 offset:33792
v_permlane16_swap_b32 v138, v146
v_mfma_f32_16x16x32_bf16 a[84:87], a[148:151], v[112:115], a[84:87]
ds_read_b64_tr_b16 a[132:133], v2 offset:32768
v_add_f32 v138, v138, v146
v_mfma_f32_16x16x32_bf16 a[116:119], a[148:151], v[116:119], a[116:119]
ds_read_b64_tr_b16 a[134:135], v2 offset:33792
v_mov_b32 v146, v138
s_nop 1
v_permlane32_swap_b32 v138, v146
v_add_f32 v138, v138, v146
v_rcp_f32 v138, v138
v_mov_b32 v147, v139
s_nop 1
v_permlane16_swap_b32 v139, v147
v_add_f32 v139, v139, v147
v_mov_b32 v147, v139
s_nop 1
v_permlane32_swap_b32 v139, v147
v_add_f32 v139, v139, v147
v_rcp_f32 v139, v139
s_waitcnt lgkmcnt(6)
v_mfma_f32_16x16x32_bf16 a[24:27], a[152:155], v[104:107], a[24:27]
s_add_u32 m0, s23, 98304
s_add_u32 s30, s26, 256
buffer_load_dwordx4 v18, s[12:15], s30 offen lds
ds_read_b64_tr_b16 a[136:137], v1 offset:49152
v_mfma_f32_16x16x32_bf16 a[56:59], a[152:155], v[108:111], a[56:59]
ds_read_b64_tr_b16 a[138:139], v1 offset:50176
v_accvgpr_read_b32 v144, a0
v_mfma_f32_16x16x32_bf16 a[88:91], a[152:155], v[112:115], a[88:91]
ds_read_b64_tr_b16 a[140:141], v2 offset:49152
v_accvgpr_read_b32 v145, a1
v_mfma_f32_16x16x32_bf16 a[120:123], a[152:155], v[116:119], a[120:123]
ds_read_b64_tr_b16 a[142:143], v2 offset:50176
s_waitcnt lgkmcnt(8)
v_mfma_f32_16x16x32_bf16 a[28:31], a[156:159], v[104:107], a[28:31]
ds_read_b64_tr_b16 a[144:145], v1 offset:34816
v_accvgpr_read_b32 v146, a2
v_mfma_f32_16x16x32_bf16 a[60:63], a[156:159], v[108:111], a[60:63]
ds_read_b64_tr_b16 a[146:147], v1 offset:35840
v_accvgpr_read_b32 v147, a3
v_mfma_f32_16x16x32_bf16 a[92:95], a[156:159], v[112:115], a[92:95]
ds_read_b64_tr_b16 a[148:149], v2 offset:34816
v_pk_mul_f32 v[144:145], v[144:145], v[136:137] op_sel_hi:[1,0]
v_pk_mul_f32 v[146:147], v[146:147], v[136:137] op_sel_hi:[1,0]
v_cvt_pk_bf16_f32 v152, v144, v145
v_cvt_pk_bf16_f32 v153, v146, v147
v_accvgpr_read_b32 v248, a4
v_accvgpr_read_b32 v249, a5
v_accvgpr_read_b32 v250, a6
v_accvgpr_read_b32 v251, a7
v_pk_mul_f32 v[248:249], v[248:249], v[136:137] op_sel_hi:[1,0]
v_pk_mul_f32 v[250:251], v[250:251], v[136:137] op_sel_hi:[1,0]
v_cvt_pk_bf16_f32 v154, v248, v249
v_cvt_pk_bf16_f32 v155, v250, v251
v_mfma_f32_16x16x32_bf16 a[124:127], a[156:159], v[116:119], a[124:127]
buffer_load_dwordx4 v19, s[12:15], s30 offen offset:1024 lds
ds_read_b64_tr_b16 a[150:151], v2 offset:35840
v_accvgpr_read_b32 v148, a32
v_accvgpr_read_b32 v149, a33
v_accvgpr_read_b32 v150, a34
v_accvgpr_read_b32 v151, a35
v_pk_mul_f32 v[148:149], v[148:149], v[136:137] op_sel:[0,1] op_sel_hi:[1,1]
v_pk_mul_f32 v[150:151], v[150:151], v[136:137] op_sel:[0,1] op_sel_hi:[1,1]
v_cvt_pk_bf16_f32 v168, v148, v149
v_cvt_pk_bf16_f32 v169, v150, v151
v_accvgpr_read_b32 v252, a36
v_accvgpr_read_b32 v253, a37
v_accvgpr_read_b32 v254, a38
v_accvgpr_read_b32 v255, a39
v_pk_mul_f32 v[252:253], v[252:253], v[136:137] op_sel:[0,1] op_sel_hi:[1,1]
v_pk_mul_f32 v[254:255], v[254:255], v[136:137] op_sel:[0,1] op_sel_hi:[1,1]
v_cvt_pk_bf16_f32 v170, v252, v253
v_cvt_pk_bf16_f32 v171, v254, v255
s_waitcnt lgkmcnt(8)
v_mfma_f32_16x16x32_bf16 v[24:27], a[128:131], v[152:155], 0
ds_read_b64_tr_b16 a[152:153], v1 offset:51200
v_accvgpr_read_b32 v144, a8
v_mfma_f32_16x16x32_bf16 v[28:31], a[128:131], v[168:171], 0
ds_read_b64_tr_b16 a[154:155], v1 offset:52224
v_accvgpr_read_b32 v145, a9
v_mfma_f32_16x16x32_bf16 v[32:35], a[132:135], v[152:155], 0
ds_read_b64_tr_b16 a[156:157], v2 offset:51200
v_accvgpr_read_b32 v146, a10
v_mfma_f32_16x16x32_bf16 v[36:39], a[132:135], v[168:171], 0
ds_read_b64_tr_b16 a[158:159], v2 offset:52224
s_waitcnt lgkmcnt(8)
v_mfma_f32_16x16x32_bf16 v[40:43], a[136:139], v[152:155], 0
ds_read_b64_tr_b16 a[128:129], v1 offset:36864
buffer_load_dwordx4 v20, s[12:15], s30 offen offset:2048 lds
v_mfma_f32_16x16x32_bf16 v[44:47], a[136:139], v[168:171], 0
ds_read_b64_tr_b16 a[130:131], v1 offset:37888
v_accvgpr_read_b32 v147, a11
v_mfma_f32_16x16x32_bf16 v[48:51], a[140:143], v[152:155], 0
ds_read_b64_tr_b16 a[132:133], v2 offset:36864
v_pk_mul_f32 v[144:145], v[144:145], v[136:137] op_sel_hi:[1,0]
v_pk_mul_f32 v[146:147], v[146:147], v[136:137] op_sel_hi:[1,0]
v_cvt_pk_bf16_f32 v156, v144, v145
v_cvt_pk_bf16_f32 v157, v146, v147
v_accvgpr_read_b32 v248, a12
v_accvgpr_read_b32 v249, a13
v_accvgpr_read_b32 v250, a14
v_accvgpr_read_b32 v251, a15
v_pk_mul_f32 v[248:249], v[248:249], v[136:137] op_sel_hi:[1,0]
v_pk_mul_f32 v[250:251], v[250:251], v[136:137] op_sel_hi:[1,0]
v_cvt_pk_bf16_f32 v158, v248, v249
v_cvt_pk_bf16_f32 v159, v250, v251
v_mfma_f32_16x16x32_bf16 v[52:55], a[140:143], v[168:171], 0
ds_read_b64_tr_b16 a[134:135], v2 offset:37888
v_accvgpr_read_b32 v148, a40
v_accvgpr_read_b32 v149, a41
v_accvgpr_read_b32 v150, a42
v_accvgpr_read_b32 v151, a43
v_pk_mul_f32 v[148:149], v[148:149], v[136:137] op_sel:[0,1] op_sel_hi:[1,1]
v_pk_mul_f32 v[150:151], v[150:151], v[136:137] op_sel:[0,1] op_sel_hi:[1,1]
v_cvt_pk_bf16_f32 v172, v148, v149
v_cvt_pk_bf16_f32 v173, v150, v151
v_accvgpr_read_b32 v252, a44
v_accvgpr_read_b32 v253, a45
v_accvgpr_read_b32 v254, a46
v_accvgpr_read_b32 v255, a47
v_pk_mul_f32 v[252:253], v[252:253], v[136:137] op_sel:[0,1] op_sel_hi:[1,1]
v_pk_mul_f32 v[254:255], v[254:255], v[136:137] op_sel:[0,1] op_sel_hi:[1,1]
v_cvt_pk_bf16_f32 v174, v252, v253
v_cvt_pk_bf16_f32 v175, v254, v255
s_waitcnt lgkmcnt(8)
v_mfma_f32_16x16x32_bf16 v[24:27], a[144:147], v[156:159], v[24:27]
ds_read_b64_tr_b16 a[136:137], v1 offset:53248
v_accvgpr_read_b32 v144, a16
v_mfma_f32_16x16x32_bf16 v[28:31], a[144:147], v[172:175], v[28:31]
ds_read_b64_tr_b16 a[138:139], v1 offset:54272
v_accvgpr_read_b32 v145, a17
v_mfma_f32_16x16x32_bf16 v[32:35], a[148:151], v[156:159], v[32:35]
ds_read_b64_tr_b16 a[140:141], v2 offset:53248
buffer_load_dwordx4 v21, s[12:15], s30 offen offset:3072 lds
v_mfma_f32_16x16x32_bf16 v[36:39], a[148:151], v[172:175], v[36:39]
ds_read_b64_tr_b16 a[142:143], v2 offset:54272
s_waitcnt lgkmcnt(8)
v_mfma_f32_16x16x32_bf16 v[40:43], a[152:155], v[156:159], v[40:43]
ds_read_b64_tr_b16 a[144:145], v1 offset:38912
v_accvgpr_read_b32 v146, a18
v_mfma_f32_16x16x32_bf16 v[44:47], a[152:155], v[172:175], v[44:47]
ds_read_b64_tr_b16 a[146:147], v1 offset:39936
v_accvgpr_read_b32 v147, a19
v_mfma_f32_16x16x32_bf16 v[48:51], a[156:159], v[156:159], v[48:51]
ds_read_b64_tr_b16 a[148:149], v2 offset:38912
v_pk_mul_f32 v[144:145], v[144:145], v[136:137] op_sel_hi:[1,0]
v_pk_mul_f32 v[146:147], v[146:147], v[136:137] op_sel_hi:[1,0]
v_cvt_pk_bf16_f32 v160, v144, v145
v_cvt_pk_bf16_f32 v161, v146, v147
v_accvgpr_read_b32 v248, a20
v_accvgpr_read_b32 v249, a21
v_accvgpr_read_b32 v250, a22
v_accvgpr_read_b32 v251, a23
v_pk_mul_f32 v[248:249], v[248:249], v[136:137] op_sel_hi:[1,0]
v_pk_mul_f32 v[250:251], v[250:251], v[136:137] op_sel_hi:[1,0]
v_cvt_pk_bf16_f32 v162, v248, v249
v_cvt_pk_bf16_f32 v163, v250, v251
v_mfma_f32_16x16x32_bf16 v[52:55], a[156:159], v[172:175], v[52:55]
ds_read_b64_tr_b16 a[150:151], v2 offset:39936
v_accvgpr_read_b32 v148, a48
v_accvgpr_read_b32 v149, a49
v_accvgpr_read_b32 v150, a50
v_accvgpr_read_b32 v151, a51
v_pk_mul_f32 v[148:149], v[148:149], v[136:137] op_sel:[0,1] op_sel_hi:[1,1]
v_pk_mul_f32 v[150:151], v[150:151], v[136:137] op_sel:[0,1] op_sel_hi:[1,1]
v_cvt_pk_bf16_f32 v176, v148, v149
v_cvt_pk_bf16_f32 v177, v150, v151
v_accvgpr_read_b32 v252, a52
v_accvgpr_read_b32 v253, a53
v_accvgpr_read_b32 v254, a54
v_accvgpr_read_b32 v255, a55
v_pk_mul_f32 v[252:253], v[252:253], v[136:137] op_sel:[0,1] op_sel_hi:[1,1]
v_pk_mul_f32 v[254:255], v[254:255], v[136:137] op_sel:[0,1] op_sel_hi:[1,1]
v_cvt_pk_bf16_f32 v178, v252, v253
v_cvt_pk_bf16_f32 v179, v254, v255
s_waitcnt lgkmcnt(8)
v_mfma_f32_16x16x32_bf16 v[24:27], a[128:131], v[160:163], v[24:27]
ds_read_b64_tr_b16 a[152:153], v1 offset:55296
v_accvgpr_read_b32 v144, a24
v_mfma_f32_16x16x32_bf16 v[28:31], a[128:131], v[176:179], v[28:31]
ds_read_b64_tr_b16 a[154:155], v1 offset:56320
s_add_u32 m0, s23, 102400
v_mfma_f32_16x16x32_bf16 v[32:35], a[132:135], v[160:163], v[32:35]
ds_read_b64_tr_b16 a[156:157], v2 offset:55296
s_add_u32 s31, s26, 73984
v_mfma_f32_16x16x32_bf16 v[36:39], a[132:135], v[176:179], v[36:39]
ds_read_b64_tr_b16 a[158:159], v2 offset:56320
s_waitcnt lgkmcnt(8)
v_mfma_f32_16x16x32_bf16 v[40:43], a[136:139], v[160:163], v[40:43]
buffer_load_dwordx4 v18, s[12:15], s31 offen lds
ds_read_b64_tr_b16 a[128:129], v1 offset:40960
v_mfma_f32_16x16x32_bf16 v[44:47], a[136:139], v[176:179], v[44:47]
ds_read_b64_tr_b16 a[130:131], v1 offset:41984
v_accvgpr_read_b32 v145, a25
v_mfma_f32_16x16x32_bf16 v[48:51], a[140:143], v[160:163], v[48:51]
ds_read_b64_tr_b16 a[132:133], v2 offset:40960
v_accvgpr_read_b32 v146, a26
v_accvgpr_read_b32 v147, a27
v_pk_mul_f32 v[144:145], v[144:145], v[136:137] op_sel_hi:[1,0]
v_pk_mul_f32 v[146:147], v[146:147], v[136:137] op_sel_hi:[1,0]
v_cvt_pk_bf16_f32 v164, v144, v145
v_cvt_pk_bf16_f32 v165, v146, v147
v_accvgpr_read_b32 v248, a28
v_accvgpr_read_b32 v249, a29
v_accvgpr_read_b32 v250, a30
v_accvgpr_read_b32 v251, a31
v_pk_mul_f32 v[248:249], v[248:249], v[136:137] op_sel_hi:[1,0]
v_pk_mul_f32 v[250:251], v[250:251], v[136:137] op_sel_hi:[1,0]
v_cvt_pk_bf16_f32 v166, v248, v249
v_cvt_pk_bf16_f32 v167, v250, v251
v_mfma_f32_16x16x32_bf16 v[52:55], a[140:143], v[176:179], v[52:55]
ds_read_b64_tr_b16 a[134:135], v2 offset:41984
v_accvgpr_read_b32 v148, a56
v_accvgpr_read_b32 v149, a57
v_accvgpr_read_b32 v150, a58
v_accvgpr_read_b32 v151, a59
v_pk_mul_f32 v[148:149], v[148:149], v[136:137] op_sel:[0,1] op_sel_hi:[1,1]
v_pk_mul_f32 v[150:151], v[150:151], v[136:137] op_sel:[0,1] op_sel_hi:[1,1]
v_cvt_pk_bf16_f32 v180, v148, v149
v_cvt_pk_bf16_f32 v181, v150, v151
v_accvgpr_read_b32 v252, a60
v_accvgpr_read_b32 v253, a61
v_accvgpr_read_b32 v254, a62
v_accvgpr_read_b32 v255, a63
v_pk_mul_f32 v[252:253], v[252:253], v[136:137] op_sel:[0,1] op_sel_hi:[1,1]
v_pk_mul_f32 v[254:255], v[254:255], v[136:137] op_sel:[0,1] op_sel_hi:[1,1]
v_cvt_pk_bf16_f32 v182, v252, v253
v_cvt_pk_bf16_f32 v183, v254, v255
s_waitcnt lgkmcnt(8)
v_mfma_f32_16x16x32_bf16 v[24:27], a[144:147], v[164:167], v[24:27]
ds_read_b64_tr_b16 a[136:137], v1 offset:57344
buffer_load_dwordx4 v19, s[12:15], s31 offen offset:1024 lds
v_mfma_f32_16x16x32_bf16 v[28:31], a[144:147], v[180:183], v[28:31]
ds_read_b64_tr_b16 a[138:139], v1 offset:58368
v_accvgpr_read_b32 v144, a64
v_mfma_f32_16x16x32_bf16 v[32:35], a[148:151], v[164:167], v[32:35]
ds_read_b64_tr_b16 a[140:141], v2 offset:57344
v_accvgpr_read_b32 v145, a65
v_mfma_f32_16x16x32_bf16 v[36:39], a[148:151], v[180:183], v[36:39]
ds_read_b64_tr_b16 a[142:143], v2 offset:58368
s_waitcnt lgkmcnt(8)
v_mfma_f32_16x16x32_bf16 v[40:43], a[152:155], v[164:167], v[40:43]
ds_read_b64_tr_b16 a[144:145], v1 offset:43008
v_accvgpr_read_b32 v146, a66
v_mfma_f32_16x16x32_bf16 v[44:47], a[152:155], v[180:183], v[44:47]
ds_read_b64_tr_b16 a[146:147], v1 offset:44032
v_accvgpr_read_b32 v147, a67
v_mfma_f32_16x16x32_bf16 v[48:51], a[156:159], v[164:167], v[48:51]
ds_read_b64_tr_b16 a[148:149], v2 offset:43008
v_pk_mul_f32 v[144:145], v[144:145], v[138:139] op_sel_hi:[1,0]
v_pk_mul_f32 v[146:147], v[146:147], v[138:139] op_sel_hi:[1,0]
v_cvt_pk_bf16_f32 v184, v144, v145
v_cvt_pk_bf16_f32 v185, v146, v147
v_accvgpr_read_b32 v248, a68
v_accvgpr_read_b32 v249, a69
v_accvgpr_read_b32 v250, a70
v_accvgpr_read_b32 v251, a71
v_pk_mul_f32 v[248:249], v[248:249], v[138:139] op_sel_hi:[1,0]
v_pk_mul_f32 v[250:251], v[250:251], v[138:139] op_sel_hi:[1,0]
v_cvt_pk_bf16_f32 v186, v248, v249
v_cvt_pk_bf16_f32 v187, v250, v251
v_mfma_f32_16x16x32_bf16 v[52:55], a[156:159], v[180:183], v[52:55]
ds_read_b64_tr_b16 a[150:151], v2 offset:44032
v_accvgpr_read_b32 v148, a96
v_accvgpr_read_b32 v149, a97
v_accvgpr_read_b32 v150, a98
v_accvgpr_read_b32 v151, a99
v_pk_mul_f32 v[148:149], v[148:149], v[138:139] op_sel:[0,1] op_sel_hi:[1,1]
v_pk_mul_f32 v[150:151], v[150:151], v[138:139] op_sel:[0,1] op_sel_hi:[1,1]
v_cvt_pk_bf16_f32 v216, v148, v149
v_cvt_pk_bf16_f32 v217, v150, v151
v_accvgpr_read_b32 v252, a100
v_accvgpr_read_b32 v253, a101
v_accvgpr_read_b32 v254, a102
v_accvgpr_read_b32 v255, a103
v_pk_mul_f32 v[252:253], v[252:253], v[138:139] op_sel:[0,1] op_sel_hi:[1,1]
v_pk_mul_f32 v[254:255], v[254:255], v[138:139] op_sel:[0,1] op_sel_hi:[1,1]
v_cvt_pk_bf16_f32 v218, v252, v253
v_cvt_pk_bf16_f32 v219, v254, v255
s_waitcnt lgkmcnt(8)
v_mfma_f32_16x16x32_bf16 v[24:27], a[128:131], v[184:187], v[24:27]
ds_read_b64_tr_b16 a[152:153], v1 offset:59392
buffer_load_dwordx4 v20, s[12:15], s31 offen offset:2048 lds
v_mfma_f32_16x16x32_bf16 v[28:31], a[128:131], v[216:219], v[28:31]
ds_read_b64_tr_b16 a[154:155], v1 offset:60416
v_accvgpr_read_b32 v144, a72
v_mfma_f32_16x16x32_bf16 v[32:35], a[132:135], v[184:187], v[32:35]
ds_read_b64_tr_b16 a[156:157], v2 offset:59392
v_accvgpr_read_b32 v145, a73
v_mfma_f32_16x16x32_bf16 v[36:39], a[132:135], v[216:219], v[36:39]
ds_read_b64_tr_b16 a[158:159], v2 offset:60416
s_waitcnt lgkmcnt(8)
v_mfma_f32_16x16x32_bf16 v[40:43], a[136:139], v[184:187], v[40:43]
ds_read_b64_tr_b16 a[128:129], v1 offset:45056
v_accvgpr_read_b32 v146, a74
v_mfma_f32_16x16x32_bf16 v[44:47], a[136:139], v[216:219], v[44:47]
ds_read_b64_tr_b16 a[130:131], v1 offset:46080
v_accvgpr_read_b32 v147, a75
v_mfma_f32_16x16x32_bf16 v[48:51], a[140:143], v[184:187], v[48:51]
ds_read_b64_tr_b16 a[132:133], v2 offset:45056
v_pk_mul_f32 v[144:145], v[144:145], v[138:139] op_sel_hi:[1,0]
v_pk_mul_f32 v[146:147], v[146:147], v[138:139] op_sel_hi:[1,0]
v_cvt_pk_bf16_f32 v188, v144, v145
v_cvt_pk_bf16_f32 v189, v146, v147
v_accvgpr_read_b32 v248, a76
v_accvgpr_read_b32 v249, a77
v_accvgpr_read_b32 v250, a78
v_accvgpr_read_b32 v251, a79
v_pk_mul_f32 v[248:249], v[248:249], v[138:139] op_sel_hi:[1,0]
v_pk_mul_f32 v[250:251], v[250:251], v[138:139] op_sel_hi:[1,0]
v_cvt_pk_bf16_f32 v190, v248, v249
v_cvt_pk_bf16_f32 v191, v250, v251
v_mfma_f32_16x16x32_bf16 v[52:55], a[140:143], v[216:219], v[52:55]
ds_read_b64_tr_b16 a[134:135], v2 offset:46080
v_accvgpr_read_b32 v148, a104
v_accvgpr_read_b32 v149, a105
v_accvgpr_read_b32 v150, a106
v_accvgpr_read_b32 v151, a107
v_pk_mul_f32 v[148:149], v[148:149], v[138:139] op_sel:[0,1] op_sel_hi:[1,1]
v_pk_mul_f32 v[150:151], v[150:151], v[138:139] op_sel:[0,1] op_sel_hi:[1,1]
v_cvt_pk_bf16_f32 v220, v148, v149
v_cvt_pk_bf16_f32 v221, v150, v151
v_accvgpr_read_b32 v252, a108
v_accvgpr_read_b32 v253, a109
v_accvgpr_read_b32 v254, a110
v_accvgpr_read_b32 v255, a111
v_pk_mul_f32 v[252:253], v[252:253], v[138:139] op_sel:[0,1] op_sel_hi:[1,1]
v_pk_mul_f32 v[254:255], v[254:255], v[138:139] op_sel:[0,1] op_sel_hi:[1,1]
v_cvt_pk_bf16_f32 v222, v252, v253
v_cvt_pk_bf16_f32 v223, v254, v255
s_waitcnt lgkmcnt(8)
v_mfma_f32_16x16x32_bf16 v[24:27], a[144:147], v[188:191], v[24:27]
ds_read_b64_tr_b16 a[136:137], v1 offset:61440
buffer_load_dwordx4 v21, s[12:15], s31 offen offset:3072 lds
v_mfma_f32_16x16x32_bf16 v[28:31], a[144:147], v[220:223], v[28:31]
ds_read_b64_tr_b16 a[138:139], v1 offset:62464
v_accvgpr_read_b32 v144, a80
v_mfma_f32_16x16x32_bf16 v[32:35], a[148:151], v[188:191], v[32:35]
ds_read_b64_tr_b16 a[140:141], v2 offset:61440
v_accvgpr_read_b32 v145, a81
v_mfma_f32_16x16x32_bf16 v[36:39], a[148:151], v[220:223], v[36:39]
ds_read_b64_tr_b16 a[142:143], v2 offset:62464
s_waitcnt lgkmcnt(8)
v_mfma_f32_16x16x32_bf16 v[40:43], a[152:155], v[188:191], v[40:43]
ds_read_b64_tr_b16 a[144:145], v1 offset:47104
v_accvgpr_read_b32 v146, a82
v_mfma_f32_16x16x32_bf16 v[44:47], a[152:155], v[220:223], v[44:47]
ds_read_b64_tr_b16 a[146:147], v1 offset:48128
v_accvgpr_read_b32 v147, a83
v_mfma_f32_16x16x32_bf16 v[48:51], a[156:159], v[188:191], v[48:51]
ds_read_b64_tr_b16 a[148:149], v2 offset:47104
v_pk_mul_f32 v[144:145], v[144:145], v[138:139] op_sel_hi:[1,0]
v_pk_mul_f32 v[146:147], v[146:147], v[138:139] op_sel_hi:[1,0]
v_cvt_pk_bf16_f32 v192, v144, v145
v_cvt_pk_bf16_f32 v193, v146, v147
v_accvgpr_read_b32 v248, a84
v_accvgpr_read_b32 v249, a85
v_accvgpr_read_b32 v250, a86
v_accvgpr_read_b32 v251, a87
v_pk_mul_f32 v[248:249], v[248:249], v[138:139] op_sel_hi:[1,0]
v_pk_mul_f32 v[250:251], v[250:251], v[138:139] op_sel_hi:[1,0]
v_cvt_pk_bf16_f32 v194, v248, v249
v_cvt_pk_bf16_f32 v195, v250, v251
v_mfma_f32_16x16x32_bf16 v[52:55], a[156:159], v[220:223], v[52:55]
ds_read_b64_tr_b16 a[150:151], v2 offset:48128
v_accvgpr_read_b32 v148, a112
v_accvgpr_read_b32 v149, a113
v_accvgpr_read_b32 v150, a114
v_accvgpr_read_b32 v151, a115
v_pk_mul_f32 v[148:149], v[148:149], v[138:139] op_sel:[0,1] op_sel_hi:[1,1]
v_pk_mul_f32 v[150:151], v[150:151], v[138:139] op_sel:[0,1] op_sel_hi:[1,1]
v_cvt_pk_bf16_f32 v224, v148, v149
v_cvt_pk_bf16_f32 v225, v150, v151
v_accvgpr_read_b32 v252, a116
v_accvgpr_read_b32 v253, a117
v_accvgpr_read_b32 v254, a118
v_accvgpr_read_b32 v255, a119
v_pk_mul_f32 v[252:253], v[252:253], v[138:139] op_sel:[0,1] op_sel_hi:[1,1]
v_pk_mul_f32 v[254:255], v[254:255], v[138:139] op_sel:[0,1] op_sel_hi:[1,1]
v_cvt_pk_bf16_f32 v226, v252, v253
v_cvt_pk_bf16_f32 v227, v254, v255
s_waitcnt lgkmcnt(8)
v_mfma_f32_16x16x32_bf16 v[24:27], a[128:131], v[192:195], v[24:27]
ds_read_b64_tr_b16 a[152:153], v1 offset:63488
v_accvgpr_read_b32 v144, a88
v_mfma_f32_16x16x32_bf16 v[28:31], a[128:131], v[224:227], v[28:31]
ds_read_b64_tr_b16 a[154:155], v1 offset:64512
v_accvgpr_read_b32 v145, a89
v_mfma_f32_16x16x32_bf16 v[32:35], a[132:135], v[192:195], v[32:35]
ds_read_b64_tr_b16 a[156:157], v2 offset:63488
v_accvgpr_read_b32 v146, a90
v_mfma_f32_16x16x32_bf16 v[36:39], a[132:135], v[224:227], v[36:39]
ds_read_b64_tr_b16 a[158:159], v2 offset:64512
s_waitcnt lgkmcnt(8)
v_mfma_f32_16x16x32_bf16 v[40:43], a[136:139], v[192:195], v[40:43]
s_waitcnt vmcnt(8)
s_barrier
ds_read_b64_tr_b16 a[128:129], v3
v_mfma_f32_16x16x32_bf16 v[44:47], a[136:139], v[224:227], v[44:47]
ds_read_b64_tr_b16 a[130:131], v3 offset:1024
v_accvgpr_read_b32 v147, a91
v_mfma_f32_16x16x32_bf16 v[48:51], a[140:143], v[192:195], v[48:51]
ds_read_b64_tr_b16 a[132:133], v4
v_pk_mul_f32 v[144:145], v[144:145], v[138:139] op_sel_hi:[1,0]
v_pk_mul_f32 v[146:147], v[146:147], v[138:139] op_sel_hi:[1,0]
v_cvt_pk_bf16_f32 v196, v144, v145
v_cvt_pk_bf16_f32 v197, v146, v147
v_accvgpr_read_b32 v248, a92
v_accvgpr_read_b32 v249, a93
v_accvgpr_read_b32 v250, a94
v_accvgpr_read_b32 v251, a95
v_pk_mul_f32 v[248:249], v[248:249], v[138:139] op_sel_hi:[1,0]
v_pk_mul_f32 v[250:251], v[250:251], v[138:139] op_sel_hi:[1,0]
v_cvt_pk_bf16_f32 v198, v248, v249
v_cvt_pk_bf16_f32 v199, v250, v251
v_mfma_f32_16x16x32_bf16 v[52:55], a[140:143], v[224:227], v[52:55]
ds_read_b64_tr_b16 a[134:135], v4 offset:1024
v_accvgpr_read_b32 v148, a120
v_accvgpr_read_b32 v149, a121
v_accvgpr_read_b32 v150, a122
v_accvgpr_read_b32 v151, a123
v_pk_mul_f32 v[148:149], v[148:149], v[138:139] op_sel:[0,1] op_sel_hi:[1,1]
v_pk_mul_f32 v[150:151], v[150:151], v[138:139] op_sel:[0,1] op_sel_hi:[1,1]
v_cvt_pk_bf16_f32 v228, v148, v149
v_cvt_pk_bf16_f32 v229, v150, v151
v_accvgpr_read_b32 v252, a124
v_accvgpr_read_b32 v253, a125
v_accvgpr_read_b32 v254, a126
v_accvgpr_read_b32 v255, a127
v_pk_mul_f32 v[252:253], v[252:253], v[138:139] op_sel:[0,1] op_sel_hi:[1,1]
v_pk_mul_f32 v[254:255], v[254:255], v[138:139] op_sel:[0,1] op_sel_hi:[1,1]
v_cvt_pk_bf16_f32 v230, v252, v253
v_cvt_pk_bf16_f32 v231, v254, v255
s_waitcnt lgkmcnt(8)
v_mfma_f32_16x16x32_bf16 v[24:27], a[144:147], v[196:199], v[24:27]
s_add_u32 m0, s23, 0
s_add_u32 s30, s26, 384
buffer_load_dwordx4 v18, s[12:15], s30 offen lds
ds_read_b64_tr_b16 a[136:137], v3 offset:16384
v_mfma_f32_16x16x32_bf16 v[28:31], a[144:147], v[228:231], v[28:31]
ds_read_b64_tr_b16 a[138:139], v3 offset:17408
s_add_u32 s34, s28, 0
v_mfma_f32_16x16x32_bf16 v[32:35], a[148:151], v[196:199], v[32:35]
ds_read_b64_tr_b16 a[140:141], v4 offset:16384
v_mfma_f32_16x16x32_bf16 v[36:39], a[148:151], v[228:231], v[36:39]
ds_read_b64_tr_b16 a[142:143], v4 offset:17408
s_waitcnt lgkmcnt(8)
v_mfma_f32_16x16x32_bf16 v[40:43], a[152:155], v[196:199], v[40:43]
ds_read_b64_tr_b16 a[144:145], v3 offset:2048
buffer_load_dwordx4 v19, s[12:15], s30 offen offset:1024 lds
v_mfma_f32_16x16x32_bf16 v[44:47], a[152:155], v[228:231], v[44:47]
ds_read_b64_tr_b16 a[146:147], v3 offset:3072
v_cvt_pk_bf16_f32 v120, v24, v25
v_mfma_f32_16x16x32_bf16 v[48:51], a[156:159], v[196:199], v[48:51]
ds_read_b64_tr_b16 a[148:149], v4 offset:2048
v_cvt_pk_bf16_f32 v121, v26, v27
v_mfma_f32_16x16x32_bf16 v[52:55], a[156:159], v[228:231], v[52:55]
ds_read_b64_tr_b16 a[150:151], v4 offset:3072
s_waitcnt lgkmcnt(8)
v_mfma_f32_16x16x32_bf16 v[56:59], a[128:131], v[152:155], 0
ds_read_b64_tr_b16 a[152:153], v3 offset:18432
v_cvt_pk_bf16_f32 v122, v32, v33
v_mfma_f32_16x16x32_bf16 v[60:63], a[128:131], v[168:171], 0
ds_read_b64_tr_b16 a[154:155], v3 offset:19456
v_cvt_pk_bf16_f32 v123, v34, v35
v_mfma_f32_16x16x32_bf16 v[64:67], a[132:135], v[152:155], 0
ds_read_b64_tr_b16 a[156:157], v4 offset:18432
buffer_store_dwordx4 v[120:123], v8, s[16:19], s34 offen sc1
v_mfma_f32_16x16x32_bf16 v[68:71], a[132:135], v[168:171], 0
ds_read_b64_tr_b16 a[158:159], v4 offset:19456
s_waitcnt lgkmcnt(8)
v_mfma_f32_16x16x32_bf16 v[72:75], a[136:139], v[152:155], 0
ds_read_b64_tr_b16 a[128:129], v3 offset:4096
buffer_load_dwordx4 v20, s[12:15], s30 offen offset:2048 lds
v_mfma_f32_16x16x32_bf16 v[76:79], a[136:139], v[168:171], 0
ds_read_b64_tr_b16 a[130:131], v3 offset:5120
v_cvt_pk_bf16_f32 v124, v28, v29
v_mfma_f32_16x16x32_bf16 v[80:83], a[140:143], v[152:155], 0
ds_read_b64_tr_b16 a[132:133], v4 offset:4096
v_cvt_pk_bf16_f32 v125, v30, v31
v_mfma_f32_16x16x32_bf16 v[84:87], a[140:143], v[168:171], 0
ds_read_b64_tr_b16 a[134:135], v4 offset:5120
s_waitcnt lgkmcnt(8)
v_mfma_f32_16x16x32_bf16 v[56:59], a[144:147], v[156:159], v[56:59]
ds_read_b64_tr_b16 a[136:137], v3 offset:20480
v_cvt_pk_bf16_f32 v126, v36, v37
v_mfma_f32_16x16x32_bf16 v[60:63], a[144:147], v[172:175], v[60:63]
ds_read_b64_tr_b16 a[138:139], v3 offset:21504
v_cvt_pk_bf16_f32 v127, v38, v39
buffer_store_dwordx4 v[124:127], v9, s[16:19], s34 offen sc1
v_mfma_f32_16x16x32_bf16 v[64:67], a[148:151], v[156:159], v[64:67]
ds_read_b64_tr_b16 a[140:141], v4 offset:20480
buffer_load_dwordx4 v21, s[12:15], s30 offen offset:3072 lds
v_mfma_f32_16x16x32_bf16 v[68:71], a[148:151], v[172:175], v[68:71]
ds_read_b64_tr_b16 a[142:143], v4 offset:21504
s_waitcnt lgkmcnt(8)
v_mfma_f32_16x16x32_bf16 v[72:75], a[152:155], v[156:159], v[72:75]
ds_read_b64_tr_b16 a[144:145], v3 offset:6144
v_mfma_f32_16x16x32_bf16 v[76:79], a[152:155], v[172:175], v[76:79]
ds_read_b64_tr_b16 a[146:147], v3 offset:7168
v_cvt_pk_bf16_f32 v128, v40, v41
v_mfma_f32_16x16x32_bf16 v[80:83], a[156:159], v[156:159], v[80:83]
ds_read_b64_tr_b16 a[148:149], v4 offset:6144
v_cvt_pk_bf16_f32 v129, v42, v43
v_mfma_f32_16x16x32_bf16 v[84:87], a[156:159], v[172:175], v[84:87]
ds_read_b64_tr_b16 a[150:151], v4 offset:7168
s_waitcnt lgkmcnt(8)
v_mfma_f32_16x16x32_bf16 v[56:59], a[128:131], v[160:163], v[56:59]
ds_read_b64_tr_b16 a[152:153], v3 offset:22528
v_cvt_pk_bf16_f32 v130, v48, v49
v_mfma_f32_16x16x32_bf16 v[60:63], a[128:131], v[176:179], v[60:63]
ds_read_b64_tr_b16 a[154:155], v3 offset:23552
v_cvt_pk_bf16_f32 v131, v50, v51
v_mfma_f32_16x16x32_bf16 v[64:67], a[132:135], v[160:163], v[64:67]
ds_read_b64_tr_b16 a[156:157], v4 offset:22528
buffer_store_dwordx4 v[128:131], v8, s[16:19], s34 offen offset:1024 sc1
v_mfma_f32_16x16x32_bf16 v[68:71], a[132:135], v[176:179], v[68:71]
ds_read_b64_tr_b16 a[158:159], v4 offset:23552
s_waitcnt lgkmcnt(8)
v_mfma_f32_16x16x32_bf16 v[72:75], a[136:139], v[160:163], v[72:75]
s_add_u32 m0, s23, 4096
s_add_u32 s31, s26, 74112
buffer_load_dwordx4 v18, s[12:15], s31 offen lds
ds_read_b64_tr_b16 a[128:129], v3 offset:8192
v_mfma_f32_16x16x32_bf16 v[76:79], a[136:139], v[176:179], v[76:79]
ds_read_b64_tr_b16 a[130:131], v3 offset:9216
v_cvt_pk_bf16_f32 v132, v44, v45
v_mfma_f32_16x16x32_bf16 v[80:83], a[140:143], v[160:163], v[80:83]
ds_read_b64_tr_b16 a[132:133], v4 offset:8192
v_cvt_pk_bf16_f32 v133, v46, v47
v_mfma_f32_16x16x32_bf16 v[84:87], a[140:143], v[176:179], v[84:87]
ds_read_b64_tr_b16 a[134:135], v4 offset:9216
s_waitcnt lgkmcnt(8)
v_mfma_f32_16x16x32_bf16 v[56:59], a[144:147], v[164:167], v[56:59]
ds_read_b64_tr_b16 a[136:137], v3 offset:24576
v_cvt_pk_bf16_f32 v134, v52, v53
v_mfma_f32_16x16x32_bf16 v[60:63], a[144:147], v[180:183], v[60:63]
ds_read_b64_tr_b16 a[138:139], v3 offset:25600
v_cvt_pk_bf16_f32 v135, v54, v55
buffer_store_dwordx4 v[132:135], v9, s[16:19], s34 offen offset:1024 sc1
v_mfma_f32_16x16x32_bf16 v[64:67], a[148:151], v[164:167], v[64:67]
ds_read_b64_tr_b16 a[140:141], v4 offset:24576
buffer_load_dwordx4 v19, s[12:15], s31 offen offset:1024 lds
v_mfma_f32_16x16x32_bf16 v[68:71], a[148:151], v[180:183], v[68:71]
ds_read_b64_tr_b16 a[142:143], v4 offset:25600
s_waitcnt lgkmcnt(8)
v_mfma_f32_16x16x32_bf16 v[72:75], a[152:155], v[164:167], v[72:75]
ds_read_b64_tr_b16 a[144:145], v3 offset:10240
v_mfma_f32_16x16x32_bf16 v[76:79], a[152:155], v[180:183], v[76:79]
ds_read_b64_tr_b16 a[146:147], v3 offset:11264
v_mfma_f32_16x16x32_bf16 v[80:83], a[156:159], v[164:167], v[80:83]
ds_read_b64_tr_b16 a[148:149], v4 offset:10240
v_mfma_f32_16x16x32_bf16 v[84:87], a[156:159], v[180:183], v[84:87]
ds_read_b64_tr_b16 a[150:151], v4 offset:11264
s_waitcnt lgkmcnt(8)
v_mfma_f32_16x16x32_bf16 v[56:59], a[128:131], v[184:187], v[56:59]
ds_read_b64_tr_b16 a[152:153], v3 offset:26624
buffer_load_dwordx4 v20, s[12:15], s31 offen offset:2048 lds
v_mfma_f32_16x16x32_bf16 v[60:63], a[128:131], v[216:219], v[60:63]
ds_read_b64_tr_b16 a[154:155], v3 offset:27648
v_mfma_f32_16x16x32_bf16 v[64:67], a[132:135], v[184:187], v[64:67]
ds_read_b64_tr_b16 a[156:157], v4 offset:26624
v_mfma_f32_16x16x32_bf16 v[68:71], a[132:135], v[216:219], v[68:71]
ds_read_b64_tr_b16 a[158:159], v4 offset:27648
s_waitcnt lgkmcnt(8)
v_mfma_f32_16x16x32_bf16 v[72:75], a[136:139], v[184:187], v[72:75]
ds_read_b64_tr_b16 a[128:129], v3 offset:12288
v_mfma_f32_16x16x32_bf16 v[76:79], a[136:139], v[216:219], v[76:79]
ds_read_b64_tr_b16 a[130:131], v3 offset:13312
v_mfma_f32_16x16x32_bf16 v[80:83], a[140:143], v[184:187], v[80:83]
ds_read_b64_tr_b16 a[132:133], v4 offset:12288
buffer_load_dwordx4 v21, s[12:15], s31 offen offset:3072 lds
v_mfma_f32_16x16x32_bf16 v[84:87], a[140:143], v[216:219], v[84:87]
ds_read_b64_tr_b16 a[134:135], v4 offset:13312
s_waitcnt lgkmcnt(8)
v_mfma_f32_16x16x32_bf16 v[56:59], a[144:147], v[188:191], v[56:59]
ds_read_b64_tr_b16 a[136:137], v3 offset:28672
v_mfma_f32_16x16x32_bf16 v[60:63], a[144:147], v[220:223], v[60:63]
ds_read_b64_tr_b16 a[138:139], v3 offset:29696
v_mfma_f32_16x16x32_bf16 v[64:67], a[148:151], v[188:191], v[64:67]
ds_read_b64_tr_b16 a[140:141], v4 offset:28672
v_mfma_f32_16x16x32_bf16 v[68:71], a[148:151], v[220:223], v[68:71]
ds_read_b64_tr_b16 a[142:143], v4 offset:29696
s_waitcnt lgkmcnt(8)
v_mfma_f32_16x16x32_bf16 v[72:75], a[152:155], v[188:191], v[72:75]
ds_read_b64_tr_b16 a[144:145], v3 offset:14336
v_mfma_f32_16x16x32_bf16 v[76:79], a[152:155], v[220:223], v[76:79]
ds_read_b64_tr_b16 a[146:147], v3 offset:15360
v_mfma_f32_16x16x32_bf16 v[80:83], a[156:159], v[188:191], v[80:83]
ds_read_b64_tr_b16 a[148:149], v4 offset:14336
v_mfma_f32_16x16x32_bf16 v[84:87], a[156:159], v[220:223], v[84:87]
ds_read_b64_tr_b16 a[150:151], v4 offset:15360
s_waitcnt lgkmcnt(8)
v_mfma_f32_16x16x32_bf16 v[56:59], a[128:131], v[192:195], v[56:59]
ds_read_b64_tr_b16 a[152:153], v3 offset:30720
v_mfma_f32_16x16x32_bf16 v[60:63], a[128:131], v[224:227], v[60:63]
ds_read_b64_tr_b16 a[154:155], v3 offset:31744
v_mfma_f32_16x16x32_bf16 v[64:67], a[132:135], v[192:195], v[64:67]
ds_read_b64_tr_b16 a[156:157], v4 offset:30720
v_mfma_f32_16x16x32_bf16 v[68:71], a[132:135], v[224:227], v[68:71]
ds_read_b64_tr_b16 a[158:159], v4 offset:31744
s_waitcnt lgkmcnt(8)
v_mfma_f32_16x16x32_bf16 v[72:75], a[136:139], v[192:195], v[72:75]
s_waitcnt vmcnt(12)
s_barrier
ds_read_b64_tr_b16 a[128:129], v3 offset:32768
v_mfma_f32_16x16x32_bf16 v[76:79], a[136:139], v[224:227], v[76:79]
ds_read_b64_tr_b16 a[130:131], v3 offset:33792
s_add_u32 m0, s23, 32768
v_mfma_f32_16x16x32_bf16 v[80:83], a[140:143], v[192:195], v[80:83]
ds_read_b64_tr_b16 a[132:133], v4 offset:32768
s_add_u32 s30, s26, 512
v_mfma_f32_16x16x32_bf16 v[84:87], a[140:143], v[224:227], v[84:87]
ds_read_b64_tr_b16 a[134:135], v4 offset:33792
s_waitcnt lgkmcnt(8)
v_mfma_f32_16x16x32_bf16 v[56:59], a[144:147], v[196:199], v[56:59]
buffer_load_dwordx4 v18, s[12:15], s30 offen lds
ds_read_b64_tr_b16 a[136:137], v3 offset:49152
v_mfma_f32_16x16x32_bf16 v[60:63], a[144:147], v[228:231], v[60:63]
ds_read_b64_tr_b16 a[138:139], v3 offset:50176
v_mfma_f32_16x16x32_bf16 v[64:67], a[148:151], v[196:199], v[64:67]
ds_read_b64_tr_b16 a[140:141], v4 offset:49152
v_mfma_f32_16x16x32_bf16 v[68:71], a[148:151], v[228:231], v[68:71]
ds_read_b64_tr_b16 a[142:143], v4 offset:50176
s_waitcnt lgkmcnt(8)
v_mfma_f32_16x16x32_bf16 v[72:75], a[152:155], v[196:199], v[72:75]
ds_read_b64_tr_b16 a[144:145], v3 offset:34816
buffer_load_dwordx4 v19, s[12:15], s30 offen offset:1024 lds
v_mfma_f32_16x16x32_bf16 v[76:79], a[152:155], v[228:231], v[76:79]
ds_read_b64_tr_b16 a[146:147], v3 offset:35840
v_cvt_pk_bf16_f32 v120, v56, v57
v_mfma_f32_16x16x32_bf16 v[80:83], a[156:159], v[196:199], v[80:83]
ds_read_b64_tr_b16 a[148:149], v4 offset:34816
v_cvt_pk_bf16_f32 v121, v58, v59
v_mfma_f32_16x16x32_bf16 v[84:87], a[156:159], v[228:231], v[84:87]
ds_read_b64_tr_b16 a[150:151], v4 offset:35840
s_waitcnt lgkmcnt(8)
v_mfma_f32_16x16x32_bf16 v[24:27], a[128:131], v[152:155], 0
ds_read_b64_tr_b16 a[152:153], v3 offset:51200
v_cvt_pk_bf16_f32 v122, v64, v65
v_mfma_f32_16x16x32_bf16 v[28:31], a[128:131], v[168:171], 0
ds_read_b64_tr_b16 a[154:155], v3 offset:52224
v_cvt_pk_bf16_f32 v123, v66, v67
v_mfma_f32_16x16x32_bf16 v[32:35], a[132:135], v[152:155], 0
ds_read_b64_tr_b16 a[156:157], v4 offset:51200
buffer_store_dwordx4 v[120:123], v8, s[16:19], s34 offen offset:2048 sc1
v_mfma_f32_16x16x32_bf16 v[36:39], a[132:135], v[168:171], 0
ds_read_b64_tr_b16 a[158:159], v4 offset:52224
s_waitcnt lgkmcnt(8)
v_mfma_f32_16x16x32_bf16 v[40:43], a[136:139], v[152:155], 0
ds_read_b64_tr_b16 a[128:129], v3 offset:36864
buffer_load_dwordx4 v20, s[12:15], s30 offen offset:2048 lds
v_mfma_f32_16x16x32_bf16 v[44:47], a[136:139], v[168:171], 0
ds_read_b64_tr_b16 a[130:131], v3 offset:37888
v_cvt_pk_bf16_f32 v124, v60, v61
v_mfma_f32_16x16x32_bf16 v[48:51], a[140:143], v[152:155], 0
ds_read_b64_tr_b16 a[132:133], v4 offset:36864
v_cvt_pk_bf16_f32 v125, v62, v63
v_mfma_f32_16x16x32_bf16 v[52:55], a[140:143], v[168:171], 0
ds_read_b64_tr_b16 a[134:135], v4 offset:37888
s_waitcnt lgkmcnt(8)
v_mfma_f32_16x16x32_bf16 v[24:27], a[144:147], v[156:159], v[24:27]
ds_read_b64_tr_b16 a[136:137], v3 offset:53248
v_cvt_pk_bf16_f32 v126, v68, v69
v_mfma_f32_16x16x32_bf16 v[28:31], a[144:147], v[172:175], v[28:31]
ds_read_b64_tr_b16 a[138:139], v3 offset:54272
v_cvt_pk_bf16_f32 v127, v70, v71
buffer_store_dwordx4 v[124:127], v9, s[16:19], s34 offen offset:2048 sc1
v_mfma_f32_16x16x32_bf16 v[32:35], a[148:151], v[156:159], v[32:35]
ds_read_b64_tr_b16 a[140:141], v4 offset:53248
buffer_load_dwordx4 v21, s[12:15], s30 offen offset:3072 lds
v_mfma_f32_16x16x32_bf16 v[36:39], a[148:151], v[172:175], v[36:39]
ds_read_b64_tr_b16 a[142:143], v4 offset:54272
s_waitcnt lgkmcnt(8)
v_mfma_f32_16x16x32_bf16 v[40:43], a[152:155], v[156:159], v[40:43]
ds_read_b64_tr_b16 a[144:145], v3 offset:38912
v_mfma_f32_16x16x32_bf16 v[44:47], a[152:155], v[172:175], v[44:47]
ds_read_b64_tr_b16 a[146:147], v3 offset:39936
v_cvt_pk_bf16_f32 v128, v72, v73
v_mfma_f32_16x16x32_bf16 v[48:51], a[156:159], v[156:159], v[48:51]
ds_read_b64_tr_b16 a[148:149], v4 offset:38912
v_cvt_pk_bf16_f32 v129, v74, v75
v_mfma_f32_16x16x32_bf16 v[52:55], a[156:159], v[172:175], v[52:55]
ds_read_b64_tr_b16 a[150:151], v4 offset:39936
s_waitcnt lgkmcnt(8)
v_mfma_f32_16x16x32_bf16 v[24:27], a[128:131], v[160:163], v[24:27]
ds_read_b64_tr_b16 a[152:153], v3 offset:55296
v_cvt_pk_bf16_f32 v130, v80, v81
v_mfma_f32_16x16x32_bf16 v[28:31], a[128:131], v[176:179], v[28:31]
ds_read_b64_tr_b16 a[154:155], v3 offset:56320
v_cvt_pk_bf16_f32 v131, v82, v83
v_mfma_f32_16x16x32_bf16 v[32:35], a[132:135], v[160:163], v[32:35]
ds_read_b64_tr_b16 a[156:157], v4 offset:55296
buffer_store_dwordx4 v[128:131], v8, s[16:19], s34 offen offset:3072 sc1
v_mfma_f32_16x16x32_bf16 v[36:39], a[132:135], v[176:179], v[36:39]
ds_read_b64_tr_b16 a[158:159], v4 offset:56320
s_waitcnt lgkmcnt(8)
v_mfma_f32_16x16x32_bf16 v[40:43], a[136:139], v[160:163], v[40:43]
s_add_u32 m0, s23, 36864
s_add_u32 s31, s26, 74240
buffer_load_dwordx4 v18, s[12:15], s31 offen lds
ds_read_b64_tr_b16 a[128:129], v3 offset:40960
v_mfma_f32_16x16x32_bf16 v[44:47], a[136:139], v[176:179], v[44:47]
ds_read_b64_tr_b16 a[130:131], v3 offset:41984
v_cvt_pk_bf16_f32 v132, v76, v77
v_mfma_f32_16x16x32_bf16 v[48:51], a[140:143], v[160:163], v[48:51]
ds_read_b64_tr_b16 a[132:133], v4 offset:40960
v_cvt_pk_bf16_f32 v133, v78, v79
v_mfma_f32_16x16x32_bf16 v[52:55], a[140:143], v[176:179], v[52:55]
ds_read_b64_tr_b16 a[134:135], v4 offset:41984
s_waitcnt lgkmcnt(8)
v_mfma_f32_16x16x32_bf16 v[24:27], a[144:147], v[164:167], v[24:27]
ds_read_b64_tr_b16 a[136:137], v3 offset:57344
v_cvt_pk_bf16_f32 v134, v84, v85
v_mfma_f32_16x16x32_bf16 v[28:31], a[144:147], v[180:183], v[28:31]
ds_read_b64_tr_b16 a[138:139], v3 offset:58368
v_cvt_pk_bf16_f32 v135, v86, v87
buffer_store_dwordx4 v[132:135], v9, s[16:19], s34 offen offset:3072 sc1
s_lshl_b32 s24, s22, 3
v_mfma_f32_16x16x32_bf16 v[32:35], a[148:151], v[164:167], v[32:35]
ds_read_b64_tr_b16 a[140:141], v4 offset:57344
buffer_load_dwordx4 v19, s[12:15], s31 offen offset:1024 lds
v_mfma_f32_16x16x32_bf16 v[36:39], a[148:151], v[180:183], v[36:39]
ds_read_b64_tr_b16 a[142:143], v4 offset:58368
s_lshr_b32 s39, s21, 1
s_waitcnt lgkmcnt(8)
v_mfma_f32_16x16x32_bf16 v[40:43], a[152:155], v[164:167], v[40:43]
ds_read_b64_tr_b16 a[144:145], v3 offset:43008
s_add_u32 s24, s24, s39
v_mfma_f32_16x16x32_bf16 v[44:47], a[152:155], v[180:183], v[44:47]
ds_read_b64_tr_b16 a[146:147], v3 offset:44032
v_mfma_f32_16x16x32_bf16 v[48:51], a[156:159], v[164:167], v[48:51]
ds_read_b64_tr_b16 a[148:149], v4 offset:43008
s_mul_i32 s24, s24, 18432
v_mfma_f32_16x16x32_bf16 v[52:55], a[156:159], v[180:183], v[52:55]
ds_read_b64_tr_b16 a[150:151], v4 offset:44032
s_waitcnt lgkmcnt(8)
v_mfma_f32_16x16x32_bf16 v[24:27], a[128:131], v[184:187], v[24:27]
ds_read_b64_tr_b16 a[152:153], v3 offset:59392
buffer_load_dwordx4 v20, s[12:15], s31 offen offset:2048 lds
v_mfma_f32_16x16x32_bf16 v[28:31], a[128:131], v[216:219], v[28:31]
ds_read_b64_tr_b16 a[154:155], v3 offset:60416
s_and_b32 s39, s21, 1
v_mfma_f32_16x16x32_bf16 v[32:35], a[132:135], v[184:187], v[32:35]
ds_read_b64_tr_b16 a[156:157], v4 offset:59392
v_mfma_f32_16x16x32_bf16 v[36:39], a[132:135], v[216:219], v[36:39]
ds_read_b64_tr_b16 a[158:159], v4 offset:60416
s_waitcnt lgkmcnt(8)
v_mfma_f32_16x16x32_bf16 v[40:43], a[136:139], v[184:187], v[40:43]
ds_read_b64_tr_b16 a[128:129], v3 offset:45056
s_lshl_b32 s39, s39, 7
v_mfma_f32_16x16x32_bf16 v[44:47], a[136:139], v[216:219], v[44:47]
ds_read_b64_tr_b16 a[130:131], v3 offset:46080
v_mfma_f32_16x16x32_bf16 v[48:51], a[140:143], v[184:187], v[48:51]
ds_read_b64_tr_b16 a[132:133], v4 offset:45056
s_add_u32 s24, s24, s39
v_mfma_f32_16x16x32_bf16 v[52:55], a[140:143], v[216:219], v[52:55]
ds_read_b64_tr_b16 a[134:135], v4 offset:46080
s_waitcnt lgkmcnt(8)
v_mfma_f32_16x16x32_bf16 v[24:27], a[144:147], v[188:191], v[24:27]
ds_read_b64_tr_b16 a[136:137], v3 offset:61440
buffer_load_dwordx4 v21, s[12:15], s31 offen offset:3072 lds
v_mfma_f32_16x16x32_bf16 v[28:31], a[144:147], v[220:223], v[28:31]
ds_read_b64_tr_b16 a[138:139], v3 offset:62464
s_mul_i32 s25, s22, 1024
v_mfma_f32_16x16x32_bf16 v[32:35], a[148:151], v[188:191], v[32:35]
ds_read_b64_tr_b16 a[140:141], v4 offset:61440
v_mfma_f32_16x16x32_bf16 v[36:39], a[148:151], v[220:223], v[36:39]
ds_read_b64_tr_b16 a[142:143], v4 offset:62464
s_waitcnt lgkmcnt(8)
v_mfma_f32_16x16x32_bf16 v[40:43], a[152:155], v[188:191], v[40:43]
ds_read_b64_tr_b16 a[144:145], v3 offset:47104
s_add_u32 s25, s25, 9961472
v_mfma_f32_16x16x32_bf16 v[44:47], a[152:155], v[220:223], v[44:47]
ds_read_b64_tr_b16 a[146:147], v3 offset:48128
v_mfma_f32_16x16x32_bf16 v[48:51], a[156:159], v[188:191], v[48:51]
ds_read_b64_tr_b16 a[148:149], v4 offset:47104
v_lshrrev_b32 v253, 3, v0
v_mfma_f32_16x16x32_bf16 v[52:55], a[156:159], v[220:223], v[52:55]
ds_read_b64_tr_b16 a[150:151], v4 offset:48128
s_waitcnt lgkmcnt(8)
v_mfma_f32_16x16x32_bf16 v[24:27], a[128:131], v[192:195], v[24:27]
ds_read_b64_tr_b16 a[152:153], v3 offset:63488
v_lshlrev_b32 v254, 8, v253
v_mfma_f32_16x16x32_bf16 v[28:31], a[128:131], v[224:227], v[28:31]
ds_read_b64_tr_b16 a[154:155], v3 offset:64512
v_mfma_f32_16x16x32_bf16 v[32:35], a[132:135], v[192:195], v[32:35]
ds_read_b64_tr_b16 a[156:157], v4 offset:63488
v_mfma_f32_16x16x32_bf16 v[36:39], a[132:135], v[224:227], v[36:39]
ds_read_b64_tr_b16 a[158:159], v4 offset:64512
s_waitcnt lgkmcnt(8)
v_mfma_f32_16x16x32_bf16 v[40:43], a[136:139], v[192:195], v[40:43]
s_waitcnt vmcnt(12)
s_barrier
ds_read_b64_tr_b16 a[128:129], v1
v_mfma_f32_16x16x32_bf16 v[44:47], a[136:139], v[224:227], v[44:47]
ds_read_b64_tr_b16 a[130:131], v1 offset:1024
v_and_b32 v244, 7, v0
v_mfma_f32_16x16x32_bf16 v[48:51], a[140:143], v[192:195], v[48:51]
ds_read_b64_tr_b16 a[132:133], v2
v_lshl_add_u32 v254, v244, 4, v254
v_mfma_f32_16x16x32_bf16 v[52:55], a[140:143], v[224:227], v[52:55]
ds_read_b64_tr_b16 a[134:135], v2 offset:1024
s_waitcnt lgkmcnt(8)
v_mfma_f32_16x16x32_bf16 v[24:27], a[144:147], v[196:199], v[24:27]
s_add_u32 m0, s23, 65536
s_add_u32 s30, s26, 640
buffer_load_dwordx4 v18, s[12:15], s30 offen lds
ds_read_b64_tr_b16 a[136:137], v1 offset:16384
v_mfma_f32_16x16x32_bf16 v[28:31], a[144:147], v[228:231], v[28:31]
ds_read_b64_tr_b16 a[138:139], v1 offset:17408
v_and_b32 v247, 3, v253
v_mfma_f32_16x16x32_bf16 v[32:35], a[148:151], v[196:199], v[32:35]
ds_read_b64_tr_b16 a[140:141], v2 offset:16384
v_lshrrev_b32 v253, 2, v253
v_mfma_f32_16x16x32_bf16 v[36:39], a[148:151], v[228:231], v[36:39]
ds_read_b64_tr_b16 a[142:143], v2 offset:17408
s_waitcnt lgkmcnt(8)
v_mfma_f32_16x16x32_bf16 v[40:43], a[152:155], v[196:199], v[40:43]
ds_read_b64_tr_b16 a[144:145], v1 offset:2048
buffer_load_dwordx4 v19, s[12:15], s30 offen offset:1024 lds
v_mfma_f32_16x16x32_bf16 v[44:47], a[152:155], v[228:231], v[44:47]
ds_read_b64_tr_b16 a[146:147], v1 offset:3072
v_lshlrev_b32 v253, 7, v253
v_mfma_f32_16x16x32_bf16 v[48:51], a[156:159], v[196:199], v[48:51]
ds_read_b64_tr_b16 a[148:149], v2 offset:2048
s_add_u32 s34, s28, 4096
v_mfma_f32_16x16x32_bf16 v[52:55], a[156:159], v[228:231], v[52:55]
ds_read_b64_tr_b16 a[150:151], v2 offset:3072
s_waitcnt lgkmcnt(8)
v_mfma_f32_16x16x32_bf16 v[56:59], a[128:131], v[152:155], 0
ds_read_b64_tr_b16 a[152:153], v1 offset:18432
v_lshl_add_u32 v253, v247, 4, v253
v_mfma_f32_16x16x32_bf16 v[60:63], a[128:131], v[168:171], 0
ds_read_b64_tr_b16 a[154:155], v1 offset:19456
v_cvt_pk_bf16_f32 v120, v24, v25
v_mfma_f32_16x16x32_bf16 v[64:67], a[132:135], v[152:155], 0
ds_read_b64_tr_b16 a[156:157], v2 offset:18432
v_cvt_pk_bf16_f32 v121, v26, v27
v_mfma_f32_16x16x32_bf16 v[68:71], a[132:135], v[168:171], 0
ds_read_b64_tr_b16 a[158:159], v2 offset:19456
v_cvt_pk_bf16_f32 v122, v32, v33
v_cvt_pk_bf16_f32 v123, v34, v35
buffer_store_dwordx4 v[120:123], v8, s[16:19], s34 offen sc1
s_waitcnt lgkmcnt(8)
v_mfma_f32_16x16x32_bf16 v[72:75], a[136:139], v[152:155], 0
ds_read_b64_tr_b16 a[128:129], v1 offset:4096
s_add_u32 s39, s20, 4
s_cmp_eq_u32 s20, 0
s_cselect_b32 s39, 8, s39
s_cselect_b32 s27, 3, 2
s_mul_i32 s27, s27, 128
s_add_u32 s27, s27, s25
s_cmp_lg_u32 s20, 1
s_cselect_b32 s37, 1.0, 0
s_cselect_b32 s38, 0, 0x7ff00000
s_mul_i32 s39, s39, 256
s_mul_i32 s40, s39, 8
s_add_u32 s40, s40, s38
v_mfma_f32_16x16x32_bf16 v[76:79], a[136:139], v[168:171], 0
ds_read_b64_tr_b16 a[130:131], v1 offset:5120
buffer_load_dwordx4 v20, s[12:15], s30 offen offset:2048 lds
v_mfma_f32_16x16x32_bf16 v[80:83], a[140:143], v[152:155], 0
ds_read_b64_tr_b16 a[132:133], v2 offset:4096
v_cvt_pk_bf16_f32 v124, v28, v29
v_mfma_f32_16x16x32_bf16 v[84:87], a[140:143], v[168:171], 0
ds_read_b64_tr_b16 a[134:135], v2 offset:5120
s_waitcnt lgkmcnt(8)
v_mfma_f32_16x16x32_bf16 v[56:59], a[144:147], v[156:159], v[56:59]
ds_read_b64_tr_b16 a[136:137], v1 offset:20480
v_cvt_pk_bf16_f32 v125, v30, v31
v_mfma_f32_16x16x32_bf16 v[60:63], a[144:147], v[172:175], v[60:63]
ds_read_b64_tr_b16 a[138:139], v1 offset:21504
v_cvt_pk_bf16_f32 v126, v36, v37
v_cvt_pk_bf16_f32 v127, v38, v39
buffer_store_dwordx4 v[124:127], v9, s[16:19], s34 offen sc1
v_mfma_f32_16x16x32_bf16 v[64:67], a[148:151], v[156:159], v[64:67]
ds_read_b64_tr_b16 a[140:141], v2 offset:20480
buffer_load_dwordx4 v21, s[12:15], s30 offen offset:3072 lds
v_mfma_f32_16x16x32_bf16 v[68:71], a[148:151], v[172:175], v[68:71]
ds_read_b64_tr_b16 a[142:143], v2 offset:21504
s_waitcnt lgkmcnt(8)
v_mfma_f32_16x16x32_bf16 v[72:75], a[152:155], v[156:159], v[72:75]
ds_read_b64_tr_b16 a[144:145], v1 offset:6144
v_mfma_f32_16x16x32_bf16 v[76:79], a[152:155], v[172:175], v[76:79]
ds_read_b64_tr_b16 a[146:147], v1 offset:7168
v_cvt_pk_bf16_f32 v128, v40, v41
v_mfma_f32_16x16x32_bf16 v[80:83], a[156:159], v[156:159], v[80:83]
ds_read_b64_tr_b16 a[148:149], v2 offset:6144
v_cvt_pk_bf16_f32 v129, v42, v43
v_mfma_f32_16x16x32_bf16 v[84:87], a[156:159], v[172:175], v[84:87]
ds_read_b64_tr_b16 a[150:151], v2 offset:7168
s_waitcnt lgkmcnt(8)
v_mfma_f32_16x16x32_bf16 v[56:59], a[128:131], v[160:163], v[56:59]
ds_read_b64_tr_b16 a[152:153], v1 offset:22528
v_cvt_pk_bf16_f32 v130, v48, v49
v_mfma_f32_16x16x32_bf16 v[60:63], a[128:131], v[176:179], v[60:63]
ds_read_b64_tr_b16 a[154:155], v1 offset:23552
v_cvt_pk_bf16_f32 v131, v50, v51
v_mfma_f32_16x16x32_bf16 v[64:67], a[132:135], v[160:163], v[64:67]
ds_read_b64_tr_b16 a[156:157], v2 offset:22528
buffer_store_dwordx4 v[128:131], v8, s[16:19], s34 offen offset:1024 sc1
v_mfma_f32_16x16x32_bf16 v[68:71], a[132:135], v[176:179], v[68:71]
ds_read_b64_tr_b16 a[158:159], v2 offset:23552
s_waitcnt lgkmcnt(8)
v_mfma_f32_16x16x32_bf16 v[72:75], a[136:139], v[160:163], v[72:75]
s_add_u32 m0, s23, 69632
s_add_u32 s31, s26, 74368
buffer_load_dwordx4 v18, s[12:15], s31 offen lds
ds_read_b64_tr_b16 a[128:129], v1 offset:8192
v_mfma_f32_16x16x32_bf16 v[76:79], a[136:139], v[176:179], v[76:79]
ds_read_b64_tr_b16 a[130:131], v1 offset:9216
v_cvt_pk_bf16_f32 v132, v44, v45
v_mfma_f32_16x16x32_bf16 v[80:83], a[140:143], v[160:163], v[80:83]
ds_read_b64_tr_b16 a[132:133], v2 offset:8192
v_cvt_pk_bf16_f32 v133, v46, v47
v_mfma_f32_16x16x32_bf16 v[84:87], a[140:143], v[176:179], v[84:87]
ds_read_b64_tr_b16 a[134:135], v2 offset:9216
s_waitcnt lgkmcnt(8)
v_mfma_f32_16x16x32_bf16 v[56:59], a[144:147], v[164:167], v[56:59]
ds_read_b64_tr_b16 a[136:137], v1 offset:24576
v_cvt_pk_bf16_f32 v134, v52, v53
v_mfma_f32_16x16x32_bf16 v[60:63], a[144:147], v[180:183], v[60:63]
ds_read_b64_tr_b16 a[138:139], v1 offset:25600
v_cvt_pk_bf16_f32 v135, v54, v55
buffer_store_dwordx4 v[132:135], v9, s[16:19], s34 offen offset:1024 sc1
v_mfma_f32_16x16x32_bf16 v[64:67], a[148:151], v[164:167], v[64:67]
ds_read_b64_tr_b16 a[140:141], v2 offset:24576
buffer_load_dwordx4 v19, s[12:15], s31 offen offset:1024 lds
v_mfma_f32_16x16x32_bf16 v[68:71], a[148:151], v[180:183], v[68:71]
ds_read_b64_tr_b16 a[142:143], v2 offset:25600
s_waitcnt lgkmcnt(8)
v_mfma_f32_16x16x32_bf16 v[72:75], a[152:155], v[164:167], v[72:75]
ds_read_b64_tr_b16 a[144:145], v1 offset:10240
v_mfma_f32_16x16x32_bf16 v[76:79], a[152:155], v[180:183], v[76:79]
ds_read_b64_tr_b16 a[146:147], v1 offset:11264
v_mfma_f32_16x16x32_bf16 v[80:83], a[156:159], v[164:167], v[80:83]
ds_read_b64_tr_b16 a[148:149], v2 offset:10240
v_mfma_f32_16x16x32_bf16 v[84:87], a[156:159], v[180:183], v[84:87]
ds_read_b64_tr_b16 a[150:151], v2 offset:11264
s_waitcnt lgkmcnt(8)
v_mfma_f32_16x16x32_bf16 v[56:59], a[128:131], v[184:187], v[56:59]
ds_read_b64_tr_b16 a[152:153], v1 offset:26624
buffer_load_dwordx4 v20, s[12:15], s31 offen offset:2048 lds
v_mfma_f32_16x16x32_bf16 v[60:63], a[128:131], v[216:219], v[60:63]
ds_read_b64_tr_b16 a[154:155], v1 offset:27648
v_add_u32 v246, s40, v254
v_mfma_f32_16x16x32_bf16 v[64:67], a[132:135], v[184:187], v[64:67]
ds_read_b64_tr_b16 a[156:157], v2 offset:26624
v_mfma_f32_16x16x32_bf16 v[68:71], a[132:135], v[216:219], v[68:71]
ds_read_b64_tr_b16 a[158:159], v2 offset:27648
s_waitcnt lgkmcnt(8)
v_mfma_f32_16x16x32_bf16 v[72:75], a[136:139], v[184:187], v[72:75]
ds_read_b64_tr_b16 a[128:129], v1 offset:12288
s_add_u32 s39, s39, 147456
v_mfma_f32_16x16x32_bf16 v[76:79], a[136:139], v[216:219], v[76:79]
ds_read_b64_tr_b16 a[130:131], v1 offset:13312
v_mfma_f32_16x16x32_bf16 v[80:83], a[140:143], v[184:187], v[80:83]
ds_read_b64_tr_b16 a[132:133], v2 offset:12288
v_add_u32 v249, s39, v253
v_mfma_f32_16x16x32_bf16 v[84:87], a[140:143], v[216:219], v[84:87]
ds_read_b64_tr_b16 a[134:135], v2 offset:13312
s_waitcnt lgkmcnt(8)
v_mfma_f32_16x16x32_bf16 v[56:59], a[144:147], v[188:191], v[56:59]
ds_read_b64_tr_b16 a[136:137], v1 offset:28672
buffer_load_dwordx4 v21, s[12:15], s31 offen offset:3072 lds
v_mfma_f32_16x16x32_bf16 v[60:63], a[144:147], v[220:223], v[60:63]
ds_read_b64_tr_b16 a[138:139], v1 offset:29696
v_mfma_f32_16x16x32_bf16 v[64:67], a[148:151], v[188:191], v[64:67]
ds_read_b64_tr_b16 a[140:141], v2 offset:28672
s_add_u32 s39, s20, 4
s_cmp_lt_u32 s20, 2
s_cselect_b32 s36, 1.0, 0
s_cselect_b32 s38, 0, 0x7ff00000
s_mul_i32 s39, s39, 256
s_mul_i32 s40, s39, 8
s_add_u32 s40, s40, s38
v_mfma_f32_16x16x32_bf16 v[68:71], a[148:151], v[220:223], v[68:71]
ds_read_b64_tr_b16 a[142:143], v2 offset:29696
s_waitcnt lgkmcnt(8)
v_mfma_f32_16x16x32_bf16 v[72:75], a[152:155], v[188:191], v[72:75]
ds_read_b64_tr_b16 a[144:145], v1 offset:14336
v_mfma_f32_16x16x32_bf16 v[76:79], a[152:155], v[220:223], v[76:79]
ds_read_b64_tr_b16 a[146:147], v1 offset:15360
v_mfma_f32_16x16x32_bf16 v[80:83], a[156:159], v[188:191], v[80:83]
ds_read_b64_tr_b16 a[148:149], v2 offset:14336
v_mfma_f32_16x16x32_bf16 v[84:87], a[156:159], v[220:223], v[84:87]
ds_read_b64_tr_b16 a[150:151], v2 offset:15360
s_waitcnt lgkmcnt(8)
v_mfma_f32_16x16x32_bf16 v[56:59], a[128:131], v[192:195], v[56:59]
ds_read_b64_tr_b16 a[152:153], v1 offset:30720
v_mfma_f32_16x16x32_bf16 v[60:63], a[128:131], v[224:227], v[60:63]
ds_read_b64_tr_b16 a[154:155], v1 offset:31744
v_mfma_f32_16x16x32_bf16 v[64:67], a[132:135], v[192:195], v[64:67]
ds_read_b64_tr_b16 a[156:157], v2 offset:30720
v_mfma_f32_16x16x32_bf16 v[68:71], a[132:135], v[224:227], v[68:71]
ds_read_b64_tr_b16 a[158:159], v2 offset:31744
s_waitcnt lgkmcnt(8)
v_mfma_f32_16x16x32_bf16 v[72:75], a[136:139], v[192:195], v[72:75]
s_waitcnt vmcnt(12)
s_barrier
ds_read_b64_tr_b16 a[128:129], v1 offset:32768
v_mfma_f32_16x16x32_bf16 v[76:79], a[136:139], v[224:227], v[76:79]
ds_read_b64_tr_b16 a[130:131], v1 offset:33792
s_add_u32 m0, s23, 98304
v_mfma_f32_16x16x32_bf16 v[80:83], a[140:143], v[192:195], v[80:83]
ds_read_b64_tr_b16 a[132:133], v2 offset:32768
s_add_u32 s30, s26, 768
v_mfma_f32_16x16x32_bf16 v[84:87], a[140:143], v[224:227], v[84:87]
ds_read_b64_tr_b16 a[134:135], v2 offset:33792
s_waitcnt lgkmcnt(8)
v_mfma_f32_16x16x32_bf16 v[56:59], a[144:147], v[196:199], v[56:59]
buffer_load_dwordx4 v18, s[12:15], s30 offen lds
ds_read_b64_tr_b16 a[136:137], v1 offset:49152
v_mfma_f32_16x16x32_bf16 v[60:63], a[144:147], v[228:231], v[60:63]
ds_read_b64_tr_b16 a[138:139], v1 offset:50176
v_mfma_f32_16x16x32_bf16 v[64:67], a[148:151], v[196:199], v[64:67]
ds_read_b64_tr_b16 a[140:141], v2 offset:49152
v_add_u32 v245, s40, v254
v_mfma_f32_16x16x32_bf16 v[68:71], a[148:151], v[228:231], v[68:71]
ds_read_b64_tr_b16 a[142:143], v2 offset:50176
s_waitcnt lgkmcnt(8)
v_mfma_f32_16x16x32_bf16 v[72:75], a[152:155], v[196:199], v[72:75]
ds_read_b64_tr_b16 a[144:145], v1 offset:34816
buffer_load_dwordx4 v19, s[12:15], s30 offen offset:1024 lds
v_mfma_f32_16x16x32_bf16 v[76:79], a[152:155], v[228:231], v[76:79]
ds_read_b64_tr_b16 a[146:147], v1 offset:35840
s_add_u32 s39, s39, 147456
v_mfma_f32_16x16x32_bf16 v[80:83], a[156:159], v[196:199], v[80:83]
ds_read_b64_tr_b16 a[148:149], v2 offset:34816
v_cvt_pk_bf16_f32 v120, v56, v57
v_mfma_f32_16x16x32_bf16 v[84:87], a[156:159], v[228:231], v[84:87]
ds_read_b64_tr_b16 a[150:151], v2 offset:35840
s_waitcnt lgkmcnt(8)
v_mfma_f32_16x16x32_bf16 v[24:27], a[128:131], v[152:155], 0
ds_read_b64_tr_b16 a[152:153], v1 offset:51200
v_add_u32 v248, s39, v253
v_mfma_f32_16x16x32_bf16 v[28:31], a[128:131], v[168:171], 0
ds_read_b64_tr_b16 a[154:155], v1 offset:52224
v_cvt_pk_bf16_f32 v121, v58, v59
v_mfma_f32_16x16x32_bf16 v[32:35], a[132:135], v[152:155], 0
ds_read_b64_tr_b16 a[156:157], v2 offset:51200
v_cvt_pk_bf16_f32 v122, v64, v65
v_mfma_f32_16x16x32_bf16 v[36:39], a[132:135], v[168:171], 0
ds_read_b64_tr_b16 a[158:159], v2 offset:52224
v_cvt_pk_bf16_f32 v123, v66, v67
buffer_store_dwordx4 v[120:123], v8, s[16:19], s34 offen offset:2048 sc1
s_waitcnt lgkmcnt(8)
v_mfma_f32_16x16x32_bf16 v[40:43], a[136:139], v[152:155], 0
ds_read_b64_tr_b16 a[128:129], v1 offset:36864
s_mov_b32 s39, s20
s_cmp_eq_u32 s20, s20
s_cselect_b32 s38, 0, 0x7ff00000
s_mul_i32 s39, s39, 256
s_mul_i32 s40, s39, 8
s_add_u32 s40, s40, s38
v_mfma_f32_16x16x32_bf16 v[44:47], a[136:139], v[168:171], 0
ds_read_b64_tr_b16 a[130:131], v1 offset:37888
buffer_load_dwordx4 v20, s[12:15], s30 offen offset:2048 lds
v_mfma_f32_16x16x32_bf16 v[48:51], a[140:143], v[152:155], 0
ds_read_b64_tr_b16 a[132:133], v2 offset:36864
v_cvt_pk_bf16_f32 v124, v60, v61
v_mfma_f32_16x16x32_bf16 v[52:55], a[140:143], v[168:171], 0
ds_read_b64_tr_b16 a[134:135], v2 offset:37888
s_waitcnt lgkmcnt(8)
v_mfma_f32_16x16x32_bf16 v[24:27], a[144:147], v[156:159], v[24:27]
ds_read_b64_tr_b16 a[136:137], v1 offset:53248
v_cvt_pk_bf16_f32 v125, v62, v63
v_mfma_f32_16x16x32_bf16 v[28:31], a[144:147], v[172:175], v[28:31]
ds_read_b64_tr_b16 a[138:139], v1 offset:54272
v_cvt_pk_bf16_f32 v126, v68, v69
v_cvt_pk_bf16_f32 v127, v70, v71
buffer_store_dwordx4 v[124:127], v9, s[16:19], s34 offen offset:2048 sc1
v_mfma_f32_16x16x32_bf16 v[32:35], a[148:151], v[156:159], v[32:35]
ds_read_b64_tr_b16 a[140:141], v2 offset:53248
buffer_load_dwordx4 v21, s[12:15], s30 offen offset:3072 lds
v_mfma_f32_16x16x32_bf16 v[36:39], a[148:151], v[172:175], v[36:39]
ds_read_b64_tr_b16 a[142:143], v2 offset:54272
s_waitcnt lgkmcnt(8)
v_mfma_f32_16x16x32_bf16 v[40:43], a[152:155], v[156:159], v[40:43]
ds_read_b64_tr_b16 a[144:145], v1 offset:38912
v_mfma_f32_16x16x32_bf16 v[44:47], a[152:155], v[172:175], v[44:47]
ds_read_b64_tr_b16 a[146:147], v1 offset:39936
v_cvt_pk_bf16_f32 v128, v72, v73
v_mfma_f32_16x16x32_bf16 v[48:51], a[156:159], v[156:159], v[48:51]
ds_read_b64_tr_b16 a[148:149], v2 offset:38912
v_cvt_pk_bf16_f32 v129, v74, v75
v_mfma_f32_16x16x32_bf16 v[52:55], a[156:159], v[172:175], v[52:55]
ds_read_b64_tr_b16 a[150:151], v2 offset:39936
s_waitcnt lgkmcnt(8)
v_mfma_f32_16x16x32_bf16 v[24:27], a[128:131], v[160:163], v[24:27]
ds_read_b64_tr_b16 a[152:153], v1 offset:55296
v_cvt_pk_bf16_f32 v130, v80, v81
v_mfma_f32_16x16x32_bf16 v[28:31], a[128:131], v[176:179], v[28:31]
ds_read_b64_tr_b16 a[154:155], v1 offset:56320
v_cvt_pk_bf16_f32 v131, v82, v83
v_mfma_f32_16x16x32_bf16 v[32:35], a[132:135], v[160:163], v[32:35]
ds_read_b64_tr_b16 a[156:157], v2 offset:55296
buffer_store_dwordx4 v[128:131], v8, s[16:19], s34 offen offset:3072 sc1
v_mfma_f32_16x16x32_bf16 v[36:39], a[132:135], v[176:179], v[36:39]
ds_read_b64_tr_b16 a[158:159], v2 offset:56320
v_add_u32 v244, s40, v254
s_waitcnt lgkmcnt(8)
v_mfma_f32_16x16x32_bf16 v[40:43], a[136:139], v[160:163], v[40:43]
s_add_u32 m0, s23, 102400
s_add_u32 s31, s26, 74496
buffer_load_dwordx4 v18, s[12:15], s31 offen lds
ds_read_b64_tr_b16 a[128:129], v1 offset:40960
v_mfma_f32_16x16x32_bf16 v[44:47], a[136:139], v[176:179], v[44:47]
ds_read_b64_tr_b16 a[130:131], v1 offset:41984
s_add_u32 s39, s39, 147456
v_mfma_f32_16x16x32_bf16 v[48:51], a[140:143], v[160:163], v[48:51]
ds_read_b64_tr_b16 a[132:133], v2 offset:40960
v_cvt_pk_bf16_f32 v132, v76, v77
v_mfma_f32_16x16x32_bf16 v[52:55], a[140:143], v[176:179], v[52:55]
ds_read_b64_tr_b16 a[134:135], v2 offset:41984
s_waitcnt lgkmcnt(8)
v_mfma_f32_16x16x32_bf16 v[24:27], a[144:147], v[164:167], v[24:27]
ds_read_b64_tr_b16 a[136:137], v1 offset:57344
v_cvt_pk_bf16_f32 v133, v78, v79
v_mfma_f32_16x16x32_bf16 v[28:31], a[144:147], v[180:183], v[28:31]
ds_read_b64_tr_b16 a[138:139], v1 offset:58368
v_cvt_pk_bf16_f32 v134, v84, v85
v_cvt_pk_bf16_f32 v135, v86, v87
buffer_store_dwordx4 v[132:135], v9, s[16:19], s34 offen offset:3072 sc1
v_add_u32 v247, s39, v253
v_mfma_f32_16x16x32_bf16 v[32:35], a[148:151], v[164:167], v[32:35]
ds_read_b64_tr_b16 a[140:141], v2 offset:57344
buffer_load_dwordx4 v19, s[12:15], s31 offen offset:1024 lds
v_mfma_f32_16x16x32_bf16 v[36:39], a[148:151], v[180:183], v[36:39]
ds_read_b64_tr_b16 a[142:143], v2 offset:58368
v_and_b32 v250, 15, v0
s_waitcnt lgkmcnt(8)
v_mfma_f32_16x16x32_bf16 v[40:43], a[152:155], v[164:167], v[40:43]
ds_read_b64_tr_b16 a[144:145], v1 offset:43008
v_mul_u32_u24 v250, 4, v250
v_mfma_f32_16x16x32_bf16 v[44:47], a[152:155], v[180:183], v[44:47]
ds_read_b64_tr_b16 a[146:147], v1 offset:44032
v_mfma_f32_16x16x32_bf16 v[48:51], a[156:159], v[164:167], v[48:51]
ds_read_b64_tr_b16 a[148:149], v2 offset:43008
v_mfma_f32_16x16x32_bf16 v[52:55], a[156:159], v[180:183], v[52:55]
ds_read_b64_tr_b16 a[150:151], v2 offset:44032
s_waitcnt lgkmcnt(8)
v_mfma_f32_16x16x32_bf16 v[24:27], a[128:131], v[184:187], v[24:27]
ds_read_b64_tr_b16 a[152:153], v1 offset:59392
s_mul_i32 s39, s21, 4
s_cmp_eq_u32 s20, 0
s_cselect_b32 s39, s39, 0x7ff00000
v_mfma_f32_16x16x32_bf16 v[28:31], a[128:131], v[216:219], v[28:31]
ds_read_b64_tr_b16 a[154:155], v1 offset:60416
buffer_load_dwordx4 v20, s[12:15], s31 offen offset:2048 lds
v_mfma_f32_16x16x32_bf16 v[32:35], a[132:135], v[184:187], v[32:35]
ds_read_b64_tr_b16 a[156:157], v2 offset:59392
v_mfma_f32_16x16x32_bf16 v[36:39], a[132:135], v[216:219], v[36:39]
ds_read_b64_tr_b16 a[158:159], v2 offset:60416
s_waitcnt lgkmcnt(8)
v_mfma_f32_16x16x32_bf16 v[40:43], a[136:139], v[184:187], v[40:43]
ds_read_b64_tr_b16 a[128:129], v1 offset:45056
v_mfma_f32_16x16x32_bf16 v[44:47], a[136:139], v[216:219], v[44:47]
ds_read_b64_tr_b16 a[130:131], v1 offset:46080
v_mfma_f32_16x16x32_bf16 v[48:51], a[140:143], v[184:187], v[48:51]
ds_read_b64_tr_b16 a[132:133], v2 offset:45056
v_mov_b32 v251, 0x7ff00000
v_mfma_f32_16x16x32_bf16 v[52:55], a[140:143], v[216:219], v[52:55]
ds_read_b64_tr_b16 a[134:135], v2 offset:46080
s_waitcnt lgkmcnt(8)
v_mfma_f32_16x16x32_bf16 v[24:27], a[144:147], v[188:191], v[24:27]
ds_read_b64_tr_b16 a[136:137], v1 offset:61440
buffer_load_dwordx4 v21, s[12:15], s31 offen offset:3072 lds
v_mfma_f32_16x16x32_bf16 v[28:31], a[144:147], v[220:223], v[28:31]
ds_read_b64_tr_b16 a[138:139], v1 offset:62464
v_mov_b32 v253, s39
v_mfma_f32_16x16x32_bf16 v[32:35], a[148:151], v[188:191], v[32:35]
ds_read_b64_tr_b16 a[140:141], v2 offset:61440
v_mfma_f32_16x16x32_bf16 v[36:39], a[148:151], v[220:223], v[36:39]
ds_read_b64_tr_b16 a[142:143], v2 offset:62464
s_waitcnt lgkmcnt(8)
v_mfma_f32_16x16x32_bf16 v[40:43], a[152:155], v[188:191], v[40:43]
ds_read_b64_tr_b16 a[144:145], v1 offset:47104
v_cmp_eq_u32 vcc, 0, v0
v_mfma_f32_16x16x32_bf16 v[44:47], a[152:155], v[220:223], v[44:47]
ds_read_b64_tr_b16 a[146:147], v1 offset:48128
v_mfma_f32_16x16x32_bf16 v[48:51], a[156:159], v[188:191], v[48:51]
ds_read_b64_tr_b16 a[148:149], v2 offset:47104
v_cndmask_b32 v251, v251, v253, vcc
v_mfma_f32_16x16x32_bf16 v[52:55], a[156:159], v[220:223], v[52:55]
ds_read_b64_tr_b16 a[150:151], v2 offset:48128
s_waitcnt lgkmcnt(8)
v_mfma_f32_16x16x32_bf16 v[24:27], a[128:131], v[192:195], v[24:27]
ds_read_b64_tr_b16 a[152:153], v1 offset:63488
v_mov_b32 v255, 1
v_mfma_f32_16x16x32_bf16 v[28:31], a[128:131], v[224:227], v[28:31]
ds_read_b64_tr_b16 a[154:155], v1 offset:64512
v_mfma_f32_16x16x32_bf16 v[32:35], a[132:135], v[192:195], v[32:35]
ds_read_b64_tr_b16 a[156:157], v2 offset:63488
v_mfma_f32_16x16x32_bf16 v[36:39], a[132:135], v[224:227], v[36:39]
ds_read_b64_tr_b16 a[158:159], v2 offset:64512
s_waitcnt lgkmcnt(8)
v_mfma_f32_16x16x32_bf16 v[40:43], a[136:139], v[192:195], v[40:43]
s_waitcnt vmcnt(12)
s_barrier
ds_read_b64_tr_b16 a[128:129], v3
v_mfma_f32_16x16x32_bf16 v[44:47], a[136:139], v[224:227], v[44:47]
ds_read_b64_tr_b16 a[130:131], v3 offset:1024
s_mov_b32 s38, 524288
v_mfma_f32_16x16x32_bf16 v[48:51], a[140:143], v[192:195], v[48:51]
ds_read_b64_tr_b16 a[132:133], v4
s_add_u32 s39, s24, 2424832
v_mfma_f32_16x16x32_bf16 v[52:55], a[140:143], v[224:227], v[52:55]
ds_read_b64_tr_b16 a[134:135], v4 offset:1024
s_waitcnt lgkmcnt(8)
v_mfma_f32_16x16x32_bf16 v[24:27], a[144:147], v[196:199], v[24:27]
s_add_u32 m0, s23, 0
s_add_u32 s30, s26, 896
buffer_load_dwordx4 v18, s[12:15], s30 offen lds
ds_read_b64_tr_b16 a[136:137], v3 offset:16384
v_mfma_f32_16x16x32_bf16 v[28:31], a[144:147], v[228:231], v[28:31]
ds_read_b64_tr_b16 a[138:139], v3 offset:17408
buffer_load_dwordx4 v[232:235], v244, s[16:19], s39 offen
v_mfma_f32_16x16x32_bf16 v[32:35], a[148:151], v[196:199], v[32:35]
ds_read_b64_tr_b16 a[140:141], v4 offset:16384
buffer_load_dwordx4 v[236:239], v245, s[16:19], s39 offen
v_mfma_f32_16x16x32_bf16 v[36:39], a[148:151], v[228:231], v[36:39]
ds_read_b64_tr_b16 a[142:143], v4 offset:17408
s_waitcnt lgkmcnt(8)
v_mfma_f32_16x16x32_bf16 v[40:43], a[152:155], v[196:199], v[40:43]
ds_read_b64_tr_b16 a[144:145], v3 offset:2048
buffer_load_dwordx4 v19, s[12:15], s30 offen offset:1024 lds
v_mfma_f32_16x16x32_bf16 v[44:47], a[152:155], v[228:231], v[44:47]
ds_read_b64_tr_b16 a[146:147], v3 offset:3072
buffer_load_dwordx4 v[240:243], v246, s[16:19], s39 offen
v_mfma_f32_16x16x32_bf16 v[48:51], a[156:159], v[196:199], v[48:51]
ds_read_b64_tr_b16 a[148:149], v4 offset:2048
s_add_u32 s34, s28, 8192
v_mfma_f32_16x16x32_bf16 v[52:55], a[156:159], v[228:231], v[52:55]
ds_read_b64_tr_b16 a[150:151], v4 offset:3072
s_waitcnt lgkmcnt(8)
v_mfma_f32_16x16x32_bf16 v[56:59], a[128:131], v[152:155], 0
ds_read_b64_tr_b16 a[152:153], v3 offset:18432
v_cvt_pk_bf16_f32 v120, v24, v25
v_mfma_f32_16x16x32_bf16 v[60:63], a[128:131], v[168:171], 0
ds_read_b64_tr_b16 a[154:155], v3 offset:19456
v_cvt_pk_bf16_f32 v121, v26, v27
v_mfma_f32_16x16x32_bf16 v[64:67], a[132:135], v[152:155], 0
ds_read_b64_tr_b16 a[156:157], v4 offset:18432
v_cvt_pk_bf16_f32 v122, v32, v33
v_mfma_f32_16x16x32_bf16 v[68:71], a[132:135], v[168:171], 0
ds_read_b64_tr_b16 a[158:159], v4 offset:19456
v_cvt_pk_bf16_f32 v123, v34, v35
buffer_store_dwordx4 v[120:123], v8, s[16:19], s34 offen sc1
s_waitcnt lgkmcnt(8)
v_mfma_f32_16x16x32_bf16 v[72:75], a[136:139], v[152:155], 0
ds_read_b64_tr_b16 a[128:129], v3 offset:4096
buffer_load_dwordx4 v20, s[12:15], s30 offen offset:2048 lds
v_mfma_f32_16x16x32_bf16 v[76:79], a[136:139], v[168:171], 0
ds_read_b64_tr_b16 a[130:131], v3 offset:5120
buffer_load_dword a164, v8, s[84:87], s101 offen
v_mfma_f32_16x16x32_bf16 v[80:83], a[140:143], v[152:155], 0
ds_read_b64_tr_b16 a[132:133], v4 offset:4096
v_cvt_pk_bf16_f32 v124, v28, v29
v_mfma_f32_16x16x32_bf16 v[84:87], a[140:143], v[168:171], 0
ds_read_b64_tr_b16 a[134:135], v4 offset:5120
s_waitcnt lgkmcnt(8)
v_mfma_f32_16x16x32_bf16 v[56:59], a[144:147], v[156:159], v[56:59]
ds_read_b64_tr_b16 a[136:137], v3 offset:20480
v_cvt_pk_bf16_f32 v125, v30, v31
v_mfma_f32_16x16x32_bf16 v[60:63], a[144:147], v[172:175], v[60:63]
ds_read_b64_tr_b16 a[138:139], v3 offset:21504
v_cvt_pk_bf16_f32 v126, v36, v37
v_cvt_pk_bf16_f32 v127, v38, v39
buffer_store_dwordx4 v[124:127], v9, s[16:19], s34 offen sc1
v_mfma_f32_16x16x32_bf16 v[64:67], a[148:151], v[156:159], v[64:67]
ds_read_b64_tr_b16 a[140:141], v4 offset:20480
buffer_load_dwordx4 v21, s[12:15], s30 offen offset:3072 lds
v_mfma_f32_16x16x32_bf16 v[68:71], a[148:151], v[172:175], v[68:71]
ds_read_b64_tr_b16 a[142:143], v4 offset:21504
s_waitcnt lgkmcnt(8)
v_mfma_f32_16x16x32_bf16 v[72:75], a[152:155], v[156:159], v[72:75]
ds_read_b64_tr_b16 a[144:145], v3 offset:6144
v_mfma_f32_16x16x32_bf16 v[76:79], a[152:155], v[172:175], v[76:79]
ds_read_b64_tr_b16 a[146:147], v3 offset:7168
v_cvt_pk_bf16_f32 v128, v40, v41
v_mfma_f32_16x16x32_bf16 v[80:83], a[156:159], v[156:159], v[80:83]
ds_read_b64_tr_b16 a[148:149], v4 offset:6144
v_cvt_pk_bf16_f32 v129, v42, v43
v_mfma_f32_16x16x32_bf16 v[84:87], a[156:159], v[172:175], v[84:87]
ds_read_b64_tr_b16 a[150:151], v4 offset:7168
s_waitcnt lgkmcnt(8)
v_mfma_f32_16x16x32_bf16 v[56:59], a[128:131], v[160:163], v[56:59]
ds_read_b64_tr_b16 a[152:153], v3 offset:22528
v_cvt_pk_bf16_f32 v130, v48, v49
v_mfma_f32_16x16x32_bf16 v[60:63], a[128:131], v[176:179], v[60:63]
ds_read_b64_tr_b16 a[154:155], v3 offset:23552
v_cvt_pk_bf16_f32 v131, v50, v51
v_mfma_f32_16x16x32_bf16 v[64:67], a[132:135], v[160:163], v[64:67]
ds_read_b64_tr_b16 a[156:157], v4 offset:22528
buffer_store_dwordx4 v[128:131], v8, s[16:19], s34 offen offset:1024 sc1
v_mfma_f32_16x16x32_bf16 v[68:71], a[132:135], v[176:179], v[68:71]
ds_read_b64_tr_b16 a[158:159], v4 offset:23552
s_waitcnt lgkmcnt(8)
v_mfma_f32_16x16x32_bf16 v[72:75], a[136:139], v[160:163], v[72:75]
s_add_u32 m0, s23, 4096
s_add_u32 s31, s26, 74624
buffer_load_dwordx4 v18, s[12:15], s31 offen lds
ds_read_b64_tr_b16 a[128:129], v3 offset:8192
v_mfma_f32_16x16x32_bf16 v[76:79], a[136:139], v[176:179], v[76:79]
ds_read_b64_tr_b16 a[130:131], v3 offset:9216
v_cvt_pk_bf16_f32 v132, v44, v45
v_mfma_f32_16x16x32_bf16 v[80:83], a[140:143], v[160:163], v[80:83]
ds_read_b64_tr_b16 a[132:133], v4 offset:8192
v_cvt_pk_bf16_f32 v133, v46, v47
v_mfma_f32_16x16x32_bf16 v[84:87], a[140:143], v[176:179], v[84:87]
ds_read_b64_tr_b16 a[134:135], v4 offset:9216
s_waitcnt lgkmcnt(8)
v_mfma_f32_16x16x32_bf16 v[56:59], a[144:147], v[164:167], v[56:59]
ds_read_b64_tr_b16 a[136:137], v3 offset:24576
v_cvt_pk_bf16_f32 v134, v52, v53
v_mfma_f32_16x16x32_bf16 v[60:63], a[144:147], v[180:183], v[60:63]
ds_read_b64_tr_b16 a[138:139], v3 offset:25600
v_cvt_pk_bf16_f32 v135, v54, v55
buffer_store_dwordx4 v[132:135], v9, s[16:19], s34 offen offset:1024 sc1
v_mfma_f32_16x16x32_bf16 v[64:67], a[148:151], v[164:167], v[64:67]
ds_read_b64_tr_b16 a[140:141], v4 offset:24576
buffer_load_dwordx4 v19, s[12:15], s31 offen offset:1024 lds
v_mfma_f32_16x16x32_bf16 v[68:71], a[148:151], v[180:183], v[68:71]
ds_read_b64_tr_b16 a[142:143], v4 offset:25600
s_waitcnt lgkmcnt(8)
v_mfma_f32_16x16x32_bf16 v[72:75], a[152:155], v[164:167], v[72:75]
ds_read_b64_tr_b16 a[144:145], v3 offset:10240
v_mfma_f32_16x16x32_bf16 v[76:79], a[152:155], v[180:183], v[76:79]
ds_read_b64_tr_b16 a[146:147], v3 offset:11264
v_mfma_f32_16x16x32_bf16 v[80:83], a[156:159], v[164:167], v[80:83]
ds_read_b64_tr_b16 a[148:149], v4 offset:10240
v_mfma_f32_16x16x32_bf16 v[84:87], a[156:159], v[180:183], v[84:87]
ds_read_b64_tr_b16 a[150:151], v4 offset:11264
s_waitcnt lgkmcnt(8)
v_mfma_f32_16x16x32_bf16 v[56:59], a[128:131], v[184:187], v[56:59]
ds_read_b64_tr_b16 a[152:153], v3 offset:26624
buffer_load_dwordx4 v20, s[12:15], s31 offen offset:2048 lds
v_mfma_f32_16x16x32_bf16 v[60:63], a[128:131], v[216:219], v[60:63]
ds_read_b64_tr_b16 a[154:155], v3 offset:27648
v_mfma_f32_16x16x32_bf16 v[64:67], a[132:135], v[184:187], v[64:67]
ds_read_b64_tr_b16 a[156:157], v4 offset:26624
v_mfma_f32_16x16x32_bf16 v[68:71], a[132:135], v[216:219], v[68:71]
ds_read_b64_tr_b16 a[158:159], v4 offset:27648
s_waitcnt lgkmcnt(8)
v_mfma_f32_16x16x32_bf16 v[72:75], a[136:139], v[184:187], v[72:75]
ds_read_b64_tr_b16 a[128:129], v3 offset:12288
v_mfma_f32_16x16x32_bf16 v[76:79], a[136:139], v[216:219], v[76:79]
ds_read_b64_tr_b16 a[130:131], v3 offset:13312
v_mfma_f32_16x16x32_bf16 v[80:83], a[140:143], v[184:187], v[80:83]
ds_read_b64_tr_b16 a[132:133], v4 offset:12288
buffer_load_dwordx4 v21, s[12:15], s31 offen offset:3072 lds
v_mfma_f32_16x16x32_bf16 v[84:87], a[140:143], v[216:219], v[84:87]
ds_read_b64_tr_b16 a[134:135], v4 offset:13312
s_waitcnt lgkmcnt(8)
v_mfma_f32_16x16x32_bf16 v[56:59], a[144:147], v[188:191], v[56:59]
ds_read_b64_tr_b16 a[136:137], v3 offset:28672
v_mfma_f32_16x16x32_bf16 v[60:63], a[144:147], v[220:223], v[60:63]
ds_read_b64_tr_b16 a[138:139], v3 offset:29696
v_mfma_f32_16x16x32_bf16 v[64:67], a[148:151], v[188:191], v[64:67]
ds_read_b64_tr_b16 a[140:141], v4 offset:28672
v_mfma_f32_16x16x32_bf16 v[68:71], a[148:151], v[220:223], v[68:71]
ds_read_b64_tr_b16 a[142:143], v4 offset:29696
s_waitcnt lgkmcnt(8)
v_mfma_f32_16x16x32_bf16 v[72:75], a[152:155], v[188:191], v[72:75]
ds_read_b64_tr_b16 a[144:145], v3 offset:14336
v_mfma_f32_16x16x32_bf16 v[76:79], a[152:155], v[220:223], v[76:79]
ds_read_b64_tr_b16 a[146:147], v3 offset:15360
v_mfma_f32_16x16x32_bf16 v[80:83], a[156:159], v[188:191], v[80:83]
ds_read_b64_tr_b16 a[148:149], v4 offset:14336
v_mfma_f32_16x16x32_bf16 v[84:87], a[156:159], v[220:223], v[84:87]
ds_read_b64_tr_b16 a[150:151], v4 offset:15360
s_waitcnt lgkmcnt(8)
v_mfma_f32_16x16x32_bf16 v[56:59], a[128:131], v[192:195], v[56:59]
ds_read_b64_tr_b16 a[152:153], v3 offset:30720
v_mfma_f32_16x16x32_bf16 v[60:63], a[128:131], v[224:227], v[60:63]
ds_read_b64_tr_b16 a[154:155], v3 offset:31744
v_mfma_f32_16x16x32_bf16 v[64:67], a[132:135], v[192:195], v[64:67]
ds_read_b64_tr_b16 a[156:157], v4 offset:30720
v_mfma_f32_16x16x32_bf16 v[68:71], a[132:135], v[224:227], v[68:71]
ds_read_b64_tr_b16 a[158:159], v4 offset:31744
s_waitcnt lgkmcnt(8)
v_mfma_f32_16x16x32_bf16 v[72:75], a[136:139], v[192:195], v[72:75]
s_waitcnt vmcnt(16)
s_barrier
s_add_u32 s41, s25, 0
buffer_store_dword v255, v251, s[16:19], s41 offen sc1
ds_read_b64_tr_b16 a[128:129], v3 offset:32768
v_mfma_f32_16x16x32_bf16 v[76:79], a[136:139], v[224:227], v[76:79]
ds_read_b64_tr_b16 a[130:131], v3 offset:33792
s_add_u32 m0, s23, 32768
v_mfma_f32_16x16x32_bf16 v[80:83], a[140:143], v[192:195], v[80:83]
ds_read_b64_tr_b16 a[132:133], v4 offset:32768
s_add_u32 s30, s26, 1024
v_mfma_f32_16x16x32_bf16 v[84:87], a[140:143], v[224:227], v[84:87]
ds_read_b64_tr_b16 a[134:135], v4 offset:33792
s_waitcnt lgkmcnt(8)
v_mfma_f32_16x16x32_bf16 v[56:59], a[144:147], v[196:199], v[56:59]
buffer_load_dwordx4 v18, s[12:15], s30 offen lds
ds_read_b64_tr_b16 a[136:137], v3 offset:49152
v_mfma_f32_16x16x32_bf16 v[60:63], a[144:147], v[228:231], v[60:63]
ds_read_b64_tr_b16 a[138:139], v3 offset:50176
v_mfma_f32_16x16x32_bf16 v[64:67], a[148:151], v[196:199], v[64:67]
ds_read_b64_tr_b16 a[140:141], v4 offset:49152
v_mfma_f32_16x16x32_bf16 v[68:71], a[148:151], v[228:231], v[68:71]
ds_read_b64_tr_b16 a[142:143], v4 offset:50176
s_waitcnt lgkmcnt(8)
v_mfma_f32_16x16x32_bf16 v[72:75], a[152:155], v[196:199], v[72:75]
ds_read_b64_tr_b16 a[144:145], v3 offset:34816
buffer_load_dwordx4 v19, s[12:15], s30 offen offset:1024 lds
v_mfma_f32_16x16x32_bf16 v[76:79], a[152:155], v[228:231], v[76:79]
ds_read_b64_tr_b16 a[146:147], v3 offset:35840
v_cvt_pk_bf16_f32 v120, v56, v57
v_mfma_f32_16x16x32_bf16 v[80:83], a[156:159], v[196:199], v[80:83]
ds_read_b64_tr_b16 a[148:149], v4 offset:34816
v_cvt_pk_bf16_f32 v121, v58, v59
v_mfma_f32_16x16x32_bf16 v[84:87], a[156:159], v[228:231], v[84:87]
ds_read_b64_tr_b16 a[150:151], v4 offset:35840
s_waitcnt lgkmcnt(8)
v_mfma_f32_16x16x32_bf16 v[24:27], a[128:131], v[152:155], 0
ds_read_b64_tr_b16 a[152:153], v3 offset:51200
v_cvt_pk_bf16_f32 v122, v64, v65
v_mfma_f32_16x16x32_bf16 v[28:31], a[128:131], v[168:171], 0
ds_read_b64_tr_b16 a[154:155], v3 offset:52224
v_cvt_pk_bf16_f32 v123, v66, v67
v_mfma_f32_16x16x32_bf16 v[32:35], a[132:135], v[152:155], 0
ds_read_b64_tr_b16 a[156:157], v4 offset:51200
buffer_store_dwordx4 v[120:123], v8, s[16:19], s34 offen offset:2048 sc1
v_mfma_f32_16x16x32_bf16 v[36:39], a[132:135], v[168:171], 0
ds_read_b64_tr_b16 a[158:159], v4 offset:52224
s_waitcnt lgkmcnt(8)
v_mfma_f32_16x16x32_bf16 v[40:43], a[136:139], v[152:155], 0
ds_read_b64_tr_b16 a[128:129], v3 offset:36864
buffer_load_dwordx4 v20, s[12:15], s30 offen offset:2048 lds
v_mfma_f32_16x16x32_bf16 v[44:47], a[136:139], v[168:171], 0
ds_read_b64_tr_b16 a[130:131], v3 offset:37888
v_cvt_pk_bf16_f32 v124, v60, v61
v_mfma_f32_16x16x32_bf16 v[48:51], a[140:143], v[152:155], 0
ds_read_b64_tr_b16 a[132:133], v4 offset:36864
v_cvt_pk_bf16_f32 v125, v62, v63
v_mfma_f32_16x16x32_bf16 v[52:55], a[140:143], v[168:171], 0
ds_read_b64_tr_b16 a[134:135], v4 offset:37888
s_waitcnt lgkmcnt(8)
v_mfma_f32_16x16x32_bf16 v[24:27], a[144:147], v[156:159], v[24:27]
ds_read_b64_tr_b16 a[136:137], v3 offset:53248
v_cvt_pk_bf16_f32 v126, v68, v69
v_mfma_f32_16x16x32_bf16 v[28:31], a[144:147], v[172:175], v[28:31]
ds_read_b64_tr_b16 a[138:139], v3 offset:54272
v_cvt_pk_bf16_f32 v127, v70, v71
buffer_store_dwordx4 v[124:127], v9, s[16:19], s34 offen offset:2048 sc1
v_mfma_f32_16x16x32_bf16 v[32:35], a[148:151], v[156:159], v[32:35]
ds_read_b64_tr_b16 a[140:141], v4 offset:53248
buffer_load_dwordx4 v21, s[12:15], s30 offen offset:3072 lds
v_mfma_f32_16x16x32_bf16 v[36:39], a[148:151], v[172:175], v[36:39]
ds_read_b64_tr_b16 a[142:143], v4 offset:54272
s_waitcnt lgkmcnt(8)
v_mfma_f32_16x16x32_bf16 v[40:43], a[152:155], v[156:159], v[40:43]
ds_read_b64_tr_b16 a[144:145], v3 offset:38912
v_mfma_f32_16x16x32_bf16 v[44:47], a[152:155], v[172:175], v[44:47]
ds_read_b64_tr_b16 a[146:147], v3 offset:39936
v_cvt_pk_bf16_f32 v128, v72, v73
v_mfma_f32_16x16x32_bf16 v[48:51], a[156:159], v[156:159], v[48:51]
ds_read_b64_tr_b16 a[148:149], v4 offset:38912
v_cvt_pk_bf16_f32 v129, v74, v75
v_mfma_f32_16x16x32_bf16 v[52:55], a[156:159], v[172:175], v[52:55]
ds_read_b64_tr_b16 a[150:151], v4 offset:39936
s_waitcnt lgkmcnt(8)
v_mfma_f32_16x16x32_bf16 v[24:27], a[128:131], v[160:163], v[24:27]
ds_read_b64_tr_b16 a[152:153], v3 offset:55296
v_cvt_pk_bf16_f32 v130, v80, v81
v_mfma_f32_16x16x32_bf16 v[28:31], a[128:131], v[176:179], v[28:31]
ds_read_b64_tr_b16 a[154:155], v3 offset:56320
v_cvt_pk_bf16_f32 v131, v82, v83
v_mfma_f32_16x16x32_bf16 v[32:35], a[132:135], v[160:163], v[32:35]
ds_read_b64_tr_b16 a[156:157], v4 offset:55296
buffer_store_dwordx4 v[128:131], v8, s[16:19], s34 offen offset:3072 sc1
v_mfma_f32_16x16x32_bf16 v[36:39], a[132:135], v[176:179], v[36:39]
ds_read_b64_tr_b16 a[158:159], v4 offset:56320
s_waitcnt lgkmcnt(8)
v_mfma_f32_16x16x32_bf16 v[40:43], a[136:139], v[160:163], v[40:43]
s_add_u32 m0, s23, 36864
s_add_u32 s31, s26, 74752
buffer_load_dwordx4 v18, s[12:15], s31 offen lds
ds_read_b64_tr_b16 a[128:129], v3 offset:40960
v_mfma_f32_16x16x32_bf16 v[44:47], a[136:139], v[176:179], v[44:47]
ds_read_b64_tr_b16 a[130:131], v3 offset:41984
v_cvt_pk_bf16_f32 v132, v76, v77
v_mfma_f32_16x16x32_bf16 v[48:51], a[140:143], v[160:163], v[48:51]
ds_read_b64_tr_b16 a[132:133], v4 offset:40960
v_cvt_pk_bf16_f32 v133, v78, v79
v_mfma_f32_16x16x32_bf16 v[52:55], a[140:143], v[176:179], v[52:55]
ds_read_b64_tr_b16 a[134:135], v4 offset:41984
s_waitcnt lgkmcnt(8)
v_mfma_f32_16x16x32_bf16 v[24:27], a[144:147], v[164:167], v[24:27]
ds_read_b64_tr_b16 a[136:137], v3 offset:57344
v_cvt_pk_bf16_f32 v134, v84, v85
v_mfma_f32_16x16x32_bf16 v[28:31], a[144:147], v[180:183], v[28:31]
ds_read_b64_tr_b16 a[138:139], v3 offset:58368
v_cvt_pk_bf16_f32 v135, v86, v87
buffer_store_dwordx4 v[132:135], v9, s[16:19], s34 offen offset:3072 sc1
v_mfma_f32_16x16x32_bf16 v[32:35], a[148:151], v[164:167], v[32:35]
ds_read_b64_tr_b16 a[140:141], v4 offset:57344
buffer_load_dwordx4 v19, s[12:15], s31 offen offset:1024 lds
v_mfma_f32_16x16x32_bf16 v[36:39], a[148:151], v[180:183], v[36:39]
ds_read_b64_tr_b16 a[142:143], v4 offset:58368
s_waitcnt lgkmcnt(8)
v_mfma_f32_16x16x32_bf16 v[40:43], a[152:155], v[164:167], v[40:43]
ds_read_b64_tr_b16 a[144:145], v3 offset:43008
v_mfma_f32_16x16x32_bf16 v[44:47], a[152:155], v[180:183], v[44:47]
ds_read_b64_tr_b16 a[146:147], v3 offset:44032
v_mfma_f32_16x16x32_bf16 v[48:51], a[156:159], v[164:167], v[48:51]
ds_read_b64_tr_b16 a[148:149], v4 offset:43008
v_mfma_f32_16x16x32_bf16 v[52:55], a[156:159], v[180:183], v[52:55]
ds_read_b64_tr_b16 a[150:151], v4 offset:44032
s_waitcnt lgkmcnt(8)
v_mfma_f32_16x16x32_bf16 v[24:27], a[128:131], v[184:187], v[24:27]
ds_read_b64_tr_b16 a[152:153], v3 offset:59392
buffer_load_dwordx4 v20, s[12:15], s31 offen offset:2048 lds
v_mfma_f32_16x16x32_bf16 v[28:31], a[128:131], v[216:219], v[28:31]
ds_read_b64_tr_b16 a[154:155], v3 offset:60416
v_mfma_f32_16x16x32_bf16 v[32:35], a[132:135], v[184:187], v[32:35]
ds_read_b64_tr_b16 a[156:157], v4 offset:59392
v_mfma_f32_16x16x32_bf16 v[36:39], a[132:135], v[216:219], v[36:39]
ds_read_b64_tr_b16 a[158:159], v4 offset:60416
s_waitcnt lgkmcnt(8)
v_mfma_f32_16x16x32_bf16 v[40:43], a[136:139], v[184:187], v[40:43]
ds_read_b64_tr_b16 a[128:129], v3 offset:45056
v_mfma_f32_16x16x32_bf16 v[44:47], a[136:139], v[216:219], v[44:47]
ds_read_b64_tr_b16 a[130:131], v3 offset:46080
v_mfma_f32_16x16x32_bf16 v[48:51], a[140:143], v[184:187], v[48:51]
ds_read_b64_tr_b16 a[132:133], v4 offset:45056
buffer_load_dwordx4 v21, s[12:15], s31 offen offset:3072 lds
v_mfma_f32_16x16x32_bf16 v[52:55], a[140:143], v[216:219], v[52:55]
ds_read_b64_tr_b16 a[134:135], v4 offset:46080
s_waitcnt lgkmcnt(8)
v_mfma_f32_16x16x32_bf16 v[24:27], a[144:147], v[188:191], v[24:27]
ds_read_b64_tr_b16 a[136:137], v3 offset:61440
v_mfma_f32_16x16x32_bf16 v[28:31], a[144:147], v[220:223], v[28:31]
ds_read_b64_tr_b16 a[138:139], v3 offset:62464
v_mfma_f32_16x16x32_bf16 v[32:35], a[148:151], v[188:191], v[32:35]
ds_read_b64_tr_b16 a[140:141], v4 offset:61440
v_mfma_f32_16x16x32_bf16 v[36:39], a[148:151], v[220:223], v[36:39]
ds_read_b64_tr_b16 a[142:143], v4 offset:62464
s_waitcnt lgkmcnt(8)
v_mfma_f32_16x16x32_bf16 v[40:43], a[152:155], v[188:191], v[40:43]
ds_read_b64_tr_b16 a[144:145], v3 offset:47104
v_mfma_f32_16x16x32_bf16 v[44:47], a[152:155], v[220:223], v[44:47]
ds_read_b64_tr_b16 a[146:147], v3 offset:48128
v_mfma_f32_16x16x32_bf16 v[48:51], a[156:159], v[188:191], v[48:51]
ds_read_b64_tr_b16 a[148:149], v4 offset:47104
v_mfma_f32_16x16x32_bf16 v[52:55], a[156:159], v[220:223], v[52:55]
ds_read_b64_tr_b16 a[150:151], v4 offset:48128
s_waitcnt lgkmcnt(8)
v_mfma_f32_16x16x32_bf16 v[24:27], a[128:131], v[192:195], v[24:27]
ds_read_b64_tr_b16 a[152:153], v3 offset:63488
v_mfma_f32_16x16x32_bf16 v[28:31], a[128:131], v[224:227], v[28:31]
ds_read_b64_tr_b16 a[154:155], v3 offset:64512
v_mfma_f32_16x16x32_bf16 v[32:35], a[132:135], v[192:195], v[32:35]
ds_read_b64_tr_b16 a[156:157], v4 offset:63488
v_mfma_f32_16x16x32_bf16 v[36:39], a[132:135], v[224:227], v[36:39]
ds_read_b64_tr_b16 a[158:159], v4 offset:64512
s_waitcnt lgkmcnt(8)
v_mfma_f32_16x16x32_bf16 v[40:43], a[136:139], v[192:195], v[40:43]
s_waitcnt vmcnt(13)
s_barrier
ds_read_b64_tr_b16 a[128:129], v1
v_mfma_f32_16x16x32_bf16 v[44:47], a[136:139], v[224:227], v[44:47]
ds_read_b64_tr_b16 a[130:131], v1 offset:1024
s_add_u32 s34, s28, 12288
v_mfma_f32_16x16x32_bf16 v[48:51], a[140:143], v[192:195], v[48:51]
ds_read_b64_tr_b16 a[132:133], v2
v_mfma_f32_16x16x32_bf16 v[52:55], a[140:143], v[224:227], v[52:55]
ds_read_b64_tr_b16 a[134:135], v2 offset:1024
s_waitcnt lgkmcnt(8)
v_mfma_f32_16x16x32_bf16 v[24:27], a[144:147], v[196:199], v[24:27]
ds_read_b64_tr_b16 a[136:137], v1 offset:16384
v_mfma_f32_16x16x32_bf16 v[28:31], a[144:147], v[228:231], v[28:31]
ds_read_b64_tr_b16 a[138:139], v1 offset:17408
v_mfma_f32_16x16x32_bf16 v[32:35], a[148:151], v[196:199], v[32:35]
ds_read_b64_tr_b16 a[140:141], v2 offset:16384
v_mfma_f32_16x16x32_bf16 v[36:39], a[148:151], v[228:231], v[36:39]
ds_read_b64_tr_b16 a[142:143], v2 offset:17408
s_waitcnt lgkmcnt(8)
v_mfma_f32_16x16x32_bf16 v[40:43], a[152:155], v[196:199], v[40:43]
ds_read_b64_tr_b16 a[144:145], v1 offset:2048
v_mfma_f32_16x16x32_bf16 v[44:47], a[152:155], v[228:231], v[44:47]
ds_read_b64_tr_b16 a[146:147], v1 offset:3072
v_cvt_pk_bf16_f32 v120, v24, v25
v_mfma_f32_16x16x32_bf16 v[48:51], a[156:159], v[196:199], v[48:51]
ds_read_b64_tr_b16 a[148:149], v2 offset:2048
v_cvt_pk_bf16_f32 v121, v26, v27
v_mfma_f32_16x16x32_bf16 v[52:55], a[156:159], v[228:231], v[52:55]
ds_read_b64_tr_b16 a[150:151], v2 offset:3072
s_waitcnt lgkmcnt(8)
v_mfma_f32_16x16x32_bf16 v[56:59], a[128:131], v[152:155], 0
ds_read_b64_tr_b16 a[152:153], v1 offset:18432
buffer_load_dword v252, v250, s[16:19], s25 offen sc1
v_mfma_f32_16x16x32_bf16 v[60:63], a[128:131], v[168:171], 0
ds_read_b64_tr_b16 a[154:155], v1 offset:19456
v_cvt_pk_bf16_f32 v122, v32, v33
v_mfma_f32_16x16x32_bf16 v[64:67], a[132:135], v[152:155], 0
ds_read_b64_tr_b16 a[156:157], v2 offset:18432
v_cvt_pk_bf16_f32 v123, v34, v35
v_mfma_f32_16x16x32_bf16 v[68:71], a[132:135], v[168:171], 0
ds_read_b64_tr_b16 a[158:159], v2 offset:19456
buffer_store_dwordx4 v[120:123], v8, s[16:19], s34 offen sc1
s_waitcnt lgkmcnt(8)
v_mfma_f32_16x16x32_bf16 v[72:75], a[136:139], v[152:155], 0
ds_read_b64_tr_b16 a[128:129], v1 offset:4096
v_cvt_pk_bf16_f32 v124, v28, v29
v_mfma_f32_16x16x32_bf16 v[76:79], a[136:139], v[168:171], 0
ds_read_b64_tr_b16 a[130:131], v1 offset:5120
v_cvt_pk_bf16_f32 v125, v30, v31
v_mfma_f32_16x16x32_bf16 v[80:83], a[140:143], v[152:155], 0
ds_read_b64_tr_b16 a[132:133], v2 offset:4096
v_cvt_pk_bf16_f32 v126, v36, v37
v_mfma_f32_16x16x32_bf16 v[84:87], a[140:143], v[168:171], 0
ds_read_b64_tr_b16 a[134:135], v2 offset:5120
s_waitcnt lgkmcnt(8)
v_mfma_f32_16x16x32_bf16 v[56:59], a[144:147], v[156:159], v[56:59]
ds_read_b64_tr_b16 a[136:137], v1 offset:20480
v_cvt_pk_bf16_f32 v127, v38, v39
v_mfma_f32_16x16x32_bf16 v[60:63], a[144:147], v[172:175], v[60:63]
ds_read_b64_tr_b16 a[138:139], v1 offset:21504
buffer_store_dwordx4 v[124:127], v9, s[16:19], s34 offen sc1
v_mfma_f32_16x16x32_bf16 v[64:67], a[148:151], v[156:159], v[64:67]
ds_read_b64_tr_b16 a[140:141], v2 offset:20480
v_mfma_f32_16x16x32_bf16 v[68:71], a[148:151], v[172:175], v[68:71]
ds_read_b64_tr_b16 a[142:143], v2 offset:21504
s_waitcnt lgkmcnt(8)
v_mfma_f32_16x16x32_bf16 v[72:75], a[152:155], v[156:159], v[72:75]
ds_read_b64_tr_b16 a[144:145], v1 offset:6144
v_mfma_f32_16x16x32_bf16 v[76:79], a[152:155], v[172:175], v[76:79]
ds_read_b64_tr_b16 a[146:147], v1 offset:7168
v_cvt_pk_bf16_f32 v128, v40, v41
v_mfma_f32_16x16x32_bf16 v[80:83], a[156:159], v[156:159], v[80:83]
ds_read_b64_tr_b16 a[148:149], v2 offset:6144
v_cvt_pk_bf16_f32 v129, v42, v43
v_mfma_f32_16x16x32_bf16 v[84:87], a[156:159], v[172:175], v[84:87]
ds_read_b64_tr_b16 a[150:151], v2 offset:7168
s_waitcnt lgkmcnt(8)
v_mfma_f32_16x16x32_bf16 v[56:59], a[128:131], v[160:163], v[56:59]
ds_read_b64_tr_b16 a[152:153], v1 offset:22528
v_cvt_pk_bf16_f32 v130, v48, v49
v_mfma_f32_16x16x32_bf16 v[60:63], a[128:131], v[176:179], v[60:63]
ds_read_b64_tr_b16 a[154:155], v1 offset:23552
v_cvt_pk_bf16_f32 v131, v50, v51
v_mfma_f32_16x16x32_bf16 v[64:67], a[132:135], v[160:163], v[64:67]
ds_read_b64_tr_b16 a[156:157], v2 offset:22528
buffer_store_dwordx4 v[128:131], v8, s[16:19], s34 offen offset:1024 sc1
v_mfma_f32_16x16x32_bf16 v[68:71], a[132:135], v[176:179], v[68:71]
ds_read_b64_tr_b16 a[158:159], v2 offset:23552
s_waitcnt lgkmcnt(8)
v_mfma_f32_16x16x32_bf16 v[72:75], a[136:139], v[160:163], v[72:75]
ds_read_b64_tr_b16 a[128:129], v1 offset:8192
v_cvt_pk_bf16_f32 v132, v44, v45
v_mfma_f32_16x16x32_bf16 v[76:79], a[136:139], v[176:179], v[76:79]
ds_read_b64_tr_b16 a[130:131], v1 offset:9216
v_cvt_pk_bf16_f32 v133, v46, v47
v_mfma_f32_16x16x32_bf16 v[80:83], a[140:143], v[160:163], v[80:83]
ds_read_b64_tr_b16 a[132:133], v2 offset:8192
v_cvt_pk_bf16_f32 v134, v52, v53
v_mfma_f32_16x16x32_bf16 v[84:87], a[140:143], v[176:179], v[84:87]
ds_read_b64_tr_b16 a[134:135], v2 offset:9216
s_waitcnt vmcnt(3)
v_cmp_ne_u32 vcc, 1, v252
s_nop 1
s_cbranch_vccnz K1_SPIN0
K1_GOT0:
s_waitcnt lgkmcnt(8)
v_mfma_f32_16x16x32_bf16 v[56:59], a[144:147], v[164:167], v[56:59]
ds_read_b64_tr_b16 a[136:137], v1 offset:24576
v_cvt_pk_bf16_f32 v135, v54, v55
v_mfma_f32_16x16x32_bf16 v[60:63], a[144:147], v[180:183], v[60:63]
ds_read_b64_tr_b16 a[138:139], v1 offset:25600
buffer_store_dwordx4 v[132:135], v9, s[16:19], s34 offen offset:1024 sc1
v_mfma_f32_16x16x32_bf16 v[64:67], a[148:151], v[164:167], v[64:67]
ds_read_b64_tr_b16 a[140:141], v2 offset:24576
s_add_u32 s39, s24, 16777216
v_mfma_f32_16x16x32_bf16 v[68:71], a[148:151], v[180:183], v[68:71]
ds_read_b64_tr_b16 a[142:143], v2 offset:25600
buffer_load_dwordx4 v[88:91], v244, s[16:19], s39 offen sc1
s_waitcnt lgkmcnt(8)
v_mfma_f32_16x16x32_bf16 v[72:75], a[152:155], v[164:167], v[72:75]
ds_read_b64_tr_b16 a[144:145], v1 offset:10240
s_add_u32 s40, s24, 19136512
v_mfma_f32_16x16x32_bf16 v[76:79], a[152:155], v[180:183], v[76:79]
ds_read_b64_tr_b16 a[146:147], v1 offset:11264
buffer_load_dwordx4 v[92:95], v244, s[16:19], s40 offen sc1
v_mfma_f32_16x16x32_bf16 v[80:83], a[156:159], v[164:167], v[80:83]
ds_read_b64_tr_b16 a[148:149], v2 offset:10240
v_mfma_f32_16x16x32_bf16 v[84:87], a[156:159], v[180:183], v[84:87]
ds_read_b64_tr_b16 a[150:151], v2 offset:11264
s_waitcnt lgkmcnt(8)
v_mfma_f32_16x16x32_bf16 v[56:59], a[128:131], v[184:187], v[56:59]
ds_read_b64_tr_b16 a[152:153], v1 offset:26624
v_mfma_f32_16x16x32_bf16 v[60:63], a[128:131], v[216:219], v[60:63]
ds_read_b64_tr_b16 a[154:155], v1 offset:27648
s_add_u32 s39, s24, 21495808
v_mfma_f32_16x16x32_bf16 v[64:67], a[132:135], v[184:187], v[64:67]
ds_read_b64_tr_b16 a[156:157], v2 offset:26624
buffer_load_dwordx4 v[96:99], v244, s[16:19], s39 offen sc1
v_mfma_f32_16x16x32_bf16 v[68:71], a[132:135], v[216:219], v[68:71]
ds_read_b64_tr_b16 a[158:159], v2 offset:27648
s_waitcnt lgkmcnt(8)
v_mfma_f32_16x16x32_bf16 v[72:75], a[136:139], v[184:187], v[72:75]
ds_read_b64_tr_b16 a[128:129], v1 offset:12288
v_mfma_f32_16x16x32_bf16 v[76:79], a[136:139], v[216:219], v[76:79]
ds_read_b64_tr_b16 a[130:131], v1 offset:13312
v_mfma_f32_16x16x32_bf16 v[80:83], a[140:143], v[184:187], v[80:83]
ds_read_b64_tr_b16 a[132:133], v2 offset:12288
s_add_u32 s40, s24, 23855104
v_mfma_f32_16x16x32_bf16 v[84:87], a[140:143], v[216:219], v[84:87]
ds_read_b64_tr_b16 a[134:135], v2 offset:13312
s_waitcnt lgkmcnt(8)
v_mfma_f32_16x16x32_bf16 v[56:59], a[144:147], v[188:191], v[56:59]
ds_read_b64_tr_b16 a[136:137], v1 offset:28672
buffer_load_dwordx4 v[100:103], v244, s[16:19], s40 offen sc1
v_mfma_f32_16x16x32_bf16 v[60:63], a[144:147], v[220:223], v[60:63]
ds_read_b64_tr_b16 a[138:139], v1 offset:29696
v_mfma_f32_16x16x32_bf16 v[64:67], a[148:151], v[188:191], v[64:67]
ds_read_b64_tr_b16 a[140:141], v2 offset:28672
v_mfma_f32_16x16x32_bf16 v[68:71], a[148:151], v[220:223], v[68:71]
ds_read_b64_tr_b16 a[142:143], v2 offset:29696
s_waitcnt lgkmcnt(8)
v_mfma_f32_16x16x32_bf16 v[72:75], a[152:155], v[188:191], v[72:75]
ds_read_b64_tr_b16 a[144:145], v1 offset:14336
s_add_u32 s39, s24, 26214400
v_mfma_f32_16x16x32_bf16 v[76:79], a[152:155], v[220:223], v[76:79]
ds_read_b64_tr_b16 a[146:147], v1 offset:15360
buffer_load_dwordx4 v[104:107], v244, s[16:19], s39 offen sc1
v_mfma_f32_16x16x32_bf16 v[80:83], a[156:159], v[188:191], v[80:83]
ds_read_b64_tr_b16 a[148:149], v2 offset:14336
v_mfma_f32_16x16x32_bf16 v[84:87], a[156:159], v[220:223], v[84:87]
ds_read_b64_tr_b16 a[150:151], v2 offset:15360
s_waitcnt lgkmcnt(8)
v_mfma_f32_16x16x32_bf16 v[56:59], a[128:131], v[192:195], v[56:59]
ds_read_b64_tr_b16 a[152:153], v1 offset:30720
s_add_u32 s40, s24, 28573696
v_mfma_f32_16x16x32_bf16 v[60:63], a[128:131], v[224:227], v[60:63]
ds_read_b64_tr_b16 a[154:155], v1 offset:31744
buffer_load_dwordx4 v[108:111], v244, s[16:19], s40 offen sc1
v_mfma_f32_16x16x32_bf16 v[64:67], a[132:135], v[192:195], v[64:67]
ds_read_b64_tr_b16 a[156:157], v2 offset:30720
v_mfma_f32_16x16x32_bf16 v[68:71], a[132:135], v[224:227], v[68:71]
ds_read_b64_tr_b16 a[158:159], v2 offset:31744
s_waitcnt lgkmcnt(8)
v_mfma_f32_16x16x32_bf16 v[72:75], a[136:139], v[192:195], v[72:75]
s_barrier
s_add_u32 s41, s25, 128
buffer_store_dword v255, v251, s[16:19], s41 offen sc1
ds_read_b64_tr_b16 a[128:129], v1 offset:32768
v_mfma_f32_16x16x32_bf16 v[76:79], a[136:139], v[224:227], v[76:79]
ds_read_b64_tr_b16 a[130:131], v1 offset:33792
s_add_u32 s39, s24, 30932992
v_mfma_f32_16x16x32_bf16 v[80:83], a[140:143], v[192:195], v[80:83]
ds_read_b64_tr_b16 a[132:133], v2 offset:32768
buffer_load_dwordx4 v[112:115], v244, s[16:19], s39 offen sc1
v_mfma_f32_16x16x32_bf16 v[84:87], a[140:143], v[224:227], v[84:87]
ds_read_b64_tr_b16 a[134:135], v2 offset:33792
s_waitcnt lgkmcnt(8)
v_mfma_f32_16x16x32_bf16 v[56:59], a[144:147], v[196:199], v[56:59]
ds_read_b64_tr_b16 a[136:137], v1 offset:49152
v_mfma_f32_16x16x32_bf16 v[60:63], a[144:147], v[228:231], v[60:63]
ds_read_b64_tr_b16 a[138:139], v1 offset:50176
v_mfma_f32_16x16x32_bf16 v[64:67], a[148:151], v[196:199], v[64:67]
ds_read_b64_tr_b16 a[140:141], v2 offset:49152
s_add_u32 s40, s24, 33292288
v_mfma_f32_16x16x32_bf16 v[68:71], a[148:151], v[228:231], v[68:71]
ds_read_b64_tr_b16 a[142:143], v2 offset:50176
s_waitcnt lgkmcnt(8)
v_mfma_f32_16x16x32_bf16 v[72:75], a[152:155], v[196:199], v[72:75]
ds_read_b64_tr_b16 a[144:145], v1 offset:34816
buffer_load_dwordx4 v[116:119], v244, s[16:19], s40 offen sc1
v_mfma_f32_16x16x32_bf16 v[76:79], a[152:155], v[228:231], v[76:79]
ds_read_b64_tr_b16 a[146:147], v1 offset:35840
v_cvt_pk_bf16_f32 v120, v56, v57
v_mfma_f32_16x16x32_bf16 v[80:83], a[156:159], v[196:199], v[80:83]
ds_read_b64_tr_b16 a[148:149], v2 offset:34816
v_cvt_pk_bf16_f32 v121, v58, v59
v_mfma_f32_16x16x32_bf16 v[84:87], a[156:159], v[228:231], v[84:87]
ds_read_b64_tr_b16 a[150:151], v2 offset:35840
s_waitcnt lgkmcnt(8)
v_mfma_f32_16x16x32_bf16 v[24:27], a[128:131], v[152:155], 0
ds_read_b64_tr_b16 a[152:153], v1 offset:51200
s_add_u32 s39, s24, 35651584
v_mfma_f32_16x16x32_bf16 v[28:31], a[128:131], v[168:171], 0
ds_read_b64_tr_b16 a[154:155], v1 offset:52224
buffer_load_dwordx4 v[136:139], v244, s[16:19], s39 offen sc1
v_mfma_f32_16x16x32_bf16 v[32:35], a[132:135], v[152:155], 0
ds_read_b64_tr_b16 a[156:157], v2 offset:51200
v_cvt_pk_bf16_f32 v122, v64, v65
v_mfma_f32_16x16x32_bf16 v[36:39], a[132:135], v[168:171], 0
ds_read_b64_tr_b16 a[158:159], v2 offset:52224
v_cvt_pk_bf16_f32 v123, v66, v67
buffer_store_dwordx4 v[120:123], v8, s[16:19], s34 offen offset:2048 sc1
s_waitcnt lgkmcnt(8)
v_mfma_f32_16x16x32_bf16 v[40:43], a[136:139], v[152:155], 0
ds_read_b64_tr_b16 a[128:129], v1 offset:36864
s_add_u32 s40, s24, 38010880
v_mfma_f32_16x16x32_bf16 v[44:47], a[136:139], v[168:171], 0
ds_read_b64_tr_b16 a[130:131], v1 offset:37888
buffer_load_dwordx4 v[140:143], v244, s[16:19], s40 offen sc1
v_mfma_f32_16x16x32_bf16 v[48:51], a[140:143], v[152:155], 0
ds_read_b64_tr_b16 a[132:133], v2 offset:36864
v_cvt_pk_bf16_f32 v124, v60, v61
v_mfma_f32_16x16x32_bf16 v[52:55], a[140:143], v[168:171], 0
ds_read_b64_tr_b16 a[134:135], v2 offset:37888
s_waitcnt lgkmcnt(8)
v_mfma_f32_16x16x32_bf16 v[24:27], a[144:147], v[156:159], v[24:27]
ds_read_b64_tr_b16 a[136:137], v1 offset:53248
v_cvt_pk_bf16_f32 v125, v62, v63
v_mfma_f32_16x16x32_bf16 v[28:31], a[144:147], v[172:175], v[28:31]
ds_read_b64_tr_b16 a[138:139], v1 offset:54272
v_cvt_pk_bf16_f32 v126, v68, v69
v_cvt_pk_bf16_f32 v127, v70, v71
buffer_store_dwordx4 v[124:127], v9, s[16:19], s34 offen offset:2048 sc1
v_mfma_f32_16x16x32_bf16 v[32:35], a[148:151], v[156:159], v[32:35]
ds_read_b64_tr_b16 a[140:141], v2 offset:53248
s_add_u32 s39, s24, 40370176
v_mfma_f32_16x16x32_bf16 v[36:39], a[148:151], v[172:175], v[36:39]
ds_read_b64_tr_b16 a[142:143], v2 offset:54272
s_waitcnt lgkmcnt(8)
v_mfma_f32_16x16x32_bf16 v[40:43], a[152:155], v[156:159], v[40:43]
ds_read_b64_tr_b16 a[144:145], v1 offset:38912
buffer_load_dwordx4 v[144:147], v244, s[16:19], s39 offen sc1
v_mfma_f32_16x16x32_bf16 v[44:47], a[152:155], v[172:175], v[44:47]
ds_read_b64_tr_b16 a[146:147], v1 offset:39936
v_cvt_pk_bf16_f32 v128, v72, v73
v_mfma_f32_16x16x32_bf16 v[48:51], a[156:159], v[156:159], v[48:51]
ds_read_b64_tr_b16 a[148:149], v2 offset:38912
s_add_u32 s40, s24, 42729472
v_mfma_f32_16x16x32_bf16 v[52:55], a[156:159], v[172:175], v[52:55]
ds_read_b64_tr_b16 a[150:151], v2 offset:39936
s_waitcnt lgkmcnt(8)
v_mfma_f32_16x16x32_bf16 v[24:27], a[128:131], v[160:163], v[24:27]
ds_read_b64_tr_b16 a[152:153], v1 offset:55296
buffer_load_dwordx4 v[148:151], v244, s[16:19], s40 offen sc1
v_mfma_f32_16x16x32_bf16 v[28:31], a[128:131], v[176:179], v[28:31]
ds_read_b64_tr_b16 a[154:155], v1 offset:56320
v_cvt_pk_bf16_f32 v129, v74, v75
v_mfma_f32_16x16x32_bf16 v[32:35], a[132:135], v[160:163], v[32:35]
ds_read_b64_tr_b16 a[156:157], v2 offset:55296
v_cvt_pk_bf16_f32 v130, v80, v81
v_mfma_f32_16x16x32_bf16 v[36:39], a[132:135], v[176:179], v[36:39]
ds_read_b64_tr_b16 a[158:159], v2 offset:56320
v_cvt_pk_bf16_f32 v131, v82, v83
buffer_store_dwordx4 v[128:131], v8, s[16:19], s34 offen offset:3072 sc1
s_waitcnt lgkmcnt(8)
v_mfma_f32_16x16x32_bf16 v[40:43], a[136:139], v[160:163], v[40:43]
ds_read_b64_tr_b16 a[128:129], v1 offset:40960
s_add_u32 s39, s24, 45088768
v_mfma_f32_16x16x32_bf16 v[44:47], a[136:139], v[176:179], v[44:47]
ds_read_b64_tr_b16 a[130:131], v1 offset:41984
buffer_load_dwordx4 v[200:203], v244, s[16:19], s39 offen sc1
v_mfma_f32_16x16x32_bf16 v[48:51], a[140:143], v[160:163], v[48:51]
ds_read_b64_tr_b16 a[132:133], v2 offset:40960
v_cvt_pk_bf16_f32 v132, v76, v77
v_mfma_f32_16x16x32_bf16 v[52:55], a[140:143], v[176:179], v[52:55]
ds_read_b64_tr_b16 a[134:135], v2 offset:41984
s_waitcnt lgkmcnt(8)
v_mfma_f32_16x16x32_bf16 v[24:27], a[144:147], v[164:167], v[24:27]
ds_read_b64_tr_b16 a[136:137], v1 offset:57344
v_cvt_pk_bf16_f32 v133, v78, v79
v_mfma_f32_16x16x32_bf16 v[28:31], a[144:147], v[180:183], v[28:31]
ds_read_b64_tr_b16 a[138:139], v1 offset:58368
v_cvt_pk_bf16_f32 v134, v84, v85
v_cvt_pk_bf16_f32 v135, v86, v87
buffer_store_dwordx4 v[132:135], v9, s[16:19], s34 offen offset:3072 sc1
v_mfma_f32_16x16x32_bf16 v[32:35], a[148:151], v[164:167], v[32:35]
ds_read_b64_tr_b16 a[140:141], v2 offset:57344
s_add_u32 s40, s24, 47448064
v_mfma_f32_16x16x32_bf16 v[36:39], a[148:151], v[180:183], v[36:39]
ds_read_b64_tr_b16 a[142:143], v2 offset:58368
buffer_load_dwordx4 v[204:207], v244, s[16:19], s40 offen sc1
s_waitcnt lgkmcnt(8)
v_mfma_f32_16x16x32_bf16 v[40:43], a[152:155], v[164:167], v[40:43]
ds_read_b64_tr_b16 a[144:145], v1 offset:43008
v_mfma_f32_16x16x32_bf16 v[44:47], a[152:155], v[180:183], v[44:47]
ds_read_b64_tr_b16 a[146:147], v1 offset:44032
s_add_u32 s39, s24, 49807360
v_mfma_f32_16x16x32_bf16 v[48:51], a[156:159], v[164:167], v[48:51]
ds_read_b64_tr_b16 a[148:149], v2 offset:43008
buffer_load_dwordx4 v[208:211], v244, s[16:19], s39 offen sc1
v_mfma_f32_16x16x32_bf16 v[52:55], a[156:159], v[180:183], v[52:55]
ds_read_b64_tr_b16 a[150:151], v2 offset:44032
s_waitcnt lgkmcnt(8)
v_mfma_f32_16x16x32_bf16 v[24:27], a[128:131], v[184:187], v[24:27]
ds_read_b64_tr_b16 a[152:153], v1 offset:59392
v_mfma_f32_16x16x32_bf16 v[28:31], a[128:131], v[216:219], v[28:31]
ds_read_b64_tr_b16 a[154:155], v1 offset:60416
v_mfma_f32_16x16x32_bf16 v[32:35], a[132:135], v[184:187], v[32:35]
ds_read_b64_tr_b16 a[156:157], v2 offset:59392
s_add_u32 s40, s24, 52166656
v_mfma_f32_16x16x32_bf16 v[36:39], a[132:135], v[216:219], v[36:39]
ds_read_b64_tr_b16 a[158:159], v2 offset:60416
s_waitcnt lgkmcnt(8)
v_mfma_f32_16x16x32_bf16 v[40:43], a[136:139], v[184:187], v[40:43]
ds_read_b64_tr_b16 a[128:129], v1 offset:45056
buffer_load_dwordx4 v[212:215], v244, s[16:19], s40 offen sc1
v_mfma_f32_16x16x32_bf16 v[44:47], a[136:139], v[216:219], v[44:47]
ds_read_b64_tr_b16 a[130:131], v1 offset:46080
v_mfma_f32_16x16x32_bf16 v[48:51], a[140:143], v[184:187], v[48:51]
ds_read_b64_tr_b16 a[132:133], v2 offset:45056
v_mfma_f32_16x16x32_bf16 v[52:55], a[140:143], v[216:219], v[52:55]
ds_read_b64_tr_b16 a[134:135], v2 offset:46080
s_waitcnt lgkmcnt(8)
v_mfma_f32_16x16x32_bf16 v[24:27], a[144:147], v[188:191], v[24:27]
ds_read_b64_tr_b16 a[136:137], v1 offset:61440
v_mfma_f32_16x16x32_bf16 v[28:31], a[144:147], v[220:223], v[28:31]
ds_read_b64_tr_b16 a[138:139], v1 offset:62464
v_mfma_f32_16x16x32_bf16 v[32:35], a[148:151], v[188:191], v[32:35]
ds_read_b64_tr_b16 a[140:141], v2 offset:61440
v_mfma_f32_16x16x32_bf16 v[36:39], a[148:151], v[220:223], v[36:39]
ds_read_b64_tr_b16 a[142:143], v2 offset:62464
s_waitcnt lgkmcnt(8)
v_mfma_f32_16x16x32_bf16 v[40:43], a[152:155], v[188:191], v[40:43]
ds_read_b64_tr_b16 a[144:145], v1 offset:47104
v_mfma_f32_16x16x32_bf16 v[44:47], a[152:155], v[220:223], v[44:47]
ds_read_b64_tr_b16 a[146:147], v1 offset:48128
v_mfma_f32_16x16x32_bf16 v[48:51], a[156:159], v[188:191], v[48:51]
ds_read_b64_tr_b16 a[148:149], v2 offset:47104
v_mfma_f32_16x16x32_bf16 v[52:55], a[156:159], v[220:223], v[52:55]
ds_read_b64_tr_b16 a[150:151], v2 offset:48128
s_waitcnt lgkmcnt(8)
v_mfma_f32_16x16x32_bf16 v[24:27], a[128:131], v[192:195], v[24:27]
ds_read_b64_tr_b16 a[152:153], v1 offset:63488
v_mfma_f32_16x16x32_bf16 v[28:31], a[128:131], v[224:227], v[28:31]
ds_read_b64_tr_b16 a[154:155], v1 offset:64512
v_mfma_f32_16x16x32_bf16 v[32:35], a[132:135], v[192:195], v[32:35]
ds_read_b64_tr_b16 a[156:157], v2 offset:63488
v_mfma_f32_16x16x32_bf16 v[36:39], a[132:135], v[224:227], v[36:39]
ds_read_b64_tr_b16 a[158:159], v2 offset:64512
s_waitcnt lgkmcnt(8)
v_mfma_f32_16x16x32_bf16 v[40:43], a[136:139], v[192:195], v[40:43]
s_add_u32 s34, s28, 16384
v_mfma_f32_16x16x32_bf16 v[44:47], a[136:139], v[224:227], v[44:47]
v_mfma_f32_16x16x32_bf16 v[48:51], a[140:143], v[192:195], v[48:51]
v_mfma_f32_16x16x32_bf16 v[52:55], a[140:143], v[224:227], v[52:55]
s_waitcnt lgkmcnt(4)
v_mfma_f32_16x16x32_bf16 v[24:27], a[144:147], v[196:199], v[24:27]
v_mfma_f32_16x16x32_bf16 v[28:31], a[144:147], v[228:231], v[28:31]
v_mfma_f32_16x16x32_bf16 v[32:35], a[148:151], v[196:199], v[32:35]
v_mfma_f32_16x16x32_bf16 v[36:39], a[148:151], v[228:231], v[36:39]
s_waitcnt lgkmcnt(0)
v_mfma_f32_16x16x32_bf16 v[40:43], a[152:155], v[196:199], v[40:43]
v_mfma_f32_16x16x32_bf16 v[44:47], a[152:155], v[228:231], v[44:47]
s_nop 1
v_cvt_pk_bf16_f32 v120, v24, v25
v_cvt_pk_bf16_f32 v121, v26, v27
v_mfma_f32_16x16x32_bf16 v[48:51], a[156:159], v[196:199], v[48:51]
v_cvt_pk_bf16_f32 v122, v32, v33
v_cvt_pk_bf16_f32 v123, v34, v35
v_mfma_f32_16x16x32_bf16 v[52:55], a[156:159], v[228:231], v[52:55]
buffer_store_dwordx4 v[120:123], v8, s[16:19], s34 offen sc1
s_add_u32 s29, s25, 128
buffer_load_dword v252, v250, s[16:19], s29 offen sc1
v_cvt_pk_bf16_f32 v124, v28, v29
v_cvt_pk_bf16_f32 v125, v30, v31
v_cvt_pk_bf16_f32 v126, v36, v37
v_cvt_pk_bf16_f32 v127, v38, v39
buffer_store_dwordx4 v[124:127], v9, s[16:19], s34 offen sc1
v_cvt_pk_bf16_f32 v128, v40, v41
v_cvt_pk_bf16_f32 v129, v42, v43
v_cvt_pk_bf16_f32 v130, v48, v49
v_cvt_pk_bf16_f32 v131, v50, v51
buffer_store_dwordx4 v[128:131], v8, s[16:19], s34 offen offset:1024 sc1
v_cvt_pk_bf16_f32 v132, v44, v45
v_cvt_pk_bf16_f32 v133, v46, v47
v_cvt_pk_bf16_f32 v134, v52, v53
v_cvt_pk_bf16_f32 v135, v54, v55
buffer_store_dwordx4 v[132:135], v9, s[16:19], s34 offen offset:1024 sc1
s_waitcnt vmcnt(8)
s_barrier
s_add_u32 s41, s25, 256
buffer_store_dword v255, v251, s[16:19], s41 offen sc1
v_lshlrev_b32 v10, 16, v88
v_and_b32 v11, 0xffff0000, v88
v_lshlrev_b32 v12, 16, v89
v_and_b32 v13, 0xffff0000, v89
v_lshlrev_b32 v14, 16, v90
v_and_b32 v15, 0xffff0000, v90
v_lshlrev_b32 v16, 16, v91
v_and_b32 v17, 0xffff0000, v91
v_lshlrev_b32 v18, 16, v92
v_and_b32 v19, 0xffff0000, v92
v_lshlrev_b32 v20, 16, v93
v_and_b32 v21, 0xffff0000, v93
v_lshlrev_b32 v1, 16, v94
v_and_b32 v2, 0xffff0000, v94
v_lshlrev_b32 v3, 16, v95
v_and_b32 v4, 0xffff0000, v95
v_add_f32 v10, v10, v18
v_add_f32 v11, v11, v19
v_add_f32 v12, v12, v20
v_add_f32 v13, v13, v21
v_add_f32 v14, v14, v1
v_add_f32 v15, v15, v2
v_add_f32 v16, v16, v3
v_add_f32 v17, v17, v4
v_lshlrev_b32 v18, 16, v96
v_and_b32 v19, 0xffff0000, v96
v_lshlrev_b32 v20, 16, v97
v_and_b32 v21, 0xffff0000, v97
v_lshlrev_b32 v1, 16, v98
v_and_b32 v2, 0xffff0000, v98
v_lshlrev_b32 v3, 16, v99
v_and_b32 v4, 0xffff0000, v99
v_add_f32 v10, v10, v18
v_add_f32 v11, v11, v19
v_add_f32 v12, v12, v20
v_add_f32 v13, v13, v21
v_add_f32 v14, v14, v1
v_add_f32 v15, v15, v2
v_add_f32 v16, v16, v3
v_add_f32 v17, v17, v4
v_lshlrev_b32 v18, 16, v100
v_and_b32 v19, 0xffff0000, v100
v_lshlrev_b32 v20, 16, v101
v_and_b32 v21, 0xffff0000, v101
v_lshlrev_b32 v1, 16, v102
v_and_b32 v2, 0xffff0000, v102
v_lshlrev_b32 v3, 16, v103
v_and_b32 v4, 0xffff0000, v103
v_add_f32 v10, v10, v18
v_add_f32 v11, v11, v19
v_add_f32 v12, v12, v20
v_add_f32 v13, v13, v21
v_add_f32 v14, v14, v1
v_add_f32 v15, v15, v2
v_add_f32 v16, v16, v3
v_add_f32 v17, v17, v4
v_lshlrev_b32 v18, 16, v104
v_and_b32 v19, 0xffff0000, v104
v_lshlrev_b32 v20, 16, v105
v_and_b32 v21, 0xffff0000, v105
v_lshlrev_b32 v1, 16, v106
v_and_b32 v2, 0xffff0000, v106
v_lshlrev_b32 v3, 16, v107
v_and_b32 v4, 0xffff0000, v107
v_add_f32 v10, v10, v18
v_add_f32 v11, v11, v19
v_add_f32 v12, v12, v20
v_add_f32 v13, v13, v21
v_add_f32 v14, v14, v1
v_add_f32 v15, v15, v2
v_add_f32 v16, v16, v3
v_add_f32 v17, v17, v4
v_lshlrev_b32 v18, 16, v108
v_and_b32 v19, 0xffff0000, v108
v_lshlrev_b32 v20, 16, v109
v_and_b32 v21, 0xffff0000, v109
v_lshlrev_b32 v1, 16, v110
v_and_b32 v2, 0xffff0000, v110
v_lshlrev_b32 v3, 16, v111
v_and_b32 v4, 0xffff0000, v111
v_add_f32 v10, v10, v18
v_add_f32 v11, v11, v19
v_add_f32 v12, v12, v20
v_add_f32 v13, v13, v21
v_add_f32 v14, v14, v1
v_add_f32 v15, v15, v2
v_add_f32 v16, v16, v3
v_add_f32 v17, v17, v4
v_lshlrev_b32 v18, 16, v112
v_and_b32 v19, 0xffff0000, v112
v_lshlrev_b32 v20, 16, v113
v_and_b32 v21, 0xffff0000, v113
v_lshlrev_b32 v1, 16, v114
v_and_b32 v2, 0xffff0000, v114
v_lshlrev_b32 v3, 16, v115
v_and_b32 v4, 0xffff0000, v115
v_add_f32 v10, v10, v18
v_add_f32 v11, v11, v19
v_add_f32 v12, v12, v20
v_add_f32 v13, v13, v21
v_add_f32 v14, v14, v1
v_add_f32 v15, v15, v2
v_add_f32 v16, v16, v3
v_add_f32 v17, v17, v4
v_lshlrev_b32 v18, 16, v116
v_and_b32 v19, 0xffff0000, v116
v_lshlrev_b32 v20, 16, v117
v_and_b32 v21, 0xffff0000, v117
v_lshlrev_b32 v1, 16, v118
v_and_b32 v2, 0xffff0000, v118
v_lshlrev_b32 v3, 16, v119
v_and_b32 v4, 0xffff0000, v119
v_add_f32 v10, v10, v18
v_add_f32 v11, v11, v19
v_add_f32 v12, v12, v20
v_add_f32 v13, v13, v21
v_add_f32 v14, v14, v1
v_add_f32 v15, v15, v2
v_add_f32 v16, v16, v3
v_add_f32 v17, v17, v4
v_lshlrev_b32 v18, 16, v136
v_and_b32 v19, 0xffff0000, v136
v_lshlrev_b32 v20, 16, v137
v_and_b32 v21, 0xffff0000, v137
v_lshlrev_b32 v1, 16, v138
v_and_b32 v2, 0xffff0000, v138
v_lshlrev_b32 v3, 16, v139
v_and_b32 v4, 0xffff0000, v139
v_add_f32 v10, v10, v18
v_add_f32 v11, v11, v19
v_add_f32 v12, v12, v20
v_add_f32 v13, v13, v21
v_add_f32 v14, v14, v1
v_add_f32 v15, v15, v2
v_add_f32 v16, v16, v3
v_add_f32 v17, v17, v4
v_lshlrev_b32 v18, 16, v140
v_and_b32 v19, 0xffff0000, v140
v_lshlrev_b32 v20, 16, v141
v_and_b32 v21, 0xffff0000, v141
v_lshlrev_b32 v1, 16, v142
v_and_b32 v2, 0xffff0000, v142
v_lshlrev_b32 v3, 16, v143
v_and_b32 v4, 0xffff0000, v143
v_add_f32 v10, v10, v18
v_add_f32 v11, v11, v19
v_add_f32 v12, v12, v20
v_add_f32 v13, v13, v21
v_add_f32 v14, v14, v1
v_add_f32 v15, v15, v2
v_add_f32 v16, v16, v3
v_add_f32 v17, v17, v4
v_lshlrev_b32 v18, 16, v144
v_and_b32 v19, 0xffff0000, v144
v_lshlrev_b32 v20, 16, v145
v_and_b32 v21, 0xffff0000, v145
v_lshlrev_b32 v1, 16, v146
v_and_b32 v2, 0xffff0000, v146
v_lshlrev_b32 v3, 16, v147
v_and_b32 v4, 0xffff0000, v147
v_add_f32 v10, v10, v18
v_add_f32 v11, v11, v19
v_add_f32 v12, v12, v20
v_add_f32 v13, v13, v21
v_add_f32 v14, v14, v1
v_add_f32 v15, v15, v2
v_add_f32 v16, v16, v3
v_add_f32 v17, v17, v4
v_lshlrev_b32 v18, 16, v148
v_and_b32 v19, 0xffff0000, v148
v_lshlrev_b32 v20, 16, v149
v_and_b32 v21, 0xffff0000, v149
v_lshlrev_b32 v1, 16, v150
v_and_b32 v2, 0xffff0000, v150
v_lshlrev_b32 v3, 16, v151
v_and_b32 v4, 0xffff0000, v151
v_add_f32 v10, v10, v18
v_add_f32 v11, v11, v19
v_add_f32 v12, v12, v20
v_add_f32 v13, v13, v21
v_add_f32 v14, v14, v1
v_add_f32 v15, v15, v2
v_add_f32 v16, v16, v3
v_add_f32 v17, v17, v4
v_lshlrev_b32 v18, 16, v200
v_and_b32 v19, 0xffff0000, v200
v_lshlrev_b32 v20, 16, v201
v_and_b32 v21, 0xffff0000, v201
v_lshlrev_b32 v1, 16, v202
v_and_b32 v2, 0xffff0000, v202
v_lshlrev_b32 v3, 16, v203
v_and_b32 v4, 0xffff0000, v203
v_add_f32 v10, v10, v18
v_add_f32 v11, v11, v19
v_add_f32 v12, v12, v20
v_add_f32 v13, v13, v21
v_add_f32 v14, v14, v1
v_add_f32 v15, v15, v2
v_add_f32 v16, v16, v3
v_add_f32 v17, v17, v4
s_waitcnt vmcnt(8)
v_lshlrev_b32 v18, 16, v204
v_and_b32 v19, 0xffff0000, v204
v_lshlrev_b32 v20, 16, v205
v_and_b32 v21, 0xffff0000, v205
v_lshlrev_b32 v1, 16, v206
v_and_b32 v2, 0xffff0000, v206
v_lshlrev_b32 v3, 16, v207
v_and_b32 v4, 0xffff0000, v207
v_add_f32 v10, v10, v18
v_add_f32 v11, v11, v19
v_add_f32 v12, v12, v20
v_add_f32 v13, v13, v21
v_add_f32 v14, v14, v1
v_add_f32 v15, v15, v2
v_add_f32 v16, v16, v3
v_add_f32 v17, v17, v4
s_waitcnt vmcnt(7)
v_lshlrev_b32 v18, 16, v208
v_and_b32 v19, 0xffff0000, v208
v_lshlrev_b32 v20, 16, v209
v_and_b32 v21, 0xffff0000, v209
v_lshlrev_b32 v1, 16, v210
v_and_b32 v2, 0xffff0000, v210
v_lshlrev_b32 v3, 16, v211
v_and_b32 v4, 0xffff0000, v211
v_add_f32 v10, v10, v18
v_add_f32 v11, v11, v19
v_add_f32 v12, v12, v20
v_add_f32 v13, v13, v21
v_add_f32 v14, v14, v1
v_add_f32 v15, v15, v2
v_add_f32 v16, v16, v3
v_add_f32 v17, v17, v4
s_waitcnt vmcnt(6)
v_lshlrev_b32 v18, 16, v212
v_and_b32 v19, 0xffff0000, v212
v_lshlrev_b32 v20, 16, v213
v_and_b32 v21, 0xffff0000, v213
v_lshlrev_b32 v1, 16, v214
v_and_b32 v2, 0xffff0000, v214
v_lshlrev_b32 v3, 16, v215
v_and_b32 v4, 0xffff0000, v215
v_add_f32 v10, v10, v18
v_add_f32 v11, v11, v19
v_add_f32 v12, v12, v20
v_add_f32 v13, v13, v21
v_add_f32 v14, v14, v1
v_add_f32 v15, v15, v2
v_add_f32 v16, v16, v3
v_add_f32 v17, v17, v4
ds_read_b128 v[88:91], v247 offset:4608
ds_read_b128 v[92:95], v247 offset:4672
v_lshlrev_b32 v18, 16, v232
v_and_b32 v19, 0xffff0000, v232
v_lshlrev_b32 v20, 16, v233
v_and_b32 v21, 0xffff0000, v233
v_lshlrev_b32 v1, 16, v234
v_and_b32 v2, 0xffff0000, v234
v_lshlrev_b32 v3, 16, v235
v_and_b32 v4, 0xffff0000, v235
s_waitcnt lgkmcnt(1)
v_fmac_f32 v18, v10, v88
v_fmac_f32 v19, v11, v89
v_fmac_f32 v20, v12, v90
v_fmac_f32 v21, v13, v91
s_waitcnt lgkmcnt(0)
v_fmac_f32 v1, v14, v92
v_fmac_f32 v2, v15, v93
v_fmac_f32 v3, v16, v94
v_fmac_f32 v4, v17, v95
v_cvt_pk_bf16_f32 v140, v18, v19
v_cvt_pk_bf16_f32 v141, v20, v21
v_cvt_pk_bf16_f32 v142, v1, v2
v_cvt_pk_bf16_f32 v143, v3, v4
v_lshlrev_b32 v10, 16, v140
v_and_b32 v11, 0xffff0000, v140
v_lshlrev_b32 v12, 16, v141
v_and_b32 v13, 0xffff0000, v141
v_lshlrev_b32 v14, 16, v142
v_and_b32 v15, 0xffff0000, v142
v_lshlrev_b32 v16, 16, v143
v_and_b32 v17, 0xffff0000, v143
s_waitcnt vmcnt(1)
s_barrier
s_add_u32 s41, s25, 384
buffer_store_dword v255, v251, s[16:19], s41 offen sc1
v_cmp_ne_u32 vcc, 1, v252
s_nop 1
s_cbranch_vccnz K1_SPIN1
K1_GOT1:
s_add_u32 s39, s24, 16777216
buffer_load_dwordx4 v[152:155], v245, s[16:19], s39 offen sc1
s_add_u32 s40, s24, 19136512
buffer_load_dwordx4 v[156:159], v245, s[16:19], s40 offen sc1
s_add_u32 s39, s24, 21495808
buffer_load_dwordx4 v[160:163], v245, s[16:19], s39 offen sc1
s_add_u32 s40, s24, 23855104
buffer_load_dwordx4 v[164:167], v245, s[16:19], s40 offen sc1
s_add_u32 s39, s24, 26214400
buffer_load_dwordx4 v[168:171], v245, s[16:19], s39 offen sc1
s_add_u32 s40, s24, 28573696
buffer_load_dwordx4 v[172:175], v245, s[16:19], s40 offen sc1
s_add_u32 s39, s24, 30932992
buffer_load_dwordx4 v[176:179], v245, s[16:19], s39 offen sc1
s_add_u32 s40, s24, 33292288
buffer_load_dwordx4 v[180:183], v245, s[16:19], s40 offen sc1
s_add_u32 s39, s24, 35651584
buffer_load_dwordx4 v[184:187], v245, s[16:19], s39 offen sc1
s_add_u32 s40, s24, 38010880
buffer_load_dwordx4 v[188:191], v245, s[16:19], s40 offen sc1
s_add_u32 s39, s24, 40370176
buffer_load_dwordx4 v[192:195], v245, s[16:19], s39 offen sc1
s_add_u32 s40, s24, 42729472
buffer_load_dwordx4 v[196:199], v245, s[16:19], s40 offen sc1
s_add_u32 s39, s24, 45088768
buffer_load_dwordx4 v[216:219], v245, s[16:19], s39 offen sc1
s_add_u32 s40, s24, 47448064
buffer_load_dwordx4 v[220:223], v245, s[16:19], s40 offen sc1
s_add_u32 s39, s24, 49807360
buffer_load_dwordx4 v[224:227], v245, s[16:19], s39 offen sc1
s_add_u32 s40, s24, 52166656
buffer_load_dwordx4 v[228:231], v245, s[16:19], s40 offen sc1
s_waitcnt vmcnt(15)
v_lshlrev_b32 v120, 16, v152
v_and_b32 v121, 0xffff0000, v152
v_lshlrev_b32 v122, 16, v153
v_and_b32 v123, 0xffff0000, v153
v_lshlrev_b32 v124, 16, v154
v_and_b32 v125, 0xffff0000, v154
v_lshlrev_b32 v126, 16, v155
v_and_b32 v127, 0xffff0000, v155
s_waitcnt vmcnt(14)
v_lshlrev_b32 v18, 16, v156
v_and_b32 v19, 0xffff0000, v156
v_lshlrev_b32 v20, 16, v157
v_and_b32 v21, 0xffff0000, v157
v_lshlrev_b32 v1, 16, v158
v_and_b32 v2, 0xffff0000, v158
v_lshlrev_b32 v3, 16, v159
v_and_b32 v4, 0xffff0000, v159
v_add_f32 v120, v120, v18
v_add_f32 v121, v121, v19
v_add_f32 v122, v122, v20
v_add_f32 v123, v123, v21
v_add_f32 v124, v124, v1
v_add_f32 v125, v125, v2
v_add_f32 v126, v126, v3
v_add_f32 v127, v127, v4
s_waitcnt vmcnt(13)
v_lshlrev_b32 v18, 16, v160
v_and_b32 v19, 0xffff0000, v160
v_lshlrev_b32 v20, 16, v161
v_and_b32 v21, 0xffff0000, v161
v_lshlrev_b32 v1, 16, v162
v_and_b32 v2, 0xffff0000, v162
v_lshlrev_b32 v3, 16, v163
v_and_b32 v4, 0xffff0000, v163
v_add_f32 v120, v120, v18
v_add_f32 v121, v121, v19
v_add_f32 v122, v122, v20
v_add_f32 v123, v123, v21
v_add_f32 v124, v124, v1
v_add_f32 v125, v125, v2
v_add_f32 v126, v126, v3
v_add_f32 v127, v127, v4
s_waitcnt vmcnt(12)
v_lshlrev_b32 v18, 16, v164
v_and_b32 v19, 0xffff0000, v164
v_lshlrev_b32 v20, 16, v165
v_and_b32 v21, 0xffff0000, v165
v_lshlrev_b32 v1, 16, v166
v_and_b32 v2, 0xffff0000, v166
v_lshlrev_b32 v3, 16, v167
v_and_b32 v4, 0xffff0000, v167
v_add_f32 v120, v120, v18
v_add_f32 v121, v121, v19
v_add_f32 v122, v122, v20
v_add_f32 v123, v123, v21
v_add_f32 v124, v124, v1
v_add_f32 v125, v125, v2
v_add_f32 v126, v126, v3
v_add_f32 v127, v127, v4
s_waitcnt vmcnt(11)
v_lshlrev_b32 v18, 16, v168
v_and_b32 v19, 0xffff0000, v168
v_lshlrev_b32 v20, 16, v169
v_and_b32 v21, 0xffff0000, v169
v_lshlrev_b32 v1, 16, v170
v_and_b32 v2, 0xffff0000, v170
v_lshlrev_b32 v3, 16, v171
v_and_b32 v4, 0xffff0000, v171
v_add_f32 v120, v120, v18
v_add_f32 v121, v121, v19
v_add_f32 v122, v122, v20
v_add_f32 v123, v123, v21
v_add_f32 v124, v124, v1
v_add_f32 v125, v125, v2
v_add_f32 v126, v126, v3
v_add_f32 v127, v127, v4
s_waitcnt vmcnt(10)
v_lshlrev_b32 v18, 16, v172
v_and_b32 v19, 0xffff0000, v172
v_lshlrev_b32 v20, 16, v173
v_and_b32 v21, 0xffff0000, v173
v_lshlrev_b32 v1, 16, v174
v_and_b32 v2, 0xffff0000, v174
v_lshlrev_b32 v3, 16, v175
v_and_b32 v4, 0xffff0000, v175
v_add_f32 v120, v120, v18
v_add_f32 v121, v121, v19
v_add_f32 v122, v122, v20
v_add_f32 v123, v123, v21
v_add_f32 v124, v124, v1
v_add_f32 v125, v125, v2
v_add_f32 v126, v126, v3
v_add_f32 v127, v127, v4
s_waitcnt vmcnt(9)
v_lshlrev_b32 v18, 16, v176
v_and_b32 v19, 0xffff0000, v176
v_lshlrev_b32 v20, 16, v177
v_and_b32 v21, 0xffff0000, v177
v_lshlrev_b32 v1, 16, v178
v_and_b32 v2, 0xffff0000, v178
v_lshlrev_b32 v3, 16, v179
v_and_b32 v4, 0xffff0000, v179
v_add_f32 v120, v120, v18
v_add_f32 v121, v121, v19
v_add_f32 v122, v122, v20
v_add_f32 v123, v123, v21
v_add_f32 v124, v124, v1
v_add_f32 v125, v125, v2
v_add_f32 v126, v126, v3
v_add_f32 v127, v127, v4
s_waitcnt vmcnt(8)
v_lshlrev_b32 v18, 16, v180
v_and_b32 v19, 0xffff0000, v180
v_lshlrev_b32 v20, 16, v181
v_and_b32 v21, 0xffff0000, v181
v_lshlrev_b32 v1, 16, v182
v_and_b32 v2, 0xffff0000, v182
v_lshlrev_b32 v3, 16, v183
v_and_b32 v4, 0xffff0000, v183
v_add_f32 v120, v120, v18
v_add_f32 v121, v121, v19
v_add_f32 v122, v122, v20
v_add_f32 v123, v123, v21
v_add_f32 v124, v124, v1
v_add_f32 v125, v125, v2
v_add_f32 v126, v126, v3
v_add_f32 v127, v127, v4
s_waitcnt vmcnt(7)
v_lshlrev_b32 v18, 16, v184
v_and_b32 v19, 0xffff0000, v184
v_lshlrev_b32 v20, 16, v185
v_and_b32 v21, 0xffff0000, v185
v_lshlrev_b32 v1, 16, v186
v_and_b32 v2, 0xffff0000, v186
v_lshlrev_b32 v3, 16, v187
v_and_b32 v4, 0xffff0000, v187
v_add_f32 v120, v120, v18
v_add_f32 v121, v121, v19
v_add_f32 v122, v122, v20
v_add_f32 v123, v123, v21
v_add_f32 v124, v124, v1
v_add_f32 v125, v125, v2
v_add_f32 v126, v126, v3
v_add_f32 v127, v127, v4
s_waitcnt vmcnt(6)
v_lshlrev_b32 v18, 16, v188
v_and_b32 v19, 0xffff0000, v188
v_lshlrev_b32 v20, 16, v189
v_and_b32 v21, 0xffff0000, v189
v_lshlrev_b32 v1, 16, v190
v_and_b32 v2, 0xffff0000, v190
v_lshlrev_b32 v3, 16, v191
v_and_b32 v4, 0xffff0000, v191
v_add_f32 v120, v120, v18
v_add_f32 v121, v121, v19
v_add_f32 v122, v122, v20
v_add_f32 v123, v123, v21
v_add_f32 v124, v124, v1
v_add_f32 v125, v125, v2
v_add_f32 v126, v126, v3
v_add_f32 v127, v127, v4
s_waitcnt vmcnt(5)
v_lshlrev_b32 v18, 16, v192
v_and_b32 v19, 0xffff0000, v192
v_lshlrev_b32 v20, 16, v193
v_and_b32 v21, 0xffff0000, v193
v_lshlrev_b32 v1, 16, v194
v_and_b32 v2, 0xffff0000, v194
v_lshlrev_b32 v3, 16, v195
v_and_b32 v4, 0xffff0000, v195
v_add_f32 v120, v120, v18
v_add_f32 v121, v121, v19
v_add_f32 v122, v122, v20
v_add_f32 v123, v123, v21
v_add_f32 v124, v124, v1
v_add_f32 v125, v125, v2
v_add_f32 v126, v126, v3
v_add_f32 v127, v127, v4
s_waitcnt vmcnt(4)
v_lshlrev_b32 v18, 16, v196
v_and_b32 v19, 0xffff0000, v196
v_lshlrev_b32 v20, 16, v197
v_and_b32 v21, 0xffff0000, v197
v_lshlrev_b32 v1, 16, v198
v_and_b32 v2, 0xffff0000, v198
v_lshlrev_b32 v3, 16, v199
v_and_b32 v4, 0xffff0000, v199
v_add_f32 v120, v120, v18
v_add_f32 v121, v121, v19
v_add_f32 v122, v122, v20
v_add_f32 v123, v123, v21
v_add_f32 v124, v124, v1
v_add_f32 v125, v125, v2
v_add_f32 v126, v126, v3
v_add_f32 v127, v127, v4
s_waitcnt vmcnt(3)
v_lshlrev_b32 v18, 16, v216
v_and_b32 v19, 0xffff0000, v216
v_lshlrev_b32 v20, 16, v217
v_and_b32 v21, 0xffff0000, v217
v_lshlrev_b32 v1, 16, v218
v_and_b32 v2, 0xffff0000, v218
v_lshlrev_b32 v3, 16, v219
v_and_b32 v4, 0xffff0000, v219
v_add_f32 v120, v120, v18
v_add_f32 v121, v121, v19
v_add_f32 v122, v122, v20
v_add_f32 v123, v123, v21
v_add_f32 v124, v124, v1
v_add_f32 v125, v125, v2
v_add_f32 v126, v126, v3
v_add_f32 v127, v127, v4
s_waitcnt vmcnt(2)
v_lshlrev_b32 v18, 16, v220
v_and_b32 v19, 0xffff0000, v220
v_lshlrev_b32 v20, 16, v221
v_and_b32 v21, 0xffff0000, v221
v_lshlrev_b32 v1, 16, v222
v_and_b32 v2, 0xffff0000, v222
v_lshlrev_b32 v3, 16, v223
v_and_b32 v4, 0xffff0000, v223
v_add_f32 v120, v120, v18
v_add_f32 v121, v121, v19
v_add_f32 v122, v122, v20
v_add_f32 v123, v123, v21
v_add_f32 v124, v124, v1
v_add_f32 v125, v125, v2
v_add_f32 v126, v126, v3
v_add_f32 v127, v127, v4
s_waitcnt vmcnt(1)
v_lshlrev_b32 v18, 16, v224
v_and_b32 v19, 0xffff0000, v224
v_lshlrev_b32 v20, 16, v225
v_and_b32 v21, 0xffff0000, v225
v_lshlrev_b32 v1, 16, v226
v_and_b32 v2, 0xffff0000, v226
v_lshlrev_b32 v3, 16, v227
v_and_b32 v4, 0xffff0000, v227
v_add_f32 v120, v120, v18
v_add_f32 v121, v121, v19
v_add_f32 v122, v122, v20
v_add_f32 v123, v123, v21
v_add_f32 v124, v124, v1
v_add_f32 v125, v125, v2
v_add_f32 v126, v126, v3
v_add_f32 v127, v127, v4
s_waitcnt vmcnt(0)
v_lshlrev_b32 v18, 16, v228
v_and_b32 v19, 0xffff0000, v228
v_lshlrev_b32 v20, 16, v229
v_and_b32 v21, 0xffff0000, v229
v_lshlrev_b32 v1, 16, v230
v_and_b32 v2, 0xffff0000, v230
v_lshlrev_b32 v3, 16, v231
v_and_b32 v4, 0xffff0000, v231
v_add_f32 v120, v120, v18
v_add_f32 v121, v121, v19
v_add_f32 v122, v122, v20
v_add_f32 v123, v123, v21
v_add_f32 v124, v124, v1
v_add_f32 v125, v125, v2
v_add_f32 v126, v126, v3
v_add_f32 v127, v127, v4
buffer_load_dword v252, v250, s[16:19], s27 offen sc1
ds_read_b128 v[88:91], v248 offset:4608
ds_read_b128 v[92:95], v248 offset:4672
v_lshlrev_b32 v18, 16, v236
v_and_b32 v19, 0xffff0000, v236
v_lshlrev_b32 v20, 16, v237
v_and_b32 v21, 0xffff0000, v237
v_lshlrev_b32 v1, 16, v238
v_and_b32 v2, 0xffff0000, v238
v_lshlrev_b32 v3, 16, v239
v_and_b32 v4, 0xffff0000, v239
s_waitcnt lgkmcnt(1)
v_fmac_f32 v18, v120, v88
v_fmac_f32 v19, v121, v89
v_fmac_f32 v20, v122, v90
v_fmac_f32 v21, v123, v91
s_waitcnt lgkmcnt(0)
v_fmac_f32 v1, v124, v92
v_fmac_f32 v2, v125, v93
v_fmac_f32 v3, v126, v94
v_fmac_f32 v4, v127, v95
v_cvt_pk_bf16_f32 v144, v18, v19
v_cvt_pk_bf16_f32 v145, v20, v21
v_cvt_pk_bf16_f32 v146, v1, v2
v_cvt_pk_bf16_f32 v147, v3, v4
v_lshlrev_b32 v120, 16, v144
v_and_b32 v121, 0xffff0000, v144
v_lshlrev_b32 v122, 16, v145
v_and_b32 v123, 0xffff0000, v145
v_lshlrev_b32 v124, 16, v146
v_and_b32 v125, 0xffff0000, v146
v_lshlrev_b32 v126, 16, v147
v_and_b32 v127, 0xffff0000, v147
s_waitcnt vmcnt(0)
v_cmp_ne_u32 vcc, 1, v252
s_nop 1
s_cbranch_vccnz K1_SPIN2
K1_GOT2:
s_add_u32 s39, s24, 16777216
buffer_load_dwordx4 v[24:27], v246, s[16:19], s39 offen sc1
s_add_u32 s40, s24, 19136512
buffer_load_dwordx4 v[28:31], v246, s[16:19], s40 offen sc1
s_add_u32 s39, s24, 21495808
buffer_load_dwordx4 v[32:35], v246, s[16:19], s39 offen sc1
s_add_u32 s40, s24, 23855104
buffer_load_dwordx4 v[36:39], v246, s[16:19], s40 offen sc1
s_add_u32 s39, s24, 26214400
buffer_load_dwordx4 v[40:43], v246, s[16:19], s39 offen sc1
s_add_u32 s40, s24, 28573696
buffer_load_dwordx4 v[44:47], v246, s[16:19], s40 offen sc1
s_add_u32 s39, s24, 30932992
buffer_load_dwordx4 v[48:51], v246, s[16:19], s39 offen sc1
s_add_u32 s40, s24, 33292288
buffer_load_dwordx4 v[52:55], v246, s[16:19], s40 offen sc1
s_add_u32 s39, s24, 35651584
buffer_load_dwordx4 v[56:59], v246, s[16:19], s39 offen sc1
s_add_u32 s40, s24, 38010880
buffer_load_dwordx4 v[60:63], v246, s[16:19], s40 offen sc1
s_add_u32 s39, s24, 40370176
buffer_load_dwordx4 v[64:67], v246, s[16:19], s39 offen sc1
s_add_u32 s40, s24, 42729472
buffer_load_dwordx4 v[68:71], v246, s[16:19], s40 offen sc1
s_add_u32 s39, s24, 45088768
buffer_load_dwordx4 v[72:75], v246, s[16:19], s39 offen sc1
s_add_u32 s40, s24, 47448064
buffer_load_dwordx4 v[76:79], v246, s[16:19], s40 offen sc1
s_add_u32 s39, s24, 49807360
buffer_load_dwordx4 v[80:83], v246, s[16:19], s39 offen sc1
s_add_u32 s40, s24, 52166656
buffer_load_dwordx4 v[84:87], v246, s[16:19], s40 offen sc1
s_load_dwordx4 s[4:7], s[0:1], 48
s_load_dwordx2 s[46:47], s[0:1], 64
s_load_dwordx2 s[42:43], s[0:1], 88
s_mul_i32 s92, s20, 9216
s_and_b32 s94, s20, 1
s_mul_i32 s93, s94, 147456
s_mul_i32 s95, s21, 576
s_add_u32 s93, s93, s95
v_lshrrev_b32 v168, 2, v0
v_mul_u32_u24 v168, 9216, v168
v_lshrrev_b32 v169, 3, v0
v_and_b32 v169, 2, v169
v_and_b32 v164, 3, v0
v_xor_b32 v164, v164, v169
v_lshl_add_u32 v164, v164, 4, v168
v_add_u32 v167, 192, v164
v_add_u32 v166, 1152, v164
v_add_u32 v165, 2112, v164
v_add_u32 v164, 3072, v164
s_waitcnt lgkmcnt(0)
s_cmp_lt_u32 s20, 2
s_cselect_b32 s94, s4, s6
s_cselect_b32 s95, s5, s7
s_sub_u32 s88, s94, 3072
s_subb_u32 s89, s95, 0
s_mov_b32 s90, 0x510c00
s_mov_b32 s91, 0x20000
s_add_u32 s39, s24, 4784128
buffer_store_dwordx4 v[140:143], v244, s[16:19], s39 offen
buffer_store_dwordx4 v[144:147], v245, s[16:19], s39 offen
v_and_b32 v6, 7, v0
v_lshlrev_b32 v6, 4, v6
v_add_u32 v6, 161792, v6
s_lshl_b32 s40, s20, 2
v_add_u32 v5, s40, v6
v_add_f32 v253, v10, v11
v_add_f32 v254, v12, v13
v_add_f32 v253, v253, v14
v_add_f32 v254, v254, v15
v_add_f32 v253, v253, v16
v_add_f32 v254, v254, v17
v_add_f32 v253, v253, v120
v_add_f32 v254, v254, v121
v_add_f32 v253, v253, v122
v_add_f32 v254, v254, v123
v_add_f32 v253, v253, v124
v_add_f32 v254, v254, v125
v_add_f32 v253, v253, v126
v_add_f32 v254, v254, v127
v_add_f32 v253, v253, v254
s_nop 1
v_add_f32_dpp v253, v253, v253 row_ror:8 row_mask:0xf bank_mask:0xf
v_mov_b32 v254, v253
s_nop 1
v_permlane16_swap_b32 v253, v254
v_add_f32 v253, v253, v254
v_mov_b32 v254, v253
s_nop 1
v_permlane32_swap_b32 v253, v254
v_add_f32 v253, v253, v254
ds_write_b32 v5, v253
s_waitcnt lgkmcnt(0)
s_barrier
ds_read_b128 v[156:159], v6
ds_read_b128 v[96:99], v247 offset:9216
ds_read_b128 v[100:103], v247 offset:9280
ds_read_b128 v[104:107], v247 offset:6912
ds_read_b128 v[108:111], v247 offset:6976
ds_read_b128 v[112:115], v248 offset:9216
ds_read_b128 v[116:119], v248 offset:9280
ds_read_b128 v[200:203], v248 offset:6912
ds_read_b128 v[204:207], v248 offset:6976
ds_read_b128 v[208:211], v249 offset:9216
ds_read_b128 v[212:215], v249 offset:9280
ds_read_b128 v[136:139], v249 offset:6912
ds_read_b128 v[152:155], v249 offset:6976
s_waitcnt lgkmcnt(12)
v_add_f32 v253, v156, v157
v_add_f32 v254, v158, v159
v_add_f32 v253, v253, v254
v_mul_f32 v253, 0x3b2aaaab, v253
v_sub_f32 v10, v10, v253
v_sub_f32 v11, v11, v253
v_sub_f32 v12, v12, v253
v_sub_f32 v13, v13, v253
v_sub_f32 v14, v14, v253
v_sub_f32 v15, v15, v253
v_sub_f32 v16, v16, v253
v_sub_f32 v17, v17, v253
v_add_f32 v7, v10, v11
v_mul_f32 v252, v10, v10
v_fmac_f32 v252, v11, v11
v_add_f32 v7, v7, v12
v_fmac_f32 v252, v12, v12
v_add_f32 v7, v7, v13
v_fmac_f32 v252, v13, v13
v_add_f32 v7, v7, v14
v_fmac_f32 v252, v14, v14
v_add_f32 v7, v7, v15
v_fmac_f32 v252, v15, v15
v_add_f32 v7, v7, v16
v_fmac_f32 v252, v16, v16
v_add_f32 v7, v7, v17
v_fmac_f32 v252, v17, v17
v_sub_f32 v120, v120, v253
v_sub_f32 v121, v121, v253
v_sub_f32 v122, v122, v253
v_sub_f32 v123, v123, v253
v_sub_f32 v124, v124, v253
v_sub_f32 v125, v125, v253
v_sub_f32 v126, v126, v253
v_sub_f32 v127, v127, v253
v_add_f32 v18, v120, v121
v_mul_f32 v19, v120, v120
v_fmac_f32 v19, v121, v121
v_add_f32 v18, v18, v122
v_fmac_f32 v19, v122, v122
v_add_f32 v18, v18, v123
v_fmac_f32 v19, v123, v123
v_add_f32 v18, v18, v124
v_fmac_f32 v19, v124, v124
v_add_f32 v18, v18, v125
v_fmac_f32 v19, v125, v125
v_add_f32 v18, v18, v126
v_fmac_f32 v19, v126, v126
v_add_f32 v18, v18, v127
v_fmac_f32 v19, v127, v127
v_fmac_f32 v7, s36, v18
v_fmac_f32 v252, s36, v19
s_waitcnt vmcnt(17)
v_lshlrev_b32 v128, 16, v24
v_and_b32 v129, 0xffff0000, v24
v_lshlrev_b32 v130, 16, v25
v_and_b32 v131, 0xffff0000, v25
v_lshlrev_b32 v132, 16, v26
v_and_b32 v133, 0xffff0000, v26
v_lshlrev_b32 v134, 16, v27
v_and_b32 v135, 0xffff0000, v27
s_waitcnt vmcnt(16)
v_lshlrev_b32 v18, 16, v28
v_and_b32 v19, 0xffff0000, v28
v_lshlrev_b32 v20, 16, v29
v_and_b32 v21, 0xffff0000, v29
v_lshlrev_b32 v1, 16, v30
v_and_b32 v2, 0xffff0000, v30
v_lshlrev_b32 v3, 16, v31
v_and_b32 v4, 0xffff0000, v31
v_add_f32 v128, v128, v18
v_add_f32 v129, v129, v19
v_add_f32 v130, v130, v20
v_add_f32 v131, v131, v21
v_add_f32 v132, v132, v1
v_add_f32 v133, v133, v2
v_add_f32 v134, v134, v3
v_add_f32 v135, v135, v4
s_waitcnt vmcnt(15)
v_lshlrev_b32 v18, 16, v32
v_and_b32 v19, 0xffff0000, v32
v_lshlrev_b32 v20, 16, v33
v_and_b32 v21, 0xffff0000, v33
v_lshlrev_b32 v1, 16, v34
v_and_b32 v2, 0xffff0000, v34
v_lshlrev_b32 v3, 16, v35
v_and_b32 v4, 0xffff0000, v35
v_add_f32 v128, v128, v18
v_add_f32 v129, v129, v19
v_add_f32 v130, v130, v20
v_add_f32 v131, v131, v21
v_add_f32 v132, v132, v1
v_add_f32 v133, v133, v2
v_add_f32 v134, v134, v3
v_add_f32 v135, v135, v4
s_waitcnt vmcnt(14)
v_lshlrev_b32 v18, 16, v36
v_and_b32 v19, 0xffff0000, v36
v_lshlrev_b32 v20, 16, v37
v_and_b32 v21, 0xffff0000, v37
v_lshlrev_b32 v1, 16, v38
v_and_b32 v2, 0xffff0000, v38
v_lshlrev_b32 v3, 16, v39
v_and_b32 v4, 0xffff0000, v39
v_add_f32 v128, v128, v18
v_add_f32 v129, v129, v19
v_add_f32 v130, v130, v20
v_add_f32 v131, v131, v21
v_add_f32 v132, v132, v1
v_add_f32 v133, v133, v2
v_add_f32 v134, v134, v3
v_add_f32 v135, v135, v4
s_waitcnt vmcnt(13)
v_lshlrev_b32 v18, 16, v40
v_and_b32 v19, 0xffff0000, v40
v_lshlrev_b32 v20, 16, v41
v_and_b32 v21, 0xffff0000, v41
v_lshlrev_b32 v1, 16, v42
v_and_b32 v2, 0xffff0000, v42
v_lshlrev_b32 v3, 16, v43
v_and_b32 v4, 0xffff0000, v43
v_add_f32 v128, v128, v18
v_add_f32 v129, v129, v19
v_add_f32 v130, v130, v20
v_add_f32 v131, v131, v21
v_add_f32 v132, v132, v1
v_add_f32 v133, v133, v2
v_add_f32 v134, v134, v3
v_add_f32 v135, v135, v4
s_waitcnt vmcnt(12)
v_lshlrev_b32 v18, 16, v44
v_and_b32 v19, 0xffff0000, v44
v_lshlrev_b32 v20, 16, v45
v_and_b32 v21, 0xffff0000, v45
v_lshlrev_b32 v1, 16, v46
v_and_b32 v2, 0xffff0000, v46
v_lshlrev_b32 v3, 16, v47
v_and_b32 v4, 0xffff0000, v47
v_add_f32 v128, v128, v18
v_add_f32 v129, v129, v19
v_add_f32 v130, v130, v20
v_add_f32 v131, v131, v21
v_add_f32 v132, v132, v1
v_add_f32 v133, v133, v2
v_add_f32 v134, v134, v3
v_add_f32 v135, v135, v4
s_waitcnt vmcnt(11)
v_lshlrev_b32 v18, 16, v48
v_and_b32 v19, 0xffff0000, v48
v_lshlrev_b32 v20, 16, v49
v_and_b32 v21, 0xffff0000, v49
v_lshlrev_b32 v1, 16, v50
v_and_b32 v2, 0xffff0000, v50
v_lshlrev_b32 v3, 16, v51
v_and_b32 v4, 0xffff0000, v51
v_add_f32 v128, v128, v18
v_add_f32 v129, v129, v19
v_add_f32 v130, v130, v20
v_add_f32 v131, v131, v21
v_add_f32 v132, v132, v1
v_add_f32 v133, v133, v2
v_add_f32 v134, v134, v3
v_add_f32 v135, v135, v4
s_waitcnt vmcnt(10)
v_lshlrev_b32 v18, 16, v52
v_and_b32 v19, 0xffff0000, v52
v_lshlrev_b32 v20, 16, v53
v_and_b32 v21, 0xffff0000, v53
v_lshlrev_b32 v1, 16, v54
v_and_b32 v2, 0xffff0000, v54
v_lshlrev_b32 v3, 16, v55
v_and_b32 v4, 0xffff0000, v55
v_add_f32 v128, v128, v18
v_add_f32 v129, v129, v19
v_add_f32 v130, v130, v20
v_add_f32 v131, v131, v21
v_add_f32 v132, v132, v1
v_add_f32 v133, v133, v2
v_add_f32 v134, v134, v3
v_add_f32 v135, v135, v4
s_waitcnt vmcnt(9)
v_lshlrev_b32 v18, 16, v56
v_and_b32 v19, 0xffff0000, v56
v_lshlrev_b32 v20, 16, v57
v_and_b32 v21, 0xffff0000, v57
v_lshlrev_b32 v1, 16, v58
v_and_b32 v2, 0xffff0000, v58
v_lshlrev_b32 v3, 16, v59
v_and_b32 v4, 0xffff0000, v59
v_add_f32 v128, v128, v18
v_add_f32 v129, v129, v19
v_add_f32 v130, v130, v20
v_add_f32 v131, v131, v21
v_add_f32 v132, v132, v1
v_add_f32 v133, v133, v2
v_add_f32 v134, v134, v3
v_add_f32 v135, v135, v4
s_waitcnt vmcnt(8)
v_lshlrev_b32 v18, 16, v60
v_and_b32 v19, 0xffff0000, v60
v_lshlrev_b32 v20, 16, v61
v_and_b32 v21, 0xffff0000, v61
v_lshlrev_b32 v1, 16, v62
v_and_b32 v2, 0xffff0000, v62
v_lshlrev_b32 v3, 16, v63
v_and_b32 v4, 0xffff0000, v63
v_add_f32 v128, v128, v18
v_add_f32 v129, v129, v19
v_add_f32 v130, v130, v20
v_add_f32 v131, v131, v21
v_add_f32 v132, v132, v1
v_add_f32 v133, v133, v2
v_add_f32 v134, v134, v3
v_add_f32 v135, v135, v4
s_waitcnt vmcnt(7)
v_lshlrev_b32 v18, 16, v64
v_and_b32 v19, 0xffff0000, v64
v_lshlrev_b32 v20, 16, v65
v_and_b32 v21, 0xffff0000, v65
v_lshlrev_b32 v1, 16, v66
v_and_b32 v2, 0xffff0000, v66
v_lshlrev_b32 v3, 16, v67
v_and_b32 v4, 0xffff0000, v67
v_add_f32 v128, v128, v18
v_add_f32 v129, v129, v19
v_add_f32 v130, v130, v20
v_add_f32 v131, v131, v21
v_add_f32 v132, v132, v1
v_add_f32 v133, v133, v2
v_add_f32 v134, v134, v3
v_add_f32 v135, v135, v4
s_waitcnt vmcnt(6)
v_lshlrev_b32 v18, 16, v68
v_and_b32 v19, 0xffff0000, v68
v_lshlrev_b32 v20, 16, v69
v_and_b32 v21, 0xffff0000, v69
v_lshlrev_b32 v1, 16, v70
v_and_b32 v2, 0xffff0000, v70
v_lshlrev_b32 v3, 16, v71
v_and_b32 v4, 0xffff0000, v71
v_add_f32 v128, v128, v18
v_add_f32 v129, v129, v19
v_add_f32 v130, v130, v20
v_add_f32 v131, v131, v21
v_add_f32 v132, v132, v1
v_add_f32 v133, v133, v2
v_add_f32 v134, v134, v3
v_add_f32 v135, v135, v4
s_waitcnt vmcnt(5)
v_lshlrev_b32 v18, 16, v72
v_and_b32 v19, 0xffff0000, v72
v_lshlrev_b32 v20, 16, v73
v_and_b32 v21, 0xffff0000, v73
v_lshlrev_b32 v1, 16, v74
v_and_b32 v2, 0xffff0000, v74
v_lshlrev_b32 v3, 16, v75
v_and_b32 v4, 0xffff0000, v75
v_add_f32 v128, v128, v18
v_add_f32 v129, v129, v19
v_add_f32 v130, v130, v20
v_add_f32 v131, v131, v21
v_add_f32 v132, v132, v1
v_add_f32 v133, v133, v2
v_add_f32 v134, v134, v3
v_add_f32 v135, v135, v4
s_waitcnt vmcnt(4)
v_lshlrev_b32 v18, 16, v76
v_and_b32 v19, 0xffff0000, v76
v_lshlrev_b32 v20, 16, v77
v_and_b32 v21, 0xffff0000, v77
v_lshlrev_b32 v1, 16, v78
v_and_b32 v2, 0xffff0000, v78
v_lshlrev_b32 v3, 16, v79
v_and_b32 v4, 0xffff0000, v79
v_add_f32 v128, v128, v18
v_add_f32 v129, v129, v19
v_add_f32 v130, v130, v20
v_add_f32 v131, v131, v21
v_add_f32 v132, v132, v1
v_add_f32 v133, v133, v2
v_add_f32 v134, v134, v3
v_add_f32 v135, v135, v4
s_waitcnt vmcnt(3)
v_lshlrev_b32 v18, 16, v80
v_and_b32 v19, 0xffff0000, v80
v_lshlrev_b32 v20, 16, v81
v_and_b32 v21, 0xffff0000, v81
v_lshlrev_b32 v1, 16, v82
v_and_b32 v2, 0xffff0000, v82
v_lshlrev_b32 v3, 16, v83
v_and_b32 v4, 0xffff0000, v83
v_add_f32 v128, v128, v18
v_add_f32 v129, v129, v19
v_add_f32 v130, v130, v20
v_add_f32 v131, v131, v21
v_add_f32 v132, v132, v1
v_add_f32 v133, v133, v2
v_add_f32 v134, v134, v3
v_add_f32 v135, v135, v4
s_waitcnt vmcnt(2)
v_lshlrev_b32 v18, 16, v84
v_and_b32 v19, 0xffff0000, v84
v_lshlrev_b32 v20, 16, v85
v_and_b32 v21, 0xffff0000, v85
v_lshlrev_b32 v1, 16, v86
v_and_b32 v2, 0xffff0000, v86
v_lshlrev_b32 v3, 16, v87
v_and_b32 v4, 0xffff0000, v87
v_add_f32 v128, v128, v18
v_add_f32 v129, v129, v19
v_add_f32 v130, v130, v20
v_add_f32 v131, v131, v21
v_add_f32 v132, v132, v1
v_add_f32 v133, v133, v2
v_add_f32 v134, v134, v3
v_add_f32 v135, v135, v4
ds_read_b128 v[88:91], v249 offset:4608
ds_read_b128 v[92:95], v249 offset:4672
v_lshlrev_b32 v18, 16, v240
v_and_b32 v19, 0xffff0000, v240
v_lshlrev_b32 v20, 16, v241
v_and_b32 v21, 0xffff0000, v241
v_lshlrev_b32 v1, 16, v242
v_and_b32 v2, 0xffff0000, v242
v_lshlrev_b32 v3, 16, v243
v_and_b32 v4, 0xffff0000, v243
s_waitcnt lgkmcnt(1)
v_fmac_f32 v18, v128, v88
v_fmac_f32 v19, v129, v89
v_fmac_f32 v20, v130, v90
v_fmac_f32 v21, v131, v91
s_waitcnt lgkmcnt(0)
v_fmac_f32 v1, v132, v92
v_fmac_f32 v2, v133, v93
v_fmac_f32 v3, v134, v94
v_fmac_f32 v4, v135, v95
v_cvt_pk_bf16_f32 v148, v18, v19
v_cvt_pk_bf16_f32 v149, v20, v21
v_cvt_pk_bf16_f32 v150, v1, v2
v_cvt_pk_bf16_f32 v151, v3, v4
v_lshlrev_b32 v128, 16, v148
v_and_b32 v129, 0xffff0000, v148
v_lshlrev_b32 v130, 16, v149
v_and_b32 v131, 0xffff0000, v149
v_lshlrev_b32 v132, 16, v150
v_and_b32 v133, 0xffff0000, v150
v_lshlrev_b32 v134, 16, v151
v_and_b32 v135, 0xffff0000, v151
buffer_store_dwordx4 v[148:151], v246, s[16:19], s39 offen
v_sub_f32 v128, v128, v253
v_sub_f32 v129, v129, v253
v_sub_f32 v130, v130, v253
v_sub_f32 v131, v131, v253
v_sub_f32 v132, v132, v253
v_sub_f32 v133, v133, v253
v_sub_f32 v134, v134, v253
v_sub_f32 v135, v135, v253
v_add_f32 v18, v128, v129
v_mul_f32 v19, v128, v128
v_fmac_f32 v19, v129, v129
v_add_f32 v18, v18, v130
v_fmac_f32 v19, v130, v130
v_add_f32 v18, v18, v131
v_fmac_f32 v19, v131, v131
v_add_f32 v18, v18, v132
v_fmac_f32 v19, v132, v132
v_add_f32 v18, v18, v133
v_fmac_f32 v19, v133, v133
v_add_f32 v18, v18, v134
v_fmac_f32 v19, v134, v134
v_add_f32 v18, v18, v135
v_fmac_f32 v19, v135, v135
v_fmac_f32 v7, s37, v18
v_fmac_f32 v252, s37, v19
s_nop 0
v_add_f32_dpp v7, v7, v7 row_ror:8 row_mask:0xf bank_mask:0xf
v_add_f32_dpp v252, v252, v252 row_ror:8 row_mask:0xf bank_mask:0xf
v_mov_b32 v254, v7
v_mov_b32 v18, v252
s_nop 0
v_permlane16_swap_b32 v7, v254
v_permlane16_swap_b32 v252, v18
v_add_f32 v7, v7, v254
v_add_f32 v252, v252, v18
v_mov_b32 v254, v7
v_mov_b32 v18, v252
s_nop 0
v_permlane32_swap_b32 v7, v254
v_permlane32_swap_b32 v252, v18
v_add_f32 v7, v7, v254
v_add_f32 v252, v252, v18
ds_write_b32 v5, v7 offset:256
ds_write_b32 v5, v252 offset:512
s_waitcnt lgkmcnt(0)
s_barrier
ds_read_b128 v[156:159], v6 offset:256
ds_read_b128 v[160:163], v6 offset:512
s_mov_b32 s40, 0x3ae38e39
s_waitcnt lgkmcnt(1)
v_add_f32 v7, v156, v157
v_add_f32 v254, v158, v159
s_waitcnt lgkmcnt(0)
v_add_f32 v252, v160, v161
v_add_f32 v18, v162, v163
v_add_f32 v7, v7, v254
v_add_f32 v252, v252, v18
v_mul_f32 v7, s40, v7
v_mul_f32 v252, s40, v252
v_fma_f32 v252, -v7, v7, v252
v_max_f32 v252, 0, v252
v_add_f32 v7, v7, v253
v_cvt_pk_bf16_f32 v7, v7, v7
v_and_b32 v7, 0xffff0000, v7
v_cvt_pk_bf16_f32 v252, v252, v252
v_and_b32 v252, 0xffff0000, v252
v_sub_f32 v7, v253, v7
v_add_f32 v252, 0x3727c5ac, v252
v_cvt_pk_bf16_f32 v252, v252, v252
v_and_b32 v252, 0xffff0000, v252
v_sqrt_f32 v252, v252
s_nop 0
v_cvt_pk_bf16_f32 v252, v252, v252
v_and_b32 v252, 0xffff0000, v252
v_rcp_f32 v252, v252
s_add_u32 s39, s24, 7143424
v_mul_f32 v7, v7, v252
v_fma_f32 v10, v10, v252, v7
v_fma_f32 v11, v11, v252, v7
v_fma_f32 v12, v12, v252, v7
v_fma_f32 v13, v13, v252, v7
v_fma_f32 v14, v14, v252, v7
v_fma_f32 v15, v15, v252, v7
v_fma_f32 v16, v16, v252, v7
v_fma_f32 v17, v17, v252, v7
v_fma_f32 v10, v10, v96, v104
v_fma_f32 v11, v11, v97, v105
v_fma_f32 v12, v12, v98, v106
v_fma_f32 v13, v13, v99, v107
v_fma_f32 v14, v14, v100, v108
v_fma_f32 v15, v15, v101, v109
v_fma_f32 v16, v16, v102, v110
v_fma_f32 v17, v17, v103, v111
v_cvt_pk_bf16_f32 v140, v10, v11
v_cvt_pk_bf16_f32 v141, v12, v13
v_cvt_pk_bf16_f32 v142, v14, v15
v_cvt_pk_bf16_f32 v143, v16, v17
buffer_store_dwordx4 v[140:143], v244, s[16:19], s39 offen sc1
v_fma_f32 v120, v120, v252, v7
v_fma_f32 v121, v121, v252, v7
v_fma_f32 v122, v122, v252, v7
v_fma_f32 v123, v123, v252, v7
v_fma_f32 v124, v124, v252, v7
v_fma_f32 v125, v125, v252, v7
v_fma_f32 v126, v126, v252, v7
v_fma_f32 v127, v127, v252, v7
v_fma_f32 v120, v120, v112, v200
v_fma_f32 v121, v121, v113, v201
v_fma_f32 v122, v122, v114, v202
v_fma_f32 v123, v123, v115, v203
v_fma_f32 v124, v124, v116, v204
v_fma_f32 v125, v125, v117, v205
v_fma_f32 v126, v126, v118, v206
v_fma_f32 v127, v127, v119, v207
v_cvt_pk_bf16_f32 v144, v120, v121
v_cvt_pk_bf16_f32 v145, v122, v123
v_cvt_pk_bf16_f32 v146, v124, v125
v_cvt_pk_bf16_f32 v147, v126, v127
buffer_store_dwordx4 v[144:147], v245, s[16:19], s39 offen sc1
v_fma_f32 v128, v128, v252, v7
v_fma_f32 v129, v129, v252, v7
v_fma_f32 v130, v130, v252, v7
v_fma_f32 v131, v131, v252, v7
v_fma_f32 v132, v132, v252, v7
v_fma_f32 v133, v133, v252, v7
v_fma_f32 v134, v134, v252, v7
v_fma_f32 v135, v135, v252, v7
v_fma_f32 v128, v128, v208, v136
v_fma_f32 v129, v129, v209, v137
v_fma_f32 v130, v130, v210, v138
v_fma_f32 v131, v131, v211, v139
v_fma_f32 v132, v132, v212, v152
v_fma_f32 v133, v133, v213, v153
v_fma_f32 v134, v134, v214, v154
v_fma_f32 v135, v135, v215, v155
v_cvt_pk_bf16_f32 v148, v128, v129
v_cvt_pk_bf16_f32 v149, v130, v131
v_cvt_pk_bf16_f32 v150, v132, v133
v_cvt_pk_bf16_f32 v151, v134, v135
buffer_store_dwordx4 v[148:151], v246, s[16:19], s39 offen sc1
s_waitcnt vmcnt(0)
s_barrier
s_add_u32 s41, s25, 512
buffer_store_dword v255, v251, s[16:19], s41 offen sc1
s_add_u32 m0, s92, 0
s_add_u32 s94, s93, 0
buffer_load_dwordx4 v164, s[88:91], s94 offen lds
buffer_load_dwordx4 v165, s[88:91], s94 offen offset:1024 lds
buffer_load_dwordx4 v166, s[88:91], s94 offen offset:2048 lds
buffer_load_dwordx4 v167, s[88:91], s94 offen offset:3072 lds
s_add_u32 m0, s92, 4096
s_add_u32 s95, s93, 256
buffer_load_dwordx4 v164, s[88:91], s95 offen lds
buffer_load_dwordx4 v165, s[88:91], s95 offen offset:1024 lds
buffer_load_dwordx4 v166, s[88:91], s95 offen offset:2048 lds
buffer_load_dwordx4 v167, s[88:91], s95 offen offset:3072 lds
s_add_u32 m0, s92, 8192
s_add_u32 s96, s93, 512
buffer_load_dwordx4 v164, s[88:91], s96 offen lds
s_add_u32 m0, s92, 36864
s_add_u32 s94, s93, 294912
buffer_load_dwordx4 v164, s[88:91], s94 offen lds
buffer_load_dwordx4 v165, s[88:91], s94 offen offset:1024 lds
buffer_load_dwordx4 v166, s[88:91], s94 offen offset:2048 lds
buffer_load_dwordx4 v167, s[88:91], s94 offen offset:3072 lds
s_add_u32 m0, s92, 40960
s_add_u32 s95, s93, 295168
buffer_load_dwordx4 v164, s[88:91], s95 offen lds
buffer_load_dwordx4 v165, s[88:91], s95 offen offset:1024 lds
buffer_load_dwordx4 v166, s[88:91], s95 offen offset:2048 lds
buffer_load_dwordx4 v167, s[88:91], s95 offen offset:3072 lds
s_add_u32 m0, s92, 45056
s_add_u32 s96, s93, 295424
buffer_load_dwordx4 v164, s[88:91], s96 offen lds
v_mov_b32 v8, v164
v_mov_b32 v9, v165
v_mov_b32 v10, v166
v_mov_b32 v11, v167
s_lshl_b32 s31, s22, 3
s_lshl_b32 s33, s20, 1
s_add_u32 s31, s31, s33
s_mul_i32 s31, s31, 18432
s_add_u32 s26, s31, 7143424
s_mul_i32 s28, s21, 2359296
s_add_u32 s28, s28, s31
s_add_u32 s28, s28, 16777216
v_lshlrev_b32 v7, 4, v0
v_add_u32 v16, 18432, v7
s_and_b32 s30, s20, 1
s_mul_i32 s23, s21, 331776
s_mul_i32 s31, s30, 165888
s_add_u32 s23, s23, s31
s_lshr_b32 s32, s20, 1
s_lshl_b32 s31, s32, 6
s_add_u32 s23, s23, s31
s_mov_b32 s8, s46
s_mov_b32 s9, s47
s_mov_b32 s10, 0x510000
s_mov_b32 s11, 0x20000
s_mov_b32 s12, s42
s_mov_b32 s13, s43
s_mov_b32 s14, 0x240000
s_mov_b32 s15, 0x20000
v_lshrrev_b32 v17, 2, v0
v_mul_u32_u24 v17, 1152, v17
v_lshrrev_b32 v18, 3, v0
v_and_b32 v18, 2, v18
v_and_b32 v12, 3, v0
v_xor_b32 v12, v12, v18
v_lshl_add_u32 v12, v12, 4, v17
v_add_u32 v13, 17408, v12
v_add_u32 v14, 34816, v12
v_add_u32 v15, 52224, v12
v_lshrrev_b32 v17, 2, v0
v_lshlrev_b32 v17, 6, v17
v_and_b32 v18, 3, v0
v_lshl_add_u32 v17, v18, 3, v17
v_lshlrev_b32 v18, 1, v0
v_and_b32 v18, 32, v18
v_add_u32 v1, v17, v18
v_xor_b32 v2, 32, v1
v_add_u32 v3, 65536, v1
v_add_u32 v4, 65536, v2
v_add_u32 v5, 131072, v1
v_add_u32 v6, 131072, v2
buffer_load_dword v252, v250, s[16:19], s41 offen sc1
s_waitcnt vmcnt(0)
v_cmp_ne_u32 vcc, 1, v252
s_nop 1
s_cbranch_vccnz K1_SPIN4
K1_GOT4:
s_add_u32 s33, s26, 0
buffer_load_dwordx4 a[176:179], v7, s[16:19], s33 offen sc1
buffer_load_dwordx4 a[180:183], v16, s[16:19], s33 offen sc1
s_add_u32 s33, s26, 0
buffer_load_dwordx4 a[184:187], v7, s[16:19], s33 offen offset:1024 sc1
buffer_load_dwordx4 a[188:191], v16, s[16:19], s33 offen offset:1024 sc1
s_add_u32 s33, s26, 0
buffer_load_dwordx4 a[192:195], v7, s[16:19], s33 offen offset:2048 sc1
buffer_load_dwordx4 a[196:199], v16, s[16:19], s33 offen offset:2048 sc1
s_barrier
ds_read_b64_tr_b16 a[144:145], v1
ds_read_b64_tr_b16 a[146:147], v1 offset:9216
ds_read_b64_tr_b16 a[148:149], v1 offset:18432
ds_read_b64_tr_b16 a[150:151], v1 offset:27648
ds_read_b64_tr_b16 a[152:153], v2
ds_read_b64_tr_b16 a[154:155], v2 offset:9216
ds_read_b64_tr_b16 a[156:157], v2 offset:18432
ds_read_b64_tr_b16 a[158:159], v2 offset:27648
ds_read_b64_tr_b16 a[160:161], v1 offset:1024
ds_read_b64_tr_b16 a[162:163], v1 offset:10240
ds_read_b64_tr_b16 a[164:165], v1 offset:19456
s_waitcnt vmcnt(5) lgkmcnt(7)
v_mfma_f32_16x16x32_bf16 v[24:27], a[144:147], a[176:179], 0
ds_read_b64_tr_b16 a[166:167], v1 offset:28672
s_add_u32 m0, s92, 73728
s_waitcnt vmcnt(4)
v_mfma_f32_16x16x32_bf16 v[28:31], a[144:147], a[180:183], 0
ds_read_b64_tr_b16 a[168:169], v2 offset:1024
s_add_u32 s30, s93, 589824
v_mfma_f32_16x16x32_bf16 a[0:3], a[148:151], a[176:179], 0
buffer_load_dwordx4 v8, s[88:91], s30 offen lds
ds_read_b64_tr_b16 a[170:171], v2 offset:10240
v_mfma_f32_16x16x32_bf16 a[4:7], a[148:151], a[180:183], 0
ds_read_b64_tr_b16 a[172:173], v2 offset:19456
s_waitcnt lgkmcnt(7)
v_mfma_f32_16x16x32_bf16 v[32:35], a[152:155], a[176:179], 0
ds_read_b64_tr_b16 a[174:175], v2 offset:28672
buffer_load_dwordx4 v9, s[88:91], s30 offen offset:1024 lds
v_mfma_f32_16x16x32_bf16 v[36:39], a[152:155], a[180:183], 0
ds_read_b64_tr_b16 a[144:145], v1 offset:2048
buffer_load_dwordx4 v10, s[88:91], s30 offen offset:2048 lds
v_mfma_f32_16x16x32_bf16 a[8:11], a[156:159], a[176:179], 0
ds_read_b64_tr_b16 a[146:147], v1 offset:11264
v_mfma_f32_16x16x32_bf16 a[12:15], a[156:159], a[180:183], 0
ds_read_b64_tr_b16 a[148:149], v1 offset:20480
s_waitcnt lgkmcnt(7)
v_mfma_f32_16x16x32_bf16 v[40:43], a[160:163], a[176:179], 0
ds_read_b64_tr_b16 a[150:151], v1 offset:29696
v_mfma_f32_16x16x32_bf16 v[44:47], a[160:163], a[180:183], 0
ds_read_b64_tr_b16 a[152:153], v2 offset:2048
buffer_load_dwordx4 v11, s[88:91], s30 offen offset:3072 lds
v_mfma_f32_16x16x32_bf16 a[16:19], a[164:167], a[176:179], 0
ds_read_b64_tr_b16 a[154:155], v2 offset:11264
v_mfma_f32_16x16x32_bf16 a[20:23], a[164:167], a[180:183], 0
ds_read_b64_tr_b16 a[156:157], v2 offset:20480
s_waitcnt lgkmcnt(7)
v_mfma_f32_16x16x32_bf16 v[48:51], a[168:171], a[176:179], 0
ds_read_b64_tr_b16 a[158:159], v2 offset:29696
s_add_u32 m0, s92, 77824
v_mfma_f32_16x16x32_bf16 v[52:55], a[168:171], a[180:183], 0
ds_read_b64_tr_b16 a[160:161], v1 offset:3072
s_add_u32 s31, s93, 590080
v_mfma_f32_16x16x32_bf16 a[24:27], a[172:175], a[176:179], 0
ds_read_b64_tr_b16 a[162:163], v1 offset:12288
buffer_load_dwordx4 v8, s[88:91], s31 offen lds
v_mfma_f32_16x16x32_bf16 a[28:31], a[172:175], a[180:183], 0
ds_read_b64_tr_b16 a[164:165], v1 offset:21504
s_waitcnt lgkmcnt(7)
v_mfma_f32_16x16x32_bf16 v[56:59], a[144:147], a[176:179], 0
ds_read_b64_tr_b16 a[166:167], v1 offset:30720
buffer_load_dwordx4 v9, s[88:91], s31 offen offset:1024 lds
v_mfma_f32_16x16x32_bf16 v[60:63], a[144:147], a[180:183], 0
ds_read_b64_tr_b16 a[168:169], v2 offset:3072
v_mfma_f32_16x16x32_bf16 a[32:35], a[148:151], a[176:179], 0
ds_read_b64_tr_b16 a[170:171], v2 offset:12288
v_mfma_f32_16x16x32_bf16 a[36:39], a[148:151], a[180:183], 0
ds_read_b64_tr_b16 a[172:173], v2 offset:21504
s_waitcnt lgkmcnt(7)
v_mfma_f32_16x16x32_bf16 v[64:67], a[152:155], a[176:179], 0
ds_read_b64_tr_b16 a[174:175], v2 offset:30720
buffer_load_dwordx4 v10, s[88:91], s31 offen offset:2048 lds
v_mfma_f32_16x16x32_bf16 v[68:71], a[152:155], a[180:183], 0
ds_read_b64_tr_b16 a[144:145], v1 offset:4096
v_mfma_f32_16x16x32_bf16 a[40:43], a[156:159], a[176:179], 0
ds_read_b64_tr_b16 a[146:147], v1 offset:13312
buffer_load_dwordx4 v11, s[88:91], s31 offen offset:3072 lds
v_mfma_f32_16x16x32_bf16 a[44:47], a[156:159], a[180:183], 0
ds_read_b64_tr_b16 a[148:149], v1 offset:22528
s_waitcnt lgkmcnt(7)
v_mfma_f32_16x16x32_bf16 v[72:75], a[160:163], a[176:179], 0
ds_read_b64_tr_b16 a[150:151], v1 offset:31744
v_mfma_f32_16x16x32_bf16 v[76:79], a[160:163], a[180:183], 0
ds_read_b64_tr_b16 a[152:153], v2 offset:4096
s_add_u32 m0, s92, 81920
v_mfma_f32_16x16x32_bf16 a[48:51], a[164:167], a[176:179], 0
ds_read_b64_tr_b16 a[154:155], v2 offset:13312
s_add_u32 s32, s93, 590336
v_mfma_f32_16x16x32_bf16 a[52:55], a[164:167], a[180:183], 0
ds_read_b64_tr_b16 a[156:157], v2 offset:22528
s_waitcnt lgkmcnt(7)
v_mfma_f32_16x16x32_bf16 v[80:83], a[168:171], a[176:179], 0
buffer_load_dwordx4 v8, s[88:91], s32 offen lds
ds_read_b64_tr_b16 a[158:159], v2 offset:31744
v_mfma_f32_16x16x32_bf16 v[84:87], a[168:171], a[180:183], 0
ds_read_b64_tr_b16 a[160:161], v1 offset:5120
v_mfma_f32_16x16x32_bf16 a[56:59], a[172:175], a[176:179], 0
ds_read_b64_tr_b16 a[162:163], v1 offset:14336
v_mfma_f32_16x16x32_bf16 a[60:63], a[172:175], a[180:183], 0
ds_read_b64_tr_b16 a[164:165], v1 offset:23552
s_waitcnt lgkmcnt(7)
v_mfma_f32_16x16x32_bf16 v[88:91], a[144:147], a[176:179], 0
ds_read_b64_tr_b16 a[166:167], v1 offset:32768
v_mfma_f32_16x16x32_bf16 v[92:95], a[144:147], a[180:183], 0
ds_read_b64_tr_b16 a[168:169], v2 offset:5120
v_mfma_f32_16x16x32_bf16 a[64:67], a[148:151], a[176:179], 0
ds_read_b64_tr_b16 a[170:171], v2 offset:14336
v_mfma_f32_16x16x32_bf16 a[68:71], a[148:151], a[180:183], 0
ds_read_b64_tr_b16 a[172:173], v2 offset:23552
s_waitcnt lgkmcnt(7)
v_mfma_f32_16x16x32_bf16 v[96:99], a[152:155], a[176:179], 0
ds_read_b64_tr_b16 a[174:175], v2 offset:32768
s_add_u32 m0, s92, 110592
v_mfma_f32_16x16x32_bf16 v[100:103], a[152:155], a[180:183], 0
ds_read_b64_tr_b16 a[144:145], v1 offset:6144
s_add_u32 s30, s93, 884736
v_mfma_f32_16x16x32_bf16 a[72:75], a[156:159], a[176:179], 0
buffer_load_dwordx4 v8, s[88:91], s30 offen lds
ds_read_b64_tr_b16 a[146:147], v1 offset:15360
v_mfma_f32_16x16x32_bf16 a[76:79], a[156:159], a[180:183], 0
ds_read_b64_tr_b16 a[148:149], v1 offset:24576
s_waitcnt lgkmcnt(7)
v_mfma_f32_16x16x32_bf16 v[104:107], a[160:163], a[176:179], 0
ds_read_b64_tr_b16 a[150:151], v1 offset:33792
s_add_u32 s33, s26, 0
v_mfma_f32_16x16x32_bf16 v[108:111], a[160:163], a[180:183], 0
ds_read_b64_tr_b16 a[152:153], v2 offset:6144
buffer_load_dwordx4 a[200:203], v7, s[16:19], s33 offen offset:3072 sc1
v_mfma_f32_16x16x32_bf16 a[80:83], a[164:167], a[176:179], 0
ds_read_b64_tr_b16 a[154:155], v2 offset:15360
buffer_load_dwordx4 v9, s[88:91], s30 offen offset:1024 lds
v_mfma_f32_16x16x32_bf16 a[84:87], a[164:167], a[180:183], 0
ds_read_b64_tr_b16 a[156:157], v2 offset:24576
s_waitcnt lgkmcnt(7)
v_mfma_f32_16x16x32_bf16 v[112:115], a[168:171], a[176:179], 0
ds_read_b64_tr_b16 a[158:159], v2 offset:33792
buffer_load_dwordx4 a[204:207], v16, s[16:19], s33 offen offset:3072 sc1
v_mfma_f32_16x16x32_bf16 v[116:119], a[168:171], a[180:183], 0
ds_read_b64_tr_b16 a[160:161], v1 offset:7168
v_mfma_f32_16x16x32_bf16 a[88:91], a[172:175], a[176:179], 0
ds_read_b64_tr_b16 a[162:163], v1 offset:16384
v_mfma_f32_16x16x32_bf16 a[92:95], a[172:175], a[180:183], 0
ds_read_b64_tr_b16 a[164:165], v1 offset:25600
s_waitcnt lgkmcnt(7)
v_mfma_f32_16x16x32_bf16 v[120:123], a[144:147], a[176:179], 0
ds_read_b64_tr_b16 a[166:167], v1 offset:34816
v_mfma_f32_16x16x32_bf16 v[124:127], a[144:147], a[180:183], 0
ds_read_b64_tr_b16 a[168:169], v2 offset:7168
buffer_load_dwordx4 v10, s[88:91], s30 offen offset:2048 lds
v_mfma_f32_16x16x32_bf16 a[96:99], a[148:151], a[176:179], 0
ds_read_b64_tr_b16 a[170:171], v2 offset:16384
v_mfma_f32_16x16x32_bf16 a[100:103], a[148:151], a[180:183], 0
ds_read_b64_tr_b16 a[172:173], v2 offset:25600
s_waitcnt lgkmcnt(7)
v_mfma_f32_16x16x32_bf16 v[128:131], a[152:155], a[176:179], 0
ds_read_b64_tr_b16 a[174:175], v2 offset:34816
v_mfma_f32_16x16x32_bf16 v[132:135], a[152:155], a[180:183], 0
ds_read_b64_tr_b16 a[144:145], v1 offset:8192
v_mfma_f32_16x16x32_bf16 a[104:107], a[156:159], a[176:179], 0
ds_read_b64_tr_b16 a[146:147], v1 offset:17408
v_mfma_f32_16x16x32_bf16 a[108:111], a[156:159], a[180:183], 0
ds_read_b64_tr_b16 a[148:149], v1 offset:26624
s_waitcnt lgkmcnt(7)
v_mfma_f32_16x16x32_bf16 v[136:139], a[160:163], a[176:179], 0
ds_read_b64_tr_b16 a[150:151], v1 offset:35840
buffer_load_dwordx4 v11, s[88:91], s30 offen offset:3072 lds
v_mfma_f32_16x16x32_bf16 v[140:143], a[160:163], a[180:183], 0
ds_read_b64_tr_b16 a[152:153], v2 offset:8192
v_mfma_f32_16x16x32_bf16 a[112:115], a[164:167], a[176:179], 0
ds_read_b64_tr_b16 a[154:155], v2 offset:17408
v_mfma_f32_16x16x32_bf16 a[116:119], a[164:167], a[180:183], 0
ds_read_b64_tr_b16 a[156:157], v2 offset:26624
s_waitcnt lgkmcnt(7)
v_mfma_f32_16x16x32_bf16 v[144:147], a[168:171], a[176:179], 0
ds_read_b64_tr_b16 a[158:159], v2 offset:35840
v_mfma_f32_16x16x32_bf16 v[148:151], a[168:171], a[180:183], 0
s_barrier
ds_read_b64_tr_b16 a[160:161], v1 offset:36864
v_mfma_f32_16x16x32_bf16 a[120:123], a[172:175], a[176:179], 0
ds_read_b64_tr_b16 a[162:163], v1 offset:46080
v_mfma_f32_16x16x32_bf16 a[124:127], a[172:175], a[180:183], 0
ds_read_b64_tr_b16 a[164:165], v1 offset:55296
s_waitcnt lgkmcnt(7)
v_mfma_f32_16x16x32_bf16 v[152:155], a[144:147], a[176:179], 0
ds_read_b64_tr_b16 a[166:167], v1 offset:64512
s_add_u32 m0, s92, 114688
v_mfma_f32_16x16x32_bf16 v[156:159], a[144:147], a[180:183], 0
ds_read_b64_tr_b16 a[168:169], v2 offset:36864
s_add_u32 s31, s93, 884992
v_mfma_f32_16x16x32_bf16 a[128:131], a[148:151], a[176:179], 0
buffer_load_dwordx4 v8, s[88:91], s31 offen lds
ds_read_b64_tr_b16 a[170:171], v2 offset:46080
v_mfma_f32_16x16x32_bf16 a[132:135], a[148:151], a[180:183], 0
ds_read_b64_tr_b16 a[172:173], v2 offset:55296
s_waitcnt lgkmcnt(7)
v_mfma_f32_16x16x32_bf16 v[160:163], a[152:155], a[176:179], 0
ds_read_b64_tr_b16 a[174:175], v2 offset:64512
v_mfma_f32_16x16x32_bf16 v[164:167], a[152:155], a[180:183], 0
ds_read_b64_tr_b16 a[144:145], v1 offset:37888
v_mfma_f32_16x16x32_bf16 a[136:139], a[156:159], a[176:179], 0
ds_read_b64_tr_b16 a[146:147], v1 offset:47104
buffer_load_dwordx4 v9, s[88:91], s31 offen offset:1024 lds
v_mfma_f32_16x16x32_bf16 a[140:143], a[156:159], a[180:183], 0
ds_read_b64_tr_b16 a[148:149], v1 offset:56320
s_waitcnt vmcnt(20) lgkmcnt(7)
v_mfma_f32_16x16x32_bf16 v[24:27], a[160:163], a[184:187], v[24:27]
ds_read_b64_tr_b16 a[150:151], v3
s_waitcnt vmcnt(19)
v_mfma_f32_16x16x32_bf16 v[28:31], a[160:163], a[188:191], v[28:31]
ds_read_b64_tr_b16 a[152:153], v2 offset:37888
v_mfma_f32_16x16x32_bf16 a[0:3], a[164:167], a[184:187], a[0:3]
ds_read_b64_tr_b16 a[154:155], v2 offset:47104
v_mfma_f32_16x16x32_bf16 a[4:7], a[164:167], a[188:191], a[4:7]
ds_read_b64_tr_b16 a[156:157], v2 offset:56320
s_waitcnt lgkmcnt(7)
v_mfma_f32_16x16x32_bf16 v[32:35], a[168:171], a[184:187], v[32:35]
ds_read_b64_tr_b16 a[158:159], v4
buffer_load_dword a208, v7, s[84:87], s101 offen
v_mfma_f32_16x16x32_bf16 v[36:39], a[168:171], a[188:191], v[36:39]
ds_read_b64_tr_b16 a[160:161], v1 offset:38912
buffer_load_dwordx4 v10, s[88:91], s31 offen offset:2048 lds
v_mfma_f32_16x16x32_bf16 a[8:11], a[172:175], a[184:187], a[8:11]
ds_read_b64_tr_b16 a[162:163], v1 offset:48128
v_mfma_f32_16x16x32_bf16 a[12:15], a[172:175], a[188:191], a[12:15]
ds_read_b64_tr_b16 a[164:165], v1 offset:57344
s_waitcnt lgkmcnt(7)
v_mfma_f32_16x16x32_bf16 v[40:43], a[144:147], a[184:187], v[40:43]
ds_read_b64_tr_b16 a[166:167], v3 offset:1024
v_mfma_f32_16x16x32_bf16 v[44:47], a[144:147], a[188:191], v[44:47]
ds_read_b64_tr_b16 a[168:169], v2 offset:38912
v_mfma_f32_16x16x32_bf16 a[16:19], a[148:151], a[184:187], a[16:19]
ds_read_b64_tr_b16 a[170:171], v2 offset:48128
v_mfma_f32_16x16x32_bf16 a[20:23], a[148:151], a[188:191], a[20:23]
ds_read_b64_tr_b16 a[172:173], v2 offset:57344
s_waitcnt lgkmcnt(7)
v_mfma_f32_16x16x32_bf16 v[48:51], a[152:155], a[184:187], v[48:51]
ds_read_b64_tr_b16 a[174:175], v4 offset:1024
buffer_load_dwordx4 v11, s[88:91], s31 offen offset:3072 lds
v_mfma_f32_16x16x32_bf16 v[52:55], a[152:155], a[188:191], v[52:55]
ds_read_b64_tr_b16 a[144:145], v1 offset:39936
v_mfma_f32_16x16x32_bf16 a[24:27], a[156:159], a[184:187], a[24:27]
ds_read_b64_tr_b16 a[146:147], v1 offset:49152
v_mfma_f32_16x16x32_bf16 a[28:31], a[156:159], a[188:191], a[28:31]
ds_read_b64_tr_b16 a[148:149], v1 offset:58368
s_waitcnt lgkmcnt(7)
v_mfma_f32_16x16x32_bf16 v[56:59], a[160:163], a[184:187], v[56:59]
ds_read_b64_tr_b16 a[150:151], v3 offset:2048
v_mfma_f32_16x16x32_bf16 v[60:63], a[160:163], a[188:191], v[60:63]
ds_read_b64_tr_b16 a[152:153], v2 offset:39936
v_mfma_f32_16x16x32_bf16 a[32:35], a[164:167], a[184:187], a[32:35]
ds_read_b64_tr_b16 a[154:155], v2 offset:49152
v_mfma_f32_16x16x32_bf16 a[36:39], a[164:167], a[188:191], a[36:39]
ds_read_b64_tr_b16 a[156:157], v2 offset:58368
s_waitcnt lgkmcnt(7)
v_mfma_f32_16x16x32_bf16 v[64:67], a[168:171], a[184:187], v[64:67]
ds_read_b64_tr_b16 a[158:159], v4 offset:2048
s_add_u32 m0, s92, 118784
v_mfma_f32_16x16x32_bf16 v[68:71], a[168:171], a[188:191], v[68:71]
ds_read_b64_tr_b16 a[160:161], v1 offset:40960
s_add_u32 s32, s93, 885248
v_mfma_f32_16x16x32_bf16 a[40:43], a[172:175], a[184:187], a[40:43]
buffer_load_dwordx4 v8, s[88:91], s32 offen lds
ds_read_b64_tr_b16 a[162:163], v1 offset:50176
v_mfma_f32_16x16x32_bf16 a[44:47], a[172:175], a[188:191], a[44:47]
ds_read_b64_tr_b16 a[164:165], v1 offset:59392
s_waitcnt lgkmcnt(7)
v_mfma_f32_16x16x32_bf16 v[72:75], a[144:147], a[184:187], v[72:75]
ds_read_b64_tr_b16 a[166:167], v3 offset:3072
v_mfma_f32_16x16x32_bf16 v[76:79], a[144:147], a[188:191], v[76:79]
ds_read_b64_tr_b16 a[168:169], v2 offset:40960
v_mfma_f32_16x16x32_bf16 a[48:51], a[148:151], a[184:187], a[48:51]
ds_read_b64_tr_b16 a[170:171], v2 offset:50176
v_mfma_f32_16x16x32_bf16 a[52:55], a[148:151], a[188:191], a[52:55]
ds_read_b64_tr_b16 a[172:173], v2 offset:59392
s_waitcnt lgkmcnt(7)
v_mfma_f32_16x16x32_bf16 v[80:83], a[152:155], a[184:187], v[80:83]
ds_read_b64_tr_b16 a[174:175], v4 offset:3072
v_mfma_f32_16x16x32_bf16 v[84:87], a[152:155], a[188:191], v[84:87]
ds_read_b64_tr_b16 a[144:145], v1 offset:41984
v_mfma_f32_16x16x32_bf16 a[56:59], a[156:159], a[184:187], a[56:59]
ds_read_b64_tr_b16 a[146:147], v1 offset:51200
v_mfma_f32_16x16x32_bf16 a[60:63], a[156:159], a[188:191], a[60:63]
ds_read_b64_tr_b16 a[148:149], v1 offset:60416
s_waitcnt lgkmcnt(7)
v_mfma_f32_16x16x32_bf16 v[88:91], a[160:163], a[184:187], v[88:91]
ds_read_b64_tr_b16 a[150:151], v3 offset:4096
v_mfma_f32_16x16x32_bf16 v[92:95], a[160:163], a[188:191], v[92:95]
ds_read_b64_tr_b16 a[152:153], v2 offset:41984
v_mfma_f32_16x16x32_bf16 a[64:67], a[164:167], a[184:187], a[64:67]
ds_read_b64_tr_b16 a[154:155], v2 offset:51200
v_mfma_f32_16x16x32_bf16 a[68:71], a[164:167], a[188:191], a[68:71]
ds_read_b64_tr_b16 a[156:157], v2 offset:60416
s_waitcnt lgkmcnt(7)
v_mfma_f32_16x16x32_bf16 v[96:99], a[168:171], a[184:187], v[96:99]
ds_read_b64_tr_b16 a[158:159], v4 offset:4096
v_mfma_f32_16x16x32_bf16 v[100:103], a[168:171], a[188:191], v[100:103]
ds_read_b64_tr_b16 a[160:161], v1 offset:43008
v_mfma_f32_16x16x32_bf16 a[72:75], a[172:175], a[184:187], a[72:75]
ds_read_b64_tr_b16 a[162:163], v1 offset:52224
v_mfma_f32_16x16x32_bf16 a[76:79], a[172:175], a[188:191], a[76:79]
ds_read_b64_tr_b16 a[164:165], v1 offset:61440
s_waitcnt lgkmcnt(7)
v_mfma_f32_16x16x32_bf16 v[104:107], a[144:147], a[184:187], v[104:107]
ds_read_b64_tr_b16 a[166:167], v3 offset:5120
s_add_u32 s33, s26, 4096
v_mfma_f32_16x16x32_bf16 v[108:111], a[144:147], a[188:191], v[108:111]
ds_read_b64_tr_b16 a[168:169], v2 offset:43008
buffer_load_dwordx4 a[176:179], v7, s[16:19], s33 offen sc1
v_mfma_f32_16x16x32_bf16 a[80:83], a[148:151], a[184:187], a[80:83]
ds_read_b64_tr_b16 a[170:171], v2 offset:52224
buffer_load_dwordx4 a[180:183], v16, s[16:19], s33 offen sc1
v_mfma_f32_16x16x32_bf16 a[84:87], a[148:151], a[188:191], a[84:87]
ds_read_b64_tr_b16 a[172:173], v2 offset:61440
s_waitcnt lgkmcnt(7)
v_mfma_f32_16x16x32_bf16 v[112:115], a[152:155], a[184:187], v[112:115]
ds_read_b64_tr_b16 a[174:175], v4 offset:5120
v_mfma_f32_16x16x32_bf16 v[116:119], a[152:155], a[188:191], v[116:119]
ds_read_b64_tr_b16 a[144:145], v1 offset:44032
v_mfma_f32_16x16x32_bf16 a[88:91], a[156:159], a[184:187], a[88:91]
ds_read_b64_tr_b16 a[146:147], v1 offset:53248
v_mfma_f32_16x16x32_bf16 a[92:95], a[156:159], a[188:191], a[92:95]
ds_read_b64_tr_b16 a[148:149], v1 offset:62464
s_waitcnt lgkmcnt(7)
v_mfma_f32_16x16x32_bf16 v[120:123], a[160:163], a[184:187], v[120:123]
ds_read_b64_tr_b16 a[150:151], v3 offset:6144
v_mfma_f32_16x16x32_bf16 v[124:127], a[160:163], a[188:191], v[124:127]
ds_read_b64_tr_b16 a[152:153], v2 offset:44032
v_mfma_f32_16x16x32_bf16 a[96:99], a[164:167], a[184:187], a[96:99]
ds_read_b64_tr_b16 a[154:155], v2 offset:53248
v_mfma_f32_16x16x32_bf16 a[100:103], a[164:167], a[188:191], a[100:103]
ds_read_b64_tr_b16 a[156:157], v2 offset:62464
s_waitcnt lgkmcnt(7)
v_mfma_f32_16x16x32_bf16 v[128:131], a[168:171], a[184:187], v[128:131]
ds_read_b64_tr_b16 a[158:159], v4 offset:6144
v_mfma_f32_16x16x32_bf16 v[132:135], a[168:171], a[188:191], v[132:135]
ds_read_b64_tr_b16 a[160:161], v1 offset:45056
v_mfma_f32_16x16x32_bf16 a[104:107], a[172:175], a[184:187], a[104:107]
ds_read_b64_tr_b16 a[162:163], v1 offset:54272
v_mfma_f32_16x16x32_bf16 a[108:111], a[172:175], a[188:191], a[108:111]
ds_read_b64_tr_b16 a[164:165], v1 offset:63488
s_waitcnt lgkmcnt(7)
v_mfma_f32_16x16x32_bf16 v[136:139], a[144:147], a[184:187], v[136:139]
ds_read_b64_tr_b16 a[166:167], v3 offset:7168
v_mfma_f32_16x16x32_bf16 v[140:143], a[144:147], a[188:191], v[140:143]
ds_read_b64_tr_b16 a[168:169], v2 offset:45056
v_mfma_f32_16x16x32_bf16 a[112:115], a[148:151], a[184:187], a[112:115]
ds_read_b64_tr_b16 a[170:171], v2 offset:54272
v_mfma_f32_16x16x32_bf16 a[116:119], a[148:151], a[188:191], a[116:119]
ds_read_b64_tr_b16 a[172:173], v2 offset:63488
s_waitcnt lgkmcnt(7)
v_mfma_f32_16x16x32_bf16 v[144:147], a[152:155], a[184:187], v[144:147]
ds_read_b64_tr_b16 a[174:175], v4 offset:7168
v_mfma_f32_16x16x32_bf16 v[148:151], a[152:155], a[188:191], v[148:151]
s_waitcnt vmcnt(14)
s_barrier
ds_read_b64_tr_b16 a[144:145], v3 offset:8192
v_mfma_f32_16x16x32_bf16 a[120:123], a[156:159], a[184:187], a[120:123]
ds_read_b64_tr_b16 a[146:147], v3 offset:17408
s_add_u32 m0, s92, 0
v_mfma_f32_16x16x32_bf16 a[124:127], a[156:159], a[188:191], a[124:127]
ds_read_b64_tr_b16 a[148:149], v3 offset:26624
s_waitcnt lgkmcnt(7)
v_mfma_f32_16x16x32_bf16 v[152:155], a[160:163], a[184:187], v[152:155]
ds_read_b64_tr_b16 a[150:151], v3 offset:35840
s_add_u32 s30, s93, 1179648
v_mfma_f32_16x16x32_bf16 v[156:159], a[160:163], a[188:191], v[156:159]
buffer_load_dwordx4 v8, s[88:91], s30 offen lds
ds_read_b64_tr_b16 a[152:153], v4 offset:8192
v_mfma_f32_16x16x32_bf16 a[128:131], a[164:167], a[184:187], a[128:131]
ds_read_b64_tr_b16 a[154:155], v4 offset:17408
v_mfma_f32_16x16x32_bf16 a[132:135], a[164:167], a[188:191], a[132:135]
ds_read_b64_tr_b16 a[156:157], v4 offset:26624
s_waitcnt lgkmcnt(7)
v_mfma_f32_16x16x32_bf16 v[160:163], a[168:171], a[184:187], v[160:163]
ds_read_b64_tr_b16 a[158:159], v4 offset:35840
v_mfma_f32_16x16x32_bf16 v[164:167], a[168:171], a[188:191], v[164:167]
ds_read_b64_tr_b16 a[160:161], v3 offset:9216
buffer_load_dwordx4 v9, s[88:91], s30 offen offset:1024 lds
v_mfma_f32_16x16x32_bf16 a[136:139], a[172:175], a[184:187], a[136:139]
ds_read_b64_tr_b16 a[162:163], v3 offset:18432
v_mfma_f32_16x16x32_bf16 a[140:143], a[172:175], a[188:191], a[140:143]
ds_read_b64_tr_b16 a[164:165], v3 offset:27648
s_waitcnt lgkmcnt(7)
v_mfma_f32_16x16x32_bf16 v[24:27], a[144:147], a[192:195], v[24:27]
ds_read_b64_tr_b16 a[166:167], v3 offset:36864
v_mfma_f32_16x16x32_bf16 v[28:31], a[144:147], a[196:199], v[28:31]
ds_read_b64_tr_b16 a[168:169], v4 offset:9216
v_mfma_f32_16x16x32_bf16 a[0:3], a[148:151], a[192:195], a[0:3]
ds_read_b64_tr_b16 a[170:171], v4 offset:18432
v_mfma_f32_16x16x32_bf16 a[4:7], a[148:151], a[196:199], a[4:7]
ds_read_b64_tr_b16 a[172:173], v4 offset:27648
s_waitcnt lgkmcnt(7)
v_mfma_f32_16x16x32_bf16 v[32:35], a[152:155], a[192:195], v[32:35]
ds_read_b64_tr_b16 a[174:175], v4 offset:36864
buffer_load_dwordx4 v10, s[88:91], s30 offen offset:2048 lds
v_mfma_f32_16x16x32_bf16 v[36:39], a[152:155], a[196:199], v[36:39]
ds_read_b64_tr_b16 a[144:145], v3 offset:10240
v_mfma_f32_16x16x32_bf16 a[8:11], a[156:159], a[192:195], a[8:11]
ds_read_b64_tr_b16 a[146:147], v3 offset:19456
v_mfma_f32_16x16x32_bf16 a[12:15], a[156:159], a[196:199], a[12:15]
ds_read_b64_tr_b16 a[148:149], v3 offset:28672
s_waitcnt lgkmcnt(7)
v_mfma_f32_16x16x32_bf16 v[40:43], a[160:163], a[192:195], v[40:43]
ds_read_b64_tr_b16 a[150:151], v3 offset:37888
v_mfma_f32_16x16x32_bf16 v[44:47], a[160:163], a[196:199], v[44:47]
ds_read_b64_tr_b16 a[152:153], v4 offset:10240
v_mfma_f32_16x16x32_bf16 a[16:19], a[164:167], a[192:195], a[16:19]
ds_read_b64_tr_b16 a[154:155], v4 offset:19456
v_mfma_f32_16x16x32_bf16 a[20:23], a[164:167], a[196:199], a[20:23]
ds_read_b64_tr_b16 a[156:157], v4 offset:28672
s_waitcnt lgkmcnt(7)
v_mfma_f32_16x16x32_bf16 v[48:51], a[168:171], a[192:195], v[48:51]
ds_read_b64_tr_b16 a[158:159], v4 offset:37888
buffer_load_dwordx4 v11, s[88:91], s30 offen offset:3072 lds
v_mfma_f32_16x16x32_bf16 v[52:55], a[168:171], a[196:199], v[52:55]
ds_read_b64_tr_b16 a[160:161], v3 offset:11264
v_mfma_f32_16x16x32_bf16 a[24:27], a[172:175], a[192:195], a[24:27]
ds_read_b64_tr_b16 a[162:163], v3 offset:20480
v_mfma_f32_16x16x32_bf16 a[28:31], a[172:175], a[196:199], a[28:31]
ds_read_b64_tr_b16 a[164:165], v3 offset:29696
s_waitcnt lgkmcnt(7)
v_mfma_f32_16x16x32_bf16 v[56:59], a[144:147], a[192:195], v[56:59]
ds_read_b64_tr_b16 a[166:167], v3 offset:38912
v_mfma_f32_16x16x32_bf16 v[60:63], a[144:147], a[196:199], v[60:63]
ds_read_b64_tr_b16 a[168:169], v4 offset:11264
v_mfma_f32_16x16x32_bf16 a[32:35], a[148:151], a[192:195], a[32:35]
ds_read_b64_tr_b16 a[170:171], v4 offset:20480
s_add_u32 m0, s92, 4096
v_mfma_f32_16x16x32_bf16 a[36:39], a[148:151], a[196:199], a[36:39]
ds_read_b64_tr_b16 a[172:173], v4 offset:29696
s_waitcnt lgkmcnt(7)
v_mfma_f32_16x16x32_bf16 v[64:67], a[152:155], a[192:195], v[64:67]
ds_read_b64_tr_b16 a[174:175], v4 offset:38912
s_add_u32 s31, s93, 1179904
v_mfma_f32_16x16x32_bf16 v[68:71], a[152:155], a[196:199], v[68:71]
buffer_load_dwordx4 v8, s[88:91], s31 offen lds
ds_read_b64_tr_b16 a[144:145], v3 offset:12288
v_mfma_f32_16x16x32_bf16 a[40:43], a[156:159], a[192:195], a[40:43]
ds_read_b64_tr_b16 a[146:147], v3 offset:21504
v_mfma_f32_16x16x32_bf16 a[44:47], a[156:159], a[196:199], a[44:47]
ds_read_b64_tr_b16 a[148:149], v3 offset:30720
s_waitcnt lgkmcnt(7)
v_mfma_f32_16x16x32_bf16 v[72:75], a[160:163], a[192:195], v[72:75]
ds_read_b64_tr_b16 a[150:151], v3 offset:39936
v_mfma_f32_16x16x32_bf16 v[76:79], a[160:163], a[196:199], v[76:79]
ds_read_b64_tr_b16 a[152:153], v4 offset:12288
buffer_load_dwordx4 v9, s[88:91], s31 offen offset:1024 lds
v_mfma_f32_16x16x32_bf16 a[48:51], a[164:167], a[192:195], a[48:51]
ds_read_b64_tr_b16 a[154:155], v4 offset:21504
v_mfma_f32_16x16x32_bf16 a[52:55], a[164:167], a[196:199], a[52:55]
ds_read_b64_tr_b16 a[156:157], v4 offset:30720
s_waitcnt lgkmcnt(7)
v_mfma_f32_16x16x32_bf16 v[80:83], a[168:171], a[192:195], v[80:83]
ds_read_b64_tr_b16 a[158:159], v4 offset:39936
v_mfma_f32_16x16x32_bf16 v[84:87], a[168:171], a[196:199], v[84:87]
ds_read_b64_tr_b16 a[160:161], v3 offset:13312
v_mfma_f32_16x16x32_bf16 a[56:59], a[172:175], a[192:195], a[56:59]
ds_read_b64_tr_b16 a[162:163], v3 offset:22528
v_mfma_f32_16x16x32_bf16 a[60:63], a[172:175], a[196:199], a[60:63]
ds_read_b64_tr_b16 a[164:165], v3 offset:31744
s_waitcnt lgkmcnt(7)
v_mfma_f32_16x16x32_bf16 v[88:91], a[144:147], a[192:195], v[88:91]
ds_read_b64_tr_b16 a[166:167], v3 offset:40960
buffer_load_dwordx4 v10, s[88:91], s31 offen offset:2048 lds
v_mfma_f32_16x16x32_bf16 v[92:95], a[144:147], a[196:199], v[92:95]
ds_read_b64_tr_b16 a[168:169], v4 offset:13312
v_mfma_f32_16x16x32_bf16 a[64:67], a[148:151], a[192:195], a[64:67]
ds_read_b64_tr_b16 a[170:171], v4 offset:22528
v_mfma_f32_16x16x32_bf16 a[68:71], a[148:151], a[196:199], a[68:71]
ds_read_b64_tr_b16 a[172:173], v4 offset:31744
s_waitcnt lgkmcnt(7)
v_mfma_f32_16x16x32_bf16 v[96:99], a[152:155], a[192:195], v[96:99]
ds_read_b64_tr_b16 a[174:175], v4 offset:40960
v_mfma_f32_16x16x32_bf16 v[100:103], a[152:155], a[196:199], v[100:103]
ds_read_b64_tr_b16 a[144:145], v3 offset:14336
v_mfma_f32_16x16x32_bf16 a[72:75], a[156:159], a[192:195], a[72:75]
ds_read_b64_tr_b16 a[146:147], v3 offset:23552
v_mfma_f32_16x16x32_bf16 a[76:79], a[156:159], a[196:199], a[76:79]
ds_read_b64_tr_b16 a[148:149], v3 offset:32768
s_waitcnt lgkmcnt(7)
v_mfma_f32_16x16x32_bf16 v[104:107], a[160:163], a[192:195], v[104:107]
ds_read_b64_tr_b16 a[150:151], v3 offset:41984
buffer_load_dwordx4 v11, s[88:91], s31 offen offset:3072 lds
v_mfma_f32_16x16x32_bf16 v[108:111], a[160:163], a[196:199], v[108:111]
ds_read_b64_tr_b16 a[152:153], v4 offset:14336
buffer_load_dwordx4 a[184:187], v7, s[16:19], s33 offen offset:1024 sc1
v_mfma_f32_16x16x32_bf16 a[80:83], a[164:167], a[192:195], a[80:83]
ds_read_b64_tr_b16 a[154:155], v4 offset:23552
buffer_load_dwordx4 a[188:191], v16, s[16:19], s33 offen offset:1024 sc1
v_mfma_f32_16x16x32_bf16 a[84:87], a[164:167], a[196:199], a[84:87]
ds_read_b64_tr_b16 a[156:157], v4 offset:32768
s_waitcnt lgkmcnt(7)
v_mfma_f32_16x16x32_bf16 v[112:115], a[168:171], a[192:195], v[112:115]
ds_read_b64_tr_b16 a[158:159], v4 offset:41984
v_mfma_f32_16x16x32_bf16 v[116:119], a[168:171], a[196:199], v[116:119]
ds_read_b64_tr_b16 a[160:161], v3 offset:15360
v_mfma_f32_16x16x32_bf16 a[88:91], a[172:175], a[192:195], a[88:91]
ds_read_b64_tr_b16 a[162:163], v3 offset:24576
s_add_u32 m0, s92, 8192
v_mfma_f32_16x16x32_bf16 a[92:95], a[172:175], a[196:199], a[92:95]
ds_read_b64_tr_b16 a[164:165], v3 offset:33792
s_waitcnt lgkmcnt(7)
v_mfma_f32_16x16x32_bf16 v[120:123], a[144:147], a[192:195], v[120:123]
ds_read_b64_tr_b16 a[166:167], v3 offset:43008
s_add_u32 s32, s93, 1180160
v_mfma_f32_16x16x32_bf16 v[124:127], a[144:147], a[196:199], v[124:127]
buffer_load_dwordx4 v8, s[88:91], s32 offen lds
ds_read_b64_tr_b16 a[168:169], v4 offset:15360
v_mfma_f32_16x16x32_bf16 a[96:99], a[148:151], a[192:195], a[96:99]
ds_read_b64_tr_b16 a[170:171], v4 offset:24576
v_mfma_f32_16x16x32_bf16 a[100:103], a[148:151], a[196:199], a[100:103]
ds_read_b64_tr_b16 a[172:173], v4 offset:33792
s_waitcnt lgkmcnt(7)
v_mfma_f32_16x16x32_bf16 v[128:131], a[152:155], a[192:195], v[128:131]
ds_read_b64_tr_b16 a[174:175], v4 offset:43008
v_mfma_f32_16x16x32_bf16 v[132:135], a[152:155], a[196:199], v[132:135]
ds_read_b64_tr_b16 a[144:145], v3 offset:16384
v_mfma_f32_16x16x32_bf16 a[104:107], a[156:159], a[192:195], a[104:107]
ds_read_b64_tr_b16 a[146:147], v3 offset:25600
v_mfma_f32_16x16x32_bf16 a[108:111], a[156:159], a[196:199], a[108:111]
ds_read_b64_tr_b16 a[148:149], v3 offset:34816
s_waitcnt lgkmcnt(7)
v_mfma_f32_16x16x32_bf16 v[136:139], a[160:163], a[192:195], v[136:139]
ds_read_b64_tr_b16 a[150:151], v3 offset:44032
v_mfma_f32_16x16x32_bf16 v[140:143], a[160:163], a[196:199], v[140:143]
ds_read_b64_tr_b16 a[152:153], v4 offset:16384
v_mfma_f32_16x16x32_bf16 a[112:115], a[164:167], a[192:195], a[112:115]
ds_read_b64_tr_b16 a[154:155], v4 offset:25600
v_mfma_f32_16x16x32_bf16 a[116:119], a[164:167], a[196:199], a[116:119]
ds_read_b64_tr_b16 a[156:157], v4 offset:34816
s_waitcnt lgkmcnt(7)
v_mfma_f32_16x16x32_bf16 v[144:147], a[168:171], a[192:195], v[144:147]
ds_read_b64_tr_b16 a[158:159], v4 offset:44032
v_mfma_f32_16x16x32_bf16 v[148:151], a[168:171], a[196:199], v[148:151]
s_waitcnt vmcnt(13)
s_barrier
ds_read_b64_tr_b16 a[160:161], v3 offset:45056
v_mfma_f32_16x16x32_bf16 a[120:123], a[172:175], a[192:195], a[120:123]
ds_read_b64_tr_b16 a[162:163], v3 offset:54272
s_add_u32 m0, s92, 36864
v_mfma_f32_16x16x32_bf16 a[124:127], a[172:175], a[196:199], a[124:127]
ds_read_b64_tr_b16 a[164:165], v3 offset:63488
s_waitcnt lgkmcnt(7)
v_mfma_f32_16x16x32_bf16 v[152:155], a[144:147], a[192:195], v[152:155]
ds_read_b64_tr_b16 a[166:167], v5 offset:7168
s_add_u32 s30, s93, 1474560
v_mfma_f32_16x16x32_bf16 v[156:159], a[144:147], a[196:199], v[156:159]
buffer_load_dwordx4 v8, s[88:91], s30 offen lds
ds_read_b64_tr_b16 a[168:169], v4 offset:45056
v_mfma_f32_16x16x32_bf16 a[128:131], a[148:151], a[192:195], a[128:131]
ds_read_b64_tr_b16 a[170:171], v4 offset:54272
v_mfma_f32_16x16x32_bf16 a[132:135], a[148:151], a[196:199], a[132:135]
ds_read_b64_tr_b16 a[172:173], v4 offset:63488
s_waitcnt lgkmcnt(7)
v_mfma_f32_16x16x32_bf16 v[160:163], a[152:155], a[192:195], v[160:163]
ds_read_b64_tr_b16 a[174:175], v6 offset:7168
v_mfma_f32_16x16x32_bf16 v[164:167], a[152:155], a[196:199], v[164:167]
ds_read_b64_tr_b16 a[144:145], v3 offset:46080
buffer_load_dwordx4 v9, s[88:91], s30 offen offset:1024 lds
v_mfma_f32_16x16x32_bf16 a[136:139], a[156:159], a[192:195], a[136:139]
ds_read_b64_tr_b16 a[146:147], v3 offset:55296
v_mfma_f32_16x16x32_bf16 a[140:143], a[156:159], a[196:199], a[140:143]
ds_read_b64_tr_b16 a[148:149], v3 offset:64512
s_waitcnt lgkmcnt(7)
v_mfma_f32_16x16x32_bf16 v[24:27], a[160:163], a[200:203], v[24:27]
ds_read_b64_tr_b16 a[150:151], v5 offset:8192
v_mfma_f32_16x16x32_bf16 v[28:31], a[160:163], a[204:207], v[28:31]
ds_read_b64_tr_b16 a[152:153], v4 offset:46080
v_mfma_f32_16x16x32_bf16 a[0:3], a[164:167], a[200:203], a[0:3]
ds_read_b64_tr_b16 a[154:155], v4 offset:55296
v_mfma_f32_16x16x32_bf16 a[4:7], a[164:167], a[204:207], a[4:7]
ds_read_b64_tr_b16 a[156:157], v4 offset:64512
s_waitcnt lgkmcnt(7)
v_mfma_f32_16x16x32_bf16 v[32:35], a[168:171], a[200:203], v[32:35]
ds_read_b64_tr_b16 a[158:159], v6 offset:8192
buffer_load_dwordx4 v10, s[88:91], s30 offen offset:2048 lds
v_mfma_f32_16x16x32_bf16 v[36:39], a[168:171], a[204:207], v[36:39]
ds_read_b64_tr_b16 a[160:161], v3 offset:47104
v_mfma_f32_16x16x32_bf16 a[8:11], a[172:175], a[200:203], a[8:11]
ds_read_b64_tr_b16 a[162:163], v3 offset:56320
v_mfma_f32_16x16x32_bf16 a[12:15], a[172:175], a[204:207], a[12:15]
ds_read_b64_tr_b16 a[164:165], v5
s_waitcnt lgkmcnt(7)
v_mfma_f32_16x16x32_bf16 v[40:43], a[144:147], a[200:203], v[40:43]
ds_read_b64_tr_b16 a[166:167], v5 offset:9216
v_mfma_f32_16x16x32_bf16 v[44:47], a[144:147], a[204:207], v[44:47]
ds_read_b64_tr_b16 a[168:169], v4 offset:47104
v_mfma_f32_16x16x32_bf16 a[16:19], a[148:151], a[200:203], a[16:19]
ds_read_b64_tr_b16 a[170:171], v4 offset:56320
v_mfma_f32_16x16x32_bf16 a[20:23], a[148:151], a[204:207], a[20:23]
ds_read_b64_tr_b16 a[172:173], v6
s_waitcnt lgkmcnt(7)
v_mfma_f32_16x16x32_bf16 v[48:51], a[152:155], a[200:203], v[48:51]
ds_read_b64_tr_b16 a[174:175], v6 offset:9216
buffer_load_dwordx4 v11, s[88:91], s30 offen offset:3072 lds
v_mfma_f32_16x16x32_bf16 v[52:55], a[152:155], a[204:207], v[52:55]
ds_read_b64_tr_b16 a[144:145], v3 offset:48128
v_mfma_f32_16x16x32_bf16 a[24:27], a[156:159], a[200:203], a[24:27]
ds_read_b64_tr_b16 a[146:147], v3 offset:57344
v_mfma_f32_16x16x32_bf16 a[28:31], a[156:159], a[204:207], a[28:31]
ds_read_b64_tr_b16 a[148:149], v5 offset:1024
s_waitcnt lgkmcnt(7)
v_mfma_f32_16x16x32_bf16 v[56:59], a[160:163], a[200:203], v[56:59]
ds_read_b64_tr_b16 a[150:151], v5 offset:10240
v_mfma_f32_16x16x32_bf16 v[60:63], a[160:163], a[204:207], v[60:63]
ds_read_b64_tr_b16 a[152:153], v4 offset:48128
v_mfma_f32_16x16x32_bf16 a[32:35], a[164:167], a[200:203], a[32:35]
ds_read_b64_tr_b16 a[154:155], v4 offset:57344
s_add_u32 m0, s92, 40960
v_mfma_f32_16x16x32_bf16 a[36:39], a[164:167], a[204:207], a[36:39]
ds_read_b64_tr_b16 a[156:157], v6 offset:1024
s_waitcnt lgkmcnt(7)
v_mfma_f32_16x16x32_bf16 v[64:67], a[168:171], a[200:203], v[64:67]
ds_read_b64_tr_b16 a[158:159], v6 offset:10240
s_add_u32 s31, s93, 1474816
v_mfma_f32_16x16x32_bf16 v[68:71], a[168:171], a[204:207], v[68:71]
buffer_load_dwordx4 v8, s[88:91], s31 offen lds
ds_read_b64_tr_b16 a[160:161], v3 offset:49152
v_mfma_f32_16x16x32_bf16 a[40:43], a[172:175], a[200:203], a[40:43]
ds_read_b64_tr_b16 a[162:163], v3 offset:58368
v_mfma_f32_16x16x32_bf16 a[44:47], a[172:175], a[204:207], a[44:47]
ds_read_b64_tr_b16 a[164:165], v5 offset:2048
s_waitcnt lgkmcnt(7)
v_mfma_f32_16x16x32_bf16 v[72:75], a[144:147], a[200:203], v[72:75]
ds_read_b64_tr_b16 a[166:167], v5 offset:11264
v_mfma_f32_16x16x32_bf16 v[76:79], a[144:147], a[204:207], v[76:79]
ds_read_b64_tr_b16 a[168:169], v4 offset:49152
buffer_load_dwordx4 v9, s[88:91], s31 offen offset:1024 lds
v_mfma_f32_16x16x32_bf16 a[48:51], a[148:151], a[200:203], a[48:51]
ds_read_b64_tr_b16 a[170:171], v4 offset:58368
v_mfma_f32_16x16x32_bf16 a[52:55], a[148:151], a[204:207], a[52:55]
ds_read_b64_tr_b16 a[172:173], v6 offset:2048
s_waitcnt lgkmcnt(7)
v_mfma_f32_16x16x32_bf16 v[80:83], a[152:155], a[200:203], v[80:83]
ds_read_b64_tr_b16 a[174:175], v6 offset:11264
v_mfma_f32_16x16x32_bf16 v[84:87], a[152:155], a[204:207], v[84:87]
ds_read_b64_tr_b16 a[144:145], v3 offset:50176
v_mfma_f32_16x16x32_bf16 a[56:59], a[156:159], a[200:203], a[56:59]
ds_read_b64_tr_b16 a[146:147], v3 offset:59392
v_mfma_f32_16x16x32_bf16 a[60:63], a[156:159], a[204:207], a[60:63]
ds_read_b64_tr_b16 a[148:149], v5 offset:3072
s_waitcnt lgkmcnt(7)
v_mfma_f32_16x16x32_bf16 v[88:91], a[160:163], a[200:203], v[88:91]
ds_read_b64_tr_b16 a[150:151], v5 offset:12288
buffer_load_dwordx4 v10, s[88:91], s31 offen offset:2048 lds
v_mfma_f32_16x16x32_bf16 v[92:95], a[160:163], a[204:207], v[92:95]
ds_read_b64_tr_b16 a[152:153], v4 offset:50176
v_mfma_f32_16x16x32_bf16 a[64:67], a[164:167], a[200:203], a[64:67]
ds_read_b64_tr_b16 a[154:155], v4 offset:59392
v_mfma_f32_16x16x32_bf16 a[68:71], a[164:167], a[204:207], a[68:71]
ds_read_b64_tr_b16 a[156:157], v6 offset:3072
s_waitcnt lgkmcnt(7)
v_mfma_f32_16x16x32_bf16 v[96:99], a[168:171], a[200:203], v[96:99]
ds_read_b64_tr_b16 a[158:159], v6 offset:12288
v_mfma_f32_16x16x32_bf16 v[100:103], a[168:171], a[204:207], v[100:103]
ds_read_b64_tr_b16 a[160:161], v3 offset:51200
v_mfma_f32_16x16x32_bf16 a[72:75], a[172:175], a[200:203], a[72:75]
ds_read_b64_tr_b16 a[162:163], v3 offset:60416
v_mfma_f32_16x16x32_bf16 a[76:79], a[172:175], a[204:207], a[76:79]
ds_read_b64_tr_b16 a[164:165], v5 offset:4096
s_waitcnt lgkmcnt(7)
v_mfma_f32_16x16x32_bf16 v[104:107], a[144:147], a[200:203], v[104:107]
ds_read_b64_tr_b16 a[166:167], v5 offset:13312
buffer_load_dwordx4 v11, s[88:91], s31 offen offset:3072 lds
v_mfma_f32_16x16x32_bf16 v[108:111], a[144:147], a[204:207], v[108:111]
ds_read_b64_tr_b16 a[168:169], v4 offset:51200
buffer_load_dwordx4 a[192:195], v7, s[16:19], s33 offen offset:2048 sc1
v_mfma_f32_16x16x32_bf16 a[80:83], a[148:151], a[200:203], a[80:83]
ds_read_b64_tr_b16 a[170:171], v4 offset:60416
buffer_load_dwordx4 a[196:199], v16, s[16:19], s33 offen offset:2048 sc1
v_mfma_f32_16x16x32_bf16 a[84:87], a[148:151], a[204:207], a[84:87]
ds_read_b64_tr_b16 a[172:173], v6 offset:4096
s_waitcnt lgkmcnt(7)
v_mfma_f32_16x16x32_bf16 v[112:115], a[152:155], a[200:203], v[112:115]
ds_read_b64_tr_b16 a[174:175], v6 offset:13312
v_mfma_f32_16x16x32_bf16 v[116:119], a[152:155], a[204:207], v[116:119]
ds_read_b64_tr_b16 a[144:145], v3 offset:52224
v_mfma_f32_16x16x32_bf16 a[88:91], a[156:159], a[200:203], a[88:91]
ds_read_b64_tr_b16 a[146:147], v3 offset:61440
s_add_u32 m0, s92, 45056
v_mfma_f32_16x16x32_bf16 a[92:95], a[156:159], a[204:207], a[92:95]
ds_read_b64_tr_b16 a[148:149], v5 offset:5120
s_waitcnt lgkmcnt(7)
v_mfma_f32_16x16x32_bf16 v[120:123], a[160:163], a[200:203], v[120:123]
ds_read_b64_tr_b16 a[150:151], v5 offset:14336
s_add_u32 s32, s93, 1475072
v_mfma_f32_16x16x32_bf16 v[124:127], a[160:163], a[204:207], v[124:127]
buffer_load_dwordx4 v8, s[88:91], s32 offen lds
ds_read_b64_tr_b16 a[152:153], v4 offset:52224
v_mfma_f32_16x16x32_bf16 a[96:99], a[164:167], a[200:203], a[96:99]
ds_read_b64_tr_b16 a[154:155], v4 offset:61440
v_mfma_f32_16x16x32_bf16 a[100:103], a[164:167], a[204:207], a[100:103]
ds_read_b64_tr_b16 a[156:157], v6 offset:5120
s_waitcnt lgkmcnt(7)
v_mfma_f32_16x16x32_bf16 v[128:131], a[168:171], a[200:203], v[128:131]
ds_read_b64_tr_b16 a[158:159], v6 offset:14336
v_mfma_f32_16x16x32_bf16 v[132:135], a[168:171], a[204:207], v[132:135]
ds_read_b64_tr_b16 a[160:161], v3 offset:53248
v_mfma_f32_16x16x32_bf16 a[104:107], a[172:175], a[200:203], a[104:107]
ds_read_b64_tr_b16 a[162:163], v3 offset:62464
v_mfma_f32_16x16x32_bf16 a[108:111], a[172:175], a[204:207], a[108:111]
ds_read_b64_tr_b16 a[164:165], v5 offset:6144
s_waitcnt lgkmcnt(7)
v_mfma_f32_16x16x32_bf16 v[136:139], a[144:147], a[200:203], v[136:139]
ds_read_b64_tr_b16 a[166:167], v5 offset:15360
v_mfma_f32_16x16x32_bf16 v[140:143], a[144:147], a[204:207], v[140:143]
ds_read_b64_tr_b16 a[168:169], v4 offset:53248
v_mfma_f32_16x16x32_bf16 a[112:115], a[148:151], a[200:203], a[112:115]
ds_read_b64_tr_b16 a[170:171], v4 offset:62464
v_mfma_f32_16x16x32_bf16 a[116:119], a[148:151], a[204:207], a[116:119]
ds_read_b64_tr_b16 a[172:173], v6 offset:6144
s_waitcnt lgkmcnt(7)
v_mfma_f32_16x16x32_bf16 v[144:147], a[152:155], a[200:203], v[144:147]
ds_read_b64_tr_b16 a[174:175], v6 offset:15360
v_mfma_f32_16x16x32_bf16 v[148:151], a[152:155], a[204:207], v[148:151]
s_waitcnt vmcnt(11)
s_barrier
ds_read_b64_tr_b16 a[144:145], v1
v_mfma_f32_16x16x32_bf16 a[120:123], a[156:159], a[200:203], a[120:123]
ds_read_b64_tr_b16 a[146:147], v1 offset:9216
s_add_u32 m0, s92, 73728
v_mfma_f32_16x16x32_bf16 a[124:127], a[156:159], a[204:207], a[124:127]
ds_read_b64_tr_b16 a[148:149], v1 offset:18432
s_waitcnt lgkmcnt(7)
v_mfma_f32_16x16x32_bf16 v[152:155], a[160:163], a[200:203], v[152:155]
ds_read_b64_tr_b16 a[150:151], v1 offset:27648
s_add_u32 s30, s93, 1769472
v_mfma_f32_16x16x32_bf16 v[156:159], a[160:163], a[204:207], v[156:159]
buffer_load_dwordx4 v8, s[88:91], s30 offen lds
ds_read_b64_tr_b16 a[152:153], v2
v_mfma_f32_16x16x32_bf16 a[128:131], a[164:167], a[200:203], a[128:131]
ds_read_b64_tr_b16 a[154:155], v2 offset:9216
v_mfma_f32_16x16x32_bf16 a[132:135], a[164:167], a[204:207], a[132:135]
ds_read_b64_tr_b16 a[156:157], v2 offset:18432
s_waitcnt lgkmcnt(7)
v_mfma_f32_16x16x32_bf16 v[160:163], a[168:171], a[200:203], v[160:163]
ds_read_b64_tr_b16 a[158:159], v2 offset:27648
v_mfma_f32_16x16x32_bf16 v[164:167], a[168:171], a[204:207], v[164:167]
ds_read_b64_tr_b16 a[160:161], v1 offset:1024
buffer_load_dwordx4 v9, s[88:91], s30 offen offset:1024 lds
v_mfma_f32_16x16x32_bf16 a[136:139], a[172:175], a[200:203], a[136:139]
ds_read_b64_tr_b16 a[162:163], v1 offset:10240
v_mfma_f32_16x16x32_bf16 a[140:143], a[172:175], a[204:207], a[140:143]
ds_read_b64_tr_b16 a[164:165], v1 offset:19456
s_waitcnt lgkmcnt(7)
v_mfma_f32_16x16x32_bf16 v[24:27], a[144:147], a[176:179], v[24:27]
ds_read_b64_tr_b16 a[166:167], v1 offset:28672
v_mfma_f32_16x16x32_bf16 v[28:31], a[144:147], a[180:183], v[28:31]
ds_read_b64_tr_b16 a[168:169], v2 offset:1024
v_mfma_f32_16x16x32_bf16 a[0:3], a[148:151], a[176:179], a[0:3]
ds_read_b64_tr_b16 a[170:171], v2 offset:10240
v_mfma_f32_16x16x32_bf16 a[4:7], a[148:151], a[180:183], a[4:7]
ds_read_b64_tr_b16 a[172:173], v2 offset:19456
s_waitcnt lgkmcnt(7)
v_mfma_f32_16x16x32_bf16 v[32:35], a[152:155], a[176:179], v[32:35]
ds_read_b64_tr_b16 a[174:175], v2 offset:28672
buffer_load_dwordx4 v10, s[88:91], s30 offen offset:2048 lds
v_mfma_f32_16x16x32_bf16 v[36:39], a[152:155], a[180:183], v[36:39]
ds_read_b64_tr_b16 a[144:145], v1 offset:2048
v_mfma_f32_16x16x32_bf16 a[8:11], a[156:159], a[176:179], a[8:11]
ds_read_b64_tr_b16 a[146:147], v1 offset:11264
v_mfma_f32_16x16x32_bf16 a[12:15], a[156:159], a[180:183], a[12:15]
ds_read_b64_tr_b16 a[148:149], v1 offset:20480
s_waitcnt lgkmcnt(7)
v_mfma_f32_16x16x32_bf16 v[40:43], a[160:163], a[176:179], v[40:43]
ds_read_b64_tr_b16 a[150:151], v1 offset:29696
v_mfma_f32_16x16x32_bf16 v[44:47], a[160:163], a[180:183], v[44:47]
ds_read_b64_tr_b16 a[152:153], v2 offset:2048
v_mfma_f32_16x16x32_bf16 a[16:19], a[164:167], a[176:179], a[16:19]
ds_read_b64_tr_b16 a[154:155], v2 offset:11264
v_mfma_f32_16x16x32_bf16 a[20:23], a[164:167], a[180:183], a[20:23]
ds_read_b64_tr_b16 a[156:157], v2 offset:20480
s_waitcnt lgkmcnt(7)
v_mfma_f32_16x16x32_bf16 v[48:51], a[168:171], a[176:179], v[48:51]
ds_read_b64_tr_b16 a[158:159], v2 offset:29696
buffer_load_dwordx4 v11, s[88:91], s30 offen offset:3072 lds
v_mfma_f32_16x16x32_bf16 v[52:55], a[168:171], a[180:183], v[52:55]
ds_read_b64_tr_b16 a[160:161], v1 offset:3072
v_mfma_f32_16x16x32_bf16 a[24:27], a[172:175], a[176:179], a[24:27]
ds_read_b64_tr_b16 a[162:163], v1 offset:12288
v_mfma_f32_16x16x32_bf16 a[28:31], a[172:175], a[180:183], a[28:31]
ds_read_b64_tr_b16 a[164:165], v1 offset:21504
s_waitcnt lgkmcnt(7)
v_mfma_f32_16x16x32_bf16 v[56:59], a[144:147], a[176:179], v[56:59]
ds_read_b64_tr_b16 a[166:167], v1 offset:30720
v_mfma_f32_16x16x32_bf16 v[60:63], a[144:147], a[180:183], v[60:63]
ds_read_b64_tr_b16 a[168:169], v2 offset:3072
v_mfma_f32_16x16x32_bf16 a[32:35], a[148:151], a[176:179], a[32:35]
ds_read_b64_tr_b16 a[170:171], v2 offset:12288
s_add_u32 m0, s92, 77824
v_mfma_f32_16x16x32_bf16 a[36:39], a[148:151], a[180:183], a[36:39]
ds_read_b64_tr_b16 a[172:173], v2 offset:21504
s_waitcnt lgkmcnt(7)
v_mfma_f32_16x16x32_bf16 v[64:67], a[152:155], a[176:179], v[64:67]
ds_read_b64_tr_b16 a[174:175], v2 offset:30720
s_add_u32 s31, s93, 1769728
v_mfma_f32_16x16x32_bf16 v[68:71], a[152:155], a[180:183], v[68:71]
buffer_load_dwordx4 v8, s[88:91], s31 offen lds
ds_read_b64_tr_b16 a[144:145], v1 offset:4096
v_mfma_f32_16x16x32_bf16 a[40:43], a[156:159], a[176:179], a[40:43]
ds_read_b64_tr_b16 a[146:147], v1 offset:13312
v_mfma_f32_16x16x32_bf16 a[44:47], a[156:159], a[180:183], a[44:47]
ds_read_b64_tr_b16 a[148:149], v1 offset:22528
s_waitcnt lgkmcnt(7)
v_mfma_f32_16x16x32_bf16 v[72:75], a[160:163], a[176:179], v[72:75]
ds_read_b64_tr_b16 a[150:151], v1 offset:31744
v_mfma_f32_16x16x32_bf16 v[76:79], a[160:163], a[180:183], v[76:79]
ds_read_b64_tr_b16 a[152:153], v2 offset:4096
buffer_load_dwordx4 v9, s[88:91], s31 offen offset:1024 lds
v_mfma_f32_16x16x32_bf16 a[48:51], a[164:167], a[176:179], a[48:51]
ds_read_b64_tr_b16 a[154:155], v2 offset:13312
v_mfma_f32_16x16x32_bf16 a[52:55], a[164:167], a[180:183], a[52:55]
ds_read_b64_tr_b16 a[156:157], v2 offset:22528
s_waitcnt lgkmcnt(7)
v_mfma_f32_16x16x32_bf16 v[80:83], a[168:171], a[176:179], v[80:83]
ds_read_b64_tr_b16 a[158:159], v2 offset:31744
v_mfma_f32_16x16x32_bf16 v[84:87], a[168:171], a[180:183], v[84:87]
ds_read_b64_tr_b16 a[160:161], v1 offset:5120
v_mfma_f32_16x16x32_bf16 a[56:59], a[172:175], a[176:179], a[56:59]
ds_read_b64_tr_b16 a[162:163], v1 offset:14336
v_mfma_f32_16x16x32_bf16 a[60:63], a[172:175], a[180:183], a[60:63]
ds_read_b64_tr_b16 a[164:165], v1 offset:23552
s_waitcnt lgkmcnt(7)
v_mfma_f32_16x16x32_bf16 v[88:91], a[144:147], a[176:179], v[88:91]
ds_read_b64_tr_b16 a[166:167], v1 offset:32768
buffer_load_dwordx4 v10, s[88:91], s31 offen offset:2048 lds
v_mfma_f32_16x16x32_bf16 v[92:95], a[144:147], a[180:183], v[92:95]
ds_read_b64_tr_b16 a[168:169], v2 offset:5120
v_mfma_f32_16x16x32_bf16 a[64:67], a[148:151], a[176:179], a[64:67]
ds_read_b64_tr_b16 a[170:171], v2 offset:14336
v_mfma_f32_16x16x32_bf16 a[68:71], a[148:151], a[180:183], a[68:71]
ds_read_b64_tr_b16 a[172:173], v2 offset:23552
s_waitcnt lgkmcnt(7)
v_mfma_f32_16x16x32_bf16 v[96:99], a[152:155], a[176:179], v[96:99]
ds_read_b64_tr_b16 a[174:175], v2 offset:32768
v_mfma_f32_16x16x32_bf16 v[100:103], a[152:155], a[180:183], v[100:103]
ds_read_b64_tr_b16 a[144:145], v1 offset:6144
v_mfma_f32_16x16x32_bf16 a[72:75], a[156:159], a[176:179], a[72:75]
ds_read_b64_tr_b16 a[146:147], v1 offset:15360
v_mfma_f32_16x16x32_bf16 a[76:79], a[156:159], a[180:183], a[76:79]
ds_read_b64_tr_b16 a[148:149], v1 offset:24576
s_waitcnt lgkmcnt(7)
v_mfma_f32_16x16x32_bf16 v[104:107], a[160:163], a[176:179], v[104:107]
ds_read_b64_tr_b16 a[150:151], v1 offset:33792
buffer_load_dwordx4 v11, s[88:91], s31 offen offset:3072 lds
v_mfma_f32_16x16x32_bf16 v[108:111], a[160:163], a[180:183], v[108:111]
ds_read_b64_tr_b16 a[152:153], v2 offset:6144
buffer_load_dwordx4 a[200:203], v7, s[16:19], s33 offen offset:3072 sc1
v_mfma_f32_16x16x32_bf16 a[80:83], a[164:167], a[176:179], a[80:83]
ds_read_b64_tr_b16 a[154:155], v2 offset:15360
buffer_load_dwordx4 a[204:207], v16, s[16:19], s33 offen offset:3072 sc1
v_mfma_f32_16x16x32_bf16 a[84:87], a[164:167], a[180:183], a[84:87]
ds_read_b64_tr_b16 a[156:157], v2 offset:24576
s_waitcnt lgkmcnt(7)
v_mfma_f32_16x16x32_bf16 v[112:115], a[168:171], a[176:179], v[112:115]
ds_read_b64_tr_b16 a[158:159], v2 offset:33792
v_mfma_f32_16x16x32_bf16 v[116:119], a[168:171], a[180:183], v[116:119]
ds_read_b64_tr_b16 a[160:161], v1 offset:7168
v_mfma_f32_16x16x32_bf16 a[88:91], a[172:175], a[176:179], a[88:91]
ds_read_b64_tr_b16 a[162:163], v1 offset:16384
s_add_u32 m0, s92, 81920
v_mfma_f32_16x16x32_bf16 a[92:95], a[172:175], a[180:183], a[92:95]
ds_read_b64_tr_b16 a[164:165], v1 offset:25600
s_waitcnt lgkmcnt(7)
v_mfma_f32_16x16x32_bf16 v[120:123], a[144:147], a[176:179], v[120:123]
ds_read_b64_tr_b16 a[166:167], v1 offset:34816
s_add_u32 s32, s93, 1769984
v_mfma_f32_16x16x32_bf16 v[124:127], a[144:147], a[180:183], v[124:127]
buffer_load_dwordx4 v8, s[88:91], s32 offen lds
ds_read_b64_tr_b16 a[168:169], v2 offset:7168
v_mfma_f32_16x16x32_bf16 a[96:99], a[148:151], a[176:179], a[96:99]
ds_read_b64_tr_b16 a[170:171], v2 offset:16384
v_mfma_f32_16x16x32_bf16 a[100:103], a[148:151], a[180:183], a[100:103]
ds_read_b64_tr_b16 a[172:173], v2 offset:25600
s_waitcnt lgkmcnt(7)
v_mfma_f32_16x16x32_bf16 v[128:131], a[152:155], a[176:179], v[128:131]
ds_read_b64_tr_b16 a[174:175], v2 offset:34816
v_mfma_f32_16x16x32_bf16 v[132:135], a[152:155], a[180:183], v[132:135]
ds_read_b64_tr_b16 a[144:145], v1 offset:8192
v_mfma_f32_16x16x32_bf16 a[104:107], a[156:159], a[176:179], a[104:107]
ds_read_b64_tr_b16 a[146:147], v1 offset:17408
v_mfma_f32_16x16x32_bf16 a[108:111], a[156:159], a[180:183], a[108:111]
ds_read_b64_tr_b16 a[148:149], v1 offset:26624
s_waitcnt lgkmcnt(7)
v_mfma_f32_16x16x32_bf16 v[136:139], a[160:163], a[176:179], v[136:139]
ds_read_b64_tr_b16 a[150:151], v1 offset:35840
v_mfma_f32_16x16x32_bf16 v[140:143], a[160:163], a[180:183], v[140:143]
ds_read_b64_tr_b16 a[152:153], v2 offset:8192
v_mfma_f32_16x16x32_bf16 a[112:115], a[164:167], a[176:179], a[112:115]
ds_read_b64_tr_b16 a[154:155], v2 offset:17408
v_mfma_f32_16x16x32_bf16 a[116:119], a[164:167], a[180:183], a[116:119]
ds_read_b64_tr_b16 a[156:157], v2 offset:26624
s_waitcnt lgkmcnt(7)
v_mfma_f32_16x16x32_bf16 v[144:147], a[168:171], a[176:179], v[144:147]
ds_read_b64_tr_b16 a[158:159], v2 offset:35840
v_mfma_f32_16x16x32_bf16 v[148:151], a[168:171], a[180:183], v[148:151]
s_waitcnt vmcnt(11)
s_barrier
ds_read_b64_tr_b16 a[160:161], v1 offset:36864
v_mfma_f32_16x16x32_bf16 a[120:123], a[172:175], a[176:179], a[120:123]
ds_read_b64_tr_b16 a[162:163], v1 offset:46080
s_add_u32 m0, s92, 110592
v_mfma_f32_16x16x32_bf16 a[124:127], a[172:175], a[180:183], a[124:127]
ds_read_b64_tr_b16 a[164:165], v1 offset:55296
s_waitcnt lgkmcnt(7)
v_mfma_f32_16x16x32_bf16 v[152:155], a[144:147], a[176:179], v[152:155]
ds_read_b64_tr_b16 a[166:167], v1 offset:64512
s_add_u32 s30, s93, 2064384
v_mfma_f32_16x16x32_bf16 v[156:159], a[144:147], a[180:183], v[156:159]
buffer_load_dwordx4 v8, s[88:91], s30 offen lds
ds_read_b64_tr_b16 a[168:169], v2 offset:36864
v_mfma_f32_16x16x32_bf16 a[128:131], a[148:151], a[176:179], a[128:131]
ds_read_b64_tr_b16 a[170:171], v2 offset:46080
v_mfma_f32_16x16x32_bf16 a[132:135], a[148:151], a[180:183], a[132:135]
ds_read_b64_tr_b16 a[172:173], v2 offset:55296
s_waitcnt lgkmcnt(7)
v_mfma_f32_16x16x32_bf16 v[160:163], a[152:155], a[176:179], v[160:163]
ds_read_b64_tr_b16 a[174:175], v2 offset:64512
v_mfma_f32_16x16x32_bf16 v[164:167], a[152:155], a[180:183], v[164:167]
ds_read_b64_tr_b16 a[144:145], v1 offset:37888
buffer_load_dwordx4 v9, s[88:91], s30 offen offset:1024 lds
v_mfma_f32_16x16x32_bf16 a[136:139], a[156:159], a[176:179], a[136:139]
ds_read_b64_tr_b16 a[146:147], v1 offset:47104
v_mfma_f32_16x16x32_bf16 a[140:143], a[156:159], a[180:183], a[140:143]
ds_read_b64_tr_b16 a[148:149], v1 offset:56320
s_waitcnt lgkmcnt(7)
v_mfma_f32_16x16x32_bf16 v[24:27], a[160:163], a[184:187], v[24:27]
ds_read_b64_tr_b16 a[150:151], v3
v_mfma_f32_16x16x32_bf16 v[28:31], a[160:163], a[188:191], v[28:31]
ds_read_b64_tr_b16 a[152:153], v2 offset:37888
v_mfma_f32_16x16x32_bf16 a[0:3], a[164:167], a[184:187], a[0:3]
ds_read_b64_tr_b16 a[154:155], v2 offset:47104
v_mfma_f32_16x16x32_bf16 a[4:7], a[164:167], a[188:191], a[4:7]
ds_read_b64_tr_b16 a[156:157], v2 offset:56320
s_waitcnt lgkmcnt(7)
v_mfma_f32_16x16x32_bf16 v[32:35], a[168:171], a[184:187], v[32:35]
ds_read_b64_tr_b16 a[158:159], v4
buffer_load_dwordx4 v10, s[88:91], s30 offen offset:2048 lds
v_mfma_f32_16x16x32_bf16 v[36:39], a[168:171], a[188:191], v[36:39]
ds_read_b64_tr_b16 a[160:161], v1 offset:38912
v_mfma_f32_16x16x32_bf16 a[8:11], a[172:175], a[184:187], a[8:11]
ds_read_b64_tr_b16 a[162:163], v1 offset:48128
v_mfma_f32_16x16x32_bf16 a[12:15], a[172:175], a[188:191], a[12:15]
ds_read_b64_tr_b16 a[164:165], v1 offset:57344
s_waitcnt lgkmcnt(7)
v_mfma_f32_16x16x32_bf16 v[40:43], a[144:147], a[184:187], v[40:43]
ds_read_b64_tr_b16 a[166:167], v3 offset:1024
v_mfma_f32_16x16x32_bf16 v[44:47], a[144:147], a[188:191], v[44:47]
ds_read_b64_tr_b16 a[168:169], v2 offset:38912
v_mfma_f32_16x16x32_bf16 a[16:19], a[148:151], a[184:187], a[16:19]
ds_read_b64_tr_b16 a[170:171], v2 offset:48128
v_mfma_f32_16x16x32_bf16 a[20:23], a[148:151], a[188:191], a[20:23]
ds_read_b64_tr_b16 a[172:173], v2 offset:57344
s_waitcnt lgkmcnt(7)
v_mfma_f32_16x16x32_bf16 v[48:51], a[152:155], a[184:187], v[48:51]
ds_read_b64_tr_b16 a[174:175], v4 offset:1024
buffer_load_dwordx4 v11, s[88:91], s30 offen offset:3072 lds
v_mfma_f32_16x16x32_bf16 v[52:55], a[152:155], a[188:191], v[52:55]
ds_read_b64_tr_b16 a[144:145], v1 offset:39936
v_mfma_f32_16x16x32_bf16 a[24:27], a[156:159], a[184:187], a[24:27]
ds_read_b64_tr_b16 a[146:147], v1 offset:49152
v_mfma_f32_16x16x32_bf16 a[28:31], a[156:159], a[188:191], a[28:31]
ds_read_b64_tr_b16 a[148:149], v1 offset:58368
s_waitcnt lgkmcnt(7)
v_mfma_f32_16x16x32_bf16 v[56:59], a[160:163], a[184:187], v[56:59]
ds_read_b64_tr_b16 a[150:151], v3 offset:2048
v_mfma_f32_16x16x32_bf16 v[60:63], a[160:163], a[188:191], v[60:63]
ds_read_b64_tr_b16 a[152:153], v2 offset:39936
v_mfma_f32_16x16x32_bf16 a[32:35], a[164:167], a[184:187], a[32:35]
ds_read_b64_tr_b16 a[154:155], v2 offset:49152
s_add_u32 m0, s92, 114688
v_mfma_f32_16x16x32_bf16 a[36:39], a[164:167], a[188:191], a[36:39]
ds_read_b64_tr_b16 a[156:157], v2 offset:58368
s_waitcnt lgkmcnt(7)
v_mfma_f32_16x16x32_bf16 v[64:67], a[168:171], a[184:187], v[64:67]
ds_read_b64_tr_b16 a[158:159], v4 offset:2048
s_add_u32 s31, s93, 2064640
v_mfma_f32_16x16x32_bf16 v[68:71], a[168:171], a[188:191], v[68:71]
buffer_load_dwordx4 v8, s[88:91], s31 offen lds
ds_read_b64_tr_b16 a[160:161], v1 offset:40960
v_mfma_f32_16x16x32_bf16 a[40:43], a[172:175], a[184:187], a[40:43]
ds_read_b64_tr_b16 a[162:163], v1 offset:50176
v_mfma_f32_16x16x32_bf16 a[44:47], a[172:175], a[188:191], a[44:47]
ds_read_b64_tr_b16 a[164:165], v1 offset:59392
s_waitcnt lgkmcnt(7)
v_mfma_f32_16x16x32_bf16 v[72:75], a[144:147], a[184:187], v[72:75]
ds_read_b64_tr_b16 a[166:167], v3 offset:3072
v_mfma_f32_16x16x32_bf16 v[76:79], a[144:147], a[188:191], v[76:79]
ds_read_b64_tr_b16 a[168:169], v2 offset:40960
buffer_load_dwordx4 v9, s[88:91], s31 offen offset:1024 lds
v_mfma_f32_16x16x32_bf16 a[48:51], a[148:151], a[184:187], a[48:51]
ds_read_b64_tr_b16 a[170:171], v2 offset:50176
v_mfma_f32_16x16x32_bf16 a[52:55], a[148:151], a[188:191], a[52:55]
ds_read_b64_tr_b16 a[172:173], v2 offset:59392
s_waitcnt lgkmcnt(7)
v_mfma_f32_16x16x32_bf16 v[80:83], a[152:155], a[184:187], v[80:83]
ds_read_b64_tr_b16 a[174:175], v4 offset:3072
v_mfma_f32_16x16x32_bf16 v[84:87], a[152:155], a[188:191], v[84:87]
ds_read_b64_tr_b16 a[144:145], v1 offset:41984
v_mfma_f32_16x16x32_bf16 a[56:59], a[156:159], a[184:187], a[56:59]
ds_read_b64_tr_b16 a[146:147], v1 offset:51200
v_mfma_f32_16x16x32_bf16 a[60:63], a[156:159], a[188:191], a[60:63]
ds_read_b64_tr_b16 a[148:149], v1 offset:60416
s_waitcnt lgkmcnt(7)
v_mfma_f32_16x16x32_bf16 v[88:91], a[160:163], a[184:187], v[88:91]
ds_read_b64_tr_b16 a[150:151], v3 offset:4096
buffer_load_dwordx4 v10, s[88:91], s31 offen offset:2048 lds
v_mfma_f32_16x16x32_bf16 v[92:95], a[160:163], a[188:191], v[92:95]
ds_read_b64_tr_b16 a[152:153], v2 offset:41984
v_mfma_f32_16x16x32_bf16 a[64:67], a[164:167], a[184:187], a[64:67]
ds_read_b64_tr_b16 a[154:155], v2 offset:51200
v_mfma_f32_16x16x32_bf16 a[68:71], a[164:167], a[188:191], a[68:71]
ds_read_b64_tr_b16 a[156:157], v2 offset:60416
s_waitcnt lgkmcnt(7)
v_mfma_f32_16x16x32_bf16 v[96:99], a[168:171], a[184:187], v[96:99]
ds_read_b64_tr_b16 a[158:159], v4 offset:4096
v_mfma_f32_16x16x32_bf16 v[100:103], a[168:171], a[188:191], v[100:103]
ds_read_b64_tr_b16 a[160:161], v1 offset:43008
v_mfma_f32_16x16x32_bf16 a[72:75], a[172:175], a[184:187], a[72:75]
ds_read_b64_tr_b16 a[162:163], v1 offset:52224
v_mfma_f32_16x16x32_bf16 a[76:79], a[172:175], a[188:191], a[76:79]
ds_read_b64_tr_b16 a[164:165], v1 offset:61440
s_waitcnt lgkmcnt(7)
v_mfma_f32_16x16x32_bf16 v[104:107], a[144:147], a[184:187], v[104:107]
ds_read_b64_tr_b16 a[166:167], v3 offset:5120
buffer_load_dwordx4 v11, s[88:91], s31 offen offset:3072 lds
v_mfma_f32_16x16x32_bf16 v[108:111], a[144:147], a[188:191], v[108:111]
ds_read_b64_tr_b16 a[168:169], v2 offset:43008
s_add_u32 s33, s26, 8192
v_mfma_f32_16x16x32_bf16 a[80:83], a[148:151], a[184:187], a[80:83]
ds_read_b64_tr_b16 a[170:171], v2 offset:52224
buffer_load_dwordx4 a[176:179], v7, s[16:19], s33 offen sc1
v_mfma_f32_16x16x32_bf16 a[84:87], a[148:151], a[188:191], a[84:87]
ds_read_b64_tr_b16 a[172:173], v2 offset:61440
s_waitcnt lgkmcnt(7)
v_mfma_f32_16x16x32_bf16 v[112:115], a[152:155], a[184:187], v[112:115]
ds_read_b64_tr_b16 a[174:175], v4 offset:5120
buffer_load_dwordx4 a[180:183], v16, s[16:19], s33 offen sc1
v_mfma_f32_16x16x32_bf16 v[116:119], a[152:155], a[188:191], v[116:119]
ds_read_b64_tr_b16 a[144:145], v1 offset:44032
v_mfma_f32_16x16x32_bf16 a[88:91], a[156:159], a[184:187], a[88:91]
ds_read_b64_tr_b16 a[146:147], v1 offset:53248
s_add_u32 m0, s92, 118784
v_mfma_f32_16x16x32_bf16 a[92:95], a[156:159], a[188:191], a[92:95]
ds_read_b64_tr_b16 a[148:149], v1 offset:62464
s_waitcnt lgkmcnt(7)
v_mfma_f32_16x16x32_bf16 v[120:123], a[160:163], a[184:187], v[120:123]
ds_read_b64_tr_b16 a[150:151], v3 offset:6144
s_add_u32 s32, s93, 2064896
v_mfma_f32_16x16x32_bf16 v[124:127], a[160:163], a[188:191], v[124:127]
buffer_load_dwordx4 v8, s[88:91], s32 offen lds
ds_read_b64_tr_b16 a[152:153], v2 offset:44032
v_mfma_f32_16x16x32_bf16 a[96:99], a[164:167], a[184:187], a[96:99]
ds_read_b64_tr_b16 a[154:155], v2 offset:53248
v_mfma_f32_16x16x32_bf16 a[100:103], a[164:167], a[188:191], a[100:103]
ds_read_b64_tr_b16 a[156:157], v2 offset:62464
s_waitcnt lgkmcnt(7)
v_mfma_f32_16x16x32_bf16 v[128:131], a[168:171], a[184:187], v[128:131]
ds_read_b64_tr_b16 a[158:159], v4 offset:6144
v_mfma_f32_16x16x32_bf16 v[132:135], a[168:171], a[188:191], v[132:135]
ds_read_b64_tr_b16 a[160:161], v1 offset:45056
v_mfma_f32_16x16x32_bf16 a[104:107], a[172:175], a[184:187], a[104:107]
ds_read_b64_tr_b16 a[162:163], v1 offset:54272
v_mfma_f32_16x16x32_bf16 a[108:111], a[172:175], a[188:191], a[108:111]
ds_read_b64_tr_b16 a[164:165], v1 offset:63488
s_waitcnt lgkmcnt(7)
v_mfma_f32_16x16x32_bf16 v[136:139], a[144:147], a[184:187], v[136:139]
ds_read_b64_tr_b16 a[166:167], v3 offset:7168
v_mfma_f32_16x16x32_bf16 v[140:143], a[144:147], a[188:191], v[140:143]
ds_read_b64_tr_b16 a[168:169], v2 offset:45056
v_mfma_f32_16x16x32_bf16 a[112:115], a[148:151], a[184:187], a[112:115]
ds_read_b64_tr_b16 a[170:171], v2 offset:54272
v_mfma_f32_16x16x32_bf16 a[116:119], a[148:151], a[188:191], a[116:119]
ds_read_b64_tr_b16 a[172:173], v2 offset:63488
s_waitcnt lgkmcnt(7)
v_mfma_f32_16x16x32_bf16 v[144:147], a[152:155], a[184:187], v[144:147]
ds_read_b64_tr_b16 a[174:175], v4 offset:7168
v_mfma_f32_16x16x32_bf16 v[148:151], a[152:155], a[188:191], v[148:151]
s_waitcnt vmcnt(11)
s_barrier
ds_read_b64_tr_b16 a[144:145], v3 offset:8192
v_mfma_f32_16x16x32_bf16 a[120:123], a[156:159], a[184:187], a[120:123]
ds_read_b64_tr_b16 a[146:147], v3 offset:17408
s_add_u32 m0, s92, 0
v_mfma_f32_16x16x32_bf16 a[124:127], a[156:159], a[188:191], a[124:127]
ds_read_b64_tr_b16 a[148:149], v3 offset:26624
s_waitcnt lgkmcnt(7)
v_mfma_f32_16x16x32_bf16 v[152:155], a[160:163], a[184:187], v[152:155]
ds_read_b64_tr_b16 a[150:151], v3 offset:35840
s_add_u32 s30, s93, 2359296
v_mfma_f32_16x16x32_bf16 v[156:159], a[160:163], a[188:191], v[156:159]
buffer_load_dwordx4 v8, s[88:91], s30 offen lds
ds_read_b64_tr_b16 a[152:153], v4 offset:8192
v_mfma_f32_16x16x32_bf16 a[128:131], a[164:167], a[184:187], a[128:131]
ds_read_b64_tr_b16 a[154:155], v4 offset:17408
v_mfma_f32_16x16x32_bf16 a[132:135], a[164:167], a[188:191], a[132:135]
ds_read_b64_tr_b16 a[156:157], v4 offset:26624
s_waitcnt lgkmcnt(7)
v_mfma_f32_16x16x32_bf16 v[160:163], a[168:171], a[184:187], v[160:163]
ds_read_b64_tr_b16 a[158:159], v4 offset:35840
v_mfma_f32_16x16x32_bf16 v[164:167], a[168:171], a[188:191], v[164:167]
ds_read_b64_tr_b16 a[160:161], v3 offset:9216
buffer_load_dwordx4 v9, s[88:91], s30 offen offset:1024 lds
v_mfma_f32_16x16x32_bf16 a[136:139], a[172:175], a[184:187], a[136:139]
ds_read_b64_tr_b16 a[162:163], v3 offset:18432
v_mfma_f32_16x16x32_bf16 a[140:143], a[172:175], a[188:191], a[140:143]
ds_read_b64_tr_b16 a[164:165], v3 offset:27648
s_waitcnt lgkmcnt(7)
v_mfma_f32_16x16x32_bf16 v[24:27], a[144:147], a[192:195], v[24:27]
ds_read_b64_tr_b16 a[166:167], v3 offset:36864
v_mfma_f32_16x16x32_bf16 v[28:31], a[144:147], a[196:199], v[28:31]
ds_read_b64_tr_b16 a[168:169], v4 offset:9216
v_mfma_f32_16x16x32_bf16 a[0:3], a[148:151], a[192:195], a[0:3]
ds_read_b64_tr_b16 a[170:171], v4 offset:18432
v_mfma_f32_16x16x32_bf16 a[4:7], a[148:151], a[196:199], a[4:7]
ds_read_b64_tr_b16 a[172:173], v4 offset:27648
s_waitcnt lgkmcnt(7)
v_mfma_f32_16x16x32_bf16 v[32:35], a[152:155], a[192:195], v[32:35]
ds_read_b64_tr_b16 a[174:175], v4 offset:36864
buffer_load_dwordx4 v10, s[88:91], s30 offen offset:2048 lds
v_mfma_f32_16x16x32_bf16 v[36:39], a[152:155], a[196:199], v[36:39]
ds_read_b64_tr_b16 a[144:145], v3 offset:10240
v_mfma_f32_16x16x32_bf16 a[8:11], a[156:159], a[192:195], a[8:11]
ds_read_b64_tr_b16 a[146:147], v3 offset:19456
v_mfma_f32_16x16x32_bf16 a[12:15], a[156:159], a[196:199], a[12:15]
ds_read_b64_tr_b16 a[148:149], v3 offset:28672
s_waitcnt lgkmcnt(7)
v_mfma_f32_16x16x32_bf16 v[40:43], a[160:163], a[192:195], v[40:43]
ds_read_b64_tr_b16 a[150:151], v3 offset:37888
v_mfma_f32_16x16x32_bf16 v[44:47], a[160:163], a[196:199], v[44:47]
ds_read_b64_tr_b16 a[152:153], v4 offset:10240
v_mfma_f32_16x16x32_bf16 a[16:19], a[164:167], a[192:195], a[16:19]
ds_read_b64_tr_b16 a[154:155], v4 offset:19456
v_mfma_f32_16x16x32_bf16 a[20:23], a[164:167], a[196:199], a[20:23]
ds_read_b64_tr_b16 a[156:157], v4 offset:28672
s_waitcnt lgkmcnt(7)
v_mfma_f32_16x16x32_bf16 v[48:51], a[168:171], a[192:195], v[48:51]
ds_read_b64_tr_b16 a[158:159], v4 offset:37888
buffer_load_dwordx4 v11, s[88:91], s30 offen offset:3072 lds
v_mfma_f32_16x16x32_bf16 v[52:55], a[168:171], a[196:199], v[52:55]
ds_read_b64_tr_b16 a[160:161], v3 offset:11264
v_mfma_f32_16x16x32_bf16 a[24:27], a[172:175], a[192:195], a[24:27]
ds_read_b64_tr_b16 a[162:163], v3 offset:20480
v_mfma_f32_16x16x32_bf16 a[28:31], a[172:175], a[196:199], a[28:31]
ds_read_b64_tr_b16 a[164:165], v3 offset:29696
s_waitcnt lgkmcnt(7)
v_mfma_f32_16x16x32_bf16 v[56:59], a[144:147], a[192:195], v[56:59]
ds_read_b64_tr_b16 a[166:167], v3 offset:38912
v_mfma_f32_16x16x32_bf16 v[60:63], a[144:147], a[196:199], v[60:63]
ds_read_b64_tr_b16 a[168:169], v4 offset:11264
v_mfma_f32_16x16x32_bf16 a[32:35], a[148:151], a[192:195], a[32:35]
ds_read_b64_tr_b16 a[170:171], v4 offset:20480
s_add_u32 m0, s92, 4096
v_mfma_f32_16x16x32_bf16 a[36:39], a[148:151], a[196:199], a[36:39]
ds_read_b64_tr_b16 a[172:173], v4 offset:29696
s_waitcnt lgkmcnt(7)
v_mfma_f32_16x16x32_bf16 v[64:67], a[152:155], a[192:195], v[64:67]
ds_read_b64_tr_b16 a[174:175], v4 offset:38912
s_add_u32 s31, s93, 2359552
v_mfma_f32_16x16x32_bf16 v[68:71], a[152:155], a[196:199], v[68:71]
buffer_load_dwordx4 v8, s[88:91], s31 offen lds
ds_read_b64_tr_b16 a[144:145], v3 offset:12288
v_mfma_f32_16x16x32_bf16 a[40:43], a[156:159], a[192:195], a[40:43]
ds_read_b64_tr_b16 a[146:147], v3 offset:21504
v_mfma_f32_16x16x32_bf16 a[44:47], a[156:159], a[196:199], a[44:47]
ds_read_b64_tr_b16 a[148:149], v3 offset:30720
s_waitcnt lgkmcnt(7)
v_mfma_f32_16x16x32_bf16 v[72:75], a[160:163], a[192:195], v[72:75]
ds_read_b64_tr_b16 a[150:151], v3 offset:39936
v_mfma_f32_16x16x32_bf16 v[76:79], a[160:163], a[196:199], v[76:79]
ds_read_b64_tr_b16 a[152:153], v4 offset:12288
buffer_load_dwordx4 v9, s[88:91], s31 offen offset:1024 lds
v_mfma_f32_16x16x32_bf16 a[48:51], a[164:167], a[192:195], a[48:51]
ds_read_b64_tr_b16 a[154:155], v4 offset:21504
v_mfma_f32_16x16x32_bf16 a[52:55], a[164:167], a[196:199], a[52:55]
ds_read_b64_tr_b16 a[156:157], v4 offset:30720
s_waitcnt lgkmcnt(7)
v_mfma_f32_16x16x32_bf16 v[80:83], a[168:171], a[192:195], v[80:83]
ds_read_b64_tr_b16 a[158:159], v4 offset:39936
v_mfma_f32_16x16x32_bf16 v[84:87], a[168:171], a[196:199], v[84:87]
ds_read_b64_tr_b16 a[160:161], v3 offset:13312
v_mfma_f32_16x16x32_bf16 a[56:59], a[172:175], a[192:195], a[56:59]
ds_read_b64_tr_b16 a[162:163], v3 offset:22528
v_mfma_f32_16x16x32_bf16 a[60:63], a[172:175], a[196:199], a[60:63]
ds_read_b64_tr_b16 a[164:165], v3 offset:31744
s_waitcnt lgkmcnt(7)
v_mfma_f32_16x16x32_bf16 v[88:91], a[144:147], a[192:195], v[88:91]
ds_read_b64_tr_b16 a[166:167], v3 offset:40960
buffer_load_dwordx4 v10, s[88:91], s31 offen offset:2048 lds
v_mfma_f32_16x16x32_bf16 v[92:95], a[144:147], a[196:199], v[92:95]
ds_read_b64_tr_b16 a[168:169], v4 offset:13312
v_mfma_f32_16x16x32_bf16 a[64:67], a[148:151], a[192:195], a[64:67]
ds_read_b64_tr_b16 a[170:171], v4 offset:22528
v_mfma_f32_16x16x32_bf16 a[68:71], a[148:151], a[196:199], a[68:71]
ds_read_b64_tr_b16 a[172:173], v4 offset:31744
s_waitcnt lgkmcnt(7)
v_mfma_f32_16x16x32_bf16 v[96:99], a[152:155], a[192:195], v[96:99]
ds_read_b64_tr_b16 a[174:175], v4 offset:40960
v_mfma_f32_16x16x32_bf16 v[100:103], a[152:155], a[196:199], v[100:103]
ds_read_b64_tr_b16 a[144:145], v3 offset:14336
v_mfma_f32_16x16x32_bf16 a[72:75], a[156:159], a[192:195], a[72:75]
ds_read_b64_tr_b16 a[146:147], v3 offset:23552
v_mfma_f32_16x16x32_bf16 a[76:79], a[156:159], a[196:199], a[76:79]
ds_read_b64_tr_b16 a[148:149], v3 offset:32768
s_waitcnt lgkmcnt(7)
v_mfma_f32_16x16x32_bf16 v[104:107], a[160:163], a[192:195], v[104:107]
ds_read_b64_tr_b16 a[150:151], v3 offset:41984
buffer_load_dwordx4 v11, s[88:91], s31 offen offset:3072 lds
v_mfma_f32_16x16x32_bf16 v[108:111], a[160:163], a[196:199], v[108:111]
ds_read_b64_tr_b16 a[152:153], v4 offset:14336
buffer_load_dwordx4 a[184:187], v7, s[16:19], s33 offen offset:1024 sc1
v_mfma_f32_16x16x32_bf16 a[80:83], a[164:167], a[192:195], a[80:83]
ds_read_b64_tr_b16 a[154:155], v4 offset:23552
buffer_load_dwordx4 a[188:191], v16, s[16:19], s33 offen offset:1024 sc1
v_mfma_f32_16x16x32_bf16 a[84:87], a[164:167], a[196:199], a[84:87]
ds_read_b64_tr_b16 a[156:157], v4 offset:32768
s_waitcnt lgkmcnt(7)
v_mfma_f32_16x16x32_bf16 v[112:115], a[168:171], a[192:195], v[112:115]
ds_read_b64_tr_b16 a[158:159], v4 offset:41984
v_mfma_f32_16x16x32_bf16 v[116:119], a[168:171], a[196:199], v[116:119]
ds_read_b64_tr_b16 a[160:161], v3 offset:15360
v_mfma_f32_16x16x32_bf16 a[88:91], a[172:175], a[192:195], a[88:91]
ds_read_b64_tr_b16 a[162:163], v3 offset:24576
s_add_u32 m0, s92, 8192
v_mfma_f32_16x16x32_bf16 a[92:95], a[172:175], a[196:199], a[92:95]
ds_read_b64_tr_b16 a[164:165], v3 offset:33792
s_waitcnt lgkmcnt(7)
v_mfma_f32_16x16x32_bf16 v[120:123], a[144:147], a[192:195], v[120:123]
ds_read_b64_tr_b16 a[166:167], v3 offset:43008
s_add_u32 s32, s93, 2359808
v_mfma_f32_16x16x32_bf16 v[124:127], a[144:147], a[196:199], v[124:127]
buffer_load_dwordx4 v8, s[88:91], s32 offen lds
ds_read_b64_tr_b16 a[168:169], v4 offset:15360
v_mfma_f32_16x16x32_bf16 a[96:99], a[148:151], a[192:195], a[96:99]
ds_read_b64_tr_b16 a[170:171], v4 offset:24576
v_mfma_f32_16x16x32_bf16 a[100:103], a[148:151], a[196:199], a[100:103]
ds_read_b64_tr_b16 a[172:173], v4 offset:33792
s_waitcnt lgkmcnt(7)
v_mfma_f32_16x16x32_bf16 v[128:131], a[152:155], a[192:195], v[128:131]
ds_read_b64_tr_b16 a[174:175], v4 offset:43008
v_mfma_f32_16x16x32_bf16 v[132:135], a[152:155], a[196:199], v[132:135]
ds_read_b64_tr_b16 a[144:145], v3 offset:16384
v_mfma_f32_16x16x32_bf16 a[104:107], a[156:159], a[192:195], a[104:107]
ds_read_b64_tr_b16 a[146:147], v3 offset:25600
v_mfma_f32_16x16x32_bf16 a[108:111], a[156:159], a[196:199], a[108:111]
ds_read_b64_tr_b16 a[148:149], v3 offset:34816
s_waitcnt lgkmcnt(7)
v_mfma_f32_16x16x32_bf16 v[136:139], a[160:163], a[192:195], v[136:139]
ds_read_b64_tr_b16 a[150:151], v3 offset:44032
v_mfma_f32_16x16x32_bf16 v[140:143], a[160:163], a[196:199], v[140:143]
ds_read_b64_tr_b16 a[152:153], v4 offset:16384
v_mfma_f32_16x16x32_bf16 a[112:115], a[164:167], a[192:195], a[112:115]
ds_read_b64_tr_b16 a[154:155], v4 offset:25600
v_mfma_f32_16x16x32_bf16 a[116:119], a[164:167], a[196:199], a[116:119]
ds_read_b64_tr_b16 a[156:157], v4 offset:34816
s_waitcnt lgkmcnt(7)
v_mfma_f32_16x16x32_bf16 v[144:147], a[168:171], a[192:195], v[144:147]
ds_read_b64_tr_b16 a[158:159], v4 offset:44032
v_mfma_f32_16x16x32_bf16 v[148:151], a[168:171], a[196:199], v[148:151]
s_waitcnt vmcnt(11)
s_barrier
ds_read_b64_tr_b16 a[160:161], v3 offset:45056
v_mfma_f32_16x16x32_bf16 a[120:123], a[172:175], a[192:195], a[120:123]
ds_read_b64_tr_b16 a[162:163], v3 offset:54272
s_add_u32 m0, s92, 36864
v_mfma_f32_16x16x32_bf16 a[124:127], a[172:175], a[196:199], a[124:127]
ds_read_b64_tr_b16 a[164:165], v3 offset:63488
s_waitcnt lgkmcnt(7)
v_mfma_f32_16x16x32_bf16 v[152:155], a[144:147], a[192:195], v[152:155]
ds_read_b64_tr_b16 a[166:167], v5 offset:7168
s_add_u32 s30, s93, 2654208
v_mfma_f32_16x16x32_bf16 v[156:159], a[144:147], a[196:199], v[156:159]
buffer_load_dwordx4 v8, s[88:91], s30 offen lds
ds_read_b64_tr_b16 a[168:169], v4 offset:45056
v_mfma_f32_16x16x32_bf16 a[128:131], a[148:151], a[192:195], a[128:131]
ds_read_b64_tr_b16 a[170:171], v4 offset:54272
v_mfma_f32_16x16x32_bf16 a[132:135], a[148:151], a[196:199], a[132:135]
ds_read_b64_tr_b16 a[172:173], v4 offset:63488
s_waitcnt lgkmcnt(7)
v_mfma_f32_16x16x32_bf16 v[160:163], a[152:155], a[192:195], v[160:163]
ds_read_b64_tr_b16 a[174:175], v6 offset:7168
v_mfma_f32_16x16x32_bf16 v[164:167], a[152:155], a[196:199], v[164:167]
ds_read_b64_tr_b16 a[144:145], v3 offset:46080
buffer_load_dwordx4 v9, s[88:91], s30 offen offset:1024 lds
v_mfma_f32_16x16x32_bf16 a[136:139], a[156:159], a[192:195], a[136:139]
ds_read_b64_tr_b16 a[146:147], v3 offset:55296
v_mfma_f32_16x16x32_bf16 a[140:143], a[156:159], a[196:199], a[140:143]
ds_read_b64_tr_b16 a[148:149], v3 offset:64512
s_waitcnt lgkmcnt(7)
v_mfma_f32_16x16x32_bf16 v[24:27], a[160:163], a[200:203], v[24:27]
ds_read_b64_tr_b16 a[150:151], v5 offset:8192
v_mfma_f32_16x16x32_bf16 v[28:31], a[160:163], a[204:207], v[28:31]
ds_read_b64_tr_b16 a[152:153], v4 offset:46080
v_mfma_f32_16x16x32_bf16 a[0:3], a[164:167], a[200:203], a[0:3]
ds_read_b64_tr_b16 a[154:155], v4 offset:55296
v_mfma_f32_16x16x32_bf16 a[4:7], a[164:167], a[204:207], a[4:7]
ds_read_b64_tr_b16 a[156:157], v4 offset:64512
s_waitcnt lgkmcnt(7)
v_mfma_f32_16x16x32_bf16 v[32:35], a[168:171], a[200:203], v[32:35]
ds_read_b64_tr_b16 a[158:159], v6 offset:8192
buffer_load_dwordx4 v10, s[88:91], s30 offen offset:2048 lds
v_mfma_f32_16x16x32_bf16 v[36:39], a[168:171], a[204:207], v[36:39]
ds_read_b64_tr_b16 a[160:161], v3 offset:47104
v_mfma_f32_16x16x32_bf16 a[8:11], a[172:175], a[200:203], a[8:11]
ds_read_b64_tr_b16 a[162:163], v3 offset:56320
v_mfma_f32_16x16x32_bf16 a[12:15], a[172:175], a[204:207], a[12:15]
ds_read_b64_tr_b16 a[164:165], v5
s_waitcnt lgkmcnt(7)
v_mfma_f32_16x16x32_bf16 v[40:43], a[144:147], a[200:203], v[40:43]
ds_read_b64_tr_b16 a[166:167], v5 offset:9216
v_mfma_f32_16x16x32_bf16 v[44:47], a[144:147], a[204:207], v[44:47]
ds_read_b64_tr_b16 a[168:169], v4 offset:47104
v_mfma_f32_16x16x32_bf16 a[16:19], a[148:151], a[200:203], a[16:19]
ds_read_b64_tr_b16 a[170:171], v4 offset:56320
v_mfma_f32_16x16x32_bf16 a[20:23], a[148:151], a[204:207], a[20:23]
ds_read_b64_tr_b16 a[172:173], v6
s_waitcnt lgkmcnt(7)
v_mfma_f32_16x16x32_bf16 v[48:51], a[152:155], a[200:203], v[48:51]
ds_read_b64_tr_b16 a[174:175], v6 offset:9216
buffer_load_dwordx4 v11, s[88:91], s30 offen offset:3072 lds
v_mfma_f32_16x16x32_bf16 v[52:55], a[152:155], a[204:207], v[52:55]
ds_read_b64_tr_b16 a[144:145], v3 offset:48128
v_mfma_f32_16x16x32_bf16 a[24:27], a[156:159], a[200:203], a[24:27]
ds_read_b64_tr_b16 a[146:147], v3 offset:57344
v_mfma_f32_16x16x32_bf16 a[28:31], a[156:159], a[204:207], a[28:31]
ds_read_b64_tr_b16 a[148:149], v5 offset:1024
s_waitcnt lgkmcnt(7)
v_mfma_f32_16x16x32_bf16 v[56:59], a[160:163], a[200:203], v[56:59]
ds_read_b64_tr_b16 a[150:151], v5 offset:10240
v_mfma_f32_16x16x32_bf16 v[60:63], a[160:163], a[204:207], v[60:63]
ds_read_b64_tr_b16 a[152:153], v4 offset:48128
v_mfma_f32_16x16x32_bf16 a[32:35], a[164:167], a[200:203], a[32:35]
ds_read_b64_tr_b16 a[154:155], v4 offset:57344
s_add_u32 m0, s92, 40960
v_mfma_f32_16x16x32_bf16 a[36:39], a[164:167], a[204:207], a[36:39]
ds_read_b64_tr_b16 a[156:157], v6 offset:1024
s_waitcnt lgkmcnt(7)
v_mfma_f32_16x16x32_bf16 v[64:67], a[168:171], a[200:203], v[64:67]
ds_read_b64_tr_b16 a[158:159], v6 offset:10240
s_add_u32 s31, s93, 2654464
v_mfma_f32_16x16x32_bf16 v[68:71], a[168:171], a[204:207], v[68:71]
buffer_load_dwordx4 v8, s[88:91], s31 offen lds
ds_read_b64_tr_b16 a[160:161], v3 offset:49152
v_mfma_f32_16x16x32_bf16 a[40:43], a[172:175], a[200:203], a[40:43]
ds_read_b64_tr_b16 a[162:163], v3 offset:58368
v_mfma_f32_16x16x32_bf16 a[44:47], a[172:175], a[204:207], a[44:47]
ds_read_b64_tr_b16 a[164:165], v5 offset:2048
s_waitcnt lgkmcnt(7)
v_mfma_f32_16x16x32_bf16 v[72:75], a[144:147], a[200:203], v[72:75]
ds_read_b64_tr_b16 a[166:167], v5 offset:11264
v_mfma_f32_16x16x32_bf16 v[76:79], a[144:147], a[204:207], v[76:79]
ds_read_b64_tr_b16 a[168:169], v4 offset:49152
buffer_load_dwordx4 v9, s[88:91], s31 offen offset:1024 lds
v_mfma_f32_16x16x32_bf16 a[48:51], a[148:151], a[200:203], a[48:51]
ds_read_b64_tr_b16 a[170:171], v4 offset:58368
v_mfma_f32_16x16x32_bf16 a[52:55], a[148:151], a[204:207], a[52:55]
ds_read_b64_tr_b16 a[172:173], v6 offset:2048
s_waitcnt lgkmcnt(7)
v_mfma_f32_16x16x32_bf16 v[80:83], a[152:155], a[200:203], v[80:83]
ds_read_b64_tr_b16 a[174:175], v6 offset:11264
v_mfma_f32_16x16x32_bf16 v[84:87], a[152:155], a[204:207], v[84:87]
ds_read_b64_tr_b16 a[144:145], v3 offset:50176
v_mfma_f32_16x16x32_bf16 a[56:59], a[156:159], a[200:203], a[56:59]
ds_read_b64_tr_b16 a[146:147], v3 offset:59392
v_mfma_f32_16x16x32_bf16 a[60:63], a[156:159], a[204:207], a[60:63]
ds_read_b64_tr_b16 a[148:149], v5 offset:3072
s_waitcnt lgkmcnt(7)
v_mfma_f32_16x16x32_bf16 v[88:91], a[160:163], a[200:203], v[88:91]
ds_read_b64_tr_b16 a[150:151], v5 offset:12288
buffer_load_dwordx4 v10, s[88:91], s31 offen offset:2048 lds
v_mfma_f32_16x16x32_bf16 v[92:95], a[160:163], a[204:207], v[92:95]
ds_read_b64_tr_b16 a[152:153], v4 offset:50176
v_mfma_f32_16x16x32_bf16 a[64:67], a[164:167], a[200:203], a[64:67]
ds_read_b64_tr_b16 a[154:155], v4 offset:59392
v_mfma_f32_16x16x32_bf16 a[68:71], a[164:167], a[204:207], a[68:71]
ds_read_b64_tr_b16 a[156:157], v6 offset:3072
s_waitcnt lgkmcnt(7)
v_mfma_f32_16x16x32_bf16 v[96:99], a[168:171], a[200:203], v[96:99]
ds_read_b64_tr_b16 a[158:159], v6 offset:12288
v_mfma_f32_16x16x32_bf16 v[100:103], a[168:171], a[204:207], v[100:103]
ds_read_b64_tr_b16 a[160:161], v3 offset:51200
v_mfma_f32_16x16x32_bf16 a[72:75], a[172:175], a[200:203], a[72:75]
ds_read_b64_tr_b16 a[162:163], v3 offset:60416
v_mfma_f32_16x16x32_bf16 a[76:79], a[172:175], a[204:207], a[76:79]
ds_read_b64_tr_b16 a[164:165], v5 offset:4096
s_waitcnt lgkmcnt(7)
v_mfma_f32_16x16x32_bf16 v[104:107], a[144:147], a[200:203], v[104:107]
ds_read_b64_tr_b16 a[166:167], v5 offset:13312
buffer_load_dwordx4 v11, s[88:91], s31 offen offset:3072 lds
v_mfma_f32_16x16x32_bf16 v[108:111], a[144:147], a[204:207], v[108:111]
ds_read_b64_tr_b16 a[168:169], v4 offset:51200
buffer_load_dwordx4 a[192:195], v7, s[16:19], s33 offen offset:2048 sc1
v_mfma_f32_16x16x32_bf16 a[80:83], a[148:151], a[200:203], a[80:83]
ds_read_b64_tr_b16 a[170:171], v4 offset:60416
buffer_load_dwordx4 a[196:199], v16, s[16:19], s33 offen offset:2048 sc1
v_mfma_f32_16x16x32_bf16 a[84:87], a[148:151], a[204:207], a[84:87]
ds_read_b64_tr_b16 a[172:173], v6 offset:4096
s_waitcnt lgkmcnt(7)
v_mfma_f32_16x16x32_bf16 v[112:115], a[152:155], a[200:203], v[112:115]
ds_read_b64_tr_b16 a[174:175], v6 offset:13312
v_mfma_f32_16x16x32_bf16 v[116:119], a[152:155], a[204:207], v[116:119]
ds_read_b64_tr_b16 a[144:145], v3 offset:52224
v_mfma_f32_16x16x32_bf16 a[88:91], a[156:159], a[200:203], a[88:91]
ds_read_b64_tr_b16 a[146:147], v3 offset:61440
s_add_u32 m0, s92, 45056
v_mfma_f32_16x16x32_bf16 a[92:95], a[156:159], a[204:207], a[92:95]
ds_read_b64_tr_b16 a[148:149], v5 offset:5120
s_waitcnt lgkmcnt(7)
v_mfma_f32_16x16x32_bf16 v[120:123], a[160:163], a[200:203], v[120:123]
ds_read_b64_tr_b16 a[150:151], v5 offset:14336
s_add_u32 s32, s93, 2654720
v_mfma_f32_16x16x32_bf16 v[124:127], a[160:163], a[204:207], v[124:127]
buffer_load_dwordx4 v8, s[88:91], s32 offen lds
ds_read_b64_tr_b16 a[152:153], v4 offset:52224
v_mfma_f32_16x16x32_bf16 a[96:99], a[164:167], a[200:203], a[96:99]
ds_read_b64_tr_b16 a[154:155], v4 offset:61440
v_mfma_f32_16x16x32_bf16 a[100:103], a[164:167], a[204:207], a[100:103]
ds_read_b64_tr_b16 a[156:157], v6 offset:5120
s_waitcnt lgkmcnt(7)
v_mfma_f32_16x16x32_bf16 v[128:131], a[168:171], a[200:203], v[128:131]
ds_read_b64_tr_b16 a[158:159], v6 offset:14336
v_mfma_f32_16x16x32_bf16 v[132:135], a[168:171], a[204:207], v[132:135]
ds_read_b64_tr_b16 a[160:161], v3 offset:53248
v_mfma_f32_16x16x32_bf16 a[104:107], a[172:175], a[200:203], a[104:107]
ds_read_b64_tr_b16 a[162:163], v3 offset:62464
v_mfma_f32_16x16x32_bf16 a[108:111], a[172:175], a[204:207], a[108:111]
ds_read_b64_tr_b16 a[164:165], v5 offset:6144
s_waitcnt lgkmcnt(7)
v_mfma_f32_16x16x32_bf16 v[136:139], a[144:147], a[200:203], v[136:139]
ds_read_b64_tr_b16 a[166:167], v5 offset:15360
v_mfma_f32_16x16x32_bf16 v[140:143], a[144:147], a[204:207], v[140:143]
ds_read_b64_tr_b16 a[168:169], v4 offset:53248
v_mfma_f32_16x16x32_bf16 a[112:115], a[148:151], a[200:203], a[112:115]
ds_read_b64_tr_b16 a[170:171], v4 offset:62464
v_mfma_f32_16x16x32_bf16 a[116:119], a[148:151], a[204:207], a[116:119]
ds_read_b64_tr_b16 a[172:173], v6 offset:6144
s_waitcnt lgkmcnt(7)
v_mfma_f32_16x16x32_bf16 v[144:147], a[152:155], a[200:203], v[144:147]
ds_read_b64_tr_b16 a[174:175], v6 offset:15360
v_mfma_f32_16x16x32_bf16 v[148:151], a[152:155], a[204:207], v[148:151]
s_waitcnt vmcnt(11)
s_barrier
ds_read_b64_tr_b16 a[144:145], v1
v_mfma_f32_16x16x32_bf16 a[120:123], a[156:159], a[200:203], a[120:123]
ds_read_b64_tr_b16 a[146:147], v1 offset:9216
s_add_u32 m0, s92, 73728
v_mfma_f32_16x16x32_bf16 a[124:127], a[156:159], a[204:207], a[124:127]
ds_read_b64_tr_b16 a[148:149], v1 offset:18432
s_waitcnt lgkmcnt(7)
v_mfma_f32_16x16x32_bf16 v[152:155], a[160:163], a[200:203], v[152:155]
ds_read_b64_tr_b16 a[150:151], v1 offset:27648
s_add_u32 s30, s93, 2949120
v_mfma_f32_16x16x32_bf16 v[156:159], a[160:163], a[204:207], v[156:159]
buffer_load_dwordx4 v8, s[88:91], s30 offen lds
ds_read_b64_tr_b16 a[152:153], v2
v_mfma_f32_16x16x32_bf16 a[128:131], a[164:167], a[200:203], a[128:131]
ds_read_b64_tr_b16 a[154:155], v2 offset:9216
v_mfma_f32_16x16x32_bf16 a[132:135], a[164:167], a[204:207], a[132:135]
ds_read_b64_tr_b16 a[156:157], v2 offset:18432
s_waitcnt lgkmcnt(7)
v_mfma_f32_16x16x32_bf16 v[160:163], a[168:171], a[200:203], v[160:163]
ds_read_b64_tr_b16 a[158:159], v2 offset:27648
v_mfma_f32_16x16x32_bf16 v[164:167], a[168:171], a[204:207], v[164:167]
ds_read_b64_tr_b16 a[160:161], v1 offset:1024
buffer_load_dwordx4 v9, s[88:91], s30 offen offset:1024 lds
v_mfma_f32_16x16x32_bf16 a[136:139], a[172:175], a[200:203], a[136:139]
ds_read_b64_tr_b16 a[162:163], v1 offset:10240
v_mfma_f32_16x16x32_bf16 a[140:143], a[172:175], a[204:207], a[140:143]
ds_read_b64_tr_b16 a[164:165], v1 offset:19456
s_waitcnt lgkmcnt(7)
v_mfma_f32_16x16x32_bf16 v[24:27], a[144:147], a[176:179], v[24:27]
ds_read_b64_tr_b16 a[166:167], v1 offset:28672
v_mfma_f32_16x16x32_bf16 v[28:31], a[144:147], a[180:183], v[28:31]
ds_read_b64_tr_b16 a[168:169], v2 offset:1024
v_mfma_f32_16x16x32_bf16 a[0:3], a[148:151], a[176:179], a[0:3]
ds_read_b64_tr_b16 a[170:171], v2 offset:10240
v_mfma_f32_16x16x32_bf16 a[4:7], a[148:151], a[180:183], a[4:7]
ds_read_b64_tr_b16 a[172:173], v2 offset:19456
s_waitcnt lgkmcnt(7)
v_mfma_f32_16x16x32_bf16 v[32:35], a[152:155], a[176:179], v[32:35]
ds_read_b64_tr_b16 a[174:175], v2 offset:28672
buffer_load_dwordx4 v10, s[88:91], s30 offen offset:2048 lds
v_mfma_f32_16x16x32_bf16 v[36:39], a[152:155], a[180:183], v[36:39]
ds_read_b64_tr_b16 a[144:145], v1 offset:2048
v_mfma_f32_16x16x32_bf16 a[8:11], a[156:159], a[176:179], a[8:11]
ds_read_b64_tr_b16 a[146:147], v1 offset:11264
v_mfma_f32_16x16x32_bf16 a[12:15], a[156:159], a[180:183], a[12:15]
ds_read_b64_tr_b16 a[148:149], v1 offset:20480
s_waitcnt lgkmcnt(7)
v_mfma_f32_16x16x32_bf16 v[40:43], a[160:163], a[176:179], v[40:43]
ds_read_b64_tr_b16 a[150:151], v1 offset:29696
v_mfma_f32_16x16x32_bf16 v[44:47], a[160:163], a[180:183], v[44:47]
ds_read_b64_tr_b16 a[152:153], v2 offset:2048
v_mfma_f32_16x16x32_bf16 a[16:19], a[164:167], a[176:179], a[16:19]
ds_read_b64_tr_b16 a[154:155], v2 offset:11264
v_mfma_f32_16x16x32_bf16 a[20:23], a[164:167], a[180:183], a[20:23]
ds_read_b64_tr_b16 a[156:157], v2 offset:20480
s_waitcnt lgkmcnt(7)
v_mfma_f32_16x16x32_bf16 v[48:51], a[168:171], a[176:179], v[48:51]
ds_read_b64_tr_b16 a[158:159], v2 offset:29696
buffer_load_dwordx4 v11, s[88:91], s30 offen offset:3072 lds
v_mfma_f32_16x16x32_bf16 v[52:55], a[168:171], a[180:183], v[52:55]
ds_read_b64_tr_b16 a[160:161], v1 offset:3072
v_mfma_f32_16x16x32_bf16 a[24:27], a[172:175], a[176:179], a[24:27]
ds_read_b64_tr_b16 a[162:163], v1 offset:12288
v_mfma_f32_16x16x32_bf16 a[28:31], a[172:175], a[180:183], a[28:31]
ds_read_b64_tr_b16 a[164:165], v1 offset:21504
s_waitcnt lgkmcnt(7)
v_mfma_f32_16x16x32_bf16 v[56:59], a[144:147], a[176:179], v[56:59]
ds_read_b64_tr_b16 a[166:167], v1 offset:30720
v_mfma_f32_16x16x32_bf16 v[60:63], a[144:147], a[180:183], v[60:63]
ds_read_b64_tr_b16 a[168:169], v2 offset:3072
v_mfma_f32_16x16x32_bf16 a[32:35], a[148:151], a[176:179], a[32:35]
ds_read_b64_tr_b16 a[170:171], v2 offset:12288
s_add_u32 m0, s92, 77824
v_mfma_f32_16x16x32_bf16 a[36:39], a[148:151], a[180:183], a[36:39]
ds_read_b64_tr_b16 a[172:173], v2 offset:21504
s_waitcnt lgkmcnt(7)
v_mfma_f32_16x16x32_bf16 v[64:67], a[152:155], a[176:179], v[64:67]
ds_read_b64_tr_b16 a[174:175], v2 offset:30720
s_add_u32 s31, s93, 2949376
v_mfma_f32_16x16x32_bf16 v[68:71], a[152:155], a[180:183], v[68:71]
buffer_load_dwordx4 v8, s[88:91], s31 offen lds
ds_read_b64_tr_b16 a[144:145], v1 offset:4096
v_mfma_f32_16x16x32_bf16 a[40:43], a[156:159], a[176:179], a[40:43]
ds_read_b64_tr_b16 a[146:147], v1 offset:13312
v_mfma_f32_16x16x32_bf16 a[44:47], a[156:159], a[180:183], a[44:47]
ds_read_b64_tr_b16 a[148:149], v1 offset:22528
s_waitcnt lgkmcnt(7)
v_mfma_f32_16x16x32_bf16 v[72:75], a[160:163], a[176:179], v[72:75]
ds_read_b64_tr_b16 a[150:151], v1 offset:31744
v_mfma_f32_16x16x32_bf16 v[76:79], a[160:163], a[180:183], v[76:79]
ds_read_b64_tr_b16 a[152:153], v2 offset:4096
buffer_load_dwordx4 v9, s[88:91], s31 offen offset:1024 lds
v_mfma_f32_16x16x32_bf16 a[48:51], a[164:167], a[176:179], a[48:51]
ds_read_b64_tr_b16 a[154:155], v2 offset:13312
v_mfma_f32_16x16x32_bf16 a[52:55], a[164:167], a[180:183], a[52:55]
ds_read_b64_tr_b16 a[156:157], v2 offset:22528
s_waitcnt lgkmcnt(7)
v_mfma_f32_16x16x32_bf16 v[80:83], a[168:171], a[176:179], v[80:83]
ds_read_b64_tr_b16 a[158:159], v2 offset:31744
v_mfma_f32_16x16x32_bf16 v[84:87], a[168:171], a[180:183], v[84:87]
ds_read_b64_tr_b16 a[160:161], v1 offset:5120
v_mfma_f32_16x16x32_bf16 a[56:59], a[172:175], a[176:179], a[56:59]
ds_read_b64_tr_b16 a[162:163], v1 offset:14336
v_mfma_f32_16x16x32_bf16 a[60:63], a[172:175], a[180:183], a[60:63]
ds_read_b64_tr_b16 a[164:165], v1 offset:23552
s_waitcnt lgkmcnt(7)
v_mfma_f32_16x16x32_bf16 v[88:91], a[144:147], a[176:179], v[88:91]
ds_read_b64_tr_b16 a[166:167], v1 offset:32768
buffer_load_dwordx4 v10, s[88:91], s31 offen offset:2048 lds
v_mfma_f32_16x16x32_bf16 v[92:95], a[144:147], a[180:183], v[92:95]
ds_read_b64_tr_b16 a[168:169], v2 offset:5120
v_mfma_f32_16x16x32_bf16 a[64:67], a[148:151], a[176:179], a[64:67]
ds_read_b64_tr_b16 a[170:171], v2 offset:14336
v_mfma_f32_16x16x32_bf16 a[68:71], a[148:151], a[180:183], a[68:71]
ds_read_b64_tr_b16 a[172:173], v2 offset:23552
s_waitcnt lgkmcnt(7)
v_mfma_f32_16x16x32_bf16 v[96:99], a[152:155], a[176:179], v[96:99]
ds_read_b64_tr_b16 a[174:175], v2 offset:32768
v_mfma_f32_16x16x32_bf16 v[100:103], a[152:155], a[180:183], v[100:103]
ds_read_b64_tr_b16 a[144:145], v1 offset:6144
v_mfma_f32_16x16x32_bf16 a[72:75], a[156:159], a[176:179], a[72:75]
ds_read_b64_tr_b16 a[146:147], v1 offset:15360
v_mfma_f32_16x16x32_bf16 a[76:79], a[156:159], a[180:183], a[76:79]
ds_read_b64_tr_b16 a[148:149], v1 offset:24576
s_waitcnt lgkmcnt(7)
v_mfma_f32_16x16x32_bf16 v[104:107], a[160:163], a[176:179], v[104:107]
ds_read_b64_tr_b16 a[150:151], v1 offset:33792
buffer_load_dwordx4 v11, s[88:91], s31 offen offset:3072 lds
v_mfma_f32_16x16x32_bf16 v[108:111], a[160:163], a[180:183], v[108:111]
ds_read_b64_tr_b16 a[152:153], v2 offset:6144
buffer_load_dwordx4 a[200:203], v7, s[16:19], s33 offen offset:3072 sc1
v_mfma_f32_16x16x32_bf16 a[80:83], a[164:167], a[176:179], a[80:83]
ds_read_b64_tr_b16 a[154:155], v2 offset:15360
buffer_load_dwordx4 a[204:207], v16, s[16:19], s33 offen offset:3072 sc1
v_mfma_f32_16x16x32_bf16 a[84:87], a[164:167], a[180:183], a[84:87]
ds_read_b64_tr_b16 a[156:157], v2 offset:24576
s_waitcnt lgkmcnt(7)
v_mfma_f32_16x16x32_bf16 v[112:115], a[168:171], a[176:179], v[112:115]
ds_read_b64_tr_b16 a[158:159], v2 offset:33792
v_mfma_f32_16x16x32_bf16 v[116:119], a[168:171], a[180:183], v[116:119]
ds_read_b64_tr_b16 a[160:161], v1 offset:7168
v_mfma_f32_16x16x32_bf16 a[88:91], a[172:175], a[176:179], a[88:91]
ds_read_b64_tr_b16 a[162:163], v1 offset:16384
s_add_u32 m0, s92, 81920
v_mfma_f32_16x16x32_bf16 a[92:95], a[172:175], a[180:183], a[92:95]
ds_read_b64_tr_b16 a[164:165], v1 offset:25600
s_waitcnt lgkmcnt(7)
v_mfma_f32_16x16x32_bf16 v[120:123], a[144:147], a[176:179], v[120:123]
ds_read_b64_tr_b16 a[166:167], v1 offset:34816
s_add_u32 s32, s93, 2949632
v_mfma_f32_16x16x32_bf16 v[124:127], a[144:147], a[180:183], v[124:127]
buffer_load_dwordx4 v8, s[88:91], s32 offen lds
ds_read_b64_tr_b16 a[168:169], v2 offset:7168
v_mfma_f32_16x16x32_bf16 a[96:99], a[148:151], a[176:179], a[96:99]
ds_read_b64_tr_b16 a[170:171], v2 offset:16384
v_mfma_f32_16x16x32_bf16 a[100:103], a[148:151], a[180:183], a[100:103]
ds_read_b64_tr_b16 a[172:173], v2 offset:25600
s_waitcnt lgkmcnt(7)
v_mfma_f32_16x16x32_bf16 v[128:131], a[152:155], a[176:179], v[128:131]
ds_read_b64_tr_b16 a[174:175], v2 offset:34816
v_mfma_f32_16x16x32_bf16 v[132:135], a[152:155], a[180:183], v[132:135]
ds_read_b64_tr_b16 a[144:145], v1 offset:8192
v_mfma_f32_16x16x32_bf16 a[104:107], a[156:159], a[176:179], a[104:107]
ds_read_b64_tr_b16 a[146:147], v1 offset:17408
v_mfma_f32_16x16x32_bf16 a[108:111], a[156:159], a[180:183], a[108:111]
ds_read_b64_tr_b16 a[148:149], v1 offset:26624
s_waitcnt lgkmcnt(7)
v_mfma_f32_16x16x32_bf16 v[136:139], a[160:163], a[176:179], v[136:139]
ds_read_b64_tr_b16 a[150:151], v1 offset:35840
v_mfma_f32_16x16x32_bf16 v[140:143], a[160:163], a[180:183], v[140:143]
ds_read_b64_tr_b16 a[152:153], v2 offset:8192
v_mfma_f32_16x16x32_bf16 a[112:115], a[164:167], a[176:179], a[112:115]
ds_read_b64_tr_b16 a[154:155], v2 offset:17408
v_mfma_f32_16x16x32_bf16 a[116:119], a[164:167], a[180:183], a[116:119]
ds_read_b64_tr_b16 a[156:157], v2 offset:26624
s_waitcnt lgkmcnt(7)
v_mfma_f32_16x16x32_bf16 v[144:147], a[168:171], a[176:179], v[144:147]
ds_read_b64_tr_b16 a[158:159], v2 offset:35840
v_mfma_f32_16x16x32_bf16 v[148:151], a[168:171], a[180:183], v[148:151]
s_waitcnt vmcnt(11)
s_barrier
ds_read_b64_tr_b16 a[160:161], v1 offset:36864
v_mfma_f32_16x16x32_bf16 a[120:123], a[172:175], a[176:179], a[120:123]
ds_read_b64_tr_b16 a[162:163], v1 offset:46080
s_add_u32 m0, s92, 110592
v_mfma_f32_16x16x32_bf16 a[124:127], a[172:175], a[180:183], a[124:127]
ds_read_b64_tr_b16 a[164:165], v1 offset:55296
s_waitcnt lgkmcnt(7)
v_mfma_f32_16x16x32_bf16 v[152:155], a[144:147], a[176:179], v[152:155]
ds_read_b64_tr_b16 a[166:167], v1 offset:64512
s_add_u32 s30, s93, 3244032
v_mfma_f32_16x16x32_bf16 v[156:159], a[144:147], a[180:183], v[156:159]
buffer_load_dwordx4 v8, s[88:91], s30 offen lds
ds_read_b64_tr_b16 a[168:169], v2 offset:36864
v_mfma_f32_16x16x32_bf16 a[128:131], a[148:151], a[176:179], a[128:131]
ds_read_b64_tr_b16 a[170:171], v2 offset:46080
v_mfma_f32_16x16x32_bf16 a[132:135], a[148:151], a[180:183], a[132:135]
ds_read_b64_tr_b16 a[172:173], v2 offset:55296
s_waitcnt lgkmcnt(7)
v_mfma_f32_16x16x32_bf16 v[160:163], a[152:155], a[176:179], v[160:163]
ds_read_b64_tr_b16 a[174:175], v2 offset:64512
v_mfma_f32_16x16x32_bf16 v[164:167], a[152:155], a[180:183], v[164:167]
ds_read_b64_tr_b16 a[144:145], v1 offset:37888
buffer_load_dwordx4 v9, s[88:91], s30 offen offset:1024 lds
v_mfma_f32_16x16x32_bf16 a[136:139], a[156:159], a[176:179], a[136:139]
ds_read_b64_tr_b16 a[146:147], v1 offset:47104
v_mfma_f32_16x16x32_bf16 a[140:143], a[156:159], a[180:183], a[140:143]
ds_read_b64_tr_b16 a[148:149], v1 offset:56320
s_waitcnt lgkmcnt(7)
v_mfma_f32_16x16x32_bf16 v[24:27], a[160:163], a[184:187], v[24:27]
ds_read_b64_tr_b16 a[150:151], v3
v_mfma_f32_16x16x32_bf16 v[28:31], a[160:163], a[188:191], v[28:31]
ds_read_b64_tr_b16 a[152:153], v2 offset:37888
v_mfma_f32_16x16x32_bf16 a[0:3], a[164:167], a[184:187], a[0:3]
ds_read_b64_tr_b16 a[154:155], v2 offset:47104
v_mfma_f32_16x16x32_bf16 a[4:7], a[164:167], a[188:191], a[4:7]
ds_read_b64_tr_b16 a[156:157], v2 offset:56320
s_waitcnt lgkmcnt(7)
v_mfma_f32_16x16x32_bf16 v[32:35], a[168:171], a[184:187], v[32:35]
ds_read_b64_tr_b16 a[158:159], v4
buffer_load_dwordx4 v10, s[88:91], s30 offen offset:2048 lds
v_mfma_f32_16x16x32_bf16 v[36:39], a[168:171], a[188:191], v[36:39]
ds_read_b64_tr_b16 a[160:161], v1 offset:38912
v_mfma_f32_16x16x32_bf16 a[8:11], a[172:175], a[184:187], a[8:11]
ds_read_b64_tr_b16 a[162:163], v1 offset:48128
v_mfma_f32_16x16x32_bf16 a[12:15], a[172:175], a[188:191], a[12:15]
ds_read_b64_tr_b16 a[164:165], v1 offset:57344
s_waitcnt lgkmcnt(7)
v_mfma_f32_16x16x32_bf16 v[40:43], a[144:147], a[184:187], v[40:43]
ds_read_b64_tr_b16 a[166:167], v3 offset:1024
v_mfma_f32_16x16x32_bf16 v[44:47], a[144:147], a[188:191], v[44:47]
ds_read_b64_tr_b16 a[168:169], v2 offset:38912
v_mfma_f32_16x16x32_bf16 a[16:19], a[148:151], a[184:187], a[16:19]
ds_read_b64_tr_b16 a[170:171], v2 offset:48128
v_mfma_f32_16x16x32_bf16 a[20:23], a[148:151], a[188:191], a[20:23]
ds_read_b64_tr_b16 a[172:173], v2 offset:57344
s_waitcnt lgkmcnt(7)
v_mfma_f32_16x16x32_bf16 v[48:51], a[152:155], a[184:187], v[48:51]
ds_read_b64_tr_b16 a[174:175], v4 offset:1024
buffer_load_dwordx4 v11, s[88:91], s30 offen offset:3072 lds
v_mfma_f32_16x16x32_bf16 v[52:55], a[152:155], a[188:191], v[52:55]
ds_read_b64_tr_b16 a[144:145], v1 offset:39936
v_mfma_f32_16x16x32_bf16 a[24:27], a[156:159], a[184:187], a[24:27]
ds_read_b64_tr_b16 a[146:147], v1 offset:49152
v_mfma_f32_16x16x32_bf16 a[28:31], a[156:159], a[188:191], a[28:31]
ds_read_b64_tr_b16 a[148:149], v1 offset:58368
s_waitcnt lgkmcnt(7)
v_mfma_f32_16x16x32_bf16 v[56:59], a[160:163], a[184:187], v[56:59]
ds_read_b64_tr_b16 a[150:151], v3 offset:2048
v_mfma_f32_16x16x32_bf16 v[60:63], a[160:163], a[188:191], v[60:63]
ds_read_b64_tr_b16 a[152:153], v2 offset:39936
v_mfma_f32_16x16x32_bf16 a[32:35], a[164:167], a[184:187], a[32:35]
ds_read_b64_tr_b16 a[154:155], v2 offset:49152
s_add_u32 m0, s92, 114688
v_mfma_f32_16x16x32_bf16 a[36:39], a[164:167], a[188:191], a[36:39]
ds_read_b64_tr_b16 a[156:157], v2 offset:58368
s_waitcnt lgkmcnt(7)
v_mfma_f32_16x16x32_bf16 v[64:67], a[168:171], a[184:187], v[64:67]
ds_read_b64_tr_b16 a[158:159], v4 offset:2048
s_add_u32 s31, s93, 3244288
v_mfma_f32_16x16x32_bf16 v[68:71], a[168:171], a[188:191], v[68:71]
buffer_load_dwordx4 v8, s[88:91], s31 offen lds
ds_read_b64_tr_b16 a[160:161], v1 offset:40960
v_mfma_f32_16x16x32_bf16 a[40:43], a[172:175], a[184:187], a[40:43]
ds_read_b64_tr_b16 a[162:163], v1 offset:50176
v_mfma_f32_16x16x32_bf16 a[44:47], a[172:175], a[188:191], a[44:47]
ds_read_b64_tr_b16 a[164:165], v1 offset:59392
s_waitcnt lgkmcnt(7)
v_mfma_f32_16x16x32_bf16 v[72:75], a[144:147], a[184:187], v[72:75]
ds_read_b64_tr_b16 a[166:167], v3 offset:3072
v_mfma_f32_16x16x32_bf16 v[76:79], a[144:147], a[188:191], v[76:79]
ds_read_b64_tr_b16 a[168:169], v2 offset:40960
buffer_load_dwordx4 v9, s[88:91], s31 offen offset:1024 lds
v_mfma_f32_16x16x32_bf16 a[48:51], a[148:151], a[184:187], a[48:51]
ds_read_b64_tr_b16 a[170:171], v2 offset:50176
v_mfma_f32_16x16x32_bf16 a[52:55], a[148:151], a[188:191], a[52:55]
ds_read_b64_tr_b16 a[172:173], v2 offset:59392
s_waitcnt lgkmcnt(7)
v_mfma_f32_16x16x32_bf16 v[80:83], a[152:155], a[184:187], v[80:83]
ds_read_b64_tr_b16 a[174:175], v4 offset:3072
v_mfma_f32_16x16x32_bf16 v[84:87], a[152:155], a[188:191], v[84:87]
ds_read_b64_tr_b16 a[144:145], v1 offset:41984
v_mfma_f32_16x16x32_bf16 a[56:59], a[156:159], a[184:187], a[56:59]
ds_read_b64_tr_b16 a[146:147], v1 offset:51200
v_mfma_f32_16x16x32_bf16 a[60:63], a[156:159], a[188:191], a[60:63]
ds_read_b64_tr_b16 a[148:149], v1 offset:60416
s_waitcnt lgkmcnt(7)
v_mfma_f32_16x16x32_bf16 v[88:91], a[160:163], a[184:187], v[88:91]
ds_read_b64_tr_b16 a[150:151], v3 offset:4096
buffer_load_dwordx4 v10, s[88:91], s31 offen offset:2048 lds
v_mfma_f32_16x16x32_bf16 v[92:95], a[160:163], a[188:191], v[92:95]
ds_read_b64_tr_b16 a[152:153], v2 offset:41984
v_mfma_f32_16x16x32_bf16 a[64:67], a[164:167], a[184:187], a[64:67]
ds_read_b64_tr_b16 a[154:155], v2 offset:51200
v_mfma_f32_16x16x32_bf16 a[68:71], a[164:167], a[188:191], a[68:71]
ds_read_b64_tr_b16 a[156:157], v2 offset:60416
s_waitcnt lgkmcnt(7)
v_mfma_f32_16x16x32_bf16 v[96:99], a[168:171], a[184:187], v[96:99]
ds_read_b64_tr_b16 a[158:159], v4 offset:4096
v_mfma_f32_16x16x32_bf16 v[100:103], a[168:171], a[188:191], v[100:103]
ds_read_b64_tr_b16 a[160:161], v1 offset:43008
v_mfma_f32_16x16x32_bf16 a[72:75], a[172:175], a[184:187], a[72:75]
ds_read_b64_tr_b16 a[162:163], v1 offset:52224
v_mfma_f32_16x16x32_bf16 a[76:79], a[172:175], a[188:191], a[76:79]
ds_read_b64_tr_b16 a[164:165], v1 offset:61440
s_waitcnt lgkmcnt(7)
v_mfma_f32_16x16x32_bf16 v[104:107], a[144:147], a[184:187], v[104:107]
ds_read_b64_tr_b16 a[166:167], v3 offset:5120
buffer_load_dwordx4 v11, s[88:91], s31 offen offset:3072 lds
v_mfma_f32_16x16x32_bf16 v[108:111], a[144:147], a[188:191], v[108:111]
ds_read_b64_tr_b16 a[168:169], v2 offset:43008
s_add_u32 s33, s26, 12288
v_mfma_f32_16x16x32_bf16 a[80:83], a[148:151], a[184:187], a[80:83]
ds_read_b64_tr_b16 a[170:171], v2 offset:52224
buffer_load_dwordx4 a[176:179], v7, s[16:19], s33 offen sc1
v_mfma_f32_16x16x32_bf16 a[84:87], a[148:151], a[188:191], a[84:87]
ds_read_b64_tr_b16 a[172:173], v2 offset:61440
s_waitcnt lgkmcnt(7)
v_mfma_f32_16x16x32_bf16 v[112:115], a[152:155], a[184:187], v[112:115]
ds_read_b64_tr_b16 a[174:175], v4 offset:5120
buffer_load_dwordx4 a[180:183], v16, s[16:19], s33 offen sc1
v_mfma_f32_16x16x32_bf16 v[116:119], a[152:155], a[188:191], v[116:119]
ds_read_b64_tr_b16 a[144:145], v1 offset:44032
v_mfma_f32_16x16x32_bf16 a[88:91], a[156:159], a[184:187], a[88:91]
ds_read_b64_tr_b16 a[146:147], v1 offset:53248
s_add_u32 m0, s92, 118784
v_mfma_f32_16x16x32_bf16 a[92:95], a[156:159], a[188:191], a[92:95]
ds_read_b64_tr_b16 a[148:149], v1 offset:62464
s_waitcnt lgkmcnt(7)
v_mfma_f32_16x16x32_bf16 v[120:123], a[160:163], a[184:187], v[120:123]
ds_read_b64_tr_b16 a[150:151], v3 offset:6144
s_add_u32 s32, s93, 3244544
v_mfma_f32_16x16x32_bf16 v[124:127], a[160:163], a[188:191], v[124:127]
buffer_load_dwordx4 v8, s[88:91], s32 offen lds
ds_read_b64_tr_b16 a[152:153], v2 offset:44032
v_mfma_f32_16x16x32_bf16 a[96:99], a[164:167], a[184:187], a[96:99]
ds_read_b64_tr_b16 a[154:155], v2 offset:53248
v_mfma_f32_16x16x32_bf16 a[100:103], a[164:167], a[188:191], a[100:103]
ds_read_b64_tr_b16 a[156:157], v2 offset:62464
s_waitcnt lgkmcnt(7)
v_mfma_f32_16x16x32_bf16 v[128:131], a[168:171], a[184:187], v[128:131]
ds_read_b64_tr_b16 a[158:159], v4 offset:6144
v_mfma_f32_16x16x32_bf16 v[132:135], a[168:171], a[188:191], v[132:135]
ds_read_b64_tr_b16 a[160:161], v1 offset:45056
v_mfma_f32_16x16x32_bf16 a[104:107], a[172:175], a[184:187], a[104:107]
ds_read_b64_tr_b16 a[162:163], v1 offset:54272
v_mfma_f32_16x16x32_bf16 a[108:111], a[172:175], a[188:191], a[108:111]
ds_read_b64_tr_b16 a[164:165], v1 offset:63488
s_waitcnt lgkmcnt(7)
v_mfma_f32_16x16x32_bf16 v[136:139], a[144:147], a[184:187], v[136:139]
ds_read_b64_tr_b16 a[166:167], v3 offset:7168
v_mfma_f32_16x16x32_bf16 v[140:143], a[144:147], a[188:191], v[140:143]
ds_read_b64_tr_b16 a[168:169], v2 offset:45056
v_mfma_f32_16x16x32_bf16 a[112:115], a[148:151], a[184:187], a[112:115]
ds_read_b64_tr_b16 a[170:171], v2 offset:54272
v_mfma_f32_16x16x32_bf16 a[116:119], a[148:151], a[188:191], a[116:119]
ds_read_b64_tr_b16 a[172:173], v2 offset:63488
s_waitcnt lgkmcnt(7)
v_mfma_f32_16x16x32_bf16 v[144:147], a[152:155], a[184:187], v[144:147]
ds_read_b64_tr_b16 a[174:175], v4 offset:7168
v_mfma_f32_16x16x32_bf16 v[148:151], a[152:155], a[188:191], v[148:151]
s_waitcnt vmcnt(11)
s_barrier
ds_read_b64_tr_b16 a[144:145], v3 offset:8192
v_mfma_f32_16x16x32_bf16 a[120:123], a[156:159], a[184:187], a[120:123]
ds_read_b64_tr_b16 a[146:147], v3 offset:17408
s_add_u32 m0, s92, 0
v_mfma_f32_16x16x32_bf16 a[124:127], a[156:159], a[188:191], a[124:127]
ds_read_b64_tr_b16 a[148:149], v3 offset:26624
s_waitcnt lgkmcnt(7)
v_mfma_f32_16x16x32_bf16 v[152:155], a[160:163], a[184:187], v[152:155]
ds_read_b64_tr_b16 a[150:151], v3 offset:35840
s_add_u32 s30, s93, 3538944
v_mfma_f32_16x16x32_bf16 v[156:159], a[160:163], a[188:191], v[156:159]
buffer_load_dwordx4 v8, s[88:91], s30 offen lds
ds_read_b64_tr_b16 a[152:153], v4 offset:8192
v_mfma_f32_16x16x32_bf16 a[128:131], a[164:167], a[184:187], a[128:131]
ds_read_b64_tr_b16 a[154:155], v4 offset:17408
v_mfma_f32_16x16x32_bf16 a[132:135], a[164:167], a[188:191], a[132:135]
ds_read_b64_tr_b16 a[156:157], v4 offset:26624
s_waitcnt lgkmcnt(7)
v_mfma_f32_16x16x32_bf16 v[160:163], a[168:171], a[184:187], v[160:163]
ds_read_b64_tr_b16 a[158:159], v4 offset:35840
v_mfma_f32_16x16x32_bf16 v[164:167], a[168:171], a[188:191], v[164:167]
ds_read_b64_tr_b16 a[160:161], v3 offset:9216
buffer_load_dwordx4 v9, s[88:91], s30 offen offset:1024 lds
v_mfma_f32_16x16x32_bf16 a[136:139], a[172:175], a[184:187], a[136:139]
ds_read_b64_tr_b16 a[162:163], v3 offset:18432
v_mfma_f32_16x16x32_bf16 a[140:143], a[172:175], a[188:191], a[140:143]
ds_read_b64_tr_b16 a[164:165], v3 offset:27648
s_waitcnt lgkmcnt(7)
v_mfma_f32_16x16x32_bf16 v[24:27], a[144:147], a[192:195], v[24:27]
ds_read_b64_tr_b16 a[166:167], v3 offset:36864
v_mfma_f32_16x16x32_bf16 v[28:31], a[144:147], a[196:199], v[28:31]
ds_read_b64_tr_b16 a[168:169], v4 offset:9216
v_mfma_f32_16x16x32_bf16 a[0:3], a[148:151], a[192:195], a[0:3]
ds_read_b64_tr_b16 a[170:171], v4 offset:18432
v_mfma_f32_16x16x32_bf16 a[4:7], a[148:151], a[196:199], a[4:7]
ds_read_b64_tr_b16 a[172:173], v4 offset:27648
s_waitcnt lgkmcnt(7)
v_mfma_f32_16x16x32_bf16 v[32:35], a[152:155], a[192:195], v[32:35]
ds_read_b64_tr_b16 a[174:175], v4 offset:36864
buffer_load_dwordx4 v10, s[88:91], s30 offen offset:2048 lds
v_mfma_f32_16x16x32_bf16 v[36:39], a[152:155], a[196:199], v[36:39]
ds_read_b64_tr_b16 a[144:145], v3 offset:10240
v_mfma_f32_16x16x32_bf16 a[8:11], a[156:159], a[192:195], a[8:11]
ds_read_b64_tr_b16 a[146:147], v3 offset:19456
v_mfma_f32_16x16x32_bf16 a[12:15], a[156:159], a[196:199], a[12:15]
ds_read_b64_tr_b16 a[148:149], v3 offset:28672
s_waitcnt lgkmcnt(7)
v_mfma_f32_16x16x32_bf16 v[40:43], a[160:163], a[192:195], v[40:43]
ds_read_b64_tr_b16 a[150:151], v3 offset:37888
v_mfma_f32_16x16x32_bf16 v[44:47], a[160:163], a[196:199], v[44:47]
ds_read_b64_tr_b16 a[152:153], v4 offset:10240
v_mfma_f32_16x16x32_bf16 a[16:19], a[164:167], a[192:195], a[16:19]
ds_read_b64_tr_b16 a[154:155], v4 offset:19456
v_mfma_f32_16x16x32_bf16 a[20:23], a[164:167], a[196:199], a[20:23]
ds_read_b64_tr_b16 a[156:157], v4 offset:28672
s_waitcnt lgkmcnt(7)
v_mfma_f32_16x16x32_bf16 v[48:51], a[168:171], a[192:195], v[48:51]
ds_read_b64_tr_b16 a[158:159], v4 offset:37888
buffer_load_dwordx4 v11, s[88:91], s30 offen offset:3072 lds
v_mfma_f32_16x16x32_bf16 v[52:55], a[168:171], a[196:199], v[52:55]
ds_read_b64_tr_b16 a[160:161], v3 offset:11264
v_mfma_f32_16x16x32_bf16 a[24:27], a[172:175], a[192:195], a[24:27]
ds_read_b64_tr_b16 a[162:163], v3 offset:20480
v_mfma_f32_16x16x32_bf16 a[28:31], a[172:175], a[196:199], a[28:31]
ds_read_b64_tr_b16 a[164:165], v3 offset:29696
s_waitcnt lgkmcnt(7)
v_mfma_f32_16x16x32_bf16 v[56:59], a[144:147], a[192:195], v[56:59]
ds_read_b64_tr_b16 a[166:167], v3 offset:38912
v_mfma_f32_16x16x32_bf16 v[60:63], a[144:147], a[196:199], v[60:63]
ds_read_b64_tr_b16 a[168:169], v4 offset:11264
v_mfma_f32_16x16x32_bf16 a[32:35], a[148:151], a[192:195], a[32:35]
ds_read_b64_tr_b16 a[170:171], v4 offset:20480
s_add_u32 m0, s92, 4096
v_mfma_f32_16x16x32_bf16 a[36:39], a[148:151], a[196:199], a[36:39]
ds_read_b64_tr_b16 a[172:173], v4 offset:29696
s_waitcnt lgkmcnt(7)
v_mfma_f32_16x16x32_bf16 v[64:67], a[152:155], a[192:195], v[64:67]
ds_read_b64_tr_b16 a[174:175], v4 offset:38912
s_add_u32 s31, s93, 3539200
v_mfma_f32_16x16x32_bf16 v[68:71], a[152:155], a[196:199], v[68:71]
buffer_load_dwordx4 v8, s[88:91], s31 offen lds
ds_read_b64_tr_b16 a[144:145], v3 offset:12288
v_mfma_f32_16x16x32_bf16 a[40:43], a[156:159], a[192:195], a[40:43]
ds_read_b64_tr_b16 a[146:147], v3 offset:21504
v_mfma_f32_16x16x32_bf16 a[44:47], a[156:159], a[196:199], a[44:47]
ds_read_b64_tr_b16 a[148:149], v3 offset:30720
s_waitcnt lgkmcnt(7)
v_mfma_f32_16x16x32_bf16 v[72:75], a[160:163], a[192:195], v[72:75]
ds_read_b64_tr_b16 a[150:151], v3 offset:39936
v_mfma_f32_16x16x32_bf16 v[76:79], a[160:163], a[196:199], v[76:79]
ds_read_b64_tr_b16 a[152:153], v4 offset:12288
buffer_load_dwordx4 v9, s[88:91], s31 offen offset:1024 lds
v_mfma_f32_16x16x32_bf16 a[48:51], a[164:167], a[192:195], a[48:51]
ds_read_b64_tr_b16 a[154:155], v4 offset:21504
v_mfma_f32_16x16x32_bf16 a[52:55], a[164:167], a[196:199], a[52:55]
ds_read_b64_tr_b16 a[156:157], v4 offset:30720
s_waitcnt lgkmcnt(7)
v_mfma_f32_16x16x32_bf16 v[80:83], a[168:171], a[192:195], v[80:83]
ds_read_b64_tr_b16 a[158:159], v4 offset:39936
v_mfma_f32_16x16x32_bf16 v[84:87], a[168:171], a[196:199], v[84:87]
ds_read_b64_tr_b16 a[160:161], v3 offset:13312
v_mfma_f32_16x16x32_bf16 a[56:59], a[172:175], a[192:195], a[56:59]
ds_read_b64_tr_b16 a[162:163], v3 offset:22528
v_mfma_f32_16x16x32_bf16 a[60:63], a[172:175], a[196:199], a[60:63]
ds_read_b64_tr_b16 a[164:165], v3 offset:31744
s_waitcnt lgkmcnt(7)
v_mfma_f32_16x16x32_bf16 v[88:91], a[144:147], a[192:195], v[88:91]
ds_read_b64_tr_b16 a[166:167], v3 offset:40960
buffer_load_dwordx4 v10, s[88:91], s31 offen offset:2048 lds
v_mfma_f32_16x16x32_bf16 v[92:95], a[144:147], a[196:199], v[92:95]
ds_read_b64_tr_b16 a[168:169], v4 offset:13312
v_mfma_f32_16x16x32_bf16 a[64:67], a[148:151], a[192:195], a[64:67]
ds_read_b64_tr_b16 a[170:171], v4 offset:22528
v_mfma_f32_16x16x32_bf16 a[68:71], a[148:151], a[196:199], a[68:71]
ds_read_b64_tr_b16 a[172:173], v4 offset:31744
s_waitcnt lgkmcnt(7)
v_mfma_f32_16x16x32_bf16 v[96:99], a[152:155], a[192:195], v[96:99]
ds_read_b64_tr_b16 a[174:175], v4 offset:40960
v_mfma_f32_16x16x32_bf16 v[100:103], a[152:155], a[196:199], v[100:103]
ds_read_b64_tr_b16 a[144:145], v3 offset:14336
v_mfma_f32_16x16x32_bf16 a[72:75], a[156:159], a[192:195], a[72:75]
ds_read_b64_tr_b16 a[146:147], v3 offset:23552
v_mfma_f32_16x16x32_bf16 a[76:79], a[156:159], a[196:199], a[76:79]
ds_read_b64_tr_b16 a[148:149], v3 offset:32768
s_waitcnt lgkmcnt(7)
v_mfma_f32_16x16x32_bf16 v[104:107], a[160:163], a[192:195], v[104:107]
ds_read_b64_tr_b16 a[150:151], v3 offset:41984
buffer_load_dwordx4 v11, s[88:91], s31 offen offset:3072 lds
v_mfma_f32_16x16x32_bf16 v[108:111], a[160:163], a[196:199], v[108:111]
ds_read_b64_tr_b16 a[152:153], v4 offset:14336
buffer_load_dwordx4 a[184:187], v7, s[16:19], s33 offen offset:1024 sc1
v_mfma_f32_16x16x32_bf16 a[80:83], a[164:167], a[192:195], a[80:83]
ds_read_b64_tr_b16 a[154:155], v4 offset:23552
buffer_load_dwordx4 a[188:191], v16, s[16:19], s33 offen offset:1024 sc1
v_mfma_f32_16x16x32_bf16 a[84:87], a[164:167], a[196:199], a[84:87]
ds_read_b64_tr_b16 a[156:157], v4 offset:32768
s_waitcnt lgkmcnt(7)
v_mfma_f32_16x16x32_bf16 v[112:115], a[168:171], a[192:195], v[112:115]
ds_read_b64_tr_b16 a[158:159], v4 offset:41984
v_mfma_f32_16x16x32_bf16 v[116:119], a[168:171], a[196:199], v[116:119]
ds_read_b64_tr_b16 a[160:161], v3 offset:15360
v_mfma_f32_16x16x32_bf16 a[88:91], a[172:175], a[192:195], a[88:91]
ds_read_b64_tr_b16 a[162:163], v3 offset:24576
s_add_u32 m0, s92, 8192
v_mfma_f32_16x16x32_bf16 a[92:95], a[172:175], a[196:199], a[92:95]
ds_read_b64_tr_b16 a[164:165], v3 offset:33792
s_waitcnt lgkmcnt(7)
v_mfma_f32_16x16x32_bf16 v[120:123], a[144:147], a[192:195], v[120:123]
ds_read_b64_tr_b16 a[166:167], v3 offset:43008
s_add_u32 s32, s93, 3539456
v_mfma_f32_16x16x32_bf16 v[124:127], a[144:147], a[196:199], v[124:127]
buffer_load_dwordx4 v8, s[88:91], s32 offen lds
ds_read_b64_tr_b16 a[168:169], v4 offset:15360
v_mfma_f32_16x16x32_bf16 a[96:99], a[148:151], a[192:195], a[96:99]
ds_read_b64_tr_b16 a[170:171], v4 offset:24576
v_mfma_f32_16x16x32_bf16 a[100:103], a[148:151], a[196:199], a[100:103]
ds_read_b64_tr_b16 a[172:173], v4 offset:33792
s_waitcnt lgkmcnt(7)
v_mfma_f32_16x16x32_bf16 v[128:131], a[152:155], a[192:195], v[128:131]
ds_read_b64_tr_b16 a[174:175], v4 offset:43008
v_mfma_f32_16x16x32_bf16 v[132:135], a[152:155], a[196:199], v[132:135]
ds_read_b64_tr_b16 a[144:145], v3 offset:16384
v_mfma_f32_16x16x32_bf16 a[104:107], a[156:159], a[192:195], a[104:107]
ds_read_b64_tr_b16 a[146:147], v3 offset:25600
v_mfma_f32_16x16x32_bf16 a[108:111], a[156:159], a[196:199], a[108:111]
ds_read_b64_tr_b16 a[148:149], v3 offset:34816
s_waitcnt lgkmcnt(7)
v_mfma_f32_16x16x32_bf16 v[136:139], a[160:163], a[192:195], v[136:139]
ds_read_b64_tr_b16 a[150:151], v3 offset:44032
v_mfma_f32_16x16x32_bf16 v[140:143], a[160:163], a[196:199], v[140:143]
ds_read_b64_tr_b16 a[152:153], v4 offset:16384
v_mfma_f32_16x16x32_bf16 a[112:115], a[164:167], a[192:195], a[112:115]
ds_read_b64_tr_b16 a[154:155], v4 offset:25600
v_mfma_f32_16x16x32_bf16 a[116:119], a[164:167], a[196:199], a[116:119]
ds_read_b64_tr_b16 a[156:157], v4 offset:34816
s_waitcnt lgkmcnt(7)
v_mfma_f32_16x16x32_bf16 v[144:147], a[168:171], a[192:195], v[144:147]
ds_read_b64_tr_b16 a[158:159], v4 offset:44032
v_mfma_f32_16x16x32_bf16 v[148:151], a[168:171], a[196:199], v[148:151]
s_waitcnt vmcnt(11)
s_barrier
ds_read_b64_tr_b16 a[160:161], v3 offset:45056
v_mfma_f32_16x16x32_bf16 a[120:123], a[172:175], a[192:195], a[120:123]
ds_read_b64_tr_b16 a[162:163], v3 offset:54272
s_add_u32 m0, s92, 36864
v_mfma_f32_16x16x32_bf16 a[124:127], a[172:175], a[196:199], a[124:127]
ds_read_b64_tr_b16 a[164:165], v3 offset:63488
s_waitcnt lgkmcnt(7)
v_mfma_f32_16x16x32_bf16 v[152:155], a[144:147], a[192:195], v[152:155]
ds_read_b64_tr_b16 a[166:167], v5 offset:7168
s_add_u32 s30, s93, 3833856
v_mfma_f32_16x16x32_bf16 v[156:159], a[144:147], a[196:199], v[156:159]
buffer_load_dwordx4 v8, s[88:91], s30 offen lds
ds_read_b64_tr_b16 a[168:169], v4 offset:45056
v_mfma_f32_16x16x32_bf16 a[128:131], a[148:151], a[192:195], a[128:131]
ds_read_b64_tr_b16 a[170:171], v4 offset:54272
v_mfma_f32_16x16x32_bf16 a[132:135], a[148:151], a[196:199], a[132:135]
ds_read_b64_tr_b16 a[172:173], v4 offset:63488
s_waitcnt lgkmcnt(7)
v_mfma_f32_16x16x32_bf16 v[160:163], a[152:155], a[192:195], v[160:163]
ds_read_b64_tr_b16 a[174:175], v6 offset:7168
v_mfma_f32_16x16x32_bf16 v[164:167], a[152:155], a[196:199], v[164:167]
ds_read_b64_tr_b16 a[144:145], v3 offset:46080
buffer_load_dwordx4 v9, s[88:91], s30 offen offset:1024 lds
v_mfma_f32_16x16x32_bf16 a[136:139], a[156:159], a[192:195], a[136:139]
ds_read_b64_tr_b16 a[146:147], v3 offset:55296
v_mfma_f32_16x16x32_bf16 a[140:143], a[156:159], a[196:199], a[140:143]
ds_read_b64_tr_b16 a[148:149], v3 offset:64512
s_waitcnt lgkmcnt(7)
v_mfma_f32_16x16x32_bf16 v[24:27], a[160:163], a[200:203], v[24:27]
ds_read_b64_tr_b16 a[150:151], v5 offset:8192
v_mfma_f32_16x16x32_bf16 v[28:31], a[160:163], a[204:207], v[28:31]
ds_read_b64_tr_b16 a[152:153], v4 offset:46080
v_mfma_f32_16x16x32_bf16 a[0:3], a[164:167], a[200:203], a[0:3]
ds_read_b64_tr_b16 a[154:155], v4 offset:55296
v_mfma_f32_16x16x32_bf16 a[4:7], a[164:167], a[204:207], a[4:7]
ds_read_b64_tr_b16 a[156:157], v4 offset:64512
s_waitcnt lgkmcnt(7)
v_mfma_f32_16x16x32_bf16 v[32:35], a[168:171], a[200:203], v[32:35]
ds_read_b64_tr_b16 a[158:159], v6 offset:8192
buffer_load_dwordx4 v10, s[88:91], s30 offen offset:2048 lds
v_mfma_f32_16x16x32_bf16 v[36:39], a[168:171], a[204:207], v[36:39]
ds_read_b64_tr_b16 a[160:161], v3 offset:47104
v_mfma_f32_16x16x32_bf16 a[8:11], a[172:175], a[200:203], a[8:11]
ds_read_b64_tr_b16 a[162:163], v3 offset:56320
v_mfma_f32_16x16x32_bf16 a[12:15], a[172:175], a[204:207], a[12:15]
ds_read_b64_tr_b16 a[164:165], v5
s_waitcnt lgkmcnt(7)
v_mfma_f32_16x16x32_bf16 v[40:43], a[144:147], a[200:203], v[40:43]
ds_read_b64_tr_b16 a[166:167], v5 offset:9216
v_mfma_f32_16x16x32_bf16 v[44:47], a[144:147], a[204:207], v[44:47]
ds_read_b64_tr_b16 a[168:169], v4 offset:47104
v_mfma_f32_16x16x32_bf16 a[16:19], a[148:151], a[200:203], a[16:19]
ds_read_b64_tr_b16 a[170:171], v4 offset:56320
v_mfma_f32_16x16x32_bf16 a[20:23], a[148:151], a[204:207], a[20:23]
ds_read_b64_tr_b16 a[172:173], v6
s_waitcnt lgkmcnt(7)
v_mfma_f32_16x16x32_bf16 v[48:51], a[152:155], a[200:203], v[48:51]
ds_read_b64_tr_b16 a[174:175], v6 offset:9216
buffer_load_dwordx4 v11, s[88:91], s30 offen offset:3072 lds
v_mfma_f32_16x16x32_bf16 v[52:55], a[152:155], a[204:207], v[52:55]
ds_read_b64_tr_b16 a[144:145], v3 offset:48128
v_mfma_f32_16x16x32_bf16 a[24:27], a[156:159], a[200:203], a[24:27]
ds_read_b64_tr_b16 a[146:147], v3 offset:57344
v_mfma_f32_16x16x32_bf16 a[28:31], a[156:159], a[204:207], a[28:31]
ds_read_b64_tr_b16 a[148:149], v5 offset:1024
s_waitcnt lgkmcnt(7)
v_mfma_f32_16x16x32_bf16 v[56:59], a[160:163], a[200:203], v[56:59]
ds_read_b64_tr_b16 a[150:151], v5 offset:10240
v_mfma_f32_16x16x32_bf16 v[60:63], a[160:163], a[204:207], v[60:63]
ds_read_b64_tr_b16 a[152:153], v4 offset:48128
v_mfma_f32_16x16x32_bf16 a[32:35], a[164:167], a[200:203], a[32:35]
ds_read_b64_tr_b16 a[154:155], v4 offset:57344
s_add_u32 m0, s92, 40960
v_mfma_f32_16x16x32_bf16 a[36:39], a[164:167], a[204:207], a[36:39]
ds_read_b64_tr_b16 a[156:157], v6 offset:1024
s_waitcnt lgkmcnt(7)
v_mfma_f32_16x16x32_bf16 v[64:67], a[168:171], a[200:203], v[64:67]
ds_read_b64_tr_b16 a[158:159], v6 offset:10240
s_add_u32 s31, s93, 3834112
v_mfma_f32_16x16x32_bf16 v[68:71], a[168:171], a[204:207], v[68:71]
buffer_load_dwordx4 v8, s[88:91], s31 offen lds
ds_read_b64_tr_b16 a[160:161], v3 offset:49152
v_mfma_f32_16x16x32_bf16 a[40:43], a[172:175], a[200:203], a[40:43]
ds_read_b64_tr_b16 a[162:163], v3 offset:58368
v_mfma_f32_16x16x32_bf16 a[44:47], a[172:175], a[204:207], a[44:47]
ds_read_b64_tr_b16 a[164:165], v5 offset:2048
s_waitcnt lgkmcnt(7)
v_mfma_f32_16x16x32_bf16 v[72:75], a[144:147], a[200:203], v[72:75]
ds_read_b64_tr_b16 a[166:167], v5 offset:11264
v_mfma_f32_16x16x32_bf16 v[76:79], a[144:147], a[204:207], v[76:79]
ds_read_b64_tr_b16 a[168:169], v4 offset:49152
buffer_load_dwordx4 v9, s[88:91], s31 offen offset:1024 lds
v_mfma_f32_16x16x32_bf16 a[48:51], a[148:151], a[200:203], a[48:51]
ds_read_b64_tr_b16 a[170:171], v4 offset:58368
v_mfma_f32_16x16x32_bf16 a[52:55], a[148:151], a[204:207], a[52:55]
ds_read_b64_tr_b16 a[172:173], v6 offset:2048
s_waitcnt lgkmcnt(7)
v_mfma_f32_16x16x32_bf16 v[80:83], a[152:155], a[200:203], v[80:83]
ds_read_b64_tr_b16 a[174:175], v6 offset:11264
v_mfma_f32_16x16x32_bf16 v[84:87], a[152:155], a[204:207], v[84:87]
ds_read_b64_tr_b16 a[144:145], v3 offset:50176
v_mfma_f32_16x16x32_bf16 a[56:59], a[156:159], a[200:203], a[56:59]
ds_read_b64_tr_b16 a[146:147], v3 offset:59392
v_mfma_f32_16x16x32_bf16 a[60:63], a[156:159], a[204:207], a[60:63]
ds_read_b64_tr_b16 a[148:149], v5 offset:3072
s_waitcnt lgkmcnt(7)
v_mfma_f32_16x16x32_bf16 v[88:91], a[160:163], a[200:203], v[88:91]
ds_read_b64_tr_b16 a[150:151], v5 offset:12288
buffer_load_dwordx4 v10, s[88:91], s31 offen offset:2048 lds
v_mfma_f32_16x16x32_bf16 v[92:95], a[160:163], a[204:207], v[92:95]
ds_read_b64_tr_b16 a[152:153], v4 offset:50176
v_mfma_f32_16x16x32_bf16 a[64:67], a[164:167], a[200:203], a[64:67]
ds_read_b64_tr_b16 a[154:155], v4 offset:59392
v_mfma_f32_16x16x32_bf16 a[68:71], a[164:167], a[204:207], a[68:71]
ds_read_b64_tr_b16 a[156:157], v6 offset:3072
s_waitcnt lgkmcnt(7)
v_mfma_f32_16x16x32_bf16 v[96:99], a[168:171], a[200:203], v[96:99]
ds_read_b64_tr_b16 a[158:159], v6 offset:12288
v_mfma_f32_16x16x32_bf16 v[100:103], a[168:171], a[204:207], v[100:103]
ds_read_b64_tr_b16 a[160:161], v3 offset:51200
v_mfma_f32_16x16x32_bf16 a[72:75], a[172:175], a[200:203], a[72:75]
ds_read_b64_tr_b16 a[162:163], v3 offset:60416
v_mfma_f32_16x16x32_bf16 a[76:79], a[172:175], a[204:207], a[76:79]
ds_read_b64_tr_b16 a[164:165], v5 offset:4096
s_waitcnt lgkmcnt(7)
v_mfma_f32_16x16x32_bf16 v[104:107], a[144:147], a[200:203], v[104:107]
ds_read_b64_tr_b16 a[166:167], v5 offset:13312
buffer_load_dwordx4 v11, s[88:91], s31 offen offset:3072 lds
v_mfma_f32_16x16x32_bf16 v[108:111], a[144:147], a[204:207], v[108:111]
ds_read_b64_tr_b16 a[168:169], v4 offset:51200
buffer_load_dwordx4 a[192:195], v7, s[16:19], s33 offen offset:2048 sc1
v_mfma_f32_16x16x32_bf16 a[80:83], a[148:151], a[200:203], a[80:83]
ds_read_b64_tr_b16 a[170:171], v4 offset:60416
buffer_load_dwordx4 a[196:199], v16, s[16:19], s33 offen offset:2048 sc1
v_mfma_f32_16x16x32_bf16 a[84:87], a[148:151], a[204:207], a[84:87]
ds_read_b64_tr_b16 a[172:173], v6 offset:4096
s_waitcnt lgkmcnt(7)
v_mfma_f32_16x16x32_bf16 v[112:115], a[152:155], a[200:203], v[112:115]
ds_read_b64_tr_b16 a[174:175], v6 offset:13312
v_mfma_f32_16x16x32_bf16 v[116:119], a[152:155], a[204:207], v[116:119]
ds_read_b64_tr_b16 a[144:145], v3 offset:52224
v_mfma_f32_16x16x32_bf16 a[88:91], a[156:159], a[200:203], a[88:91]
ds_read_b64_tr_b16 a[146:147], v3 offset:61440
s_add_u32 m0, s92, 45056
v_mfma_f32_16x16x32_bf16 a[92:95], a[156:159], a[204:207], a[92:95]
ds_read_b64_tr_b16 a[148:149], v5 offset:5120
s_waitcnt lgkmcnt(7)
v_mfma_f32_16x16x32_bf16 v[120:123], a[160:163], a[200:203], v[120:123]
ds_read_b64_tr_b16 a[150:151], v5 offset:14336
s_add_u32 s32, s93, 3834368
v_mfma_f32_16x16x32_bf16 v[124:127], a[160:163], a[204:207], v[124:127]
buffer_load_dwordx4 v8, s[88:91], s32 offen lds
ds_read_b64_tr_b16 a[152:153], v4 offset:52224
v_mfma_f32_16x16x32_bf16 a[96:99], a[164:167], a[200:203], a[96:99]
ds_read_b64_tr_b16 a[154:155], v4 offset:61440
v_mfma_f32_16x16x32_bf16 a[100:103], a[164:167], a[204:207], a[100:103]
ds_read_b64_tr_b16 a[156:157], v6 offset:5120
s_waitcnt lgkmcnt(7)
v_mfma_f32_16x16x32_bf16 v[128:131], a[168:171], a[200:203], v[128:131]
ds_read_b64_tr_b16 a[158:159], v6 offset:14336
v_mfma_f32_16x16x32_bf16 v[132:135], a[168:171], a[204:207], v[132:135]
ds_read_b64_tr_b16 a[160:161], v3 offset:53248
v_mfma_f32_16x16x32_bf16 a[104:107], a[172:175], a[200:203], a[104:107]
ds_read_b64_tr_b16 a[162:163], v3 offset:62464
v_mfma_f32_16x16x32_bf16 a[108:111], a[172:175], a[204:207], a[108:111]
ds_read_b64_tr_b16 a[164:165], v5 offset:6144
s_waitcnt lgkmcnt(7)
v_mfma_f32_16x16x32_bf16 v[136:139], a[144:147], a[200:203], v[136:139]
ds_read_b64_tr_b16 a[166:167], v5 offset:15360
v_mfma_f32_16x16x32_bf16 v[140:143], a[144:147], a[204:207], v[140:143]
ds_read_b64_tr_b16 a[168:169], v4 offset:53248
v_mfma_f32_16x16x32_bf16 a[112:115], a[148:151], a[200:203], a[112:115]
ds_read_b64_tr_b16 a[170:171], v4 offset:62464
v_mfma_f32_16x16x32_bf16 a[116:119], a[148:151], a[204:207], a[116:119]
ds_read_b64_tr_b16 a[172:173], v6 offset:6144
s_waitcnt lgkmcnt(7)
v_mfma_f32_16x16x32_bf16 v[144:147], a[152:155], a[200:203], v[144:147]
ds_read_b64_tr_b16 a[174:175], v6 offset:15360
v_mfma_f32_16x16x32_bf16 v[148:151], a[152:155], a[204:207], v[148:151]
s_waitcnt vmcnt(11)
s_barrier
ds_read_b64_tr_b16 a[144:145], v1
v_mfma_f32_16x16x32_bf16 a[120:123], a[156:159], a[200:203], a[120:123]
ds_read_b64_tr_b16 a[146:147], v1 offset:9216
s_add_u32 m0, s92, 73728
v_mfma_f32_16x16x32_bf16 a[124:127], a[156:159], a[204:207], a[124:127]
ds_read_b64_tr_b16 a[148:149], v1 offset:18432
s_waitcnt lgkmcnt(7)
v_mfma_f32_16x16x32_bf16 v[152:155], a[160:163], a[200:203], v[152:155]
ds_read_b64_tr_b16 a[150:151], v1 offset:27648
s_add_u32 s30, s93, 4128768
v_mfma_f32_16x16x32_bf16 v[156:159], a[160:163], a[204:207], v[156:159]
buffer_load_dwordx4 v8, s[88:91], s30 offen lds
ds_read_b64_tr_b16 a[152:153], v2
v_mfma_f32_16x16x32_bf16 a[128:131], a[164:167], a[200:203], a[128:131]
ds_read_b64_tr_b16 a[154:155], v2 offset:9216
v_mfma_f32_16x16x32_bf16 a[132:135], a[164:167], a[204:207], a[132:135]
ds_read_b64_tr_b16 a[156:157], v2 offset:18432
s_waitcnt lgkmcnt(7)
v_mfma_f32_16x16x32_bf16 v[160:163], a[168:171], a[200:203], v[160:163]
ds_read_b64_tr_b16 a[158:159], v2 offset:27648
v_mfma_f32_16x16x32_bf16 v[164:167], a[168:171], a[204:207], v[164:167]
ds_read_b64_tr_b16 a[160:161], v1 offset:1024
buffer_load_dwordx4 v9, s[88:91], s30 offen offset:1024 lds
v_mfma_f32_16x16x32_bf16 a[136:139], a[172:175], a[200:203], a[136:139]
ds_read_b64_tr_b16 a[162:163], v1 offset:10240
v_mfma_f32_16x16x32_bf16 a[140:143], a[172:175], a[204:207], a[140:143]
ds_read_b64_tr_b16 a[164:165], v1 offset:19456
s_waitcnt lgkmcnt(7)
v_mfma_f32_16x16x32_bf16 v[24:27], a[144:147], a[176:179], v[24:27]
ds_read_b64_tr_b16 a[166:167], v1 offset:28672
v_mfma_f32_16x16x32_bf16 v[28:31], a[144:147], a[180:183], v[28:31]
ds_read_b64_tr_b16 a[168:169], v2 offset:1024
v_mfma_f32_16x16x32_bf16 a[0:3], a[148:151], a[176:179], a[0:3]
ds_read_b64_tr_b16 a[170:171], v2 offset:10240
v_mfma_f32_16x16x32_bf16 a[4:7], a[148:151], a[180:183], a[4:7]
ds_read_b64_tr_b16 a[172:173], v2 offset:19456
s_waitcnt lgkmcnt(7)
v_mfma_f32_16x16x32_bf16 v[32:35], a[152:155], a[176:179], v[32:35]
ds_read_b64_tr_b16 a[174:175], v2 offset:28672
buffer_load_dwordx4 v10, s[88:91], s30 offen offset:2048 lds
v_mfma_f32_16x16x32_bf16 v[36:39], a[152:155], a[180:183], v[36:39]
ds_read_b64_tr_b16 a[144:145], v1 offset:2048
v_mfma_f32_16x16x32_bf16 a[8:11], a[156:159], a[176:179], a[8:11]
ds_read_b64_tr_b16 a[146:147], v1 offset:11264
v_mfma_f32_16x16x32_bf16 a[12:15], a[156:159], a[180:183], a[12:15]
ds_read_b64_tr_b16 a[148:149], v1 offset:20480
s_waitcnt lgkmcnt(7)
v_mfma_f32_16x16x32_bf16 v[40:43], a[160:163], a[176:179], v[40:43]
ds_read_b64_tr_b16 a[150:151], v1 offset:29696
v_mfma_f32_16x16x32_bf16 v[44:47], a[160:163], a[180:183], v[44:47]
ds_read_b64_tr_b16 a[152:153], v2 offset:2048
v_mfma_f32_16x16x32_bf16 a[16:19], a[164:167], a[176:179], a[16:19]
ds_read_b64_tr_b16 a[154:155], v2 offset:11264
v_mfma_f32_16x16x32_bf16 a[20:23], a[164:167], a[180:183], a[20:23]
ds_read_b64_tr_b16 a[156:157], v2 offset:20480
s_waitcnt lgkmcnt(7)
v_mfma_f32_16x16x32_bf16 v[48:51], a[168:171], a[176:179], v[48:51]
ds_read_b64_tr_b16 a[158:159], v2 offset:29696
buffer_load_dwordx4 v11, s[88:91], s30 offen offset:3072 lds
v_mfma_f32_16x16x32_bf16 v[52:55], a[168:171], a[180:183], v[52:55]
ds_read_b64_tr_b16 a[160:161], v1 offset:3072
v_mfma_f32_16x16x32_bf16 a[24:27], a[172:175], a[176:179], a[24:27]
ds_read_b64_tr_b16 a[162:163], v1 offset:12288
v_mfma_f32_16x16x32_bf16 a[28:31], a[172:175], a[180:183], a[28:31]
ds_read_b64_tr_b16 a[164:165], v1 offset:21504
s_waitcnt lgkmcnt(7)
v_mfma_f32_16x16x32_bf16 v[56:59], a[144:147], a[176:179], v[56:59]
ds_read_b64_tr_b16 a[166:167], v1 offset:30720
v_mfma_f32_16x16x32_bf16 v[60:63], a[144:147], a[180:183], v[60:63]
ds_read_b64_tr_b16 a[168:169], v2 offset:3072
v_mfma_f32_16x16x32_bf16 a[32:35], a[148:151], a[176:179], a[32:35]
ds_read_b64_tr_b16 a[170:171], v2 offset:12288
s_add_u32 m0, s92, 77824
v_mfma_f32_16x16x32_bf16 a[36:39], a[148:151], a[180:183], a[36:39]
ds_read_b64_tr_b16 a[172:173], v2 offset:21504
s_waitcnt lgkmcnt(7)
v_mfma_f32_16x16x32_bf16 v[64:67], a[152:155], a[176:179], v[64:67]
ds_read_b64_tr_b16 a[174:175], v2 offset:30720
s_add_u32 s31, s93, 4129024
v_mfma_f32_16x16x32_bf16 v[68:71], a[152:155], a[180:183], v[68:71]
buffer_load_dwordx4 v8, s[88:91], s31 offen lds
ds_read_b64_tr_b16 a[144:145], v1 offset:4096
v_mfma_f32_16x16x32_bf16 a[40:43], a[156:159], a[176:179], a[40:43]
ds_read_b64_tr_b16 a[146:147], v1 offset:13312
v_mfma_f32_16x16x32_bf16 a[44:47], a[156:159], a[180:183], a[44:47]
ds_read_b64_tr_b16 a[148:149], v1 offset:22528
s_waitcnt lgkmcnt(7)
v_mfma_f32_16x16x32_bf16 v[72:75], a[160:163], a[176:179], v[72:75]
ds_read_b64_tr_b16 a[150:151], v1 offset:31744
v_mfma_f32_16x16x32_bf16 v[76:79], a[160:163], a[180:183], v[76:79]
ds_read_b64_tr_b16 a[152:153], v2 offset:4096
buffer_load_dwordx4 v9, s[88:91], s31 offen offset:1024 lds
v_mfma_f32_16x16x32_bf16 a[48:51], a[164:167], a[176:179], a[48:51]
ds_read_b64_tr_b16 a[154:155], v2 offset:13312
v_mfma_f32_16x16x32_bf16 a[52:55], a[164:167], a[180:183], a[52:55]
ds_read_b64_tr_b16 a[156:157], v2 offset:22528
s_waitcnt lgkmcnt(7)
v_mfma_f32_16x16x32_bf16 v[80:83], a[168:171], a[176:179], v[80:83]
ds_read_b64_tr_b16 a[158:159], v2 offset:31744
v_mfma_f32_16x16x32_bf16 v[84:87], a[168:171], a[180:183], v[84:87]
ds_read_b64_tr_b16 a[160:161], v1 offset:5120
v_mfma_f32_16x16x32_bf16 a[56:59], a[172:175], a[176:179], a[56:59]
ds_read_b64_tr_b16 a[162:163], v1 offset:14336
v_mfma_f32_16x16x32_bf16 a[60:63], a[172:175], a[180:183], a[60:63]
ds_read_b64_tr_b16 a[164:165], v1 offset:23552
s_waitcnt lgkmcnt(7)
v_mfma_f32_16x16x32_bf16 v[88:91], a[144:147], a[176:179], v[88:91]
ds_read_b64_tr_b16 a[166:167], v1 offset:32768
buffer_load_dwordx4 v10, s[88:91], s31 offen offset:2048 lds
v_mfma_f32_16x16x32_bf16 v[92:95], a[144:147], a[180:183], v[92:95]
ds_read_b64_tr_b16 a[168:169], v2 offset:5120
v_mfma_f32_16x16x32_bf16 a[64:67], a[148:151], a[176:179], a[64:67]
ds_read_b64_tr_b16 a[170:171], v2 offset:14336
v_mfma_f32_16x16x32_bf16 a[68:71], a[148:151], a[180:183], a[68:71]
ds_read_b64_tr_b16 a[172:173], v2 offset:23552
s_waitcnt lgkmcnt(7)
v_mfma_f32_16x16x32_bf16 v[96:99], a[152:155], a[176:179], v[96:99]
ds_read_b64_tr_b16 a[174:175], v2 offset:32768
v_mfma_f32_16x16x32_bf16 v[100:103], a[152:155], a[180:183], v[100:103]
ds_read_b64_tr_b16 a[144:145], v1 offset:6144
v_mfma_f32_16x16x32_bf16 a[72:75], a[156:159], a[176:179], a[72:75]
ds_read_b64_tr_b16 a[146:147], v1 offset:15360
v_mfma_f32_16x16x32_bf16 a[76:79], a[156:159], a[180:183], a[76:79]
ds_read_b64_tr_b16 a[148:149], v1 offset:24576
s_waitcnt lgkmcnt(7)
v_mfma_f32_16x16x32_bf16 v[104:107], a[160:163], a[176:179], v[104:107]
ds_read_b64_tr_b16 a[150:151], v1 offset:33792
buffer_load_dwordx4 v11, s[88:91], s31 offen offset:3072 lds
v_mfma_f32_16x16x32_bf16 v[108:111], a[160:163], a[180:183], v[108:111]
ds_read_b64_tr_b16 a[152:153], v2 offset:6144
buffer_load_dwordx4 a[200:203], v7, s[16:19], s33 offen offset:3072 sc1
v_mfma_f32_16x16x32_bf16 a[80:83], a[164:167], a[176:179], a[80:83]
ds_read_b64_tr_b16 a[154:155], v2 offset:15360
buffer_load_dwordx4 a[204:207], v16, s[16:19], s33 offen offset:3072 sc1
v_mfma_f32_16x16x32_bf16 a[84:87], a[164:167], a[180:183], a[84:87]
ds_read_b64_tr_b16 a[156:157], v2 offset:24576
s_waitcnt lgkmcnt(7)
v_mfma_f32_16x16x32_bf16 v[112:115], a[168:171], a[176:179], v[112:115]
ds_read_b64_tr_b16 a[158:159], v2 offset:33792
v_mfma_f32_16x16x32_bf16 v[116:119], a[168:171], a[180:183], v[116:119]
ds_read_b64_tr_b16 a[160:161], v1 offset:7168
v_mfma_f32_16x16x32_bf16 a[88:91], a[172:175], a[176:179], a[88:91]
ds_read_b64_tr_b16 a[162:163], v1 offset:16384
s_add_u32 m0, s92, 81920
v_mfma_f32_16x16x32_bf16 a[92:95], a[172:175], a[180:183], a[92:95]
ds_read_b64_tr_b16 a[164:165], v1 offset:25600
s_waitcnt lgkmcnt(7)
v_mfma_f32_16x16x32_bf16 v[120:123], a[144:147], a[176:179], v[120:123]
ds_read_b64_tr_b16 a[166:167], v1 offset:34816
s_add_u32 s32, s93, 4129280
v_mfma_f32_16x16x32_bf16 v[124:127], a[144:147], a[180:183], v[124:127]
buffer_load_dwordx4 v8, s[88:91], s32 offen lds
ds_read_b64_tr_b16 a[168:169], v2 offset:7168
v_mfma_f32_16x16x32_bf16 a[96:99], a[148:151], a[176:179], a[96:99]
ds_read_b64_tr_b16 a[170:171], v2 offset:16384
v_mfma_f32_16x16x32_bf16 a[100:103], a[148:151], a[180:183], a[100:103]
ds_read_b64_tr_b16 a[172:173], v2 offset:25600
s_waitcnt lgkmcnt(7)
v_mfma_f32_16x16x32_bf16 v[128:131], a[152:155], a[176:179], v[128:131]
ds_read_b64_tr_b16 a[174:175], v2 offset:34816
v_mfma_f32_16x16x32_bf16 v[132:135], a[152:155], a[180:183], v[132:135]
ds_read_b64_tr_b16 a[144:145], v1 offset:8192
v_mfma_f32_16x16x32_bf16 a[104:107], a[156:159], a[176:179], a[104:107]
ds_read_b64_tr_b16 a[146:147], v1 offset:17408
v_mfma_f32_16x16x32_bf16 a[108:111], a[156:159], a[180:183], a[108:111]
ds_read_b64_tr_b16 a[148:149], v1 offset:26624
s_waitcnt lgkmcnt(7)
v_mfma_f32_16x16x32_bf16 v[136:139], a[160:163], a[176:179], v[136:139]
ds_read_b64_tr_b16 a[150:151], v1 offset:35840
v_mfma_f32_16x16x32_bf16 v[140:143], a[160:163], a[180:183], v[140:143]
ds_read_b64_tr_b16 a[152:153], v2 offset:8192
v_mfma_f32_16x16x32_bf16 a[112:115], a[164:167], a[176:179], a[112:115]
ds_read_b64_tr_b16 a[154:155], v2 offset:17408
v_mfma_f32_16x16x32_bf16 a[116:119], a[164:167], a[180:183], a[116:119]
ds_read_b64_tr_b16 a[156:157], v2 offset:26624
s_waitcnt lgkmcnt(7)
v_mfma_f32_16x16x32_bf16 v[144:147], a[168:171], a[176:179], v[144:147]
ds_read_b64_tr_b16 a[158:159], v2 offset:35840
v_mfma_f32_16x16x32_bf16 v[148:151], a[168:171], a[180:183], v[148:151]
s_waitcnt vmcnt(11)
s_barrier
ds_read_b64_tr_b16 a[160:161], v1 offset:36864
v_mfma_f32_16x16x32_bf16 a[120:123], a[172:175], a[176:179], a[120:123]
ds_read_b64_tr_b16 a[162:163], v1 offset:46080
s_add_u32 m0, s92, 110592
v_mfma_f32_16x16x32_bf16 a[124:127], a[172:175], a[180:183], a[124:127]
ds_read_b64_tr_b16 a[164:165], v1 offset:55296
s_waitcnt lgkmcnt(7)
v_mfma_f32_16x16x32_bf16 v[152:155], a[144:147], a[176:179], v[152:155]
ds_read_b64_tr_b16 a[166:167], v1 offset:64512
s_add_u32 s30, s93, 4423680
v_mfma_f32_16x16x32_bf16 v[156:159], a[144:147], a[180:183], v[156:159]
buffer_load_dwordx4 v8, s[88:91], s30 offen lds
ds_read_b64_tr_b16 a[168:169], v2 offset:36864
v_mfma_f32_16x16x32_bf16 a[128:131], a[148:151], a[176:179], a[128:131]
ds_read_b64_tr_b16 a[170:171], v2 offset:46080
v_mfma_f32_16x16x32_bf16 a[132:135], a[148:151], a[180:183], a[132:135]
ds_read_b64_tr_b16 a[172:173], v2 offset:55296
s_waitcnt lgkmcnt(7)
v_mfma_f32_16x16x32_bf16 v[160:163], a[152:155], a[176:179], v[160:163]
ds_read_b64_tr_b16 a[174:175], v2 offset:64512
v_mfma_f32_16x16x32_bf16 v[164:167], a[152:155], a[180:183], v[164:167]
ds_read_b64_tr_b16 a[144:145], v1 offset:37888
buffer_load_dwordx4 v9, s[88:91], s30 offen offset:1024 lds
v_mfma_f32_16x16x32_bf16 a[136:139], a[156:159], a[176:179], a[136:139]
ds_read_b64_tr_b16 a[146:147], v1 offset:47104
v_mfma_f32_16x16x32_bf16 a[140:143], a[156:159], a[180:183], a[140:143]
ds_read_b64_tr_b16 a[148:149], v1 offset:56320
s_waitcnt lgkmcnt(7)
v_mfma_f32_16x16x32_bf16 v[24:27], a[160:163], a[184:187], v[24:27]
ds_read_b64_tr_b16 a[150:151], v3
v_mfma_f32_16x16x32_bf16 v[28:31], a[160:163], a[188:191], v[28:31]
ds_read_b64_tr_b16 a[152:153], v2 offset:37888
v_mfma_f32_16x16x32_bf16 a[0:3], a[164:167], a[184:187], a[0:3]
ds_read_b64_tr_b16 a[154:155], v2 offset:47104
v_mfma_f32_16x16x32_bf16 a[4:7], a[164:167], a[188:191], a[4:7]
ds_read_b64_tr_b16 a[156:157], v2 offset:56320
s_waitcnt lgkmcnt(7)
v_mfma_f32_16x16x32_bf16 v[32:35], a[168:171], a[184:187], v[32:35]
ds_read_b64_tr_b16 a[158:159], v4
buffer_load_dwordx4 v10, s[88:91], s30 offen offset:2048 lds
v_mfma_f32_16x16x32_bf16 v[36:39], a[168:171], a[188:191], v[36:39]
ds_read_b64_tr_b16 a[160:161], v1 offset:38912
v_mfma_f32_16x16x32_bf16 a[8:11], a[172:175], a[184:187], a[8:11]
ds_read_b64_tr_b16 a[162:163], v1 offset:48128
v_mfma_f32_16x16x32_bf16 a[12:15], a[172:175], a[188:191], a[12:15]
ds_read_b64_tr_b16 a[164:165], v1 offset:57344
s_waitcnt lgkmcnt(7)
v_mfma_f32_16x16x32_bf16 v[40:43], a[144:147], a[184:187], v[40:43]
ds_read_b64_tr_b16 a[166:167], v3 offset:1024
v_mfma_f32_16x16x32_bf16 v[44:47], a[144:147], a[188:191], v[44:47]
ds_read_b64_tr_b16 a[168:169], v2 offset:38912
v_mfma_f32_16x16x32_bf16 a[16:19], a[148:151], a[184:187], a[16:19]
ds_read_b64_tr_b16 a[170:171], v2 offset:48128
v_mfma_f32_16x16x32_bf16 a[20:23], a[148:151], a[188:191], a[20:23]
ds_read_b64_tr_b16 a[172:173], v2 offset:57344
s_waitcnt lgkmcnt(7)
v_mfma_f32_16x16x32_bf16 v[48:51], a[152:155], a[184:187], v[48:51]
ds_read_b64_tr_b16 a[174:175], v4 offset:1024
buffer_load_dwordx4 v11, s[88:91], s30 offen offset:3072 lds
v_mfma_f32_16x16x32_bf16 v[52:55], a[152:155], a[188:191], v[52:55]
ds_read_b64_tr_b16 a[144:145], v1 offset:39936
v_mfma_f32_16x16x32_bf16 a[24:27], a[156:159], a[184:187], a[24:27]
ds_read_b64_tr_b16 a[146:147], v1 offset:49152
v_mfma_f32_16x16x32_bf16 a[28:31], a[156:159], a[188:191], a[28:31]
ds_read_b64_tr_b16 a[148:149], v1 offset:58368
s_waitcnt lgkmcnt(7)
v_mfma_f32_16x16x32_bf16 v[56:59], a[160:163], a[184:187], v[56:59]
ds_read_b64_tr_b16 a[150:151], v3 offset:2048
v_mfma_f32_16x16x32_bf16 v[60:63], a[160:163], a[188:191], v[60:63]
ds_read_b64_tr_b16 a[152:153], v2 offset:39936
v_mfma_f32_16x16x32_bf16 a[32:35], a[164:167], a[184:187], a[32:35]
ds_read_b64_tr_b16 a[154:155], v2 offset:49152
s_add_u32 m0, s92, 114688
v_mfma_f32_16x16x32_bf16 a[36:39], a[164:167], a[188:191], a[36:39]
ds_read_b64_tr_b16 a[156:157], v2 offset:58368
s_waitcnt lgkmcnt(7)
v_mfma_f32_16x16x32_bf16 v[64:67], a[168:171], a[184:187], v[64:67]
ds_read_b64_tr_b16 a[158:159], v4 offset:2048
s_add_u32 s31, s93, 4423936
v_mfma_f32_16x16x32_bf16 v[68:71], a[168:171], a[188:191], v[68:71]
buffer_load_dwordx4 v8, s[88:91], s31 offen lds
ds_read_b64_tr_b16 a[160:161], v1 offset:40960
v_mfma_f32_16x16x32_bf16 a[40:43], a[172:175], a[184:187], a[40:43]
ds_read_b64_tr_b16 a[162:163], v1 offset:50176
v_mfma_f32_16x16x32_bf16 a[44:47], a[172:175], a[188:191], a[44:47]
ds_read_b64_tr_b16 a[164:165], v1 offset:59392
s_waitcnt lgkmcnt(7)
v_mfma_f32_16x16x32_bf16 v[72:75], a[144:147], a[184:187], v[72:75]
ds_read_b64_tr_b16 a[166:167], v3 offset:3072
v_mfma_f32_16x16x32_bf16 v[76:79], a[144:147], a[188:191], v[76:79]
ds_read_b64_tr_b16 a[168:169], v2 offset:40960
buffer_load_dwordx4 v9, s[88:91], s31 offen offset:1024 lds
v_mfma_f32_16x16x32_bf16 a[48:51], a[148:151], a[184:187], a[48:51]
ds_read_b64_tr_b16 a[170:171], v2 offset:50176
v_mfma_f32_16x16x32_bf16 a[52:55], a[148:151], a[188:191], a[52:55]
ds_read_b64_tr_b16 a[172:173], v2 offset:59392
s_waitcnt lgkmcnt(7)
v_mfma_f32_16x16x32_bf16 v[80:83], a[152:155], a[184:187], v[80:83]
ds_read_b64_tr_b16 a[174:175], v4 offset:3072
v_mfma_f32_16x16x32_bf16 v[84:87], a[152:155], a[188:191], v[84:87]
ds_read_b64_tr_b16 a[144:145], v1 offset:41984
v_mfma_f32_16x16x32_bf16 a[56:59], a[156:159], a[184:187], a[56:59]
ds_read_b64_tr_b16 a[146:147], v1 offset:51200
v_mfma_f32_16x16x32_bf16 a[60:63], a[156:159], a[188:191], a[60:63]
ds_read_b64_tr_b16 a[148:149], v1 offset:60416
s_waitcnt lgkmcnt(7)
v_mfma_f32_16x16x32_bf16 v[88:91], a[160:163], a[184:187], v[88:91]
ds_read_b64_tr_b16 a[150:151], v3 offset:4096
buffer_load_dwordx4 v10, s[88:91], s31 offen offset:2048 lds
v_mfma_f32_16x16x32_bf16 v[92:95], a[160:163], a[188:191], v[92:95]
ds_read_b64_tr_b16 a[152:153], v2 offset:41984
v_mfma_f32_16x16x32_bf16 a[64:67], a[164:167], a[184:187], a[64:67]
ds_read_b64_tr_b16 a[154:155], v2 offset:51200
v_mfma_f32_16x16x32_bf16 a[68:71], a[164:167], a[188:191], a[68:71]
ds_read_b64_tr_b16 a[156:157], v2 offset:60416
s_waitcnt lgkmcnt(7)
v_mfma_f32_16x16x32_bf16 v[96:99], a[168:171], a[184:187], v[96:99]
ds_read_b64_tr_b16 a[158:159], v4 offset:4096
v_mfma_f32_16x16x32_bf16 v[100:103], a[168:171], a[188:191], v[100:103]
ds_read_b64_tr_b16 a[160:161], v1 offset:43008
v_mfma_f32_16x16x32_bf16 a[72:75], a[172:175], a[184:187], a[72:75]
ds_read_b64_tr_b16 a[162:163], v1 offset:52224
v_mfma_f32_16x16x32_bf16 a[76:79], a[172:175], a[188:191], a[76:79]
ds_read_b64_tr_b16 a[164:165], v1 offset:61440
s_waitcnt lgkmcnt(7)
v_mfma_f32_16x16x32_bf16 v[104:107], a[144:147], a[184:187], v[104:107]
ds_read_b64_tr_b16 a[166:167], v3 offset:5120
buffer_load_dwordx4 v11, s[88:91], s31 offen offset:3072 lds
v_mfma_f32_16x16x32_bf16 v[108:111], a[144:147], a[188:191], v[108:111]
ds_read_b64_tr_b16 a[168:169], v2 offset:43008
s_add_u32 s33, s26, 16384
v_mfma_f32_16x16x32_bf16 a[80:83], a[148:151], a[184:187], a[80:83]
ds_read_b64_tr_b16 a[170:171], v2 offset:52224
buffer_load_dwordx4 a[176:179], v7, s[16:19], s33 offen sc1
v_mfma_f32_16x16x32_bf16 a[84:87], a[148:151], a[188:191], a[84:87]
ds_read_b64_tr_b16 a[172:173], v2 offset:61440
s_waitcnt lgkmcnt(7)
v_mfma_f32_16x16x32_bf16 v[112:115], a[152:155], a[184:187], v[112:115]
ds_read_b64_tr_b16 a[174:175], v4 offset:5120
buffer_load_dwordx4 a[180:183], v16, s[16:19], s33 offen sc1
v_mfma_f32_16x16x32_bf16 v[116:119], a[152:155], a[188:191], v[116:119]
ds_read_b64_tr_b16 a[144:145], v1 offset:44032
v_mfma_f32_16x16x32_bf16 a[88:91], a[156:159], a[184:187], a[88:91]
ds_read_b64_tr_b16 a[146:147], v1 offset:53248
s_add_u32 m0, s92, 118784
v_mfma_f32_16x16x32_bf16 a[92:95], a[156:159], a[188:191], a[92:95]
ds_read_b64_tr_b16 a[148:149], v1 offset:62464
s_waitcnt lgkmcnt(7)
v_mfma_f32_16x16x32_bf16 v[120:123], a[160:163], a[184:187], v[120:123]
ds_read_b64_tr_b16 a[150:151], v3 offset:6144
s_add_u32 s32, s93, 4424192
v_mfma_f32_16x16x32_bf16 v[124:127], a[160:163], a[188:191], v[124:127]
buffer_load_dwordx4 v8, s[88:91], s32 offen lds
ds_read_b64_tr_b16 a[152:153], v2 offset:44032
v_mfma_f32_16x16x32_bf16 a[96:99], a[164:167], a[184:187], a[96:99]
ds_read_b64_tr_b16 a[154:155], v2 offset:53248
v_mfma_f32_16x16x32_bf16 a[100:103], a[164:167], a[188:191], a[100:103]
ds_read_b64_tr_b16 a[156:157], v2 offset:62464
s_waitcnt lgkmcnt(7)
v_mfma_f32_16x16x32_bf16 v[128:131], a[168:171], a[184:187], v[128:131]
ds_read_b64_tr_b16 a[158:159], v4 offset:6144
v_mfma_f32_16x16x32_bf16 v[132:135], a[168:171], a[188:191], v[132:135]
ds_read_b64_tr_b16 a[160:161], v1 offset:45056
v_mfma_f32_16x16x32_bf16 a[104:107], a[172:175], a[184:187], a[104:107]
ds_read_b64_tr_b16 a[162:163], v1 offset:54272
v_mfma_f32_16x16x32_bf16 a[108:111], a[172:175], a[188:191], a[108:111]
ds_read_b64_tr_b16 a[164:165], v1 offset:63488
s_waitcnt lgkmcnt(7)
v_mfma_f32_16x16x32_bf16 v[136:139], a[144:147], a[184:187], v[136:139]
ds_read_b64_tr_b16 a[166:167], v3 offset:7168
v_mfma_f32_16x16x32_bf16 v[140:143], a[144:147], a[188:191], v[140:143]
ds_read_b64_tr_b16 a[168:169], v2 offset:45056
v_mfma_f32_16x16x32_bf16 a[112:115], a[148:151], a[184:187], a[112:115]
ds_read_b64_tr_b16 a[170:171], v2 offset:54272
v_mfma_f32_16x16x32_bf16 a[116:119], a[148:151], a[188:191], a[116:119]
ds_read_b64_tr_b16 a[172:173], v2 offset:63488
s_waitcnt lgkmcnt(7)
v_mfma_f32_16x16x32_bf16 v[144:147], a[152:155], a[184:187], v[144:147]
ds_read_b64_tr_b16 a[174:175], v4 offset:7168
v_mfma_f32_16x16x32_bf16 v[148:151], a[152:155], a[188:191], v[148:151]
s_waitcnt vmcnt(11)
s_barrier
ds_read_b64_tr_b16 a[144:145], v3 offset:8192
v_mfma_f32_16x16x32_bf16 a[120:123], a[156:159], a[184:187], a[120:123]
ds_read_b64_tr_b16 a[146:147], v3 offset:17408
s_add_u32 m0, s92, 0
v_mfma_f32_16x16x32_bf16 a[124:127], a[156:159], a[188:191], a[124:127]
ds_read_b64_tr_b16 a[148:149], v3 offset:26624
s_waitcnt lgkmcnt(7)
v_mfma_f32_16x16x32_bf16 v[152:155], a[160:163], a[184:187], v[152:155]
ds_read_b64_tr_b16 a[150:151], v3 offset:35840
s_add_u32 s30, s93, 4718592
v_mfma_f32_16x16x32_bf16 v[156:159], a[160:163], a[188:191], v[156:159]
buffer_load_dwordx4 v8, s[88:91], s30 offen lds
ds_read_b64_tr_b16 a[152:153], v4 offset:8192
v_mfma_f32_16x16x32_bf16 a[128:131], a[164:167], a[184:187], a[128:131]
ds_read_b64_tr_b16 a[154:155], v4 offset:17408
v_mfma_f32_16x16x32_bf16 a[132:135], a[164:167], a[188:191], a[132:135]
ds_read_b64_tr_b16 a[156:157], v4 offset:26624
s_waitcnt lgkmcnt(7)
v_mfma_f32_16x16x32_bf16 v[160:163], a[168:171], a[184:187], v[160:163]
ds_read_b64_tr_b16 a[158:159], v4 offset:35840
v_mfma_f32_16x16x32_bf16 v[164:167], a[168:171], a[188:191], v[164:167]
ds_read_b64_tr_b16 a[160:161], v3 offset:9216
buffer_load_dwordx4 v9, s[88:91], s30 offen offset:1024 lds
v_mfma_f32_16x16x32_bf16 a[136:139], a[172:175], a[184:187], a[136:139]
ds_read_b64_tr_b16 a[162:163], v3 offset:18432
v_mfma_f32_16x16x32_bf16 a[140:143], a[172:175], a[188:191], a[140:143]
ds_read_b64_tr_b16 a[164:165], v3 offset:27648
s_waitcnt lgkmcnt(7)
v_mfma_f32_16x16x32_bf16 v[24:27], a[144:147], a[192:195], v[24:27]
ds_read_b64_tr_b16 a[166:167], v3 offset:36864
v_mfma_f32_16x16x32_bf16 v[28:31], a[144:147], a[196:199], v[28:31]
ds_read_b64_tr_b16 a[168:169], v4 offset:9216
v_mfma_f32_16x16x32_bf16 a[0:3], a[148:151], a[192:195], a[0:3]
ds_read_b64_tr_b16 a[170:171], v4 offset:18432
v_mfma_f32_16x16x32_bf16 a[4:7], a[148:151], a[196:199], a[4:7]
ds_read_b64_tr_b16 a[172:173], v4 offset:27648
s_waitcnt lgkmcnt(7)
v_mfma_f32_16x16x32_bf16 v[32:35], a[152:155], a[192:195], v[32:35]
ds_read_b64_tr_b16 a[174:175], v4 offset:36864
buffer_load_dwordx4 v10, s[88:91], s30 offen offset:2048 lds
v_mfma_f32_16x16x32_bf16 v[36:39], a[152:155], a[196:199], v[36:39]
ds_read_b64_tr_b16 a[144:145], v3 offset:10240
v_mfma_f32_16x16x32_bf16 a[8:11], a[156:159], a[192:195], a[8:11]
ds_read_b64_tr_b16 a[146:147], v3 offset:19456
v_mfma_f32_16x16x32_bf16 a[12:15], a[156:159], a[196:199], a[12:15]
ds_read_b64_tr_b16 a[148:149], v3 offset:28672
s_waitcnt lgkmcnt(7)
v_mfma_f32_16x16x32_bf16 v[40:43], a[160:163], a[192:195], v[40:43]
ds_read_b64_tr_b16 a[150:151], v3 offset:37888
v_mfma_f32_16x16x32_bf16 v[44:47], a[160:163], a[196:199], v[44:47]
ds_read_b64_tr_b16 a[152:153], v4 offset:10240
v_mfma_f32_16x16x32_bf16 a[16:19], a[164:167], a[192:195], a[16:19]
ds_read_b64_tr_b16 a[154:155], v4 offset:19456
v_mfma_f32_16x16x32_bf16 a[20:23], a[164:167], a[196:199], a[20:23]
ds_read_b64_tr_b16 a[156:157], v4 offset:28672
s_waitcnt lgkmcnt(7)
v_mfma_f32_16x16x32_bf16 v[48:51], a[168:171], a[192:195], v[48:51]
ds_read_b64_tr_b16 a[158:159], v4 offset:37888
buffer_load_dwordx4 v11, s[88:91], s30 offen offset:3072 lds
v_mfma_f32_16x16x32_bf16 v[52:55], a[168:171], a[196:199], v[52:55]
ds_read_b64_tr_b16 a[160:161], v3 offset:11264
v_mfma_f32_16x16x32_bf16 a[24:27], a[172:175], a[192:195], a[24:27]
ds_read_b64_tr_b16 a[162:163], v3 offset:20480
v_mfma_f32_16x16x32_bf16 a[28:31], a[172:175], a[196:199], a[28:31]
ds_read_b64_tr_b16 a[164:165], v3 offset:29696
s_waitcnt lgkmcnt(7)
v_mfma_f32_16x16x32_bf16 v[56:59], a[144:147], a[192:195], v[56:59]
ds_read_b64_tr_b16 a[166:167], v3 offset:38912
v_mfma_f32_16x16x32_bf16 v[60:63], a[144:147], a[196:199], v[60:63]
ds_read_b64_tr_b16 a[168:169], v4 offset:11264
v_mfma_f32_16x16x32_bf16 a[32:35], a[148:151], a[192:195], a[32:35]
ds_read_b64_tr_b16 a[170:171], v4 offset:20480
s_add_u32 m0, s92, 4096
v_mfma_f32_16x16x32_bf16 a[36:39], a[148:151], a[196:199], a[36:39]
ds_read_b64_tr_b16 a[172:173], v4 offset:29696
s_waitcnt lgkmcnt(7)
v_mfma_f32_16x16x32_bf16 v[64:67], a[152:155], a[192:195], v[64:67]
ds_read_b64_tr_b16 a[174:175], v4 offset:38912
s_add_u32 s31, s93, 4718848
v_mfma_f32_16x16x32_bf16 v[68:71], a[152:155], a[196:199], v[68:71]
buffer_load_dwordx4 v8, s[88:91], s31 offen lds
ds_read_b64_tr_b16 a[144:145], v3 offset:12288
v_mfma_f32_16x16x32_bf16 a[40:43], a[156:159], a[192:195], a[40:43]
ds_read_b64_tr_b16 a[146:147], v3 offset:21504
v_mfma_f32_16x16x32_bf16 a[44:47], a[156:159], a[196:199], a[44:47]
ds_read_b64_tr_b16 a[148:149], v3 offset:30720
s_waitcnt lgkmcnt(7)
v_mfma_f32_16x16x32_bf16 v[72:75], a[160:163], a[192:195], v[72:75]
ds_read_b64_tr_b16 a[150:151], v3 offset:39936
v_mfma_f32_16x16x32_bf16 v[76:79], a[160:163], a[196:199], v[76:79]
ds_read_b64_tr_b16 a[152:153], v4 offset:12288
buffer_load_dwordx4 v9, s[88:91], s31 offen offset:1024 lds
v_mfma_f32_16x16x32_bf16 a[48:51], a[164:167], a[192:195], a[48:51]
ds_read_b64_tr_b16 a[154:155], v4 offset:21504
v_mfma_f32_16x16x32_bf16 a[52:55], a[164:167], a[196:199], a[52:55]
ds_read_b64_tr_b16 a[156:157], v4 offset:30720
s_waitcnt lgkmcnt(7)
v_mfma_f32_16x16x32_bf16 v[80:83], a[168:171], a[192:195], v[80:83]
ds_read_b64_tr_b16 a[158:159], v4 offset:39936
v_mfma_f32_16x16x32_bf16 v[84:87], a[168:171], a[196:199], v[84:87]
ds_read_b64_tr_b16 a[160:161], v3 offset:13312
v_mfma_f32_16x16x32_bf16 a[56:59], a[172:175], a[192:195], a[56:59]
ds_read_b64_tr_b16 a[162:163], v3 offset:22528
v_mfma_f32_16x16x32_bf16 a[60:63], a[172:175], a[196:199], a[60:63]
ds_read_b64_tr_b16 a[164:165], v3 offset:31744
s_waitcnt lgkmcnt(7)
v_mfma_f32_16x16x32_bf16 v[88:91], a[144:147], a[192:195], v[88:91]
ds_read_b64_tr_b16 a[166:167], v3 offset:40960
buffer_load_dwordx4 v10, s[88:91], s31 offen offset:2048 lds
v_mfma_f32_16x16x32_bf16 v[92:95], a[144:147], a[196:199], v[92:95]
ds_read_b64_tr_b16 a[168:169], v4 offset:13312
v_mfma_f32_16x16x32_bf16 a[64:67], a[148:151], a[192:195], a[64:67]
ds_read_b64_tr_b16 a[170:171], v4 offset:22528
v_mfma_f32_16x16x32_bf16 a[68:71], a[148:151], a[196:199], a[68:71]
ds_read_b64_tr_b16 a[172:173], v4 offset:31744
s_waitcnt lgkmcnt(7)
v_mfma_f32_16x16x32_bf16 v[96:99], a[152:155], a[192:195], v[96:99]
ds_read_b64_tr_b16 a[174:175], v4 offset:40960
v_mfma_f32_16x16x32_bf16 v[100:103], a[152:155], a[196:199], v[100:103]
ds_read_b64_tr_b16 a[144:145], v3 offset:14336
v_mfma_f32_16x16x32_bf16 a[72:75], a[156:159], a[192:195], a[72:75]
ds_read_b64_tr_b16 a[146:147], v3 offset:23552
v_mfma_f32_16x16x32_bf16 a[76:79], a[156:159], a[196:199], a[76:79]
ds_read_b64_tr_b16 a[148:149], v3 offset:32768
s_waitcnt lgkmcnt(7)
v_mfma_f32_16x16x32_bf16 v[104:107], a[160:163], a[192:195], v[104:107]
ds_read_b64_tr_b16 a[150:151], v3 offset:41984
buffer_load_dwordx4 v11, s[88:91], s31 offen offset:3072 lds
v_mfma_f32_16x16x32_bf16 v[108:111], a[160:163], a[196:199], v[108:111]
ds_read_b64_tr_b16 a[152:153], v4 offset:14336
buffer_load_dwordx4 a[184:187], v7, s[16:19], s33 offen offset:1024 sc1
v_mfma_f32_16x16x32_bf16 a[80:83], a[164:167], a[192:195], a[80:83]
ds_read_b64_tr_b16 a[154:155], v4 offset:23552
buffer_load_dwordx4 a[188:191], v16, s[16:19], s33 offen offset:1024 sc1
v_mfma_f32_16x16x32_bf16 a[84:87], a[164:167], a[196:199], a[84:87]
ds_read_b64_tr_b16 a[156:157], v4 offset:32768
s_waitcnt lgkmcnt(7)
v_mfma_f32_16x16x32_bf16 v[112:115], a[168:171], a[192:195], v[112:115]
ds_read_b64_tr_b16 a[158:159], v4 offset:41984
v_mfma_f32_16x16x32_bf16 v[116:119], a[168:171], a[196:199], v[116:119]
ds_read_b64_tr_b16 a[160:161], v3 offset:15360
v_mfma_f32_16x16x32_bf16 a[88:91], a[172:175], a[192:195], a[88:91]
ds_read_b64_tr_b16 a[162:163], v3 offset:24576
s_add_u32 m0, s92, 8192
v_mfma_f32_16x16x32_bf16 a[92:95], a[172:175], a[196:199], a[92:95]
ds_read_b64_tr_b16 a[164:165], v3 offset:33792
s_waitcnt lgkmcnt(7)
v_mfma_f32_16x16x32_bf16 v[120:123], a[144:147], a[192:195], v[120:123]
ds_read_b64_tr_b16 a[166:167], v3 offset:43008
s_add_u32 s32, s93, 4719104
v_mfma_f32_16x16x32_bf16 v[124:127], a[144:147], a[196:199], v[124:127]
buffer_load_dwordx4 v8, s[88:91], s32 offen lds
ds_read_b64_tr_b16 a[168:169], v4 offset:15360
v_mfma_f32_16x16x32_bf16 a[96:99], a[148:151], a[192:195], a[96:99]
ds_read_b64_tr_b16 a[170:171], v4 offset:24576
v_mfma_f32_16x16x32_bf16 a[100:103], a[148:151], a[196:199], a[100:103]
ds_read_b64_tr_b16 a[172:173], v4 offset:33792
s_waitcnt lgkmcnt(7)
v_mfma_f32_16x16x32_bf16 v[128:131], a[152:155], a[192:195], v[128:131]
ds_read_b64_tr_b16 a[174:175], v4 offset:43008
v_mfma_f32_16x16x32_bf16 v[132:135], a[152:155], a[196:199], v[132:135]
ds_read_b64_tr_b16 a[144:145], v3 offset:16384
v_mfma_f32_16x16x32_bf16 a[104:107], a[156:159], a[192:195], a[104:107]
ds_read_b64_tr_b16 a[146:147], v3 offset:25600
v_mfma_f32_16x16x32_bf16 a[108:111], a[156:159], a[196:199], a[108:111]
ds_read_b64_tr_b16 a[148:149], v3 offset:34816
s_waitcnt lgkmcnt(7)
v_mfma_f32_16x16x32_bf16 v[136:139], a[160:163], a[192:195], v[136:139]
ds_read_b64_tr_b16 a[150:151], v3 offset:44032
v_mfma_f32_16x16x32_bf16 v[140:143], a[160:163], a[196:199], v[140:143]
ds_read_b64_tr_b16 a[152:153], v4 offset:16384
v_mfma_f32_16x16x32_bf16 a[112:115], a[164:167], a[192:195], a[112:115]
ds_read_b64_tr_b16 a[154:155], v4 offset:25600
v_mfma_f32_16x16x32_bf16 a[116:119], a[164:167], a[196:199], a[116:119]
ds_read_b64_tr_b16 a[156:157], v4 offset:34816
s_waitcnt lgkmcnt(7)
v_mfma_f32_16x16x32_bf16 v[144:147], a[168:171], a[192:195], v[144:147]
ds_read_b64_tr_b16 a[158:159], v4 offset:44032
v_mfma_f32_16x16x32_bf16 v[148:151], a[168:171], a[196:199], v[148:151]
s_waitcnt vmcnt(11)
s_barrier
ds_read_b64_tr_b16 a[160:161], v3 offset:45056
v_mfma_f32_16x16x32_bf16 a[120:123], a[172:175], a[192:195], a[120:123]
ds_read_b64_tr_b16 a[162:163], v3 offset:54272
s_add_u32 m0, s92, 36864
v_mfma_f32_16x16x32_bf16 a[124:127], a[172:175], a[196:199], a[124:127]
ds_read_b64_tr_b16 a[164:165], v3 offset:63488
s_waitcnt lgkmcnt(7)
v_mfma_f32_16x16x32_bf16 v[152:155], a[144:147], a[192:195], v[152:155]
ds_read_b64_tr_b16 a[166:167], v5 offset:7168
s_add_u32 s30, s93, 5013504
v_mfma_f32_16x16x32_bf16 v[156:159], a[144:147], a[196:199], v[156:159]
buffer_load_dwordx4 v8, s[88:91], s30 offen lds
ds_read_b64_tr_b16 a[168:169], v4 offset:45056
v_mfma_f32_16x16x32_bf16 a[128:131], a[148:151], a[192:195], a[128:131]
ds_read_b64_tr_b16 a[170:171], v4 offset:54272
v_mfma_f32_16x16x32_bf16 a[132:135], a[148:151], a[196:199], a[132:135]
ds_read_b64_tr_b16 a[172:173], v4 offset:63488
s_waitcnt lgkmcnt(7)
v_mfma_f32_16x16x32_bf16 v[160:163], a[152:155], a[192:195], v[160:163]
ds_read_b64_tr_b16 a[174:175], v6 offset:7168
v_mfma_f32_16x16x32_bf16 v[164:167], a[152:155], a[196:199], v[164:167]
ds_read_b64_tr_b16 a[144:145], v3 offset:46080
buffer_load_dwordx4 v9, s[88:91], s30 offen offset:1024 lds
v_mfma_f32_16x16x32_bf16 a[136:139], a[156:159], a[192:195], a[136:139]
ds_read_b64_tr_b16 a[146:147], v3 offset:55296
v_mfma_f32_16x16x32_bf16 a[140:143], a[156:159], a[196:199], a[140:143]
ds_read_b64_tr_b16 a[148:149], v3 offset:64512
s_waitcnt lgkmcnt(7)
v_mfma_f32_16x16x32_bf16 v[24:27], a[160:163], a[200:203], v[24:27]
ds_read_b64_tr_b16 a[150:151], v5 offset:8192
v_mfma_f32_16x16x32_bf16 v[28:31], a[160:163], a[204:207], v[28:31]
ds_read_b64_tr_b16 a[152:153], v4 offset:46080
v_mfma_f32_16x16x32_bf16 a[0:3], a[164:167], a[200:203], a[0:3]
ds_read_b64_tr_b16 a[154:155], v4 offset:55296
v_mfma_f32_16x16x32_bf16 a[4:7], a[164:167], a[204:207], a[4:7]
ds_read_b64_tr_b16 a[156:157], v4 offset:64512
s_waitcnt lgkmcnt(7)
v_mfma_f32_16x16x32_bf16 v[32:35], a[168:171], a[200:203], v[32:35]
ds_read_b64_tr_b16 a[158:159], v6 offset:8192
buffer_load_dwordx4 v10, s[88:91], s30 offen offset:2048 lds
v_mfma_f32_16x16x32_bf16 v[36:39], a[168:171], a[204:207], v[36:39]
ds_read_b64_tr_b16 a[160:161], v3 offset:47104
v_mfma_f32_16x16x32_bf16 a[8:11], a[172:175], a[200:203], a[8:11]
ds_read_b64_tr_b16 a[162:163], v3 offset:56320
v_mfma_f32_16x16x32_bf16 a[12:15], a[172:175], a[204:207], a[12:15]
ds_read_b64_tr_b16 a[164:165], v5
s_waitcnt lgkmcnt(7)
v_mfma_f32_16x16x32_bf16 v[40:43], a[144:147], a[200:203], v[40:43]
ds_read_b64_tr_b16 a[166:167], v5 offset:9216
v_mfma_f32_16x16x32_bf16 v[44:47], a[144:147], a[204:207], v[44:47]
ds_read_b64_tr_b16 a[168:169], v4 offset:47104
v_mfma_f32_16x16x32_bf16 a[16:19], a[148:151], a[200:203], a[16:19]
ds_read_b64_tr_b16 a[170:171], v4 offset:56320
v_mfma_f32_16x16x32_bf16 a[20:23], a[148:151], a[204:207], a[20:23]
ds_read_b64_tr_b16 a[172:173], v6
s_waitcnt lgkmcnt(7)
v_mfma_f32_16x16x32_bf16 v[48:51], a[152:155], a[200:203], v[48:51]
ds_read_b64_tr_b16 a[174:175], v6 offset:9216
buffer_load_dwordx4 v11, s[88:91], s30 offen offset:3072 lds
v_mfma_f32_16x16x32_bf16 v[52:55], a[152:155], a[204:207], v[52:55]
ds_read_b64_tr_b16 a[144:145], v3 offset:48128
v_mfma_f32_16x16x32_bf16 a[24:27], a[156:159], a[200:203], a[24:27]
ds_read_b64_tr_b16 a[146:147], v3 offset:57344
v_mfma_f32_16x16x32_bf16 a[28:31], a[156:159], a[204:207], a[28:31]
ds_read_b64_tr_b16 a[148:149], v5 offset:1024
s_waitcnt lgkmcnt(7)
v_mfma_f32_16x16x32_bf16 v[56:59], a[160:163], a[200:203], v[56:59]
ds_read_b64_tr_b16 a[150:151], v5 offset:10240
v_mfma_f32_16x16x32_bf16 v[60:63], a[160:163], a[204:207], v[60:63]
ds_read_b64_tr_b16 a[152:153], v4 offset:48128
v_mfma_f32_16x16x32_bf16 a[32:35], a[164:167], a[200:203], a[32:35]
ds_read_b64_tr_b16 a[154:155], v4 offset:57344
s_add_u32 m0, s92, 40960
v_mfma_f32_16x16x32_bf16 a[36:39], a[164:167], a[204:207], a[36:39]
ds_read_b64_tr_b16 a[156:157], v6 offset:1024
s_waitcnt lgkmcnt(7)
v_mfma_f32_16x16x32_bf16 v[64:67], a[168:171], a[200:203], v[64:67]
ds_read_b64_tr_b16 a[158:159], v6 offset:10240
s_add_u32 s31, s93, 5013760
v_mfma_f32_16x16x32_bf16 v[68:71], a[168:171], a[204:207], v[68:71]
buffer_load_dwordx4 v8, s[88:91], s31 offen lds
ds_read_b64_tr_b16 a[160:161], v3 offset:49152
v_mfma_f32_16x16x32_bf16 a[40:43], a[172:175], a[200:203], a[40:43]
ds_read_b64_tr_b16 a[162:163], v3 offset:58368
v_mfma_f32_16x16x32_bf16 a[44:47], a[172:175], a[204:207], a[44:47]
ds_read_b64_tr_b16 a[164:165], v5 offset:2048
s_waitcnt lgkmcnt(7)
v_mfma_f32_16x16x32_bf16 v[72:75], a[144:147], a[200:203], v[72:75]
ds_read_b64_tr_b16 a[166:167], v5 offset:11264
v_mfma_f32_16x16x32_bf16 v[76:79], a[144:147], a[204:207], v[76:79]
ds_read_b64_tr_b16 a[168:169], v4 offset:49152
buffer_load_dwordx4 v9, s[88:91], s31 offen offset:1024 lds
v_mfma_f32_16x16x32_bf16 a[48:51], a[148:151], a[200:203], a[48:51]
ds_read_b64_tr_b16 a[170:171], v4 offset:58368
v_mfma_f32_16x16x32_bf16 a[52:55], a[148:151], a[204:207], a[52:55]
ds_read_b64_tr_b16 a[172:173], v6 offset:2048
s_waitcnt lgkmcnt(7)
v_mfma_f32_16x16x32_bf16 v[80:83], a[152:155], a[200:203], v[80:83]
ds_read_b64_tr_b16 a[174:175], v6 offset:11264
v_mfma_f32_16x16x32_bf16 v[84:87], a[152:155], a[204:207], v[84:87]
ds_read_b64_tr_b16 a[144:145], v3 offset:50176
v_mfma_f32_16x16x32_bf16 a[56:59], a[156:159], a[200:203], a[56:59]
ds_read_b64_tr_b16 a[146:147], v3 offset:59392
v_mfma_f32_16x16x32_bf16 a[60:63], a[156:159], a[204:207], a[60:63]
ds_read_b64_tr_b16 a[148:149], v5 offset:3072
s_waitcnt lgkmcnt(7)
v_mfma_f32_16x16x32_bf16 v[88:91], a[160:163], a[200:203], v[88:91]
ds_read_b64_tr_b16 a[150:151], v5 offset:12288
buffer_load_dwordx4 v10, s[88:91], s31 offen offset:2048 lds
v_mfma_f32_16x16x32_bf16 v[92:95], a[160:163], a[204:207], v[92:95]
ds_read_b64_tr_b16 a[152:153], v4 offset:50176
v_mfma_f32_16x16x32_bf16 a[64:67], a[164:167], a[200:203], a[64:67]
ds_read_b64_tr_b16 a[154:155], v4 offset:59392
v_mfma_f32_16x16x32_bf16 a[68:71], a[164:167], a[204:207], a[68:71]
ds_read_b64_tr_b16 a[156:157], v6 offset:3072
s_waitcnt lgkmcnt(7)
v_mfma_f32_16x16x32_bf16 v[96:99], a[168:171], a[200:203], v[96:99]
ds_read_b64_tr_b16 a[158:159], v6 offset:12288
v_mfma_f32_16x16x32_bf16 v[100:103], a[168:171], a[204:207], v[100:103]
ds_read_b64_tr_b16 a[160:161], v3 offset:51200
v_mfma_f32_16x16x32_bf16 a[72:75], a[172:175], a[200:203], a[72:75]
ds_read_b64_tr_b16 a[162:163], v3 offset:60416
v_mfma_f32_16x16x32_bf16 a[76:79], a[172:175], a[204:207], a[76:79]
ds_read_b64_tr_b16 a[164:165], v5 offset:4096
s_waitcnt lgkmcnt(7)
v_mfma_f32_16x16x32_bf16 v[104:107], a[144:147], a[200:203], v[104:107]
ds_read_b64_tr_b16 a[166:167], v5 offset:13312
buffer_load_dwordx4 v11, s[88:91], s31 offen offset:3072 lds
v_mfma_f32_16x16x32_bf16 v[108:111], a[144:147], a[204:207], v[108:111]
ds_read_b64_tr_b16 a[168:169], v4 offset:51200
v_mfma_f32_16x16x32_bf16 a[80:83], a[148:151], a[200:203], a[80:83]
ds_read_b64_tr_b16 a[170:171], v4 offset:60416
v_mfma_f32_16x16x32_bf16 a[84:87], a[148:151], a[204:207], a[84:87]
ds_read_b64_tr_b16 a[172:173], v6 offset:4096
s_waitcnt lgkmcnt(7)
v_mfma_f32_16x16x32_bf16 v[112:115], a[152:155], a[200:203], v[112:115]
ds_read_b64_tr_b16 a[174:175], v6 offset:13312
v_mfma_f32_16x16x32_bf16 v[116:119], a[152:155], a[204:207], v[116:119]
ds_read_b64_tr_b16 a[144:145], v3 offset:52224
v_mfma_f32_16x16x32_bf16 a[88:91], a[156:159], a[200:203], a[88:91]
ds_read_b64_tr_b16 a[146:147], v3 offset:61440
s_add_u32 m0, s92, 45056
v_mfma_f32_16x16x32_bf16 a[92:95], a[156:159], a[204:207], a[92:95]
ds_read_b64_tr_b16 a[148:149], v5 offset:5120
s_waitcnt lgkmcnt(7)
v_mfma_f32_16x16x32_bf16 v[120:123], a[160:163], a[200:203], v[120:123]
ds_read_b64_tr_b16 a[150:151], v5 offset:14336
s_add_u32 s32, s93, 5014016
v_mfma_f32_16x16x32_bf16 v[124:127], a[160:163], a[204:207], v[124:127]
buffer_load_dwordx4 v8, s[88:91], s32 offen lds
ds_read_b64_tr_b16 a[152:153], v4 offset:52224
v_mfma_f32_16x16x32_bf16 a[96:99], a[164:167], a[200:203], a[96:99]
ds_read_b64_tr_b16 a[154:155], v4 offset:61440
v_mfma_f32_16x16x32_bf16 a[100:103], a[164:167], a[204:207], a[100:103]
ds_read_b64_tr_b16 a[156:157], v6 offset:5120
s_waitcnt lgkmcnt(7)
v_mfma_f32_16x16x32_bf16 v[128:131], a[168:171], a[200:203], v[128:131]
ds_read_b64_tr_b16 a[158:159], v6 offset:14336
v_mfma_f32_16x16x32_bf16 v[132:135], a[168:171], a[204:207], v[132:135]
ds_read_b64_tr_b16 a[160:161], v3 offset:53248
v_mfma_f32_16x16x32_bf16 a[104:107], a[172:175], a[200:203], a[104:107]
ds_read_b64_tr_b16 a[162:163], v3 offset:62464
v_mfma_f32_16x16x32_bf16 a[108:111], a[172:175], a[204:207], a[108:111]
ds_read_b64_tr_b16 a[164:165], v5 offset:6144
s_waitcnt lgkmcnt(7)
v_mfma_f32_16x16x32_bf16 v[136:139], a[144:147], a[200:203], v[136:139]
ds_read_b64_tr_b16 a[166:167], v5 offset:15360
v_mfma_f32_16x16x32_bf16 v[140:143], a[144:147], a[204:207], v[140:143]
ds_read_b64_tr_b16 a[168:169], v4 offset:53248
v_mfma_f32_16x16x32_bf16 a[112:115], a[148:151], a[200:203], a[112:115]
ds_read_b64_tr_b16 a[170:171], v4 offset:62464
v_mfma_f32_16x16x32_bf16 a[116:119], a[148:151], a[204:207], a[116:119]
ds_read_b64_tr_b16 a[172:173], v6 offset:6144
s_waitcnt lgkmcnt(7)
v_mfma_f32_16x16x32_bf16 v[144:147], a[152:155], a[200:203], v[144:147]
ds_read_b64_tr_b16 a[174:175], v6 offset:15360
v_mfma_f32_16x16x32_bf16 v[148:151], a[152:155], a[204:207], v[148:151]
s_waitcnt vmcnt(9)
s_barrier
ds_read_b64_tr_b16 a[144:145], v1
v_mfma_f32_16x16x32_bf16 a[120:123], a[156:159], a[200:203], a[120:123]
ds_read_b64_tr_b16 a[146:147], v1 offset:9216
s_add_u32 m0, s92, 73728
v_mfma_f32_16x16x32_bf16 a[124:127], a[156:159], a[204:207], a[124:127]
ds_read_b64_tr_b16 a[148:149], v1 offset:18432
s_waitcnt lgkmcnt(7)
v_mfma_f32_16x16x32_bf16 v[152:155], a[160:163], a[200:203], v[152:155]
ds_read_b64_tr_b16 a[150:151], v1 offset:27648
s_add_u32 s30, s23, 0
v_mfma_f32_16x16x32_bf16 v[156:159], a[160:163], a[204:207], v[156:159]
buffer_load_dwordx4 v12, s[8:11], s30 offen lds
ds_read_b64_tr_b16 a[152:153], v2
v_mfma_f32_16x16x32_bf16 a[128:131], a[164:167], a[200:203], a[128:131]
ds_read_b64_tr_b16 a[154:155], v2 offset:9216
v_mfma_f32_16x16x32_bf16 a[132:135], a[164:167], a[204:207], a[132:135]
ds_read_b64_tr_b16 a[156:157], v2 offset:18432
s_waitcnt lgkmcnt(7)
v_mfma_f32_16x16x32_bf16 v[160:163], a[168:171], a[200:203], v[160:163]
ds_read_b64_tr_b16 a[158:159], v2 offset:27648
v_mfma_f32_16x16x32_bf16 v[164:167], a[168:171], a[204:207], v[164:167]
ds_read_b64_tr_b16 a[160:161], v1 offset:1024
buffer_load_dwordx4 v13, s[8:11], s30 offen offset:1024 lds
v_mfma_f32_16x16x32_bf16 a[136:139], a[172:175], a[200:203], a[136:139]
ds_read_b64_tr_b16 a[162:163], v1 offset:10240
v_mfma_f32_16x16x32_bf16 a[140:143], a[172:175], a[204:207], a[140:143]
ds_read_b64_tr_b16 a[164:165], v1 offset:19456
s_waitcnt lgkmcnt(7)
v_mfma_f32_16x16x32_bf16 v[24:27], a[144:147], a[176:179], v[24:27]
ds_read_b64_tr_b16 a[166:167], v1 offset:28672
v_mfma_f32_16x16x32_bf16 v[28:31], a[144:147], a[180:183], v[28:31]
ds_read_b64_tr_b16 a[168:169], v2 offset:1024
v_mfma_f32_16x16x32_bf16 a[0:3], a[148:151], a[176:179], a[0:3]
ds_read_b64_tr_b16 a[170:171], v2 offset:10240
v_mfma_f32_16x16x32_bf16 a[4:7], a[148:151], a[180:183], a[4:7]
ds_read_b64_tr_b16 a[172:173], v2 offset:19456
s_waitcnt lgkmcnt(7)
v_mfma_f32_16x16x32_bf16 v[32:35], a[152:155], a[176:179], v[32:35]
ds_read_b64_tr_b16 a[174:175], v2 offset:28672
buffer_load_dwordx4 v14, s[8:11], s30 offen offset:2048 lds
v_mfma_f32_16x16x32_bf16 v[36:39], a[152:155], a[180:183], v[36:39]
ds_read_b64_tr_b16 a[144:145], v1 offset:2048
v_mfma_f32_16x16x32_bf16 a[8:11], a[156:159], a[176:179], a[8:11]
ds_read_b64_tr_b16 a[146:147], v1 offset:11264
v_mfma_f32_16x16x32_bf16 a[12:15], a[156:159], a[180:183], a[12:15]
ds_read_b64_tr_b16 a[148:149], v1 offset:20480
s_waitcnt lgkmcnt(7)
v_mfma_f32_16x16x32_bf16 v[40:43], a[160:163], a[176:179], v[40:43]
ds_read_b64_tr_b16 a[150:151], v1 offset:29696
v_mfma_f32_16x16x32_bf16 v[44:47], a[160:163], a[180:183], v[44:47]
ds_read_b64_tr_b16 a[152:153], v2 offset:2048
v_mfma_f32_16x16x32_bf16 a[16:19], a[164:167], a[176:179], a[16:19]
ds_read_b64_tr_b16 a[154:155], v2 offset:11264
v_mfma_f32_16x16x32_bf16 a[20:23], a[164:167], a[180:183], a[20:23]
ds_read_b64_tr_b16 a[156:157], v2 offset:20480
s_waitcnt lgkmcnt(7)
v_mfma_f32_16x16x32_bf16 v[48:51], a[168:171], a[176:179], v[48:51]
ds_read_b64_tr_b16 a[158:159], v2 offset:29696
buffer_load_dwordx4 v15, s[8:11], s30 offen offset:3072 lds
v_mfma_f32_16x16x32_bf16 v[52:55], a[168:171], a[180:183], v[52:55]
ds_read_b64_tr_b16 a[160:161], v1 offset:3072
v_mfma_f32_16x16x32_bf16 a[24:27], a[172:175], a[176:179], a[24:27]
ds_read_b64_tr_b16 a[162:163], v1 offset:12288
v_mfma_f32_16x16x32_bf16 a[28:31], a[172:175], a[180:183], a[28:31]
ds_read_b64_tr_b16 a[164:165], v1 offset:21504
s_waitcnt lgkmcnt(7)
v_mfma_f32_16x16x32_bf16 v[56:59], a[144:147], a[176:179], v[56:59]
ds_read_b64_tr_b16 a[166:167], v1 offset:30720
v_mfma_f32_16x16x32_bf16 v[60:63], a[144:147], a[180:183], v[60:63]
ds_read_b64_tr_b16 a[168:169], v2 offset:3072
v_mfma_f32_16x16x32_bf16 a[32:35], a[148:151], a[176:179], a[32:35]
ds_read_b64_tr_b16 a[170:171], v2 offset:12288
s_add_u32 m0, s92, 77824
v_mfma_f32_16x16x32_bf16 a[36:39], a[148:151], a[180:183], a[36:39]
ds_read_b64_tr_b16 a[172:173], v2 offset:21504
s_waitcnt lgkmcnt(7)
v_mfma_f32_16x16x32_bf16 v[64:67], a[152:155], a[176:179], v[64:67]
ds_read_b64_tr_b16 a[174:175], v2 offset:30720
s_add_u32 s31, s23, 73728
v_mfma_f32_16x16x32_bf16 v[68:71], a[152:155], a[180:183], v[68:71]
buffer_load_dwordx4 v12, s[8:11], s31 offen lds
ds_read_b64_tr_b16 a[144:145], v1 offset:4096
v_mfma_f32_16x16x32_bf16 a[40:43], a[156:159], a[176:179], a[40:43]
ds_read_b64_tr_b16 a[146:147], v1 offset:13312
v_mfma_f32_16x16x32_bf16 a[44:47], a[156:159], a[180:183], a[44:47]
ds_read_b64_tr_b16 a[148:149], v1 offset:22528
s_waitcnt lgkmcnt(7)
v_mfma_f32_16x16x32_bf16 v[72:75], a[160:163], a[176:179], v[72:75]
ds_read_b64_tr_b16 a[150:151], v1 offset:31744
v_mfma_f32_16x16x32_bf16 v[76:79], a[160:163], a[180:183], v[76:79]
ds_read_b64_tr_b16 a[152:153], v2 offset:4096
buffer_load_dwordx4 v13, s[8:11], s31 offen offset:1024 lds
v_mfma_f32_16x16x32_bf16 a[48:51], a[164:167], a[176:179], a[48:51]
ds_read_b64_tr_b16 a[154:155], v2 offset:13312
v_mfma_f32_16x16x32_bf16 a[52:55], a[164:167], a[180:183], a[52:55]
ds_read_b64_tr_b16 a[156:157], v2 offset:22528
s_waitcnt lgkmcnt(7)
v_mfma_f32_16x16x32_bf16 v[80:83], a[168:171], a[176:179], v[80:83]
ds_read_b64_tr_b16 a[158:159], v2 offset:31744
v_mfma_f32_16x16x32_bf16 v[84:87], a[168:171], a[180:183], v[84:87]
ds_read_b64_tr_b16 a[160:161], v1 offset:5120
v_mfma_f32_16x16x32_bf16 a[56:59], a[172:175], a[176:179], a[56:59]
ds_read_b64_tr_b16 a[162:163], v1 offset:14336
v_mfma_f32_16x16x32_bf16 a[60:63], a[172:175], a[180:183], a[60:63]
ds_read_b64_tr_b16 a[164:165], v1 offset:23552
s_waitcnt lgkmcnt(7)
v_mfma_f32_16x16x32_bf16 v[88:91], a[144:147], a[176:179], v[88:91]
ds_read_b64_tr_b16 a[166:167], v1 offset:32768
buffer_load_dwordx4 v14, s[8:11], s31 offen offset:2048 lds
v_mfma_f32_16x16x32_bf16 v[92:95], a[144:147], a[180:183], v[92:95]
ds_read_b64_tr_b16 a[168:169], v2 offset:5120
v_mfma_f32_16x16x32_bf16 a[64:67], a[148:151], a[176:179], a[64:67]
ds_read_b64_tr_b16 a[170:171], v2 offset:14336
v_mfma_f32_16x16x32_bf16 a[68:71], a[148:151], a[180:183], a[68:71]
ds_read_b64_tr_b16 a[172:173], v2 offset:23552
s_waitcnt lgkmcnt(7)
v_mfma_f32_16x16x32_bf16 v[96:99], a[152:155], a[176:179], v[96:99]
ds_read_b64_tr_b16 a[174:175], v2 offset:32768
v_mfma_f32_16x16x32_bf16 v[100:103], a[152:155], a[180:183], v[100:103]
ds_read_b64_tr_b16 a[144:145], v1 offset:6144
v_mfma_f32_16x16x32_bf16 a[72:75], a[156:159], a[176:179], a[72:75]
ds_read_b64_tr_b16 a[146:147], v1 offset:15360
v_mfma_f32_16x16x32_bf16 a[76:79], a[156:159], a[180:183], a[76:79]
ds_read_b64_tr_b16 a[148:149], v1 offset:24576
s_waitcnt lgkmcnt(7)
v_mfma_f32_16x16x32_bf16 v[104:107], a[160:163], a[176:179], v[104:107]
ds_read_b64_tr_b16 a[150:151], v1 offset:33792
buffer_load_dwordx4 v15, s[8:11], s31 offen offset:3072 lds
v_mfma_f32_16x16x32_bf16 v[108:111], a[160:163], a[180:183], v[108:111]
ds_read_b64_tr_b16 a[152:153], v2 offset:6144
v_mfma_f32_16x16x32_bf16 a[80:83], a[164:167], a[176:179], a[80:83]
ds_read_b64_tr_b16 a[154:155], v2 offset:15360
v_mfma_f32_16x16x32_bf16 a[84:87], a[164:167], a[180:183], a[84:87]
ds_read_b64_tr_b16 a[156:157], v2 offset:24576
s_waitcnt lgkmcnt(7)
v_mfma_f32_16x16x32_bf16 v[112:115], a[168:171], a[176:179], v[112:115]
ds_read_b64_tr_b16 a[158:159], v2 offset:33792
v_mfma_f32_16x16x32_bf16 v[116:119], a[168:171], a[180:183], v[116:119]
ds_read_b64_tr_b16 a[160:161], v1 offset:7168
v_mfma_f32_16x16x32_bf16 a[88:91], a[172:175], a[176:179], a[88:91]
ds_read_b64_tr_b16 a[162:163], v1 offset:16384
s_add_u32 m0, s92, 81920
v_mfma_f32_16x16x32_bf16 a[92:95], a[172:175], a[180:183], a[92:95]
ds_read_b64_tr_b16 a[164:165], v1 offset:25600
s_waitcnt lgkmcnt(7)
v_mfma_f32_16x16x32_bf16 v[120:123], a[144:147], a[176:179], v[120:123]
ds_read_b64_tr_b16 a[166:167], v1 offset:34816
s_add_u32 s32, s23, 147456
v_mfma_f32_16x16x32_bf16 v[124:127], a[144:147], a[180:183], v[124:127]
buffer_load_dwordx4 v12, s[8:11], s32 offen lds
ds_read_b64_tr_b16 a[168:169], v2 offset:7168
v_mfma_f32_16x16x32_bf16 a[96:99], a[148:151], a[176:179], a[96:99]
ds_read_b64_tr_b16 a[170:171], v2 offset:16384
v_mfma_f32_16x16x32_bf16 a[100:103], a[148:151], a[180:183], a[100:103]
ds_read_b64_tr_b16 a[172:173], v2 offset:25600
s_waitcnt lgkmcnt(7)
v_mfma_f32_16x16x32_bf16 v[128:131], a[152:155], a[176:179], v[128:131]
ds_read_b64_tr_b16 a[174:175], v2 offset:34816
v_mfma_f32_16x16x32_bf16 v[132:135], a[152:155], a[180:183], v[132:135]
ds_read_b64_tr_b16 a[144:145], v1 offset:8192
v_mfma_f32_16x16x32_bf16 a[104:107], a[156:159], a[176:179], a[104:107]
ds_read_b64_tr_b16 a[146:147], v1 offset:17408
v_mfma_f32_16x16x32_bf16 a[108:111], a[156:159], a[180:183], a[108:111]
ds_read_b64_tr_b16 a[148:149], v1 offset:26624
s_waitcnt lgkmcnt(7)
v_mfma_f32_16x16x32_bf16 v[136:139], a[160:163], a[176:179], v[136:139]
ds_read_b64_tr_b16 a[150:151], v1 offset:35840
v_mfma_f32_16x16x32_bf16 v[140:143], a[160:163], a[180:183], v[140:143]
ds_read_b64_tr_b16 a[152:153], v2 offset:8192
v_mfma_f32_16x16x32_bf16 a[112:115], a[164:167], a[176:179], a[112:115]
ds_read_b64_tr_b16 a[154:155], v2 offset:17408
v_mfma_f32_16x16x32_bf16 a[116:119], a[164:167], a[180:183], a[116:119]
ds_read_b64_tr_b16 a[156:157], v2 offset:26624
s_waitcnt lgkmcnt(7)
v_mfma_f32_16x16x32_bf16 v[144:147], a[168:171], a[176:179], v[144:147]
ds_read_b64_tr_b16 a[158:159], v2 offset:35840
v_mfma_f32_16x16x32_bf16 v[148:151], a[168:171], a[180:183], v[148:151]
s_waitcnt vmcnt(9)
s_barrier
ds_read_b64_tr_b16 a[160:161], v1 offset:36864
v_mfma_f32_16x16x32_bf16 a[120:123], a[172:175], a[176:179], a[120:123]
ds_read_b64_tr_b16 a[162:163], v1 offset:46080
s_add_u32 m0, s92, 110592
v_mfma_f32_16x16x32_bf16 a[124:127], a[172:175], a[180:183], a[124:127]
ds_read_b64_tr_b16 a[164:165], v1 offset:55296
s_waitcnt lgkmcnt(7)
v_mfma_f32_16x16x32_bf16 v[152:155], a[144:147], a[176:179], v[152:155]
ds_read_b64_tr_b16 a[166:167], v1 offset:64512
s_add_u32 s30, s23, 128
v_mfma_f32_16x16x32_bf16 v[156:159], a[144:147], a[180:183], v[156:159]
buffer_load_dwordx4 v12, s[8:11], s30 offen lds
ds_read_b64_tr_b16 a[168:169], v2 offset:36864
v_mfma_f32_16x16x32_bf16 a[128:131], a[148:151], a[176:179], a[128:131]
ds_read_b64_tr_b16 a[170:171], v2 offset:46080
v_mfma_f32_16x16x32_bf16 a[132:135], a[148:151], a[180:183], a[132:135]
ds_read_b64_tr_b16 a[172:173], v2 offset:55296
s_waitcnt lgkmcnt(7)
v_mfma_f32_16x16x32_bf16 v[160:163], a[152:155], a[176:179], v[160:163]
ds_read_b64_tr_b16 a[174:175], v2 offset:64512
v_mfma_f32_16x16x32_bf16 v[164:167], a[152:155], a[180:183], v[164:167]
ds_read_b64_tr_b16 a[144:145], v1 offset:37888
buffer_load_dwordx4 v13, s[8:11], s30 offen offset:1024 lds
v_mfma_f32_16x16x32_bf16 a[136:139], a[156:159], a[176:179], a[136:139]
ds_read_b64_tr_b16 a[146:147], v1 offset:47104
v_mfma_f32_16x16x32_bf16 a[140:143], a[156:159], a[180:183], a[140:143]
ds_read_b64_tr_b16 a[148:149], v1 offset:56320
s_waitcnt lgkmcnt(7)
v_mfma_f32_16x16x32_bf16 v[24:27], a[160:163], a[184:187], v[24:27]
ds_read_b64_tr_b16 a[150:151], v3
v_mfma_f32_16x16x32_bf16 v[28:31], a[160:163], a[188:191], v[28:31]
ds_read_b64_tr_b16 a[152:153], v2 offset:37888
v_mfma_f32_16x16x32_bf16 a[0:3], a[164:167], a[184:187], a[0:3]
ds_read_b64_tr_b16 a[154:155], v2 offset:47104
v_mfma_f32_16x16x32_bf16 a[4:7], a[164:167], a[188:191], a[4:7]
ds_read_b64_tr_b16 a[156:157], v2 offset:56320
s_waitcnt lgkmcnt(7)
v_mfma_f32_16x16x32_bf16 v[32:35], a[168:171], a[184:187], v[32:35]
ds_read_b64_tr_b16 a[158:159], v4
buffer_load_dwordx4 v14, s[8:11], s30 offen offset:2048 lds
v_mfma_f32_16x16x32_bf16 v[36:39], a[168:171], a[188:191], v[36:39]
ds_read_b64_tr_b16 a[160:161], v1 offset:38912
v_mfma_f32_16x16x32_bf16 a[8:11], a[172:175], a[184:187], a[8:11]
ds_read_b64_tr_b16 a[162:163], v1 offset:48128
v_mfma_f32_16x16x32_bf16 a[12:15], a[172:175], a[188:191], a[12:15]
ds_read_b64_tr_b16 a[164:165], v1 offset:57344
s_waitcnt lgkmcnt(7)
v_mfma_f32_16x16x32_bf16 v[40:43], a[144:147], a[184:187], v[40:43]
ds_read_b64_tr_b16 a[166:167], v3 offset:1024
v_accvgpr_read_b32 v168, a0
v_mfma_f32_16x16x32_bf16 v[44:47], a[144:147], a[188:191], v[44:47]
ds_read_b64_tr_b16 a[168:169], v2 offset:38912
v_max_f32 v24, 0, v24
v_mfma_f32_16x16x32_bf16 a[16:19], a[148:151], a[184:187], a[16:19]
ds_read_b64_tr_b16 a[170:171], v2 offset:48128
v_accvgpr_read_b32 v169, a1
v_mfma_f32_16x16x32_bf16 a[20:23], a[148:151], a[188:191], a[20:23]
ds_read_b64_tr_b16 a[172:173], v2 offset:57344
s_waitcnt lgkmcnt(7)
v_mfma_f32_16x16x32_bf16 v[48:51], a[152:155], a[184:187], v[48:51]
ds_read_b64_tr_b16 a[174:175], v4 offset:1024
buffer_load_dwordx4 v15, s[8:11], s30 offen offset:3072 lds
v_mfma_f32_16x16x32_bf16 v[52:55], a[152:155], a[188:191], v[52:55]
ds_read_b64_tr_b16 a[144:145], v1 offset:39936
v_max_f32 v25, 0, v25
v_mfma_f32_16x16x32_bf16 a[24:27], a[156:159], a[184:187], a[24:27]
ds_read_b64_tr_b16 a[146:147], v1 offset:49152
v_accvgpr_read_b32 v170, a2
v_mfma_f32_16x16x32_bf16 a[28:31], a[156:159], a[188:191], a[28:31]
ds_read_b64_tr_b16 a[148:149], v1 offset:58368
s_waitcnt lgkmcnt(7)
v_mfma_f32_16x16x32_bf16 v[56:59], a[160:163], a[184:187], v[56:59]
ds_read_b64_tr_b16 a[150:151], v3 offset:2048
v_max_f32 v26, 0, v26
v_mfma_f32_16x16x32_bf16 v[60:63], a[160:163], a[188:191], v[60:63]
ds_read_b64_tr_b16 a[152:153], v2 offset:39936
v_accvgpr_read_b32 v171, a3
v_mfma_f32_16x16x32_bf16 a[32:35], a[164:167], a[184:187], a[32:35]
ds_read_b64_tr_b16 a[154:155], v2 offset:49152
s_add_u32 m0, s92, 114688
v_mfma_f32_16x16x32_bf16 a[36:39], a[164:167], a[188:191], a[36:39]
ds_read_b64_tr_b16 a[156:157], v2 offset:58368
s_waitcnt lgkmcnt(7)
v_mfma_f32_16x16x32_bf16 v[64:67], a[168:171], a[184:187], v[64:67]
ds_read_b64_tr_b16 a[158:159], v4 offset:2048
s_add_u32 s31, s23, 73856
v_mfma_f32_16x16x32_bf16 v[68:71], a[168:171], a[188:191], v[68:71]
buffer_load_dwordx4 v12, s[8:11], s31 offen lds
ds_read_b64_tr_b16 a[160:161], v1 offset:40960
v_mfma_f32_16x16x32_bf16 a[40:43], a[172:175], a[184:187], a[40:43]
ds_read_b64_tr_b16 a[162:163], v1 offset:50176
v_max_f32 v27, 0, v27
v_mfma_f32_16x16x32_bf16 a[44:47], a[172:175], a[188:191], a[44:47]
ds_read_b64_tr_b16 a[164:165], v1 offset:59392
s_waitcnt lgkmcnt(7)
v_mfma_f32_16x16x32_bf16 v[72:75], a[144:147], a[184:187], v[72:75]
ds_read_b64_tr_b16 a[166:167], v3 offset:3072
v_pk_mul_f32 v[24:25], v[24:25], v[168:169]
v_mfma_f32_16x16x32_bf16 v[76:79], a[144:147], a[188:191], v[76:79]
ds_read_b64_tr_b16 a[168:169], v2 offset:40960
buffer_load_dwordx4 v13, s[8:11], s31 offen offset:1024 lds
v_mfma_f32_16x16x32_bf16 a[48:51], a[148:151], a[184:187], a[48:51]
ds_read_b64_tr_b16 a[170:171], v2 offset:50176
v_pk_mul_f32 v[26:27], v[26:27], v[170:171]
v_mfma_f32_16x16x32_bf16 a[52:55], a[148:151], a[188:191], a[52:55]
ds_read_b64_tr_b16 a[172:173], v2 offset:59392
s_waitcnt lgkmcnt(7)
v_mfma_f32_16x16x32_bf16 v[80:83], a[152:155], a[184:187], v[80:83]
ds_read_b64_tr_b16 a[174:175], v4 offset:3072
v_cvt_pk_bf16_f32 v24, v24, v25
v_mfma_f32_16x16x32_bf16 v[84:87], a[152:155], a[188:191], v[84:87]
ds_read_b64_tr_b16 a[144:145], v1 offset:41984
v_cvt_pk_bf16_f32 v25, v26, v27
v_mfma_f32_16x16x32_bf16 a[56:59], a[156:159], a[184:187], a[56:59]
ds_read_b64_tr_b16 a[146:147], v1 offset:51200
v_accvgpr_read_b32 v172, a8
v_mfma_f32_16x16x32_bf16 a[60:63], a[156:159], a[188:191], a[60:63]
ds_read_b64_tr_b16 a[148:149], v1 offset:60416
s_waitcnt lgkmcnt(7)
v_mfma_f32_16x16x32_bf16 v[88:91], a[160:163], a[184:187], v[88:91]
ds_read_b64_tr_b16 a[150:151], v3 offset:4096
buffer_load_dwordx4 v14, s[8:11], s31 offen offset:2048 lds
v_mfma_f32_16x16x32_bf16 v[92:95], a[160:163], a[188:191], v[92:95]
ds_read_b64_tr_b16 a[152:153], v2 offset:41984
v_max_f32 v32, 0, v32
v_mfma_f32_16x16x32_bf16 a[64:67], a[164:167], a[184:187], a[64:67]
ds_read_b64_tr_b16 a[154:155], v2 offset:51200
v_accvgpr_read_b32 v173, a9
v_mfma_f32_16x16x32_bf16 a[68:71], a[164:167], a[188:191], a[68:71]
ds_read_b64_tr_b16 a[156:157], v2 offset:60416
s_waitcnt lgkmcnt(7)
v_mfma_f32_16x16x32_bf16 v[96:99], a[168:171], a[184:187], v[96:99]
ds_read_b64_tr_b16 a[158:159], v4 offset:4096
v_max_f32 v33, 0, v33
v_mfma_f32_16x16x32_bf16 v[100:103], a[168:171], a[188:191], v[100:103]
ds_read_b64_tr_b16 a[160:161], v1 offset:43008
v_accvgpr_read_b32 v174, a10
v_mfma_f32_16x16x32_bf16 a[72:75], a[172:175], a[184:187], a[72:75]
ds_read_b64_tr_b16 a[162:163], v1 offset:52224
v_max_f32 v34, 0, v34
v_mfma_f32_16x16x32_bf16 a[76:79], a[172:175], a[188:191], a[76:79]
ds_read_b64_tr_b16 a[164:165], v1 offset:61440
s_waitcnt lgkmcnt(7)
v_mfma_f32_16x16x32_bf16 v[104:107], a[144:147], a[184:187], v[104:107]
ds_read_b64_tr_b16 a[166:167], v3 offset:5120
buffer_load_dwordx4 v15, s[8:11], s31 offen offset:3072 lds
v_mfma_f32_16x16x32_bf16 v[108:111], a[144:147], a[188:191], v[108:111]
ds_read_b64_tr_b16 a[168:169], v2 offset:43008
v_accvgpr_read_b32 v175, a11
v_mfma_f32_16x16x32_bf16 a[80:83], a[148:151], a[184:187], a[80:83]
ds_read_b64_tr_b16 a[170:171], v2 offset:52224
v_max_f32 v35, 0, v35
v_mfma_f32_16x16x32_bf16 a[84:87], a[148:151], a[188:191], a[84:87]
ds_read_b64_tr_b16 a[172:173], v2 offset:61440
s_waitcnt lgkmcnt(7)
v_mfma_f32_16x16x32_bf16 v[112:115], a[152:155], a[184:187], v[112:115]
ds_read_b64_tr_b16 a[174:175], v4 offset:5120
v_pk_mul_f32 v[32:33], v[32:33], v[172:173]
v_mfma_f32_16x16x32_bf16 v[116:119], a[152:155], a[188:191], v[116:119]
ds_read_b64_tr_b16 a[144:145], v1 offset:44032
v_pk_mul_f32 v[34:35], v[34:35], v[174:175]
v_mfma_f32_16x16x32_bf16 a[88:91], a[156:159], a[184:187], a[88:91]
ds_read_b64_tr_b16 a[146:147], v1 offset:53248
s_add_u32 m0, s92, 118784
v_mfma_f32_16x16x32_bf16 a[92:95], a[156:159], a[188:191], a[92:95]
ds_read_b64_tr_b16 a[148:149], v1 offset:62464
s_waitcnt lgkmcnt(7)
v_mfma_f32_16x16x32_bf16 v[120:123], a[160:163], a[184:187], v[120:123]
ds_read_b64_tr_b16 a[150:151], v3 offset:6144
s_add_u32 s32, s23, 147584
v_mfma_f32_16x16x32_bf16 v[124:127], a[160:163], a[188:191], v[124:127]
buffer_load_dwordx4 v12, s[8:11], s32 offen lds
ds_read_b64_tr_b16 a[152:153], v2 offset:44032
v_mfma_f32_16x16x32_bf16 a[96:99], a[164:167], a[184:187], a[96:99]
ds_read_b64_tr_b16 a[154:155], v2 offset:53248
v_cvt_pk_bf16_f32 v26, v32, v33
v_mfma_f32_16x16x32_bf16 a[100:103], a[164:167], a[188:191], a[100:103]
ds_read_b64_tr_b16 a[156:157], v2 offset:62464
s_waitcnt lgkmcnt(7)
v_mfma_f32_16x16x32_bf16 v[128:131], a[168:171], a[184:187], v[128:131]
ds_read_b64_tr_b16 a[158:159], v4 offset:6144
v_cvt_pk_bf16_f32 v27, v34, v35
v_mfma_f32_16x16x32_bf16 v[132:135], a[168:171], a[188:191], v[132:135]
ds_read_b64_tr_b16 a[160:161], v1 offset:45056
v_accvgpr_read_b32 v168, a4
v_mfma_f32_16x16x32_bf16 a[104:107], a[172:175], a[184:187], a[104:107]
ds_read_b64_tr_b16 a[162:163], v1 offset:54272
v_max_f32 v28, 0, v28
v_mfma_f32_16x16x32_bf16 a[108:111], a[172:175], a[188:191], a[108:111]
ds_read_b64_tr_b16 a[164:165], v1 offset:63488
s_waitcnt lgkmcnt(7)
v_mfma_f32_16x16x32_bf16 v[136:139], a[144:147], a[184:187], v[136:139]
ds_read_b64_tr_b16 a[166:167], v3 offset:7168
v_accvgpr_read_b32 v169, a5
v_mfma_f32_16x16x32_bf16 v[140:143], a[144:147], a[188:191], v[140:143]
ds_read_b64_tr_b16 a[168:169], v2 offset:45056
v_max_f32 v29, 0, v29
v_mfma_f32_16x16x32_bf16 a[112:115], a[148:151], a[184:187], a[112:115]
ds_read_b64_tr_b16 a[170:171], v2 offset:54272
v_accvgpr_read_b32 v170, a6
v_mfma_f32_16x16x32_bf16 a[116:119], a[148:151], a[188:191], a[116:119]
ds_read_b64_tr_b16 a[172:173], v2 offset:63488
s_waitcnt lgkmcnt(7)
v_mfma_f32_16x16x32_bf16 v[144:147], a[152:155], a[184:187], v[144:147]
ds_read_b64_tr_b16 a[174:175], v4 offset:7168
v_max_f32 v30, 0, v30
v_mfma_f32_16x16x32_bf16 v[148:151], a[152:155], a[188:191], v[148:151]
s_waitcnt vmcnt(9)
s_barrier
ds_read_b64_tr_b16 a[144:145], v3 offset:8192
v_mfma_f32_16x16x32_bf16 a[120:123], a[156:159], a[184:187], a[120:123]
ds_read_b64_tr_b16 a[146:147], v3 offset:9216
s_add_u32 m0, s92, 0
v_mfma_f32_16x16x32_bf16 a[124:127], a[156:159], a[188:191], a[124:127]
ds_read_b64_tr_b16 a[148:149], v4 offset:8192
s_waitcnt lgkmcnt(7)
v_mfma_f32_16x16x32_bf16 v[152:155], a[160:163], a[184:187], v[152:155]
ds_read_b64_tr_b16 a[150:151], v4 offset:9216
s_add_u32 s30, s23, 256
v_mfma_f32_16x16x32_bf16 v[156:159], a[160:163], a[188:191], v[156:159]
buffer_load_dwordx4 v12, s[8:11], s30 offen lds
ds_read_b64_tr_b16 a[152:153], v3 offset:26624
v_mfma_f32_16x16x32_bf16 a[128:131], a[164:167], a[184:187], a[128:131]
ds_read_b64_tr_b16 a[154:155], v3 offset:27648
v_accvgpr_read_b32 v171, a7
v_mfma_f32_16x16x32_bf16 a[132:135], a[164:167], a[188:191], a[132:135]
ds_read_b64_tr_b16 a[156:157], v4 offset:26624
s_waitcnt lgkmcnt(7)
v_mfma_f32_16x16x32_bf16 v[160:163], a[168:171], a[184:187], v[160:163]
ds_read_b64_tr_b16 a[158:159], v4 offset:27648
v_max_f32 v31, 0, v31
v_mfma_f32_16x16x32_bf16 v[164:167], a[168:171], a[188:191], v[164:167]
ds_read_b64_tr_b16 a[160:161], v3 offset:10240
v_pk_mul_f32 v[28:29], v[28:29], v[168:169]
v_mfma_f32_16x16x32_bf16 a[136:139], a[172:175], a[184:187], a[136:139]
ds_read_b64_tr_b16 a[162:163], v3 offset:11264
v_pk_mul_f32 v[30:31], v[30:31], v[170:171]
v_mfma_f32_16x16x32_bf16 a[140:143], a[172:175], a[188:191], a[140:143]
ds_read_b64_tr_b16 a[164:165], v4 offset:10240
v_cvt_pk_bf16_f32 v28, v28, v29
v_cvt_pk_bf16_f32 v29, v30, v31
v_accvgpr_read_b32 v172, a12
v_max_f32 v36, 0, v36
v_accvgpr_read_b32 v173, a13
v_max_f32 v37, 0, v37
v_accvgpr_read_b32 v174, a14
v_max_f32 v38, 0, v38
v_accvgpr_read_b32 v175, a15
v_max_f32 v39, 0, v39
v_pk_mul_f32 v[36:37], v[36:37], v[172:173]
v_pk_mul_f32 v[38:39], v[38:39], v[174:175]
v_cvt_pk_bf16_f32 v30, v36, v37
v_cvt_pk_bf16_f32 v31, v38, v39
s_waitcnt lgkmcnt(7)
v_mfma_f32_16x16x32_bf16 v[176:179], a[144:147], v[24:27], 0
buffer_load_dwordx4 v13, s[8:11], s30 offen offset:1024 lds
ds_read_b64_tr_b16 a[166:167], v4 offset:11264
v_mfma_f32_16x16x32_bf16 v[180:183], a[144:147], v[28:31], 0
ds_read_b64_tr_b16 a[168:169], v3 offset:28672
v_accvgpr_read_b32 v168, a16
v_mfma_f32_16x16x32_bf16 v[184:187], a[148:151], v[24:27], 0
ds_read_b64_tr_b16 a[170:171], v3 offset:29696
v_max_f32 v40, 0, v40
v_mfma_f32_16x16x32_bf16 v[188:191], a[148:151], v[28:31], 0
ds_read_b64_tr_b16 a[172:173], v4 offset:28672
s_waitcnt lgkmcnt(7)
v_mfma_f32_16x16x32_bf16 v[192:195], a[152:155], v[24:27], 0
ds_read_b64_tr_b16 a[174:175], v4 offset:29696
v_accvgpr_read_b32 v169, a17
v_mfma_f32_16x16x32_bf16 v[196:199], a[152:155], v[28:31], 0
ds_read_b64_tr_b16 a[144:145], v3 offset:12288
v_max_f32 v41, 0, v41
v_mfma_f32_16x16x32_bf16 v[200:203], a[156:159], v[24:27], 0
ds_read_b64_tr_b16 a[146:147], v3 offset:13312
v_accvgpr_read_b32 v170, a18
v_max_f32 v42, 0, v42
v_accvgpr_read_b32 v171, a19
v_max_f32 v43, 0, v43
v_pk_mul_f32 v[40:41], v[40:41], v[168:169]
v_pk_mul_f32 v[42:43], v[42:43], v[170:171]
v_cvt_pk_bf16_f32 v40, v40, v41
v_cvt_pk_bf16_f32 v41, v42, v43
v_accvgpr_read_b32 v172, a24
v_max_f32 v48, 0, v48
v_accvgpr_read_b32 v173, a25
v_max_f32 v49, 0, v49
v_accvgpr_read_b32 v174, a26
v_max_f32 v50, 0, v50
v_accvgpr_read_b32 v175, a27
v_max_f32 v51, 0, v51
v_pk_mul_f32 v[48:49], v[48:49], v[172:173]
v_pk_mul_f32 v[50:51], v[50:51], v[174:175]
v_cvt_pk_bf16_f32 v42, v48, v49
v_cvt_pk_bf16_f32 v43, v50, v51
v_mfma_f32_16x16x32_bf16 v[204:207], a[156:159], v[28:31], 0
buffer_load_dwordx4 v14, s[8:11], s30 offen offset:2048 lds
ds_read_b64_tr_b16 a[148:149], v4 offset:12288
v_accvgpr_read_b32 v168, a20
v_max_f32 v44, 0, v44
v_accvgpr_read_b32 v169, a21
v_max_f32 v45, 0, v45
v_accvgpr_read_b32 v170, a22
v_max_f32 v46, 0, v46
v_accvgpr_read_b32 v171, a23
v_max_f32 v47, 0, v47
v_pk_mul_f32 v[44:45], v[44:45], v[168:169]
v_pk_mul_f32 v[46:47], v[46:47], v[170:171]
v_cvt_pk_bf16_f32 v44, v44, v45
v_cvt_pk_bf16_f32 v45, v46, v47
v_accvgpr_read_b32 v172, a28
v_max_f32 v52, 0, v52
v_accvgpr_read_b32 v173, a29
v_max_f32 v53, 0, v53
v_accvgpr_read_b32 v174, a30
v_max_f32 v54, 0, v54
v_accvgpr_read_b32 v175, a31
v_max_f32 v55, 0, v55
v_pk_mul_f32 v[52:53], v[52:53], v[172:173]
v_pk_mul_f32 v[54:55], v[54:55], v[174:175]
v_cvt_pk_bf16_f32 v46, v52, v53
v_cvt_pk_bf16_f32 v47, v54, v55
s_waitcnt lgkmcnt(7)
v_mfma_f32_16x16x32_bf16 v[176:179], a[160:163], v[40:43], v[176:179]
ds_read_b64_tr_b16 a[150:151], v4 offset:13312
v_accvgpr_read_b32 v168, a32
v_mfma_f32_16x16x32_bf16 v[180:183], a[160:163], v[44:47], v[180:183]
ds_read_b64_tr_b16 a[152:153], v3 offset:30720
v_max_f32 v56, 0, v56
v_mfma_f32_16x16x32_bf16 v[184:187], a[164:167], v[40:43], v[184:187]
ds_read_b64_tr_b16 a[154:155], v3 offset:31744
v_accvgpr_read_b32 v169, a33
v_mfma_f32_16x16x32_bf16 v[188:191], a[164:167], v[44:47], v[188:191]
ds_read_b64_tr_b16 a[156:157], v4 offset:30720
s_waitcnt lgkmcnt(7)
v_mfma_f32_16x16x32_bf16 v[192:195], a[168:171], v[40:43], v[192:195]
ds_read_b64_tr_b16 a[158:159], v4 offset:31744
buffer_load_dwordx4 v15, s[8:11], s30 offen offset:3072 lds
v_mfma_f32_16x16x32_bf16 v[196:199], a[168:171], v[44:47], v[196:199]
ds_read_b64_tr_b16 a[160:161], v3 offset:14336
v_max_f32 v57, 0, v57
v_mfma_f32_16x16x32_bf16 v[200:203], a[172:175], v[40:43], v[200:203]
ds_read_b64_tr_b16 a[162:163], v3 offset:15360
v_accvgpr_read_b32 v170, a34
v_max_f32 v58, 0, v58
v_accvgpr_read_b32 v171, a35
v_max_f32 v59, 0, v59
v_pk_mul_f32 v[56:57], v[56:57], v[168:169]
v_pk_mul_f32 v[58:59], v[58:59], v[170:171]
v_cvt_pk_bf16_f32 v56, v56, v57
v_cvt_pk_bf16_f32 v57, v58, v59
v_accvgpr_read_b32 v172, a40
v_max_f32 v64, 0, v64
v_accvgpr_read_b32 v173, a41
v_max_f32 v65, 0, v65
v_accvgpr_read_b32 v174, a42
v_max_f32 v66, 0, v66
v_accvgpr_read_b32 v175, a43
v_max_f32 v67, 0, v67
v_pk_mul_f32 v[64:65], v[64:65], v[172:173]
v_pk_mul_f32 v[66:67], v[66:67], v[174:175]
v_cvt_pk_bf16_f32 v58, v64, v65
v_cvt_pk_bf16_f32 v59, v66, v67
v_mfma_f32_16x16x32_bf16 v[204:207], a[172:175], v[44:47], v[204:207]
ds_read_b64_tr_b16 a[164:165], v4 offset:14336
v_accvgpr_read_b32 v168, a36
v_max_f32 v60, 0, v60
v_accvgpr_read_b32 v169, a37
v_max_f32 v61, 0, v61
v_accvgpr_read_b32 v170, a38
v_max_f32 v62, 0, v62
v_accvgpr_read_b32 v171, a39
v_max_f32 v63, 0, v63
v_pk_mul_f32 v[60:61], v[60:61], v[168:169]
v_pk_mul_f32 v[62:63], v[62:63], v[170:171]
v_cvt_pk_bf16_f32 v60, v60, v61
v_cvt_pk_bf16_f32 v61, v62, v63
v_accvgpr_read_b32 v172, a44
v_max_f32 v68, 0, v68
v_accvgpr_read_b32 v173, a45
v_max_f32 v69, 0, v69
v_accvgpr_read_b32 v174, a46
v_max_f32 v70, 0, v70
v_accvgpr_read_b32 v175, a47
v_max_f32 v71, 0, v71
v_pk_mul_f32 v[68:69], v[68:69], v[172:173]
v_pk_mul_f32 v[70:71], v[70:71], v[174:175]
v_cvt_pk_bf16_f32 v62, v68, v69
v_cvt_pk_bf16_f32 v63, v70, v71
s_waitcnt lgkmcnt(7)
v_mfma_f32_16x16x32_bf16 v[176:179], a[144:147], v[56:59], v[176:179]
ds_read_b64_tr_b16 a[166:167], v4 offset:15360
v_accvgpr_read_b32 v168, a48
v_mfma_f32_16x16x32_bf16 v[180:183], a[144:147], v[60:63], v[180:183]
ds_read_b64_tr_b16 a[168:169], v3 offset:32768
v_max_f32 v72, 0, v72
v_mfma_f32_16x16x32_bf16 v[184:187], a[148:151], v[56:59], v[184:187]
ds_read_b64_tr_b16 a[170:171], v3 offset:33792
s_add_u32 m0, s92, 4096
v_mfma_f32_16x16x32_bf16 v[188:191], a[148:151], v[60:63], v[188:191]
ds_read_b64_tr_b16 a[172:173], v4 offset:32768
s_waitcnt lgkmcnt(7)
v_mfma_f32_16x16x32_bf16 v[192:195], a[152:155], v[56:59], v[192:195]
ds_read_b64_tr_b16 a[174:175], v4 offset:33792
s_add_u32 s31, s23, 73984
v_mfma_f32_16x16x32_bf16 v[196:199], a[152:155], v[60:63], v[196:199]
buffer_load_dwordx4 v12, s[8:11], s31 offen lds
ds_read_b64_tr_b16 a[144:145], v3 offset:16384
v_mfma_f32_16x16x32_bf16 v[200:203], a[156:159], v[56:59], v[200:203]
ds_read_b64_tr_b16 a[146:147], v3 offset:17408
v_accvgpr_read_b32 v169, a49
v_max_f32 v73, 0, v73
v_accvgpr_read_b32 v170, a50
v_max_f32 v74, 0, v74
v_accvgpr_read_b32 v171, a51
v_max_f32 v75, 0, v75
v_pk_mul_f32 v[72:73], v[72:73], v[168:169]
v_pk_mul_f32 v[74:75], v[74:75], v[170:171]
v_cvt_pk_bf16_f32 v72, v72, v73
v_cvt_pk_bf16_f32 v73, v74, v75
v_accvgpr_read_b32 v172, a56
v_max_f32 v80, 0, v80
v_accvgpr_read_b32 v173, a57
v_max_f32 v81, 0, v81
v_accvgpr_read_b32 v174, a58
v_max_f32 v82, 0, v82
v_accvgpr_read_b32 v175, a59
v_max_f32 v83, 0, v83
v_pk_mul_f32 v[80:81], v[80:81], v[172:173]
v_pk_mul_f32 v[82:83], v[82:83], v[174:175]
v_cvt_pk_bf16_f32 v74, v80, v81
v_cvt_pk_bf16_f32 v75, v82, v83
v_mfma_f32_16x16x32_bf16 v[204:207], a[156:159], v[60:63], v[204:207]
ds_read_b64_tr_b16 a[148:149], v4 offset:16384
v_accvgpr_read_b32 v168, a52
v_max_f32 v76, 0, v76
v_accvgpr_read_b32 v169, a53
v_max_f32 v77, 0, v77
v_accvgpr_read_b32 v170, a54
v_max_f32 v78, 0, v78
v_accvgpr_read_b32 v171, a55
v_max_f32 v79, 0, v79
v_pk_mul_f32 v[76:77], v[76:77], v[168:169]
v_pk_mul_f32 v[78:79], v[78:79], v[170:171]
v_cvt_pk_bf16_f32 v76, v76, v77
v_cvt_pk_bf16_f32 v77, v78, v79
v_accvgpr_read_b32 v172, a60
v_max_f32 v84, 0, v84
v_accvgpr_read_b32 v173, a61
v_max_f32 v85, 0, v85
v_accvgpr_read_b32 v174, a62
v_max_f32 v86, 0, v86
v_accvgpr_read_b32 v175, a63
v_max_f32 v87, 0, v87
v_pk_mul_f32 v[84:85], v[84:85], v[172:173]
v_pk_mul_f32 v[86:87], v[86:87], v[174:175]
v_cvt_pk_bf16_f32 v78, v84, v85
v_cvt_pk_bf16_f32 v79, v86, v87
s_waitcnt lgkmcnt(7)
v_mfma_f32_16x16x32_bf16 v[176:179], a[160:163], v[72:75], v[176:179]
ds_read_b64_tr_b16 a[150:151], v4 offset:17408
v_accvgpr_read_b32 v168, a64
v_mfma_f32_16x16x32_bf16 v[180:183], a[160:163], v[76:79], v[180:183]
ds_read_b64_tr_b16 a[152:153], v3 offset:34816
buffer_load_dwordx4 v13, s[8:11], s31 offen offset:1024 lds
v_mfma_f32_16x16x32_bf16 v[184:187], a[164:167], v[72:75], v[184:187]
ds_read_b64_tr_b16 a[154:155], v3 offset:35840
v_max_f32 v88, 0, v88
v_mfma_f32_16x16x32_bf16 v[188:191], a[164:167], v[76:79], v[188:191]
ds_read_b64_tr_b16 a[156:157], v4 offset:34816
s_waitcnt lgkmcnt(7)
v_mfma_f32_16x16x32_bf16 v[192:195], a[168:171], v[72:75], v[192:195]
ds_read_b64_tr_b16 a[158:159], v4 offset:35840
v_accvgpr_read_b32 v169, a65
v_mfma_f32_16x16x32_bf16 v[196:199], a[168:171], v[76:79], v[196:199]
ds_read_b64_tr_b16 a[160:161], v3 offset:18432
v_max_f32 v89, 0, v89
v_mfma_f32_16x16x32_bf16 v[200:203], a[172:175], v[72:75], v[200:203]
ds_read_b64_tr_b16 a[162:163], v3 offset:19456
v_accvgpr_read_b32 v170, a66
v_max_f32 v90, 0, v90
v_accvgpr_read_b32 v171, a67
v_max_f32 v91, 0, v91
v_pk_mul_f32 v[88:89], v[88:89], v[168:169]
v_pk_mul_f32 v[90:91], v[90:91], v[170:171]
v_cvt_pk_bf16_f32 v88, v88, v89
v_cvt_pk_bf16_f32 v89, v90, v91
v_accvgpr_read_b32 v172, a72
v_max_f32 v96, 0, v96
v_accvgpr_read_b32 v173, a73
v_max_f32 v97, 0, v97
v_accvgpr_read_b32 v174, a74
v_max_f32 v98, 0, v98
v_accvgpr_read_b32 v175, a75
v_max_f32 v99, 0, v99
v_pk_mul_f32 v[96:97], v[96:97], v[172:173]
v_pk_mul_f32 v[98:99], v[98:99], v[174:175]
v_cvt_pk_bf16_f32 v90, v96, v97
v_cvt_pk_bf16_f32 v91, v98, v99
v_mfma_f32_16x16x32_bf16 v[204:207], a[172:175], v[76:79], v[204:207]
ds_read_b64_tr_b16 a[164:165], v4 offset:18432
v_accvgpr_read_b32 v168, a68
v_max_f32 v92, 0, v92
v_accvgpr_read_b32 v169, a69
v_max_f32 v93, 0, v93
v_accvgpr_read_b32 v170, a70
v_max_f32 v94, 0, v94
v_accvgpr_read_b32 v171, a71
v_max_f32 v95, 0, v95
v_pk_mul_f32 v[92:93], v[92:93], v[168:169]
v_pk_mul_f32 v[94:95], v[94:95], v[170:171]
v_cvt_pk_bf16_f32 v92, v92, v93
v_cvt_pk_bf16_f32 v93, v94, v95
v_accvgpr_read_b32 v172, a76
v_max_f32 v100, 0, v100
v_accvgpr_read_b32 v173, a77
v_max_f32 v101, 0, v101
v_accvgpr_read_b32 v174, a78
v_max_f32 v102, 0, v102
v_accvgpr_read_b32 v175, a79
v_max_f32 v103, 0, v103
v_pk_mul_f32 v[100:101], v[100:101], v[172:173]
v_pk_mul_f32 v[102:103], v[102:103], v[174:175]
v_cvt_pk_bf16_f32 v94, v100, v101
v_cvt_pk_bf16_f32 v95, v102, v103
s_waitcnt lgkmcnt(7)
v_mfma_f32_16x16x32_bf16 v[176:179], a[144:147], v[88:91], v[176:179]
ds_read_b64_tr_b16 a[166:167], v4 offset:19456
buffer_load_dwordx4 v14, s[8:11], s31 offen offset:2048 lds
v_mfma_f32_16x16x32_bf16 v[180:183], a[144:147], v[92:95], v[180:183]
ds_read_b64_tr_b16 a[168:169], v3 offset:36864
v_accvgpr_read_b32 v168, a80
v_mfma_f32_16x16x32_bf16 v[184:187], a[148:151], v[88:91], v[184:187]
ds_read_b64_tr_b16 a[170:171], v3 offset:37888
v_max_f32 v104, 0, v104
v_mfma_f32_16x16x32_bf16 v[188:191], a[148:151], v[92:95], v[188:191]
ds_read_b64_tr_b16 a[172:173], v4 offset:36864
s_waitcnt lgkmcnt(7)
v_mfma_f32_16x16x32_bf16 v[192:195], a[152:155], v[88:91], v[192:195]
ds_read_b64_tr_b16 a[174:175], v4 offset:37888
v_accvgpr_read_b32 v169, a81
v_mfma_f32_16x16x32_bf16 v[196:199], a[152:155], v[92:95], v[196:199]
ds_read_b64_tr_b16 a[144:145], v3 offset:20480
v_max_f32 v105, 0, v105
v_mfma_f32_16x16x32_bf16 v[200:203], a[156:159], v[88:91], v[200:203]
ds_read_b64_tr_b16 a[146:147], v3 offset:21504
v_accvgpr_read_b32 v170, a82
v_max_f32 v106, 0, v106
v_accvgpr_read_b32 v171, a83
v_max_f32 v107, 0, v107
v_pk_mul_f32 v[104:105], v[104:105], v[168:169]
v_pk_mul_f32 v[106:107], v[106:107], v[170:171]
v_cvt_pk_bf16_f32 v104, v104, v105
v_cvt_pk_bf16_f32 v105, v106, v107
v_accvgpr_read_b32 v172, a88
v_max_f32 v112, 0, v112
v_accvgpr_read_b32 v173, a89
v_max_f32 v113, 0, v113
v_accvgpr_read_b32 v174, a90
v_max_f32 v114, 0, v114
v_accvgpr_read_b32 v175, a91
v_max_f32 v115, 0, v115
v_pk_mul_f32 v[112:113], v[112:113], v[172:173]
v_pk_mul_f32 v[114:115], v[114:115], v[174:175]
v_cvt_pk_bf16_f32 v106, v112, v113
v_cvt_pk_bf16_f32 v107, v114, v115
v_mfma_f32_16x16x32_bf16 v[204:207], a[156:159], v[92:95], v[204:207]
ds_read_b64_tr_b16 a[148:149], v4 offset:20480
v_accvgpr_read_b32 v168, a84
v_max_f32 v108, 0, v108
v_accvgpr_read_b32 v169, a85
v_max_f32 v109, 0, v109
v_accvgpr_read_b32 v170, a86
v_max_f32 v110, 0, v110
v_accvgpr_read_b32 v171, a87
v_max_f32 v111, 0, v111
v_pk_mul_f32 v[108:109], v[108:109], v[168:169]
v_pk_mul_f32 v[110:111], v[110:111], v[170:171]
v_cvt_pk_bf16_f32 v108, v108, v109
v_cvt_pk_bf16_f32 v109, v110, v111
v_accvgpr_read_b32 v172, a92
v_max_f32 v116, 0, v116
v_accvgpr_read_b32 v173, a93
v_max_f32 v117, 0, v117
v_accvgpr_read_b32 v174, a94
v_max_f32 v118, 0, v118
v_accvgpr_read_b32 v175, a95
v_max_f32 v119, 0, v119
v_pk_mul_f32 v[116:117], v[116:117], v[172:173]
v_pk_mul_f32 v[118:119], v[118:119], v[174:175]
v_cvt_pk_bf16_f32 v110, v116, v117
v_cvt_pk_bf16_f32 v111, v118, v119
s_waitcnt lgkmcnt(7)
v_mfma_f32_16x16x32_bf16 v[176:179], a[160:163], v[104:107], v[176:179]
ds_read_b64_tr_b16 a[150:151], v4 offset:21504
buffer_load_dwordx4 v15, s[8:11], s31 offen offset:3072 lds
v_mfma_f32_16x16x32_bf16 v[180:183], a[160:163], v[108:111], v[180:183]
ds_read_b64_tr_b16 a[152:153], v3 offset:38912
v_accvgpr_read_b32 v168, a96
v_mfma_f32_16x16x32_bf16 v[184:187], a[164:167], v[104:107], v[184:187]
ds_read_b64_tr_b16 a[154:155], v3 offset:39936
v_max_f32 v120, 0, v120
v_mfma_f32_16x16x32_bf16 v[188:191], a[164:167], v[108:111], v[188:191]
ds_read_b64_tr_b16 a[156:157], v4 offset:38912
s_waitcnt lgkmcnt(7)
v_mfma_f32_16x16x32_bf16 v[192:195], a[168:171], v[104:107], v[192:195]
ds_read_b64_tr_b16 a[158:159], v4 offset:39936
v_accvgpr_read_b32 v169, a97
v_mfma_f32_16x16x32_bf16 v[196:199], a[168:171], v[108:111], v[196:199]
ds_read_b64_tr_b16 a[160:161], v3 offset:22528
v_max_f32 v121, 0, v121
v_mfma_f32_16x16x32_bf16 v[200:203], a[172:175], v[104:107], v[200:203]
ds_read_b64_tr_b16 a[162:163], v3 offset:23552
v_accvgpr_read_b32 v170, a98
v_max_f32 v122, 0, v122
v_accvgpr_read_b32 v171, a99
v_max_f32 v123, 0, v123
v_pk_mul_f32 v[120:121], v[120:121], v[168:169]
v_pk_mul_f32 v[122:123], v[122:123], v[170:171]
v_cvt_pk_bf16_f32 v120, v120, v121
v_cvt_pk_bf16_f32 v121, v122, v123
v_accvgpr_read_b32 v172, a104
v_max_f32 v128, 0, v128
v_accvgpr_read_b32 v173, a105
v_max_f32 v129, 0, v129
v_accvgpr_read_b32 v174, a106
v_max_f32 v130, 0, v130
v_accvgpr_read_b32 v175, a107
v_max_f32 v131, 0, v131
v_pk_mul_f32 v[128:129], v[128:129], v[172:173]
v_pk_mul_f32 v[130:131], v[130:131], v[174:175]
v_cvt_pk_bf16_f32 v122, v128, v129
v_cvt_pk_bf16_f32 v123, v130, v131
v_mfma_f32_16x16x32_bf16 v[204:207], a[172:175], v[108:111], v[204:207]
ds_read_b64_tr_b16 a[164:165], v4 offset:22528
v_accvgpr_read_b32 v168, a100
v_max_f32 v124, 0, v124
v_accvgpr_read_b32 v169, a101
v_max_f32 v125, 0, v125
v_accvgpr_read_b32 v170, a102
v_max_f32 v126, 0, v126
v_accvgpr_read_b32 v171, a103
v_max_f32 v127, 0, v127
v_pk_mul_f32 v[124:125], v[124:125], v[168:169]
v_pk_mul_f32 v[126:127], v[126:127], v[170:171]
v_cvt_pk_bf16_f32 v124, v124, v125
v_cvt_pk_bf16_f32 v125, v126, v127
v_accvgpr_read_b32 v172, a108
v_max_f32 v132, 0, v132
v_accvgpr_read_b32 v173, a109
v_max_f32 v133, 0, v133
v_accvgpr_read_b32 v174, a110
v_max_f32 v134, 0, v134
v_accvgpr_read_b32 v175, a111
v_max_f32 v135, 0, v135
v_pk_mul_f32 v[132:133], v[132:133], v[172:173]
v_pk_mul_f32 v[134:135], v[134:135], v[174:175]
v_cvt_pk_bf16_f32 v126, v132, v133
v_cvt_pk_bf16_f32 v127, v134, v135
s_waitcnt lgkmcnt(7)
v_mfma_f32_16x16x32_bf16 v[176:179], a[144:147], v[120:123], v[176:179]
ds_read_b64_tr_b16 a[166:167], v4 offset:23552
s_add_u32 m0, s92, 8192
v_mfma_f32_16x16x32_bf16 v[180:183], a[144:147], v[124:127], v[180:183]
s_add_u32 s32, s23, 147712
buffer_load_dwordx4 v12, s[8:11], s32 offen lds
ds_read_b64_tr_b16 a[168:169], v3 offset:40960
v_mfma_f32_16x16x32_bf16 v[184:187], a[148:151], v[120:123], v[184:187]
ds_read_b64_tr_b16 a[170:171], v3 offset:41984
v_accvgpr_read_b32 v168, a112
v_mfma_f32_16x16x32_bf16 v[188:191], a[148:151], v[124:127], v[188:191]
ds_read_b64_tr_b16 a[172:173], v4 offset:40960
s_waitcnt lgkmcnt(7)
v_mfma_f32_16x16x32_bf16 v[192:195], a[152:155], v[120:123], v[192:195]
ds_read_b64_tr_b16 a[174:175], v4 offset:41984
v_max_f32 v136, 0, v136
v_mfma_f32_16x16x32_bf16 v[196:199], a[152:155], v[124:127], v[196:199]
ds_read_b64_tr_b16 a[144:145], v3 offset:24576
v_accvgpr_read_b32 v169, a113
v_mfma_f32_16x16x32_bf16 v[200:203], a[156:159], v[120:123], v[200:203]
ds_read_b64_tr_b16 a[146:147], v3 offset:25600
v_max_f32 v137, 0, v137
v_accvgpr_read_b32 v170, a114
v_max_f32 v138, 0, v138
v_accvgpr_read_b32 v171, a115
v_max_f32 v139, 0, v139
v_pk_mul_f32 v[136:137], v[136:137], v[168:169]
v_pk_mul_f32 v[138:139], v[138:139], v[170:171]
v_cvt_pk_bf16_f32 v136, v136, v137
v_cvt_pk_bf16_f32 v137, v138, v139
v_accvgpr_read_b32 v172, a120
v_max_f32 v144, 0, v144
v_accvgpr_read_b32 v173, a121
v_max_f32 v145, 0, v145
v_accvgpr_read_b32 v174, a122
v_max_f32 v146, 0, v146
v_accvgpr_read_b32 v175, a123
v_max_f32 v147, 0, v147
v_pk_mul_f32 v[144:145], v[144:145], v[172:173]
v_pk_mul_f32 v[146:147], v[146:147], v[174:175]
v_cvt_pk_bf16_f32 v138, v144, v145
v_cvt_pk_bf16_f32 v139, v146, v147
v_mfma_f32_16x16x32_bf16 v[204:207], a[156:159], v[124:127], v[204:207]
ds_read_b64_tr_b16 a[148:149], v4 offset:24576
v_accvgpr_read_b32 v168, a116
v_max_f32 v140, 0, v140
v_accvgpr_read_b32 v169, a117
v_max_f32 v141, 0, v141
v_accvgpr_read_b32 v170, a118
v_max_f32 v142, 0, v142
v_accvgpr_read_b32 v171, a119
v_max_f32 v143, 0, v143
v_pk_mul_f32 v[140:141], v[140:141], v[168:169]
v_pk_mul_f32 v[142:143], v[142:143], v[170:171]
v_cvt_pk_bf16_f32 v140, v140, v141
v_cvt_pk_bf16_f32 v141, v142, v143
v_accvgpr_read_b32 v172, a124
v_max_f32 v148, 0, v148
v_accvgpr_read_b32 v173, a125
v_max_f32 v149, 0, v149
v_accvgpr_read_b32 v174, a126
v_max_f32 v150, 0, v150
v_accvgpr_read_b32 v175, a127
v_max_f32 v151, 0, v151
v_pk_mul_f32 v[148:149], v[148:149], v[172:173]
v_pk_mul_f32 v[150:151], v[150:151], v[174:175]
v_cvt_pk_bf16_f32 v142, v148, v149
v_cvt_pk_bf16_f32 v143, v150, v151
s_waitcnt lgkmcnt(7)
v_mfma_f32_16x16x32_bf16 v[176:179], a[160:163], v[136:139], v[176:179]
ds_read_b64_tr_b16 a[150:151], v4 offset:25600
v_accvgpr_read_b32 v168, a128
v_mfma_f32_16x16x32_bf16 v[180:183], a[160:163], v[140:143], v[180:183]
ds_read_b64_tr_b16 a[152:153], v3 offset:43008
v_max_f32 v152, 0, v152
v_mfma_f32_16x16x32_bf16 v[184:187], a[164:167], v[136:139], v[184:187]
ds_read_b64_tr_b16 a[154:155], v3 offset:44032
v_accvgpr_read_b32 v169, a129
v_mfma_f32_16x16x32_bf16 v[188:191], a[164:167], v[140:143], v[188:191]
ds_read_b64_tr_b16 a[156:157], v4 offset:43008
s_waitcnt lgkmcnt(7)
v_mfma_f32_16x16x32_bf16 v[192:195], a[168:171], v[136:139], v[192:195]
ds_read_b64_tr_b16 a[158:159], v4 offset:44032
v_max_f32 v153, 0, v153
v_mfma_f32_16x16x32_bf16 v[196:199], a[168:171], v[140:143], v[196:199]
s_waitcnt vmcnt(9)
s_barrier
ds_read_b64_tr_b16 a[160:161], v3 offset:45056
v_mfma_f32_16x16x32_bf16 v[200:203], a[172:175], v[136:139], v[200:203]
ds_read_b64_tr_b16 a[162:163], v3 offset:46080
v_accvgpr_read_b32 v170, a130
v_max_f32 v154, 0, v154
v_accvgpr_read_b32 v171, a131
v_max_f32 v155, 0, v155
v_pk_mul_f32 v[152:153], v[152:153], v[168:169]
v_pk_mul_f32 v[154:155], v[154:155], v[170:171]
v_cvt_pk_bf16_f32 v152, v152, v153
v_cvt_pk_bf16_f32 v153, v154, v155
v_accvgpr_read_b32 v172, a136
v_max_f32 v160, 0, v160
v_accvgpr_read_b32 v173, a137
v_max_f32 v161, 0, v161
v_accvgpr_read_b32 v174, a138
v_max_f32 v162, 0, v162
v_accvgpr_read_b32 v175, a139
v_max_f32 v163, 0, v163
v_pk_mul_f32 v[160:161], v[160:161], v[172:173]
v_pk_mul_f32 v[162:163], v[162:163], v[174:175]
v_cvt_pk_bf16_f32 v154, v160, v161
v_cvt_pk_bf16_f32 v155, v162, v163
v_mfma_f32_16x16x32_bf16 v[204:207], a[172:175], v[140:143], v[204:207]
ds_read_b64_tr_b16 a[164:165], v4 offset:45056
v_accvgpr_read_b32 v168, a132
v_max_f32 v156, 0, v156
v_accvgpr_read_b32 v169, a133
v_max_f32 v157, 0, v157
v_accvgpr_read_b32 v170, a134
v_max_f32 v158, 0, v158
v_accvgpr_read_b32 v171, a135
v_max_f32 v159, 0, v159
v_pk_mul_f32 v[156:157], v[156:157], v[168:169]
v_pk_mul_f32 v[158:159], v[158:159], v[170:171]
v_cvt_pk_bf16_f32 v156, v156, v157
v_cvt_pk_bf16_f32 v157, v158, v159
v_accvgpr_read_b32 v172, a140
v_max_f32 v164, 0, v164
v_accvgpr_read_b32 v173, a141
v_max_f32 v165, 0, v165
v_accvgpr_read_b32 v174, a142
v_max_f32 v166, 0, v166
v_accvgpr_read_b32 v175, a143
v_max_f32 v167, 0, v167
v_pk_mul_f32 v[164:165], v[164:165], v[172:173]
v_pk_mul_f32 v[166:167], v[166:167], v[174:175]
v_cvt_pk_bf16_f32 v158, v164, v165
v_cvt_pk_bf16_f32 v159, v166, v167
s_waitcnt lgkmcnt(7)
v_mfma_f32_16x16x32_bf16 v[176:179], a[144:147], v[152:155], v[176:179]
ds_read_b64_tr_b16 a[166:167], v4 offset:46080
s_add_u32 m0, s92, 36864
v_mfma_f32_16x16x32_bf16 v[180:183], a[144:147], v[156:159], v[180:183]
s_add_u32 s30, s23, 384
buffer_load_dwordx4 v12, s[8:11], s30 offen lds
ds_read_b64_tr_b16 a[168:169], v3 offset:63488
v_mfma_f32_16x16x32_bf16 v[184:187], a[148:151], v[152:155], v[184:187]
ds_read_b64_tr_b16 a[170:171], v3 offset:64512
s_add_u32 s34, s28, 0
v_mfma_f32_16x16x32_bf16 v[188:191], a[148:151], v[156:159], v[188:191]
ds_read_b64_tr_b16 a[172:173], v4 offset:63488
s_waitcnt lgkmcnt(7)
v_mfma_f32_16x16x32_bf16 v[192:195], a[152:155], v[152:155], v[192:195]
ds_read_b64_tr_b16 a[174:175], v4 offset:64512
v_mfma_f32_16x16x32_bf16 v[196:199], a[152:155], v[156:159], v[196:199]
ds_read_b64_tr_b16 a[144:145], v3 offset:47104
buffer_load_dwordx4 v13, s[8:11], s30 offen offset:1024 lds
v_mfma_f32_16x16x32_bf16 v[200:203], a[156:159], v[152:155], v[200:203]
ds_read_b64_tr_b16 a[146:147], v3 offset:48128
v_cvt_pk_bf16_f32 v240, v176, v177
v_mfma_f32_16x16x32_bf16 v[204:207], a[156:159], v[156:159], v[204:207]
ds_read_b64_tr_b16 a[148:149], v4 offset:47104
s_waitcnt lgkmcnt(7)
v_mfma_f32_16x16x32_bf16 v[208:211], a[160:163], v[24:27], 0
ds_read_b64_tr_b16 a[150:151], v4 offset:48128
v_cvt_pk_bf16_f32 v241, v178, v179
v_mfma_f32_16x16x32_bf16 v[212:215], a[160:163], v[28:31], 0
ds_read_b64_tr_b16 a[152:153], v5
v_cvt_pk_bf16_f32 v242, v184, v185
v_mfma_f32_16x16x32_bf16 v[216:219], a[164:167], v[24:27], 0
ds_read_b64_tr_b16 a[154:155], v5 offset:1024
v_cvt_pk_bf16_f32 v243, v186, v187
v_mfma_f32_16x16x32_bf16 v[220:223], a[164:167], v[28:31], 0
ds_read_b64_tr_b16 a[156:157], v6
buffer_store_dwordx4 v[240:243], v7, s[16:19], s34 offen sc1
s_waitcnt lgkmcnt(7)
v_mfma_f32_16x16x32_bf16 v[224:227], a[168:171], v[24:27], 0
ds_read_b64_tr_b16 a[158:159], v6 offset:1024
buffer_load_dwordx4 v14, s[8:11], s30 offen offset:2048 lds
v_mfma_f32_16x16x32_bf16 v[228:231], a[168:171], v[28:31], 0
ds_read_b64_tr_b16 a[160:161], v3 offset:49152
v_cvt_pk_bf16_f32 v244, v180, v181
v_mfma_f32_16x16x32_bf16 v[232:235], a[172:175], v[24:27], 0
ds_read_b64_tr_b16 a[162:163], v3 offset:50176
v_cvt_pk_bf16_f32 v245, v182, v183
v_mfma_f32_16x16x32_bf16 v[236:239], a[172:175], v[28:31], 0
ds_read_b64_tr_b16 a[164:165], v4 offset:49152
s_waitcnt lgkmcnt(7)
v_mfma_f32_16x16x32_bf16 v[208:211], a[144:147], v[40:43], v[208:211]
ds_read_b64_tr_b16 a[166:167], v4 offset:50176
v_cvt_pk_bf16_f32 v246, v188, v189
v_mfma_f32_16x16x32_bf16 v[212:215], a[144:147], v[44:47], v[212:215]
ds_read_b64_tr_b16 a[168:169], v5 offset:2048
v_cvt_pk_bf16_f32 v247, v190, v191
buffer_store_dwordx4 v[244:247], v16, s[16:19], s34 offen sc1
v_mfma_f32_16x16x32_bf16 v[216:219], a[148:151], v[40:43], v[216:219]
ds_read_b64_tr_b16 a[170:171], v5 offset:3072
v_mfma_f32_16x16x32_bf16 v[220:223], a[148:151], v[44:47], v[220:223]
ds_read_b64_tr_b16 a[172:173], v6 offset:2048
s_waitcnt lgkmcnt(7)
v_mfma_f32_16x16x32_bf16 v[224:227], a[152:155], v[40:43], v[224:227]
ds_read_b64_tr_b16 a[174:175], v6 offset:3072
buffer_load_dwordx4 v15, s[8:11], s30 offen offset:3072 lds
v_mfma_f32_16x16x32_bf16 v[228:231], a[152:155], v[44:47], v[228:231]
ds_read_b64_tr_b16 a[144:145], v3 offset:51200
v_cvt_pk_bf16_f32 v248, v192, v193
v_mfma_f32_16x16x32_bf16 v[232:235], a[156:159], v[40:43], v[232:235]
ds_read_b64_tr_b16 a[146:147], v3 offset:52224
v_cvt_pk_bf16_f32 v249, v194, v195
v_mfma_f32_16x16x32_bf16 v[236:239], a[156:159], v[44:47], v[236:239]
ds_read_b64_tr_b16 a[148:149], v4 offset:51200
s_waitcnt lgkmcnt(7)
v_mfma_f32_16x16x32_bf16 v[208:211], a[160:163], v[56:59], v[208:211]
ds_read_b64_tr_b16 a[150:151], v4 offset:52224
v_cvt_pk_bf16_f32 v250, v200, v201
v_mfma_f32_16x16x32_bf16 v[212:215], a[160:163], v[60:63], v[212:215]
ds_read_b64_tr_b16 a[152:153], v5 offset:4096
v_cvt_pk_bf16_f32 v251, v202, v203
v_mfma_f32_16x16x32_bf16 v[216:219], a[164:167], v[56:59], v[216:219]
ds_read_b64_tr_b16 a[154:155], v5 offset:5120
buffer_store_dwordx4 v[248:251], v7, s[16:19], s34 offen offset:1024 sc1
v_mfma_f32_16x16x32_bf16 v[220:223], a[164:167], v[60:63], v[220:223]
ds_read_b64_tr_b16 a[156:157], v6 offset:4096
s_waitcnt lgkmcnt(7)
v_mfma_f32_16x16x32_bf16 v[224:227], a[168:171], v[56:59], v[224:227]
ds_read_b64_tr_b16 a[158:159], v6 offset:5120
s_add_u32 m0, s92, 40960
v_mfma_f32_16x16x32_bf16 v[228:231], a[168:171], v[60:63], v[228:231]
s_add_u32 s31, s23, 74112
buffer_load_dwordx4 v12, s[8:11], s31 offen lds
ds_read_b64_tr_b16 a[160:161], v3 offset:53248
v_mfma_f32_16x16x32_bf16 v[232:235], a[172:175], v[56:59], v[232:235]
ds_read_b64_tr_b16 a[162:163], v3 offset:54272
v_cvt_pk_bf16_f32 v252, v196, v197
v_mfma_f32_16x16x32_bf16 v[236:239], a[172:175], v[60:63], v[236:239]
ds_read_b64_tr_b16 a[164:165], v4 offset:53248
s_waitcnt lgkmcnt(7)
v_mfma_f32_16x16x32_bf16 v[208:211], a[144:147], v[72:75], v[208:211]
ds_read_b64_tr_b16 a[166:167], v4 offset:54272
v_cvt_pk_bf16_f32 v253, v198, v199
v_mfma_f32_16x16x32_bf16 v[212:215], a[144:147], v[76:79], v[212:215]
ds_read_b64_tr_b16 a[168:169], v5 offset:6144
v_cvt_pk_bf16_f32 v254, v204, v205
v_cvt_pk_bf16_f32 v255, v206, v207
buffer_store_dwordx4 v[252:255], v16, s[16:19], s34 offen offset:1024 sc1
v_mfma_f32_16x16x32_bf16 v[216:219], a[148:151], v[72:75], v[216:219]
ds_read_b64_tr_b16 a[170:171], v5 offset:7168
buffer_load_dwordx4 v13, s[8:11], s31 offen offset:1024 lds
v_mfma_f32_16x16x32_bf16 v[220:223], a[148:151], v[76:79], v[220:223]
ds_read_b64_tr_b16 a[172:173], v6 offset:6144
s_waitcnt lgkmcnt(7)
v_mfma_f32_16x16x32_bf16 v[224:227], a[152:155], v[72:75], v[224:227]
ds_read_b64_tr_b16 a[174:175], v6 offset:7168
v_mfma_f32_16x16x32_bf16 v[228:231], a[152:155], v[76:79], v[228:231]
ds_read_b64_tr_b16 a[144:145], v3 offset:55296
v_mfma_f32_16x16x32_bf16 v[232:235], a[156:159], v[72:75], v[232:235]
ds_read_b64_tr_b16 a[146:147], v3 offset:56320
v_mfma_f32_16x16x32_bf16 v[236:239], a[156:159], v[76:79], v[236:239]
ds_read_b64_tr_b16 a[148:149], v4 offset:55296
s_waitcnt lgkmcnt(7)
v_mfma_f32_16x16x32_bf16 v[208:211], a[160:163], v[88:91], v[208:211]
ds_read_b64_tr_b16 a[150:151], v4 offset:56320
buffer_load_dwordx4 v14, s[8:11], s31 offen offset:2048 lds
v_mfma_f32_16x16x32_bf16 v[212:215], a[160:163], v[92:95], v[212:215]
ds_read_b64_tr_b16 a[152:153], v5 offset:8192
v_mfma_f32_16x16x32_bf16 v[216:219], a[164:167], v[88:91], v[216:219]
ds_read_b64_tr_b16 a[154:155], v5 offset:9216
v_mfma_f32_16x16x32_bf16 v[220:223], a[164:167], v[92:95], v[220:223]
ds_read_b64_tr_b16 a[156:157], v6 offset:8192
s_waitcnt lgkmcnt(7)
v_mfma_f32_16x16x32_bf16 v[224:227], a[168:171], v[88:91], v[224:227]
ds_read_b64_tr_b16 a[158:159], v6 offset:9216
v_mfma_f32_16x16x32_bf16 v[228:231], a[168:171], v[92:95], v[228:231]
ds_read_b64_tr_b16 a[160:161], v3 offset:57344
v_mfma_f32_16x16x32_bf16 v[232:235], a[172:175], v[88:91], v[232:235]
ds_read_b64_tr_b16 a[162:163], v3 offset:58368
v_mfma_f32_16x16x32_bf16 v[236:239], a[172:175], v[92:95], v[236:239]
ds_read_b64_tr_b16 a[164:165], v4 offset:57344
s_waitcnt lgkmcnt(7)
v_mfma_f32_16x16x32_bf16 v[208:211], a[144:147], v[104:107], v[208:211]
ds_read_b64_tr_b16 a[166:167], v4 offset:58368
buffer_load_dwordx4 v15, s[8:11], s31 offen offset:3072 lds
v_mfma_f32_16x16x32_bf16 v[212:215], a[144:147], v[108:111], v[212:215]
ds_read_b64_tr_b16 a[168:169], v5 offset:10240
v_mfma_f32_16x16x32_bf16 v[216:219], a[148:151], v[104:107], v[216:219]
ds_read_b64_tr_b16 a[170:171], v5 offset:11264
v_mfma_f32_16x16x32_bf16 v[220:223], a[148:151], v[108:111], v[220:223]
ds_read_b64_tr_b16 a[172:173], v6 offset:10240
s_waitcnt lgkmcnt(7)
v_mfma_f32_16x16x32_bf16 v[224:227], a[152:155], v[104:107], v[224:227]
ds_read_b64_tr_b16 a[174:175], v6 offset:11264
v_mfma_f32_16x16x32_bf16 v[228:231], a[152:155], v[108:111], v[228:231]
ds_read_b64_tr_b16 a[144:145], v3 offset:59392
v_mfma_f32_16x16x32_bf16 v[232:235], a[156:159], v[104:107], v[232:235]
ds_read_b64_tr_b16 a[146:147], v3 offset:60416
s_add_u32 m0, s92, 45056
v_mfma_f32_16x16x32_bf16 v[236:239], a[156:159], v[108:111], v[236:239]
ds_read_b64_tr_b16 a[148:149], v4 offset:59392
s_waitcnt lgkmcnt(7)
v_mfma_f32_16x16x32_bf16 v[208:211], a[160:163], v[120:123], v[208:211]
ds_read_b64_tr_b16 a[150:151], v4 offset:60416
s_add_u32 s32, s23, 147840
v_mfma_f32_16x16x32_bf16 v[212:215], a[160:163], v[124:127], v[212:215]
buffer_load_dwordx4 v12, s[8:11], s32 offen lds
ds_read_b64_tr_b16 a[152:153], v5 offset:12288
v_mfma_f32_16x16x32_bf16 v[216:219], a[164:167], v[120:123], v[216:219]
ds_read_b64_tr_b16 a[154:155], v5 offset:13312
v_mfma_f32_16x16x32_bf16 v[220:223], a[164:167], v[124:127], v[220:223]
ds_read_b64_tr_b16 a[156:157], v6 offset:12288
s_waitcnt lgkmcnt(7)
v_mfma_f32_16x16x32_bf16 v[224:227], a[168:171], v[120:123], v[224:227]
ds_read_b64_tr_b16 a[158:159], v6 offset:13312
v_mfma_f32_16x16x32_bf16 v[228:231], a[168:171], v[124:127], v[228:231]
ds_read_b64_tr_b16 a[160:161], v3 offset:61440
v_mfma_f32_16x16x32_bf16 v[232:235], a[172:175], v[120:123], v[232:235]
ds_read_b64_tr_b16 a[162:163], v3 offset:62464
v_mfma_f32_16x16x32_bf16 v[236:239], a[172:175], v[124:127], v[236:239]
ds_read_b64_tr_b16 a[164:165], v4 offset:61440
s_waitcnt lgkmcnt(7)
v_mfma_f32_16x16x32_bf16 v[208:211], a[144:147], v[136:139], v[208:211]
ds_read_b64_tr_b16 a[166:167], v4 offset:62464
v_mfma_f32_16x16x32_bf16 v[212:215], a[144:147], v[140:143], v[212:215]
ds_read_b64_tr_b16 a[168:169], v5 offset:14336
v_mfma_f32_16x16x32_bf16 v[216:219], a[148:151], v[136:139], v[216:219]
ds_read_b64_tr_b16 a[170:171], v5 offset:15360
v_mfma_f32_16x16x32_bf16 v[220:223], a[148:151], v[140:143], v[220:223]
ds_read_b64_tr_b16 a[172:173], v6 offset:14336
s_waitcnt lgkmcnt(7)
v_mfma_f32_16x16x32_bf16 v[224:227], a[152:155], v[136:139], v[224:227]
ds_read_b64_tr_b16 a[174:175], v6 offset:15360
v_mfma_f32_16x16x32_bf16 v[228:231], a[152:155], v[140:143], v[228:231]
s_waitcnt vmcnt(13)
s_barrier
ds_read_b64_tr_b16 a[144:145], v1
v_mfma_f32_16x16x32_bf16 v[232:235], a[156:159], v[136:139], v[232:235]
ds_read_b64_tr_b16 a[146:147], v1 offset:1024
s_add_u32 m0, s92, 73728
v_mfma_f32_16x16x32_bf16 v[236:239], a[156:159], v[140:143], v[236:239]
ds_read_b64_tr_b16 a[148:149], v2
s_waitcnt lgkmcnt(7)
v_mfma_f32_16x16x32_bf16 v[208:211], a[160:163], v[152:155], v[208:211]
ds_read_b64_tr_b16 a[150:151], v2 offset:1024
s_add_u32 s30, s23, 512
v_mfma_f32_16x16x32_bf16 v[212:215], a[160:163], v[156:159], v[212:215]
buffer_load_dwordx4 v12, s[8:11], s30 offen lds
ds_read_b64_tr_b16 a[152:153], v1 offset:18432
v_mfma_f32_16x16x32_bf16 v[216:219], a[164:167], v[152:155], v[216:219]
ds_read_b64_tr_b16 a[154:155], v1 offset:19456
v_mfma_f32_16x16x32_bf16 v[220:223], a[164:167], v[156:159], v[220:223]
ds_read_b64_tr_b16 a[156:157], v2 offset:18432
s_waitcnt lgkmcnt(7)
v_mfma_f32_16x16x32_bf16 v[224:227], a[168:171], v[152:155], v[224:227]
ds_read_b64_tr_b16 a[158:159], v2 offset:19456
v_mfma_f32_16x16x32_bf16 v[228:231], a[168:171], v[156:159], v[228:231]
ds_read_b64_tr_b16 a[160:161], v1 offset:2048
buffer_load_dwordx4 v13, s[8:11], s30 offen offset:1024 lds
v_mfma_f32_16x16x32_bf16 v[232:235], a[172:175], v[152:155], v[232:235]
ds_read_b64_tr_b16 a[162:163], v1 offset:3072
v_cvt_pk_bf16_f32 v240, v208, v209
v_mfma_f32_16x16x32_bf16 v[236:239], a[172:175], v[156:159], v[236:239]
ds_read_b64_tr_b16 a[164:165], v2 offset:2048
s_waitcnt lgkmcnt(7)
v_mfma_f32_16x16x32_bf16 v[176:179], a[144:147], v[24:27], 0
ds_read_b64_tr_b16 a[166:167], v2 offset:3072
v_cvt_pk_bf16_f32 v241, v210, v211
v_mfma_f32_16x16x32_bf16 v[180:183], a[144:147], v[28:31], 0
ds_read_b64_tr_b16 a[168:169], v1 offset:20480
v_cvt_pk_bf16_f32 v242, v216, v217
v_mfma_f32_16x16x32_bf16 v[184:187], a[148:151], v[24:27], 0
ds_read_b64_tr_b16 a[170:171], v1 offset:21504
v_cvt_pk_bf16_f32 v243, v218, v219
v_mfma_f32_16x16x32_bf16 v[188:191], a[148:151], v[28:31], 0
ds_read_b64_tr_b16 a[172:173], v2 offset:20480
buffer_store_dwordx4 v[240:243], v7, s[16:19], s34 offen offset:2048 sc1
s_waitcnt lgkmcnt(7)
v_mfma_f32_16x16x32_bf16 v[192:195], a[152:155], v[24:27], 0
ds_read_b64_tr_b16 a[174:175], v2 offset:21504
buffer_load_dwordx4 v14, s[8:11], s30 offen offset:2048 lds
v_mfma_f32_16x16x32_bf16 v[196:199], a[152:155], v[28:31], 0
ds_read_b64_tr_b16 a[144:145], v1 offset:4096
v_cvt_pk_bf16_f32 v244, v212, v213
v_mfma_f32_16x16x32_bf16 v[200:203], a[156:159], v[24:27], 0
ds_read_b64_tr_b16 a[146:147], v1 offset:5120
v_cvt_pk_bf16_f32 v245, v214, v215
v_mfma_f32_16x16x32_bf16 v[204:207], a[156:159], v[28:31], 0
ds_read_b64_tr_b16 a[148:149], v2 offset:4096
s_waitcnt lgkmcnt(7)
v_mfma_f32_16x16x32_bf16 v[176:179], a[160:163], v[40:43], v[176:179]
ds_read_b64_tr_b16 a[150:151], v2 offset:5120
v_cvt_pk_bf16_f32 v246, v220, v221
v_mfma_f32_16x16x32_bf16 v[180:183], a[160:163], v[44:47], v[180:183]
ds_read_b64_tr_b16 a[152:153], v1 offset:22528
v_cvt_pk_bf16_f32 v247, v222, v223
buffer_store_dwordx4 v[244:247], v16, s[16:19], s34 offen offset:2048 sc1
v_mfma_f32_16x16x32_bf16 v[184:187], a[164:167], v[40:43], v[184:187]
ds_read_b64_tr_b16 a[154:155], v1 offset:23552
v_mfma_f32_16x16x32_bf16 v[188:191], a[164:167], v[44:47], v[188:191]
ds_read_b64_tr_b16 a[156:157], v2 offset:22528
s_waitcnt lgkmcnt(7)
v_mfma_f32_16x16x32_bf16 v[192:195], a[168:171], v[40:43], v[192:195]
ds_read_b64_tr_b16 a[158:159], v2 offset:23552
buffer_load_dwordx4 v15, s[8:11], s30 offen offset:3072 lds
v_mfma_f32_16x16x32_bf16 v[196:199], a[168:171], v[44:47], v[196:199]
ds_read_b64_tr_b16 a[160:161], v1 offset:6144
v_cvt_pk_bf16_f32 v248, v224, v225
v_mfma_f32_16x16x32_bf16 v[200:203], a[172:175], v[40:43], v[200:203]
ds_read_b64_tr_b16 a[162:163], v1 offset:7168
v_cvt_pk_bf16_f32 v249, v226, v227
v_mfma_f32_16x16x32_bf16 v[204:207], a[172:175], v[44:47], v[204:207]
ds_read_b64_tr_b16 a[164:165], v2 offset:6144
s_waitcnt lgkmcnt(7)
v_mfma_f32_16x16x32_bf16 v[176:179], a[144:147], v[56:59], v[176:179]
ds_read_b64_tr_b16 a[166:167], v2 offset:7168
v_cvt_pk_bf16_f32 v250, v232, v233
v_mfma_f32_16x16x32_bf16 v[180:183], a[144:147], v[60:63], v[180:183]
ds_read_b64_tr_b16 a[168:169], v1 offset:24576
v_cvt_pk_bf16_f32 v251, v234, v235
v_mfma_f32_16x16x32_bf16 v[184:187], a[148:151], v[56:59], v[184:187]
ds_read_b64_tr_b16 a[170:171], v1 offset:25600
buffer_store_dwordx4 v[248:251], v7, s[16:19], s34 offen offset:3072 sc1
v_mfma_f32_16x16x32_bf16 v[188:191], a[148:151], v[60:63], v[188:191]
ds_read_b64_tr_b16 a[172:173], v2 offset:24576
s_waitcnt lgkmcnt(7)
v_mfma_f32_16x16x32_bf16 v[192:195], a[152:155], v[56:59], v[192:195]
ds_read_b64_tr_b16 a[174:175], v2 offset:25600
s_add_u32 m0, s92, 77824
v_mfma_f32_16x16x32_bf16 v[196:199], a[152:155], v[60:63], v[196:199]
s_add_u32 s31, s23, 74240
buffer_load_dwordx4 v12, s[8:11], s31 offen lds
ds_read_b64_tr_b16 a[144:145], v1 offset:8192
v_mfma_f32_16x16x32_bf16 v[200:203], a[156:159], v[56:59], v[200:203]
ds_read_b64_tr_b16 a[146:147], v1 offset:9216
v_cvt_pk_bf16_f32 v252, v228, v229
v_mfma_f32_16x16x32_bf16 v[204:207], a[156:159], v[60:63], v[204:207]
ds_read_b64_tr_b16 a[148:149], v2 offset:8192
s_waitcnt lgkmcnt(7)
v_mfma_f32_16x16x32_bf16 v[176:179], a[160:163], v[72:75], v[176:179]
ds_read_b64_tr_b16 a[150:151], v2 offset:9216
v_cvt_pk_bf16_f32 v253, v230, v231
v_mfma_f32_16x16x32_bf16 v[180:183], a[160:163], v[76:79], v[180:183]
ds_read_b64_tr_b16 a[152:153], v1 offset:26624
v_cvt_pk_bf16_f32 v254, v236, v237
v_cvt_pk_bf16_f32 v255, v238, v239
buffer_store_dwordx4 v[252:255], v16, s[16:19], s34 offen offset:3072 sc1
s_lshl_b32 s24, s22, 3
v_mfma_f32_16x16x32_bf16 v[184:187], a[164:167], v[72:75], v[184:187]
ds_read_b64_tr_b16 a[154:155], v1 offset:27648
s_lshr_b32 s39, s21, 1
v_mfma_f32_16x16x32_bf16 v[188:191], a[164:167], v[76:79], v[188:191]
ds_read_b64_tr_b16 a[156:157], v2 offset:26624
s_waitcnt lgkmcnt(7)
v_mfma_f32_16x16x32_bf16 v[192:195], a[168:171], v[72:75], v[192:195]
buffer_load_dwordx4 v13, s[8:11], s31 offen offset:1024 lds
ds_read_b64_tr_b16 a[158:159], v2 offset:27648
v_mfma_f32_16x16x32_bf16 v[196:199], a[168:171], v[76:79], v[196:199]
ds_read_b64_tr_b16 a[160:161], v1 offset:10240
s_add_u32 s24, s24, s39
v_mfma_f32_16x16x32_bf16 v[200:203], a[172:175], v[72:75], v[200:203]
ds_read_b64_tr_b16 a[162:163], v1 offset:11264
s_mul_i32 s24, s24, 18432
v_mfma_f32_16x16x32_bf16 v[204:207], a[172:175], v[76:79], v[204:207]
ds_read_b64_tr_b16 a[164:165], v2 offset:10240
s_waitcnt lgkmcnt(7)
v_mfma_f32_16x16x32_bf16 v[176:179], a[144:147], v[88:91], v[176:179]
ds_read_b64_tr_b16 a[166:167], v2 offset:11264
buffer_load_dwordx4 v14, s[8:11], s31 offen offset:2048 lds
v_mfma_f32_16x16x32_bf16 v[180:183], a[144:147], v[92:95], v[180:183]
ds_read_b64_tr_b16 a[168:169], v1 offset:28672
s_and_b32 s39, s21, 1
v_mfma_f32_16x16x32_bf16 v[184:187], a[148:151], v[88:91], v[184:187]
ds_read_b64_tr_b16 a[170:171], v1 offset:29696
v_mfma_f32_16x16x32_bf16 v[188:191], a[148:151], v[92:95], v[188:191]
ds_read_b64_tr_b16 a[172:173], v2 offset:28672
s_waitcnt lgkmcnt(7)
v_mfma_f32_16x16x32_bf16 v[192:195], a[152:155], v[88:91], v[192:195]
ds_read_b64_tr_b16 a[174:175], v2 offset:29696
s_lshl_b32 s39, s39, 7
v_mfma_f32_16x16x32_bf16 v[196:199], a[152:155], v[92:95], v[196:199]
ds_read_b64_tr_b16 a[144:145], v1 offset:12288
v_mfma_f32_16x16x32_bf16 v[200:203], a[156:159], v[88:91], v[200:203]
ds_read_b64_tr_b16 a[146:147], v1 offset:13312
s_add_u32 s24, s24, s39
v_mfma_f32_16x16x32_bf16 v[204:207], a[156:159], v[92:95], v[204:207]
ds_read_b64_tr_b16 a[148:149], v2 offset:12288
s_waitcnt lgkmcnt(7)
v_mfma_f32_16x16x32_bf16 v[176:179], a[160:163], v[104:107], v[176:179]
ds_read_b64_tr_b16 a[150:151], v2 offset:13312
buffer_load_dwordx4 v15, s[8:11], s31 offen offset:3072 lds
v_mfma_f32_16x16x32_bf16 v[180:183], a[160:163], v[108:111], v[180:183]
ds_read_b64_tr_b16 a[152:153], v1 offset:30720
s_mul_i32 s25, s22, 1024
v_mfma_f32_16x16x32_bf16 v[184:187], a[164:167], v[104:107], v[184:187]
ds_read_b64_tr_b16 a[154:155], v1 offset:31744
v_mfma_f32_16x16x32_bf16 v[188:191], a[164:167], v[108:111], v[188:191]
ds_read_b64_tr_b16 a[156:157], v2 offset:30720
s_waitcnt lgkmcnt(7)
v_mfma_f32_16x16x32_bf16 v[192:195], a[168:171], v[104:107], v[192:195]
ds_read_b64_tr_b16 a[158:159], v2 offset:31744
s_add_u32 s25, s25, 9977856
v_mfma_f32_16x16x32_bf16 v[196:199], a[168:171], v[108:111], v[196:199]
ds_read_b64_tr_b16 a[160:161], v1 offset:14336
v_lshrrev_b32 v17, 3, v0
v_mfma_f32_16x16x32_bf16 v[200:203], a[172:175], v[104:107], v[200:203]
ds_read_b64_tr_b16 a[162:163], v1 offset:15360
s_add_u32 m0, s92, 81920
v_mfma_f32_16x16x32_bf16 v[204:207], a[172:175], v[108:111], v[204:207]
ds_read_b64_tr_b16 a[164:165], v2 offset:14336
s_waitcnt lgkmcnt(7)
v_mfma_f32_16x16x32_bf16 v[176:179], a[144:147], v[120:123], v[176:179]
ds_read_b64_tr_b16 a[166:167], v2 offset:15360
s_add_u32 s32, s23, 147968
v_mfma_f32_16x16x32_bf16 v[180:183], a[144:147], v[124:127], v[180:183]
buffer_load_dwordx4 v12, s[8:11], s32 offen lds
ds_read_b64_tr_b16 a[168:169], v1 offset:32768
v_mfma_f32_16x16x32_bf16 v[184:187], a[148:151], v[120:123], v[184:187]
ds_read_b64_tr_b16 a[170:171], v1 offset:33792
v_lshlrev_b32 v18, 8, v17
v_mfma_f32_16x16x32_bf16 v[188:191], a[148:151], v[124:127], v[188:191]
ds_read_b64_tr_b16 a[172:173], v2 offset:32768
s_waitcnt lgkmcnt(7)
v_mfma_f32_16x16x32_bf16 v[192:195], a[152:155], v[120:123], v[192:195]
ds_read_b64_tr_b16 a[174:175], v2 offset:33792
v_and_b32 v19, 7, v0
v_mfma_f32_16x16x32_bf16 v[196:199], a[152:155], v[124:127], v[196:199]
ds_read_b64_tr_b16 a[144:145], v1 offset:16384
v_lshl_add_u32 v18, v19, 4, v18
v_mfma_f32_16x16x32_bf16 v[200:203], a[156:159], v[120:123], v[200:203]
ds_read_b64_tr_b16 a[146:147], v1 offset:17408
v_mfma_f32_16x16x32_bf16 v[204:207], a[156:159], v[124:127], v[204:207]
ds_read_b64_tr_b16 a[148:149], v2 offset:16384
s_waitcnt lgkmcnt(7)
v_mfma_f32_16x16x32_bf16 v[176:179], a[160:163], v[136:139], v[176:179]
ds_read_b64_tr_b16 a[150:151], v2 offset:17408
v_and_b32 v168, 3, v17
v_mfma_f32_16x16x32_bf16 v[180:183], a[160:163], v[140:143], v[180:183]
ds_read_b64_tr_b16 a[152:153], v1 offset:34816
v_mfma_f32_16x16x32_bf16 v[184:187], a[164:167], v[136:139], v[184:187]
ds_read_b64_tr_b16 a[154:155], v1 offset:35840
v_lshrrev_b32 v17, 2, v17
v_mfma_f32_16x16x32_bf16 v[188:191], a[164:167], v[140:143], v[188:191]
ds_read_b64_tr_b16 a[156:157], v2 offset:34816
s_waitcnt lgkmcnt(7)
v_mfma_f32_16x16x32_bf16 v[192:195], a[168:171], v[136:139], v[192:195]
ds_read_b64_tr_b16 a[158:159], v2 offset:35840
s_add_u32 s34, s28, 4096
v_mfma_f32_16x16x32_bf16 v[196:199], a[168:171], v[140:143], v[196:199]
s_waitcnt vmcnt(13)
s_barrier
ds_read_b64_tr_b16 a[160:161], v1 offset:36864
v_mfma_f32_16x16x32_bf16 v[200:203], a[172:175], v[136:139], v[200:203]
ds_read_b64_tr_b16 a[162:163], v1 offset:37888
v_lshlrev_b32 v17, 7, v17
v_mfma_f32_16x16x32_bf16 v[204:207], a[172:175], v[140:143], v[204:207]
ds_read_b64_tr_b16 a[164:165], v2 offset:36864
s_waitcnt lgkmcnt(7)
v_mfma_f32_16x16x32_bf16 v[176:179], a[144:147], v[152:155], v[176:179]
ds_read_b64_tr_b16 a[166:167], v2 offset:37888
s_add_u32 m0, s92, 110592
v_mfma_f32_16x16x32_bf16 v[180:183], a[144:147], v[156:159], v[180:183]
s_add_u32 s30, s23, 640
buffer_load_dwordx4 v12, s[8:11], s30 offen lds
ds_read_b64_tr_b16 a[168:169], v1 offset:55296
v_lshl_add_u32 v17, v168, 4, v17
v_mfma_f32_16x16x32_bf16 v[184:187], a[148:151], v[152:155], v[184:187]
ds_read_b64_tr_b16 a[170:171], v1 offset:56320
v_mul_u32_u24 v173, 1152, v19
v_mfma_f32_16x16x32_bf16 v[188:191], a[148:151], v[156:159], v[188:191]
ds_read_b64_tr_b16 a[172:173], v2 offset:55296
s_waitcnt lgkmcnt(7)
v_mfma_f32_16x16x32_bf16 v[192:195], a[152:155], v[152:155], v[192:195]
ds_read_b64_tr_b16 a[174:175], v2 offset:56320
v_mfma_f32_16x16x32_bf16 v[196:199], a[152:155], v[156:159], v[196:199]
ds_read_b64_tr_b16 a[144:145], v1 offset:38912
v_mfma_f32_16x16x32_bf16 v[200:203], a[156:159], v[152:155], v[200:203]
ds_read_b64_tr_b16 a[146:147], v1 offset:39936
s_add_u32 s39, s20, 4
s_cmp_eq_u32 s20, 0
s_cselect_b32 s39, 8, s39
s_cselect_b32 s27, 3, 2
s_mul_i32 s27, s27, 128
s_add_u32 s27, s27, s25
s_cmp_lg_u32 s20, 1
s_cselect_b32 s37, 1.0, 0
s_cselect_b32 s38, 0, 0x7ff00000
s_mul_i32 s39, s39, 256
s_mul_i32 s40, s39, 8
s_add_u32 s40, s40, s38
v_mfma_f32_16x16x32_bf16 v[204:207], a[156:159], v[156:159], v[204:207]
ds_read_b64_tr_b16 a[148:149], v2 offset:38912
s_waitcnt lgkmcnt(7)
v_mfma_f32_16x16x32_bf16 v[208:211], a[160:163], v[24:27], 0
buffer_load_dwordx4 v13, s[8:11], s30 offen offset:1024 lds
ds_read_b64_tr_b16 a[150:151], v2 offset:39936
v_mfma_f32_16x16x32_bf16 v[212:215], a[160:163], v[28:31], 0
ds_read_b64_tr_b16 a[152:153], v1 offset:57344
v_cvt_pk_bf16_f32 v240, v176, v177
v_mfma_f32_16x16x32_bf16 v[216:219], a[164:167], v[24:27], 0
ds_read_b64_tr_b16 a[154:155], v1 offset:58368
v_cvt_pk_bf16_f32 v241, v178, v179
v_mfma_f32_16x16x32_bf16 v[220:223], a[164:167], v[28:31], 0
ds_read_b64_tr_b16 a[156:157], v2 offset:57344
v_cvt_pk_bf16_f32 v242, v184, v185
v_cvt_pk_bf16_f32 v243, v186, v187
buffer_store_dwordx4 v[240:243], v7, s[16:19], s34 offen sc1
s_waitcnt lgkmcnt(7)
v_mfma_f32_16x16x32_bf16 v[224:227], a[168:171], v[24:27], 0
ds_read_b64_tr_b16 a[158:159], v2 offset:58368
buffer_load_dwordx4 v14, s[8:11], s30 offen offset:2048 lds
v_mfma_f32_16x16x32_bf16 v[228:231], a[168:171], v[28:31], 0
ds_read_b64_tr_b16 a[160:161], v1 offset:40960
v_cvt_pk_bf16_f32 v244, v180, v181
v_mfma_f32_16x16x32_bf16 v[232:235], a[172:175], v[24:27], 0
ds_read_b64_tr_b16 a[162:163], v1 offset:41984
v_cvt_pk_bf16_f32 v245, v182, v183
v_mfma_f32_16x16x32_bf16 v[236:239], a[172:175], v[28:31], 0
ds_read_b64_tr_b16 a[164:165], v2 offset:40960
s_waitcnt lgkmcnt(7)
v_mfma_f32_16x16x32_bf16 v[208:211], a[144:147], v[40:43], v[208:211]
ds_read_b64_tr_b16 a[166:167], v2 offset:41984
v_cvt_pk_bf16_f32 v246, v188, v189
v_mfma_f32_16x16x32_bf16 v[212:215], a[144:147], v[44:47], v[212:215]
ds_read_b64_tr_b16 a[168:169], v1 offset:59392
v_cvt_pk_bf16_f32 v247, v190, v191
buffer_store_dwordx4 v[244:247], v16, s[16:19], s34 offen sc1
v_mfma_f32_16x16x32_bf16 v[216:219], a[148:151], v[40:43], v[216:219]
ds_read_b64_tr_b16 a[170:171], v1 offset:60416
v_mfma_f32_16x16x32_bf16 v[220:223], a[148:151], v[44:47], v[220:223]
ds_read_b64_tr_b16 a[172:173], v2 offset:59392
s_waitcnt lgkmcnt(7)
v_mfma_f32_16x16x32_bf16 v[224:227], a[152:155], v[40:43], v[224:227]
ds_read_b64_tr_b16 a[174:175], v2 offset:60416
buffer_load_dwordx4 v15, s[8:11], s30 offen offset:3072 lds
v_mfma_f32_16x16x32_bf16 v[228:231], a[152:155], v[44:47], v[228:231]
ds_read_b64_tr_b16 a[144:145], v1 offset:43008
v_cvt_pk_bf16_f32 v248, v192, v193
v_mfma_f32_16x16x32_bf16 v[232:235], a[156:159], v[40:43], v[232:235]
ds_read_b64_tr_b16 a[146:147], v1 offset:44032
v_cvt_pk_bf16_f32 v249, v194, v195
v_mfma_f32_16x16x32_bf16 v[236:239], a[156:159], v[44:47], v[236:239]
ds_read_b64_tr_b16 a[148:149], v2 offset:43008
s_waitcnt lgkmcnt(7)
v_mfma_f32_16x16x32_bf16 v[208:211], a[160:163], v[56:59], v[208:211]
ds_read_b64_tr_b16 a[150:151], v2 offset:44032
v_cvt_pk_bf16_f32 v250, v200, v201
v_mfma_f32_16x16x32_bf16 v[212:215], a[160:163], v[60:63], v[212:215]
ds_read_b64_tr_b16 a[152:153], v1 offset:61440
v_cvt_pk_bf16_f32 v251, v202, v203
v_mfma_f32_16x16x32_bf16 v[216:219], a[164:167], v[56:59], v[216:219]
ds_read_b64_tr_b16 a[154:155], v1 offset:62464
buffer_store_dwordx4 v[248:251], v7, s[16:19], s34 offen offset:1024 sc1
v_mfma_f32_16x16x32_bf16 v[220:223], a[164:167], v[60:63], v[220:223]
ds_read_b64_tr_b16 a[156:157], v2 offset:61440
s_waitcnt lgkmcnt(7)
v_mfma_f32_16x16x32_bf16 v[224:227], a[168:171], v[56:59], v[224:227]
ds_read_b64_tr_b16 a[158:159], v2 offset:62464
s_add_u32 m0, s92, 114688
v_mfma_f32_16x16x32_bf16 v[228:231], a[168:171], v[60:63], v[228:231]
s_add_u32 s31, s23, 74368
buffer_load_dwordx4 v12, s[8:11], s31 offen lds
ds_read_b64_tr_b16 a[160:161], v1 offset:45056
v_mfma_f32_16x16x32_bf16 v[232:235], a[172:175], v[56:59], v[232:235]
ds_read_b64_tr_b16 a[162:163], v1 offset:46080
v_cvt_pk_bf16_f32 v252, v196, v197
v_mfma_f32_16x16x32_bf16 v[236:239], a[172:175], v[60:63], v[236:239]
ds_read_b64_tr_b16 a[164:165], v2 offset:45056
s_waitcnt lgkmcnt(7)
v_mfma_f32_16x16x32_bf16 v[208:211], a[144:147], v[72:75], v[208:211]
ds_read_b64_tr_b16 a[166:167], v2 offset:46080
v_cvt_pk_bf16_f32 v253, v198, v199
v_mfma_f32_16x16x32_bf16 v[212:215], a[144:147], v[76:79], v[212:215]
ds_read_b64_tr_b16 a[168:169], v1 offset:63488
v_cvt_pk_bf16_f32 v254, v204, v205
v_cvt_pk_bf16_f32 v255, v206, v207
buffer_store_dwordx4 v[252:255], v16, s[16:19], s34 offen offset:1024 sc1
v_mfma_f32_16x16x32_bf16 v[216:219], a[148:151], v[72:75], v[216:219]
ds_read_b64_tr_b16 a[170:171], v1 offset:64512
buffer_load_dwordx4 v13, s[8:11], s31 offen offset:1024 lds
v_mfma_f32_16x16x32_bf16 v[220:223], a[148:151], v[76:79], v[220:223]
ds_read_b64_tr_b16 a[172:173], v2 offset:63488
s_waitcnt lgkmcnt(7)
v_mfma_f32_16x16x32_bf16 v[224:227], a[152:155], v[72:75], v[224:227]
ds_read_b64_tr_b16 a[174:175], v2 offset:64512
v_add_u32 v21, s40, v18
v_mfma_f32_16x16x32_bf16 v[228:231], a[152:155], v[76:79], v[228:231]
ds_read_b64_tr_b16 a[144:145], v1 offset:47104
v_add_u32 v170, s39, v17
v_mfma_f32_16x16x32_bf16 v[232:235], a[156:159], v[72:75], v[232:235]
ds_read_b64_tr_b16 a[146:147], v1 offset:48128
v_mfma_f32_16x16x32_bf16 v[236:239], a[156:159], v[76:79], v[236:239]
ds_read_b64_tr_b16 a[148:149], v2 offset:47104
s_waitcnt lgkmcnt(7)
v_mfma_f32_16x16x32_bf16 v[208:211], a[160:163], v[88:91], v[208:211]
ds_read_b64_tr_b16 a[150:151], v2 offset:48128
v_lshrrev_b32 v22, 1, v170
v_mfma_f32_16x16x32_bf16 v[212:215], a[160:163], v[92:95], v[212:215]
ds_read_b64_tr_b16 a[152:153], v3
buffer_load_dwordx4 v14, s[8:11], s31 offen offset:2048 lds
v_mfma_f32_16x16x32_bf16 v[216:219], a[164:167], v[88:91], v[216:219]
ds_read_b64_tr_b16 a[154:155], v3 offset:1024
v_add3_u32 v175, v173, v22, s38
v_mfma_f32_16x16x32_bf16 v[220:223], a[164:167], v[92:95], v[220:223]
ds_read_b64_tr_b16 a[156:157], v4
s_waitcnt lgkmcnt(7)
v_mfma_f32_16x16x32_bf16 v[224:227], a[168:171], v[88:91], v[224:227]
ds_read_b64_tr_b16 a[158:159], v4 offset:1024
v_mfma_f32_16x16x32_bf16 v[228:231], a[168:171], v[92:95], v[228:231]
ds_read_b64_tr_b16 a[160:161], v1 offset:49152
v_add_u32 v170, 147456, v170
v_mfma_f32_16x16x32_bf16 v[232:235], a[172:175], v[88:91], v[232:235]
ds_read_b64_tr_b16 a[162:163], v1 offset:50176
v_mfma_f32_16x16x32_bf16 v[236:239], a[172:175], v[92:95], v[236:239]
ds_read_b64_tr_b16 a[164:165], v2 offset:49152
s_waitcnt lgkmcnt(7)
v_mfma_f32_16x16x32_bf16 v[208:211], a[144:147], v[104:107], v[208:211]
ds_read_b64_tr_b16 a[166:167], v2 offset:50176
v_mfma_f32_16x16x32_bf16 v[212:215], a[144:147], v[108:111], v[212:215]
ds_read_b64_tr_b16 a[168:169], v3 offset:2048
s_add_u32 s39, s20, 4
s_cmp_lt_u32 s20, 2
s_cselect_b32 s36, 1.0, 0
s_cselect_b32 s38, 0, 0x7ff00000
s_mul_i32 s39, s39, 256
s_mul_i32 s40, s39, 8
s_add_u32 s40, s40, s38
v_mfma_f32_16x16x32_bf16 v[216:219], a[148:151], v[104:107], v[216:219]
buffer_load_dwordx4 v15, s[8:11], s31 offen offset:3072 lds
ds_read_b64_tr_b16 a[170:171], v3 offset:3072
v_mfma_f32_16x16x32_bf16 v[220:223], a[148:151], v[108:111], v[220:223]
ds_read_b64_tr_b16 a[172:173], v4 offset:2048
s_waitcnt lgkmcnt(7)
v_mfma_f32_16x16x32_bf16 v[224:227], a[152:155], v[104:107], v[224:227]
ds_read_b64_tr_b16 a[174:175], v4 offset:3072
v_mfma_f32_16x16x32_bf16 v[228:231], a[152:155], v[108:111], v[228:231]
ds_read_b64_tr_b16 a[144:145], v1 offset:51200
v_mfma_f32_16x16x32_bf16 v[232:235], a[156:159], v[104:107], v[232:235]
ds_read_b64_tr_b16 a[146:147], v1 offset:52224
s_add_u32 m0, s92, 118784
v_mfma_f32_16x16x32_bf16 v[236:239], a[156:159], v[108:111], v[236:239]
ds_read_b64_tr_b16 a[148:149], v2 offset:51200
s_waitcnt lgkmcnt(7)
v_mfma_f32_16x16x32_bf16 v[208:211], a[160:163], v[120:123], v[208:211]
ds_read_b64_tr_b16 a[150:151], v2 offset:52224
s_add_u32 s32, s23, 148096
v_mfma_f32_16x16x32_bf16 v[212:215], a[160:163], v[124:127], v[212:215]
buffer_load_dwordx4 v12, s[8:11], s32 offen lds
ds_read_b64_tr_b16 a[152:153], v3 offset:4096
v_mfma_f32_16x16x32_bf16 v[216:219], a[164:167], v[120:123], v[216:219]
ds_read_b64_tr_b16 a[154:155], v3 offset:5120
v_mfma_f32_16x16x32_bf16 v[220:223], a[164:167], v[124:127], v[220:223]
ds_read_b64_tr_b16 a[156:157], v4 offset:4096
s_waitcnt lgkmcnt(7)
v_mfma_f32_16x16x32_bf16 v[224:227], a[168:171], v[120:123], v[224:227]
ds_read_b64_tr_b16 a[158:159], v4 offset:5120
v_mfma_f32_16x16x32_bf16 v[228:231], a[168:171], v[124:127], v[228:231]
ds_read_b64_tr_b16 a[160:161], v1 offset:53248
v_mfma_f32_16x16x32_bf16 v[232:235], a[172:175], v[120:123], v[232:235]
ds_read_b64_tr_b16 a[162:163], v1 offset:54272
v_mfma_f32_16x16x32_bf16 v[236:239], a[172:175], v[124:127], v[236:239]
ds_read_b64_tr_b16 a[164:165], v2 offset:53248
s_waitcnt lgkmcnt(7)
v_mfma_f32_16x16x32_bf16 v[208:211], a[144:147], v[136:139], v[208:211]
ds_read_b64_tr_b16 a[166:167], v2 offset:54272
v_mfma_f32_16x16x32_bf16 v[212:215], a[144:147], v[140:143], v[212:215]
ds_read_b64_tr_b16 a[168:169], v3 offset:6144
v_add_u32 v20, s40, v18
v_mfma_f32_16x16x32_bf16 v[216:219], a[148:151], v[136:139], v[216:219]
ds_read_b64_tr_b16 a[170:171], v3 offset:7168
v_mfma_f32_16x16x32_bf16 v[220:223], a[148:151], v[140:143], v[220:223]
ds_read_b64_tr_b16 a[172:173], v4 offset:6144
s_waitcnt lgkmcnt(7)
v_mfma_f32_16x16x32_bf16 v[224:227], a[152:155], v[136:139], v[224:227]
ds_read_b64_tr_b16 a[174:175], v4 offset:7168
v_add_u32 v169, s39, v17
v_mfma_f32_16x16x32_bf16 v[228:231], a[152:155], v[140:143], v[228:231]
s_waitcnt vmcnt(13)
s_barrier
ds_read_b64_tr_b16 a[144:145], v3 offset:8192
v_mfma_f32_16x16x32_bf16 v[232:235], a[156:159], v[136:139], v[232:235]
ds_read_b64_tr_b16 a[146:147], v3 offset:9216
v_lshrrev_b32 v22, 1, v169
v_mfma_f32_16x16x32_bf16 v[236:239], a[156:159], v[140:143], v[236:239]
ds_read_b64_tr_b16 a[148:149], v4 offset:8192
s_waitcnt lgkmcnt(7)
v_mfma_f32_16x16x32_bf16 v[208:211], a[160:163], v[152:155], v[208:211]
ds_read_b64_tr_b16 a[150:151], v4 offset:9216
s_add_u32 m0, s92, 0
v_mfma_f32_16x16x32_bf16 v[212:215], a[160:163], v[156:159], v[212:215]
s_add_u32 s30, s23, 768
buffer_load_dwordx4 v12, s[8:11], s30 offen lds
ds_read_b64_tr_b16 a[152:153], v3 offset:26624
v_mfma_f32_16x16x32_bf16 v[216:219], a[164:167], v[152:155], v[216:219]
ds_read_b64_tr_b16 a[154:155], v3 offset:27648
v_add3_u32 v174, v173, v22, s38
v_mfma_f32_16x16x32_bf16 v[220:223], a[164:167], v[156:159], v[220:223]
ds_read_b64_tr_b16 a[156:157], v4 offset:26624
s_waitcnt lgkmcnt(7)
v_mfma_f32_16x16x32_bf16 v[224:227], a[168:171], v[152:155], v[224:227]
ds_read_b64_tr_b16 a[158:159], v4 offset:27648
v_add_u32 v169, 147456, v169
v_mfma_f32_16x16x32_bf16 v[228:231], a[168:171], v[156:159], v[228:231]
ds_read_b64_tr_b16 a[160:161], v3 offset:10240
buffer_load_dwordx4 v13, s[8:11], s30 offen offset:1024 lds
v_mfma_f32_16x16x32_bf16 v[232:235], a[172:175], v[152:155], v[232:235]
ds_read_b64_tr_b16 a[162:163], v3 offset:11264
v_mfma_f32_16x16x32_bf16 v[236:239], a[172:175], v[156:159], v[236:239]
ds_read_b64_tr_b16 a[164:165], v4 offset:10240
s_waitcnt lgkmcnt(7)
v_mfma_f32_16x16x32_bf16 v[176:179], a[144:147], v[24:27], 0
ds_read_b64_tr_b16 a[166:167], v4 offset:11264
s_mov_b32 s39, s20
s_cmp_eq_u32 s20, s20
s_cselect_b32 s38, 0, 0x7ff00000
s_mul_i32 s39, s39, 256
s_mul_i32 s40, s39, 8
s_add_u32 s40, s40, s38
v_mfma_f32_16x16x32_bf16 v[180:183], a[144:147], v[28:31], 0
ds_read_b64_tr_b16 a[168:169], v3 offset:28672
v_cvt_pk_bf16_f32 v240, v208, v209
v_mfma_f32_16x16x32_bf16 v[184:187], a[148:151], v[24:27], 0
ds_read_b64_tr_b16 a[170:171], v3 offset:29696
v_cvt_pk_bf16_f32 v241, v210, v211
v_mfma_f32_16x16x32_bf16 v[188:191], a[148:151], v[28:31], 0
ds_read_b64_tr_b16 a[172:173], v4 offset:28672
v_cvt_pk_bf16_f32 v242, v216, v217
v_cvt_pk_bf16_f32 v243, v218, v219
buffer_store_dwordx4 v[240:243], v7, s[16:19], s34 offen offset:2048 sc1
s_waitcnt lgkmcnt(7)
v_mfma_f32_16x16x32_bf16 v[192:195], a[152:155], v[24:27], 0
ds_read_b64_tr_b16 a[174:175], v4 offset:29696
buffer_load_dwordx4 v14, s[8:11], s30 offen offset:2048 lds
v_mfma_f32_16x16x32_bf16 v[196:199], a[152:155], v[28:31], 0
ds_read_b64_tr_b16 a[144:145], v3 offset:12288
v_cvt_pk_bf16_f32 v244, v212, v213
v_mfma_f32_16x16x32_bf16 v[200:203], a[156:159], v[24:27], 0
ds_read_b64_tr_b16 a[146:147], v3 offset:13312
v_cvt_pk_bf16_f32 v245, v214, v215
v_mfma_f32_16x16x32_bf16 v[204:207], a[156:159], v[28:31], 0
ds_read_b64_tr_b16 a[148:149], v4 offset:12288
s_waitcnt lgkmcnt(7)
v_mfma_f32_16x16x32_bf16 v[176:179], a[160:163], v[40:43], v[176:179]
ds_read_b64_tr_b16 a[150:151], v4 offset:13312
v_cvt_pk_bf16_f32 v246, v220, v221
v_mfma_f32_16x16x32_bf16 v[180:183], a[160:163], v[44:47], v[180:183]
ds_read_b64_tr_b16 a[152:153], v3 offset:30720
v_cvt_pk_bf16_f32 v247, v222, v223
buffer_store_dwordx4 v[244:247], v16, s[16:19], s34 offen offset:2048 sc1
v_mfma_f32_16x16x32_bf16 v[184:187], a[164:167], v[40:43], v[184:187]
ds_read_b64_tr_b16 a[154:155], v3 offset:31744
v_mfma_f32_16x16x32_bf16 v[188:191], a[164:167], v[44:47], v[188:191]
ds_read_b64_tr_b16 a[156:157], v4 offset:30720
s_waitcnt lgkmcnt(7)
v_mfma_f32_16x16x32_bf16 v[192:195], a[168:171], v[40:43], v[192:195]
ds_read_b64_tr_b16 a[158:159], v4 offset:31744
buffer_load_dwordx4 v15, s[8:11], s30 offen offset:3072 lds
v_mfma_f32_16x16x32_bf16 v[196:199], a[168:171], v[44:47], v[196:199]
ds_read_b64_tr_b16 a[160:161], v3 offset:14336
v_add_u32 v19, s40, v18
v_mfma_f32_16x16x32_bf16 v[200:203], a[172:175], v[40:43], v[200:203]
ds_read_b64_tr_b16 a[162:163], v3 offset:15360
v_cvt_pk_bf16_f32 v248, v224, v225
v_mfma_f32_16x16x32_bf16 v[204:207], a[172:175], v[44:47], v[204:207]
ds_read_b64_tr_b16 a[164:165], v4 offset:14336
s_waitcnt lgkmcnt(7)
v_mfma_f32_16x16x32_bf16 v[176:179], a[144:147], v[56:59], v[176:179]
ds_read_b64_tr_b16 a[166:167], v4 offset:15360
v_add_u32 v168, s39, v17
v_mfma_f32_16x16x32_bf16 v[180:183], a[144:147], v[60:63], v[180:183]
ds_read_b64_tr_b16 a[168:169], v3 offset:32768
v_cvt_pk_bf16_f32 v249, v226, v227
v_mfma_f32_16x16x32_bf16 v[184:187], a[148:151], v[56:59], v[184:187]
ds_read_b64_tr_b16 a[170:171], v3 offset:33792
v_cvt_pk_bf16_f32 v250, v232, v233
v_mfma_f32_16x16x32_bf16 v[188:191], a[148:151], v[60:63], v[188:191]
ds_read_b64_tr_b16 a[172:173], v4 offset:32768
v_cvt_pk_bf16_f32 v251, v234, v235
buffer_store_dwordx4 v[248:251], v7, s[16:19], s34 offen offset:3072 sc1
s_waitcnt lgkmcnt(7)
v_mfma_f32_16x16x32_bf16 v[192:195], a[152:155], v[56:59], v[192:195]
ds_read_b64_tr_b16 a[174:175], v4 offset:33792
v_lshrrev_b32 v22, 1, v168
v_mfma_f32_16x16x32_bf16 v[196:199], a[152:155], v[60:63], v[196:199]
s_add_u32 m0, s92, 4096
s_add_u32 s31, s23, 74496
buffer_load_dwordx4 v12, s[8:11], s31 offen lds
ds_read_b64_tr_b16 a[144:145], v3 offset:16384
v_mfma_f32_16x16x32_bf16 v[200:203], a[156:159], v[56:59], v[200:203]
ds_read_b64_tr_b16 a[146:147], v3 offset:17408
v_add3_u32 v173, v173, v22, s38
v_mfma_f32_16x16x32_bf16 v[204:207], a[156:159], v[60:63], v[204:207]
ds_read_b64_tr_b16 a[148:149], v4 offset:16384
s_waitcnt lgkmcnt(7)
v_mfma_f32_16x16x32_bf16 v[176:179], a[160:163], v[72:75], v[176:179]
ds_read_b64_tr_b16 a[150:151], v4 offset:17408
v_cvt_pk_bf16_f32 v252, v228, v229
v_mfma_f32_16x16x32_bf16 v[180:183], a[160:163], v[76:79], v[180:183]
ds_read_b64_tr_b16 a[152:153], v3 offset:34816
v_cvt_pk_bf16_f32 v253, v230, v231
v_cvt_pk_bf16_f32 v254, v236, v237
v_cvt_pk_bf16_f32 v255, v238, v239
buffer_store_dwordx4 v[252:255], v16, s[16:19], s34 offen offset:3072 sc1
v_add_u32 v168, 147456, v168
v_mfma_f32_16x16x32_bf16 v[184:187], a[164:167], v[72:75], v[184:187]
ds_read_b64_tr_b16 a[154:155], v3 offset:35840
buffer_load_dwordx4 v13, s[8:11], s31 offen offset:1024 lds
v_mfma_f32_16x16x32_bf16 v[188:191], a[164:167], v[76:79], v[188:191]
ds_read_b64_tr_b16 a[156:157], v4 offset:34816
s_waitcnt lgkmcnt(7)
v_mfma_f32_16x16x32_bf16 v[192:195], a[168:171], v[72:75], v[192:195]
ds_read_b64_tr_b16 a[158:159], v4 offset:35840
v_and_b32 v22, 15, v0
v_mfma_f32_16x16x32_bf16 v[196:199], a[168:171], v[76:79], v[196:199]
ds_read_b64_tr_b16 a[160:161], v3 offset:18432
v_mul_u32_u24 v22, 4, v22
v_mfma_f32_16x16x32_bf16 v[200:203], a[172:175], v[72:75], v[200:203]
ds_read_b64_tr_b16 a[162:163], v3 offset:19456
v_mfma_f32_16x16x32_bf16 v[204:207], a[172:175], v[76:79], v[204:207]
ds_read_b64_tr_b16 a[164:165], v4 offset:18432
s_waitcnt lgkmcnt(7)
v_mfma_f32_16x16x32_bf16 v[176:179], a[144:147], v[88:91], v[176:179]
ds_read_b64_tr_b16 a[166:167], v4 offset:19456
v_mfma_f32_16x16x32_bf16 v[180:183], a[144:147], v[92:95], v[180:183]
ds_read_b64_tr_b16 a[168:169], v3 offset:36864
s_mul_i32 s39, s21, 4
s_cmp_eq_u32 s20, 0
s_cselect_b32 s39, s39, 0x7ff00000
v_mfma_f32_16x16x32_bf16 v[184:187], a[148:151], v[88:91], v[184:187]
ds_read_b64_tr_b16 a[170:171], v3 offset:37888
buffer_load_dwordx4 v14, s[8:11], s31 offen offset:2048 lds
v_mfma_f32_16x16x32_bf16 v[188:191], a[148:151], v[92:95], v[188:191]
ds_read_b64_tr_b16 a[172:173], v4 offset:36864
s_waitcnt lgkmcnt(7)
v_mfma_f32_16x16x32_bf16 v[192:195], a[152:155], v[88:91], v[192:195]
ds_read_b64_tr_b16 a[174:175], v4 offset:37888
v_mfma_f32_16x16x32_bf16 v[196:199], a[152:155], v[92:95], v[196:199]
ds_read_b64_tr_b16 a[144:145], v3 offset:20480
v_mfma_f32_16x16x32_bf16 v[200:203], a[156:159], v[88:91], v[200:203]
ds_read_b64_tr_b16 a[146:147], v3 offset:21504
v_mov_b32 v23, 0x7ff00000
v_mfma_f32_16x16x32_bf16 v[204:207], a[156:159], v[92:95], v[204:207]
ds_read_b64_tr_b16 a[148:149], v4 offset:20480
s_waitcnt lgkmcnt(7)
v_mfma_f32_16x16x32_bf16 v[176:179], a[160:163], v[104:107], v[176:179]
ds_read_b64_tr_b16 a[150:151], v4 offset:21504
buffer_load_dwordx4 v15, s[8:11], s31 offen offset:3072 lds
v_mfma_f32_16x16x32_bf16 v[180:183], a[160:163], v[108:111], v[180:183]
ds_read_b64_tr_b16 a[152:153], v3 offset:38912
v_mov_b32 v17, s39
v_mfma_f32_16x16x32_bf16 v[184:187], a[164:167], v[104:107], v[184:187]
ds_read_b64_tr_b16 a[154:155], v3 offset:39936
v_mfma_f32_16x16x32_bf16 v[188:191], a[164:167], v[108:111], v[188:191]
ds_read_b64_tr_b16 a[156:157], v4 offset:38912
s_waitcnt lgkmcnt(7)
v_mfma_f32_16x16x32_bf16 v[192:195], a[168:171], v[104:107], v[192:195]
ds_read_b64_tr_b16 a[158:159], v4 offset:39936
v_cmp_eq_u32 vcc, 0, v0
v_mfma_f32_16x16x32_bf16 v[196:199], a[168:171], v[108:111], v[196:199]
ds_read_b64_tr_b16 a[160:161], v3 offset:22528
v_mfma_f32_16x16x32_bf16 v[200:203], a[172:175], v[104:107], v[200:203]
ds_read_b64_tr_b16 a[162:163], v3 offset:23552
v_cndmask_b32 v23, v23, v17, vcc
v_mfma_f32_16x16x32_bf16 v[204:207], a[172:175], v[108:111], v[204:207]
ds_read_b64_tr_b16 a[164:165], v4 offset:22528
s_waitcnt lgkmcnt(7)
v_mfma_f32_16x16x32_bf16 v[176:179], a[144:147], v[120:123], v[176:179]
ds_read_b64_tr_b16 a[166:167], v4 offset:23552
s_add_u32 m0, s92, 8192
v_mfma_f32_16x16x32_bf16 v[180:183], a[144:147], v[124:127], v[180:183]
s_add_u32 s32, s23, 148224
buffer_load_dwordx4 v12, s[8:11], s32 offen lds
ds_read_b64_tr_b16 a[168:169], v3 offset:40960
v_mfma_f32_16x16x32_bf16 v[184:187], a[148:151], v[120:123], v[184:187]
ds_read_b64_tr_b16 a[170:171], v3 offset:41984
v_mov_b32 v172, 1
v_mfma_f32_16x16x32_bf16 v[188:191], a[148:151], v[124:127], v[188:191]
ds_read_b64_tr_b16 a[172:173], v4 offset:40960
s_waitcnt lgkmcnt(7)
v_mfma_f32_16x16x32_bf16 v[192:195], a[152:155], v[120:123], v[192:195]
ds_read_b64_tr_b16 a[174:175], v4 offset:41984
s_mov_b32 s38, 524288
v_mfma_f32_16x16x32_bf16 v[196:199], a[152:155], v[124:127], v[196:199]
ds_read_b64_tr_b16 a[144:145], v3 offset:24576
v_mfma_f32_16x16x32_bf16 v[200:203], a[156:159], v[120:123], v[200:203]
ds_read_b64_tr_b16 a[146:147], v3 offset:25600
s_add_u32 s39, s24, 4784128
v_mfma_f32_16x16x32_bf16 v[204:207], a[156:159], v[124:127], v[204:207]
ds_read_b64_tr_b16 a[148:149], v4 offset:24576
s_waitcnt lgkmcnt(7)
v_mfma_f32_16x16x32_bf16 v[176:179], a[160:163], v[136:139], v[176:179]
ds_read_b64_tr_b16 a[150:151], v4 offset:25600
buffer_load_dwordx4 v[160:163], v19, s[16:19], s39 offen
v_mfma_f32_16x16x32_bf16 v[180:183], a[160:163], v[140:143], v[180:183]
ds_read_b64_tr_b16 a[152:153], v3 offset:43008
v_mfma_f32_16x16x32_bf16 v[184:187], a[164:167], v[136:139], v[184:187]
ds_read_b64_tr_b16 a[154:155], v3 offset:44032
v_mfma_f32_16x16x32_bf16 v[188:191], a[164:167], v[140:143], v[188:191]
ds_read_b64_tr_b16 a[156:157], v4 offset:43008
s_waitcnt lgkmcnt(7)
v_mfma_f32_16x16x32_bf16 v[192:195], a[168:171], v[136:139], v[192:195]
ds_read_b64_tr_b16 a[158:159], v4 offset:44032
buffer_load_dwordx4 v[164:167], v20, s[16:19], s39 offen
v_mfma_f32_16x16x32_bf16 v[196:199], a[168:171], v[140:143], v[196:199]
s_waitcnt vmcnt(15)
s_barrier
ds_read_b64_tr_b16 a[160:161], v3 offset:45056
v_mfma_f32_16x16x32_bf16 v[200:203], a[172:175], v[136:139], v[200:203]
ds_read_b64_tr_b16 a[162:163], v3 offset:46080
buffer_load_dwordx4 v[8:11], v21, s[16:19], s39 offen
v_mfma_f32_16x16x32_bf16 v[204:207], a[172:175], v[140:143], v[204:207]
ds_read_b64_tr_b16 a[164:165], v4 offset:45056
s_waitcnt lgkmcnt(7)
v_mfma_f32_16x16x32_bf16 v[176:179], a[144:147], v[152:155], v[176:179]
ds_read_b64_tr_b16 a[166:167], v4 offset:46080
s_add_u32 m0, s92, 36864
v_mfma_f32_16x16x32_bf16 v[180:183], a[144:147], v[156:159], v[180:183]
s_add_u32 s30, s23, 896
buffer_load_dwordx4 v12, s[8:11], s30 offen lds
ds_read_b64_tr_b16 a[168:169], v3 offset:63488
v_mfma_f32_16x16x32_bf16 v[184:187], a[148:151], v[152:155], v[184:187]
ds_read_b64_tr_b16 a[170:171], v3 offset:64512
s_lshl_b32 s93, s22, 4
v_mfma_f32_16x16x32_bf16 v[188:191], a[148:151], v[156:159], v[188:191]
ds_read_b64_tr_b16 a[172:173], v4 offset:63488
s_waitcnt lgkmcnt(7)
v_mfma_f32_16x16x32_bf16 v[192:195], a[152:155], v[152:155], v[192:195]
ds_read_b64_tr_b16 a[174:175], v4 offset:64512
s_add_u32 s93, s93, s21
v_mfma_f32_16x16x32_bf16 v[196:199], a[152:155], v[156:159], v[196:199]
ds_read_b64_tr_b16 a[144:145], v3 offset:47104
s_mul_i32 s93, s93, 9216
v_mfma_f32_16x16x32_bf16 v[200:203], a[156:159], v[152:155], v[200:203]
ds_read_b64_tr_b16 a[146:147], v3 offset:48128
buffer_load_dwordx4 v13, s[8:11], s30 offen offset:1024 lds
v_mfma_f32_16x16x32_bf16 v[204:207], a[156:159], v[156:159], v[204:207]
ds_read_b64_tr_b16 a[148:149], v4 offset:47104
s_waitcnt lgkmcnt(7)
v_mfma_f32_16x16x32_bf16 v[208:211], a[160:163], v[24:27], 0
ds_read_b64_tr_b16 a[150:151], v4 offset:48128
s_add_u32 s34, s28, 8192
v_mfma_f32_16x16x32_bf16 v[212:215], a[160:163], v[28:31], 0
ds_read_b64_tr_b16 a[152:153], v5
v_cvt_pk_bf16_f32 v240, v176, v177
v_mfma_f32_16x16x32_bf16 v[216:219], a[164:167], v[24:27], 0
ds_read_b64_tr_b16 a[154:155], v5 offset:1024
v_cvt_pk_bf16_f32 v241, v178, v179
v_mfma_f32_16x16x32_bf16 v[220:223], a[164:167], v[28:31], 0
ds_read_b64_tr_b16 a[156:157], v6
v_cvt_pk_bf16_f32 v242, v184, v185
v_cvt_pk_bf16_f32 v243, v186, v187
buffer_store_dwordx4 v[240:243], v7, s[16:19], s34 offen sc1
s_waitcnt lgkmcnt(7)
v_mfma_f32_16x16x32_bf16 v[224:227], a[168:171], v[24:27], 0
ds_read_b64_tr_b16 a[158:159], v6 offset:1024
buffer_load_dwordx4 v14, s[8:11], s30 offen offset:2048 lds
v_mfma_f32_16x16x32_bf16 v[228:231], a[168:171], v[28:31], 0
ds_read_b64_tr_b16 a[160:161], v3 offset:49152
v_cvt_pk_bf16_f32 v244, v180, v181
v_mfma_f32_16x16x32_bf16 v[232:235], a[172:175], v[24:27], 0
ds_read_b64_tr_b16 a[162:163], v3 offset:50176
v_cvt_pk_bf16_f32 v245, v182, v183
v_mfma_f32_16x16x32_bf16 v[236:239], a[172:175], v[28:31], 0
ds_read_b64_tr_b16 a[164:165], v4 offset:49152
s_waitcnt lgkmcnt(7)
v_mfma_f32_16x16x32_bf16 v[208:211], a[144:147], v[40:43], v[208:211]
ds_read_b64_tr_b16 a[166:167], v4 offset:50176
v_cvt_pk_bf16_f32 v246, v188, v189
v_mfma_f32_16x16x32_bf16 v[212:215], a[144:147], v[44:47], v[212:215]
ds_read_b64_tr_b16 a[168:169], v5 offset:2048
v_cvt_pk_bf16_f32 v247, v190, v191
buffer_store_dwordx4 v[244:247], v16, s[16:19], s34 offen sc1
v_mfma_f32_16x16x32_bf16 v[216:219], a[148:151], v[40:43], v[216:219]
ds_read_b64_tr_b16 a[170:171], v5 offset:3072
v_mfma_f32_16x16x32_bf16 v[220:223], a[148:151], v[44:47], v[220:223]
ds_read_b64_tr_b16 a[172:173], v6 offset:2048
s_waitcnt lgkmcnt(7)
v_mfma_f32_16x16x32_bf16 v[224:227], a[152:155], v[40:43], v[224:227]
ds_read_b64_tr_b16 a[174:175], v6 offset:3072
buffer_load_dwordx4 v15, s[8:11], s30 offen offset:3072 lds
v_mfma_f32_16x16x32_bf16 v[228:231], a[152:155], v[44:47], v[228:231]
ds_read_b64_tr_b16 a[144:145], v3 offset:51200
v_cvt_pk_bf16_f32 v248, v192, v193
v_mfma_f32_16x16x32_bf16 v[232:235], a[156:159], v[40:43], v[232:235]
ds_read_b64_tr_b16 a[146:147], v3 offset:52224
v_cvt_pk_bf16_f32 v249, v194, v195
v_mfma_f32_16x16x32_bf16 v[236:239], a[156:159], v[44:47], v[236:239]
ds_read_b64_tr_b16 a[148:149], v4 offset:51200
s_waitcnt lgkmcnt(7)
v_mfma_f32_16x16x32_bf16 v[208:211], a[160:163], v[56:59], v[208:211]
ds_read_b64_tr_b16 a[150:151], v4 offset:52224
v_cvt_pk_bf16_f32 v250, v200, v201
v_mfma_f32_16x16x32_bf16 v[212:215], a[160:163], v[60:63], v[212:215]
ds_read_b64_tr_b16 a[152:153], v5 offset:4096
v_cvt_pk_bf16_f32 v251, v202, v203
v_mfma_f32_16x16x32_bf16 v[216:219], a[164:167], v[56:59], v[216:219]
ds_read_b64_tr_b16 a[154:155], v5 offset:5120
buffer_store_dwordx4 v[248:251], v7, s[16:19], s34 offen offset:1024 sc1
v_mfma_f32_16x16x32_bf16 v[220:223], a[164:167], v[60:63], v[220:223]
ds_read_b64_tr_b16 a[156:157], v6 offset:4096
s_waitcnt lgkmcnt(7)
v_mfma_f32_16x16x32_bf16 v[224:227], a[168:171], v[56:59], v[224:227]
ds_read_b64_tr_b16 a[158:159], v6 offset:5120
s_add_u32 m0, s92, 40960
v_mfma_f32_16x16x32_bf16 v[228:231], a[168:171], v[60:63], v[228:231]
s_add_u32 s31, s23, 74624
buffer_load_dwordx4 v12, s[8:11], s31 offen lds
ds_read_b64_tr_b16 a[160:161], v3 offset:53248
v_mfma_f32_16x16x32_bf16 v[232:235], a[172:175], v[56:59], v[232:235]
ds_read_b64_tr_b16 a[162:163], v3 offset:54272
v_cvt_pk_bf16_f32 v252, v196, v197
v_mfma_f32_16x16x32_bf16 v[236:239], a[172:175], v[60:63], v[236:239]
ds_read_b64_tr_b16 a[164:165], v4 offset:53248
s_waitcnt lgkmcnt(7)
v_mfma_f32_16x16x32_bf16 v[208:211], a[144:147], v[72:75], v[208:211]
ds_read_b64_tr_b16 a[166:167], v4 offset:54272
v_cvt_pk_bf16_f32 v253, v198, v199
v_mfma_f32_16x16x32_bf16 v[212:215], a[144:147], v[76:79], v[212:215]
ds_read_b64_tr_b16 a[168:169], v5 offset:6144
v_cvt_pk_bf16_f32 v254, v204, v205
v_cvt_pk_bf16_f32 v255, v206, v207
buffer_store_dwordx4 v[252:255], v16, s[16:19], s34 offen offset:1024 sc1
v_mfma_f32_16x16x32_bf16 v[216:219], a[148:151], v[72:75], v[216:219]
ds_read_b64_tr_b16 a[170:171], v5 offset:7168
buffer_load_dwordx4 v13, s[8:11], s31 offen offset:1024 lds
v_mfma_f32_16x16x32_bf16 v[220:223], a[148:151], v[76:79], v[220:223]
ds_read_b64_tr_b16 a[172:173], v6 offset:6144
s_waitcnt lgkmcnt(7)
v_mfma_f32_16x16x32_bf16 v[224:227], a[152:155], v[72:75], v[224:227]
ds_read_b64_tr_b16 a[174:175], v6 offset:7168
v_mfma_f32_16x16x32_bf16 v[228:231], a[152:155], v[76:79], v[228:231]
ds_read_b64_tr_b16 a[144:145], v3 offset:55296
v_mfma_f32_16x16x32_bf16 v[232:235], a[156:159], v[72:75], v[232:235]
ds_read_b64_tr_b16 a[146:147], v3 offset:56320
v_mfma_f32_16x16x32_bf16 v[236:239], a[156:159], v[76:79], v[236:239]
ds_read_b64_tr_b16 a[148:149], v4 offset:55296
s_waitcnt lgkmcnt(7)
v_mfma_f32_16x16x32_bf16 v[208:211], a[160:163], v[88:91], v[208:211]
ds_read_b64_tr_b16 a[150:151], v4 offset:56320
buffer_load_dwordx4 v14, s[8:11], s31 offen offset:2048 lds
v_mfma_f32_16x16x32_bf16 v[212:215], a[160:163], v[92:95], v[212:215]
ds_read_b64_tr_b16 a[152:153], v5 offset:8192
v_mfma_f32_16x16x32_bf16 v[216:219], a[164:167], v[88:91], v[216:219]
ds_read_b64_tr_b16 a[154:155], v5 offset:9216
v_mfma_f32_16x16x32_bf16 v[220:223], a[164:167], v[92:95], v[220:223]
ds_read_b64_tr_b16 a[156:157], v6 offset:8192
s_waitcnt lgkmcnt(7)
v_mfma_f32_16x16x32_bf16 v[224:227], a[168:171], v[88:91], v[224:227]
ds_read_b64_tr_b16 a[158:159], v6 offset:9216
v_mfma_f32_16x16x32_bf16 v[228:231], a[168:171], v[92:95], v[228:231]
ds_read_b64_tr_b16 a[160:161], v3 offset:57344
v_mfma_f32_16x16x32_bf16 v[232:235], a[172:175], v[88:91], v[232:235]
ds_read_b64_tr_b16 a[162:163], v3 offset:58368
v_mfma_f32_16x16x32_bf16 v[236:239], a[172:175], v[92:95], v[236:239]
ds_read_b64_tr_b16 a[164:165], v4 offset:57344
s_waitcnt lgkmcnt(7)
v_mfma_f32_16x16x32_bf16 v[208:211], a[144:147], v[104:107], v[208:211]
ds_read_b64_tr_b16 a[166:167], v4 offset:58368
buffer_load_dwordx4 v15, s[8:11], s31 offen offset:3072 lds
v_mfma_f32_16x16x32_bf16 v[212:215], a[144:147], v[108:111], v[212:215]
ds_read_b64_tr_b16 a[168:169], v5 offset:10240
v_mfma_f32_16x16x32_bf16 v[216:219], a[148:151], v[104:107], v[216:219]
ds_read_b64_tr_b16 a[170:171], v5 offset:11264
v_mfma_f32_16x16x32_bf16 v[220:223], a[148:151], v[108:111], v[220:223]
ds_read_b64_tr_b16 a[172:173], v6 offset:10240
s_waitcnt lgkmcnt(7)
v_mfma_f32_16x16x32_bf16 v[224:227], a[152:155], v[104:107], v[224:227]
ds_read_b64_tr_b16 a[174:175], v6 offset:11264
v_mfma_f32_16x16x32_bf16 v[228:231], a[152:155], v[108:111], v[228:231]
ds_read_b64_tr_b16 a[144:145], v3 offset:59392
v_mfma_f32_16x16x32_bf16 v[232:235], a[156:159], v[104:107], v[232:235]
ds_read_b64_tr_b16 a[146:147], v3 offset:60416
s_add_u32 m0, s92, 45056
v_mfma_f32_16x16x32_bf16 v[236:239], a[156:159], v[108:111], v[236:239]
ds_read_b64_tr_b16 a[148:149], v4 offset:59392
s_waitcnt lgkmcnt(7)
v_mfma_f32_16x16x32_bf16 v[208:211], a[160:163], v[120:123], v[208:211]
ds_read_b64_tr_b16 a[150:151], v4 offset:60416
s_add_u32 s32, s23, 148352
v_mfma_f32_16x16x32_bf16 v[212:215], a[160:163], v[124:127], v[212:215]
buffer_load_dwordx4 v12, s[8:11], s32 offen lds
ds_read_b64_tr_b16 a[152:153], v5 offset:12288
v_mfma_f32_16x16x32_bf16 v[216:219], a[164:167], v[120:123], v[216:219]
ds_read_b64_tr_b16 a[154:155], v5 offset:13312
v_mfma_f32_16x16x32_bf16 v[220:223], a[164:167], v[124:127], v[220:223]
ds_read_b64_tr_b16 a[156:157], v6 offset:12288
s_waitcnt lgkmcnt(7)
v_mfma_f32_16x16x32_bf16 v[224:227], a[168:171], v[120:123], v[224:227]
ds_read_b64_tr_b16 a[158:159], v6 offset:13312
v_mfma_f32_16x16x32_bf16 v[228:231], a[168:171], v[124:127], v[228:231]
ds_read_b64_tr_b16 a[160:161], v3 offset:61440
v_mfma_f32_16x16x32_bf16 v[232:235], a[172:175], v[120:123], v[232:235]
ds_read_b64_tr_b16 a[162:163], v3 offset:62464
v_mfma_f32_16x16x32_bf16 v[236:239], a[172:175], v[124:127], v[236:239]
ds_read_b64_tr_b16 a[164:165], v4 offset:61440
s_waitcnt lgkmcnt(7)
v_mfma_f32_16x16x32_bf16 v[208:211], a[144:147], v[136:139], v[208:211]
ds_read_b64_tr_b16 a[166:167], v4 offset:62464
v_mfma_f32_16x16x32_bf16 v[212:215], a[144:147], v[140:143], v[212:215]
ds_read_b64_tr_b16 a[168:169], v5 offset:14336
v_mfma_f32_16x16x32_bf16 v[216:219], a[148:151], v[136:139], v[216:219]
ds_read_b64_tr_b16 a[170:171], v5 offset:15360
v_mfma_f32_16x16x32_bf16 v[220:223], a[148:151], v[140:143], v[220:223]
ds_read_b64_tr_b16 a[172:173], v6 offset:14336
s_waitcnt lgkmcnt(7)
v_mfma_f32_16x16x32_bf16 v[224:227], a[152:155], v[136:139], v[224:227]
ds_read_b64_tr_b16 a[174:175], v6 offset:15360
v_mfma_f32_16x16x32_bf16 v[228:231], a[152:155], v[140:143], v[228:231]
s_waitcnt vmcnt(16)
s_barrier
s_add_u32 s41, s25, 0
buffer_store_dword v172, v23, s[16:19], s41 offen sc1
ds_read_b64_tr_b16 a[144:145], v1
v_mfma_f32_16x16x32_bf16 v[232:235], a[156:159], v[136:139], v[232:235]
ds_read_b64_tr_b16 a[146:147], v1 offset:1024
s_add_u32 m0, s92, 73728
v_mfma_f32_16x16x32_bf16 v[236:239], a[156:159], v[140:143], v[236:239]
ds_read_b64_tr_b16 a[148:149], v2
s_waitcnt lgkmcnt(7)
v_mfma_f32_16x16x32_bf16 v[208:211], a[160:163], v[152:155], v[208:211]
ds_read_b64_tr_b16 a[150:151], v2 offset:1024
s_add_u32 s30, s23, 1024
v_mfma_f32_16x16x32_bf16 v[212:215], a[160:163], v[156:159], v[212:215]
buffer_load_dwordx4 v12, s[8:11], s30 offen lds
ds_read_b64_tr_b16 a[152:153], v1 offset:18432
v_mfma_f32_16x16x32_bf16 v[216:219], a[164:167], v[152:155], v[216:219]
ds_read_b64_tr_b16 a[154:155], v1 offset:19456
v_mfma_f32_16x16x32_bf16 v[220:223], a[164:167], v[156:159], v[220:223]
ds_read_b64_tr_b16 a[156:157], v2 offset:18432
s_waitcnt lgkmcnt(7)
v_mfma_f32_16x16x32_bf16 v[224:227], a[168:171], v[152:155], v[224:227]
ds_read_b64_tr_b16 a[158:159], v2 offset:19456
v_mfma_f32_16x16x32_bf16 v[228:231], a[168:171], v[156:159], v[228:231]
ds_read_b64_tr_b16 a[160:161], v1 offset:2048
buffer_load_dwordx4 v13, s[8:11], s30 offen offset:1024 lds
v_mfma_f32_16x16x32_bf16 v[232:235], a[172:175], v[152:155], v[232:235]
ds_read_b64_tr_b16 a[162:163], v1 offset:3072
v_cvt_pk_bf16_f32 v240, v208, v209
v_mfma_f32_16x16x32_bf16 v[236:239], a[172:175], v[156:159], v[236:239]
ds_read_b64_tr_b16 a[164:165], v2 offset:2048
s_waitcnt lgkmcnt(7)
v_mfma_f32_16x16x32_bf16 v[176:179], a[144:147], v[24:27], 0
ds_read_b64_tr_b16 a[166:167], v2 offset:3072
v_cvt_pk_bf16_f32 v241, v210, v211
v_mfma_f32_16x16x32_bf16 v[180:183], a[144:147], v[28:31], 0
ds_read_b64_tr_b16 a[168:169], v1 offset:20480
v_cvt_pk_bf16_f32 v242, v216, v217
v_mfma_f32_16x16x32_bf16 v[184:187], a[148:151], v[24:27], 0
ds_read_b64_tr_b16 a[170:171], v1 offset:21504
v_cvt_pk_bf16_f32 v243, v218, v219
v_mfma_f32_16x16x32_bf16 v[188:191], a[148:151], v[28:31], 0
ds_read_b64_tr_b16 a[172:173], v2 offset:20480
buffer_store_dwordx4 v[240:243], v7, s[16:19], s34 offen offset:2048 sc1
s_waitcnt lgkmcnt(7)
v_mfma_f32_16x16x32_bf16 v[192:195], a[152:155], v[24:27], 0
ds_read_b64_tr_b16 a[174:175], v2 offset:21504
buffer_load_dwordx4 v14, s[8:11], s30 offen offset:2048 lds
v_mfma_f32_16x16x32_bf16 v[196:199], a[152:155], v[28:31], 0
ds_read_b64_tr_b16 a[144:145], v1 offset:4096
v_cvt_pk_bf16_f32 v244, v212, v213
v_mfma_f32_16x16x32_bf16 v[200:203], a[156:159], v[24:27], 0
ds_read_b64_tr_b16 a[146:147], v1 offset:5120
v_cvt_pk_bf16_f32 v245, v214, v215
v_mfma_f32_16x16x32_bf16 v[204:207], a[156:159], v[28:31], 0
ds_read_b64_tr_b16 a[148:149], v2 offset:4096
s_waitcnt lgkmcnt(7)
v_mfma_f32_16x16x32_bf16 v[176:179], a[160:163], v[40:43], v[176:179]
ds_read_b64_tr_b16 a[150:151], v2 offset:5120
v_cvt_pk_bf16_f32 v246, v220, v221
v_mfma_f32_16x16x32_bf16 v[180:183], a[160:163], v[44:47], v[180:183]
ds_read_b64_tr_b16 a[152:153], v1 offset:22528
v_cvt_pk_bf16_f32 v247, v222, v223
buffer_store_dwordx4 v[244:247], v16, s[16:19], s34 offen offset:2048 sc1
v_mfma_f32_16x16x32_bf16 v[184:187], a[164:167], v[40:43], v[184:187]
ds_read_b64_tr_b16 a[154:155], v1 offset:23552
v_mfma_f32_16x16x32_bf16 v[188:191], a[164:167], v[44:47], v[188:191]
ds_read_b64_tr_b16 a[156:157], v2 offset:22528
s_waitcnt lgkmcnt(7)
v_mfma_f32_16x16x32_bf16 v[192:195], a[168:171], v[40:43], v[192:195]
ds_read_b64_tr_b16 a[158:159], v2 offset:23552
buffer_load_dwordx4 v15, s[8:11], s30 offen offset:3072 lds
v_mfma_f32_16x16x32_bf16 v[196:199], a[168:171], v[44:47], v[196:199]
ds_read_b64_tr_b16 a[160:161], v1 offset:6144
v_cvt_pk_bf16_f32 v248, v224, v225
v_mfma_f32_16x16x32_bf16 v[200:203], a[172:175], v[40:43], v[200:203]
ds_read_b64_tr_b16 a[162:163], v1 offset:7168
v_cvt_pk_bf16_f32 v249, v226, v227
v_mfma_f32_16x16x32_bf16 v[204:207], a[172:175], v[44:47], v[204:207]
ds_read_b64_tr_b16 a[164:165], v2 offset:6144
s_waitcnt lgkmcnt(7)
v_mfma_f32_16x16x32_bf16 v[176:179], a[144:147], v[56:59], v[176:179]
ds_read_b64_tr_b16 a[166:167], v2 offset:7168
v_cvt_pk_bf16_f32 v250, v232, v233
v_mfma_f32_16x16x32_bf16 v[180:183], a[144:147], v[60:63], v[180:183]
ds_read_b64_tr_b16 a[168:169], v1 offset:24576
v_cvt_pk_bf16_f32 v251, v234, v235
v_mfma_f32_16x16x32_bf16 v[184:187], a[148:151], v[56:59], v[184:187]
ds_read_b64_tr_b16 a[170:171], v1 offset:25600
buffer_store_dwordx4 v[248:251], v7, s[16:19], s34 offen offset:3072 sc1
v_mfma_f32_16x16x32_bf16 v[188:191], a[148:151], v[60:63], v[188:191]
ds_read_b64_tr_b16 a[172:173], v2 offset:24576
s_waitcnt lgkmcnt(7)
v_mfma_f32_16x16x32_bf16 v[192:195], a[152:155], v[56:59], v[192:195]
ds_read_b64_tr_b16 a[174:175], v2 offset:25600
s_add_u32 m0, s92, 77824
v_mfma_f32_16x16x32_bf16 v[196:199], a[152:155], v[60:63], v[196:199]
s_add_u32 s31, s23, 74752
buffer_load_dwordx4 v12, s[8:11], s31 offen lds
ds_read_b64_tr_b16 a[144:145], v1 offset:8192
v_mfma_f32_16x16x32_bf16 v[200:203], a[156:159], v[56:59], v[200:203]
ds_read_b64_tr_b16 a[146:147], v1 offset:9216
v_cvt_pk_bf16_f32 v252, v228, v229
v_mfma_f32_16x16x32_bf16 v[204:207], a[156:159], v[60:63], v[204:207]
ds_read_b64_tr_b16 a[148:149], v2 offset:8192
s_waitcnt lgkmcnt(7)
v_mfma_f32_16x16x32_bf16 v[176:179], a[160:163], v[72:75], v[176:179]
ds_read_b64_tr_b16 a[150:151], v2 offset:9216
v_cvt_pk_bf16_f32 v253, v230, v231
v_mfma_f32_16x16x32_bf16 v[180:183], a[160:163], v[76:79], v[180:183]
ds_read_b64_tr_b16 a[152:153], v1 offset:26624
v_cvt_pk_bf16_f32 v254, v236, v237
v_cvt_pk_bf16_f32 v255, v238, v239
buffer_store_dwordx4 v[252:255], v16, s[16:19], s34 offen offset:3072 sc1
v_mfma_f32_16x16x32_bf16 v[184:187], a[164:167], v[72:75], v[184:187]
ds_read_b64_tr_b16 a[154:155], v1 offset:27648
buffer_load_dwordx4 v13, s[8:11], s31 offen offset:1024 lds
v_mfma_f32_16x16x32_bf16 v[188:191], a[164:167], v[76:79], v[188:191]
ds_read_b64_tr_b16 a[156:157], v2 offset:26624
s_waitcnt lgkmcnt(7)
v_mfma_f32_16x16x32_bf16 v[192:195], a[168:171], v[72:75], v[192:195]
ds_read_b64_tr_b16 a[158:159], v2 offset:27648
v_mfma_f32_16x16x32_bf16 v[196:199], a[168:171], v[76:79], v[196:199]
ds_read_b64_tr_b16 a[160:161], v1 offset:10240
v_mfma_f32_16x16x32_bf16 v[200:203], a[172:175], v[72:75], v[200:203]
ds_read_b64_tr_b16 a[162:163], v1 offset:11264
v_mfma_f32_16x16x32_bf16 v[204:207], a[172:175], v[76:79], v[204:207]
ds_read_b64_tr_b16 a[164:165], v2 offset:10240
s_waitcnt lgkmcnt(7)
v_mfma_f32_16x16x32_bf16 v[176:179], a[144:147], v[88:91], v[176:179]
ds_read_b64_tr_b16 a[166:167], v2 offset:11264
buffer_load_dwordx4 v14, s[8:11], s31 offen offset:2048 lds
v_mfma_f32_16x16x32_bf16 v[180:183], a[144:147], v[92:95], v[180:183]
ds_read_b64_tr_b16 a[168:169], v1 offset:28672
v_mfma_f32_16x16x32_bf16 v[184:187], a[148:151], v[88:91], v[184:187]
ds_read_b64_tr_b16 a[170:171], v1 offset:29696
v_mfma_f32_16x16x32_bf16 v[188:191], a[148:151], v[92:95], v[188:191]
ds_read_b64_tr_b16 a[172:173], v2 offset:28672
s_waitcnt lgkmcnt(7)
v_mfma_f32_16x16x32_bf16 v[192:195], a[152:155], v[88:91], v[192:195]
ds_read_b64_tr_b16 a[174:175], v2 offset:29696
v_mfma_f32_16x16x32_bf16 v[196:199], a[152:155], v[92:95], v[196:199]
ds_read_b64_tr_b16 a[144:145], v1 offset:12288
v_mfma_f32_16x16x32_bf16 v[200:203], a[156:159], v[88:91], v[200:203]
ds_read_b64_tr_b16 a[146:147], v1 offset:13312
v_mfma_f32_16x16x32_bf16 v[204:207], a[156:159], v[92:95], v[204:207]
ds_read_b64_tr_b16 a[148:149], v2 offset:12288
s_waitcnt lgkmcnt(7)
v_mfma_f32_16x16x32_bf16 v[176:179], a[160:163], v[104:107], v[176:179]
ds_read_b64_tr_b16 a[150:151], v2 offset:13312
buffer_load_dwordx4 v15, s[8:11], s31 offen offset:3072 lds
v_mfma_f32_16x16x32_bf16 v[180:183], a[160:163], v[108:111], v[180:183]
ds_read_b64_tr_b16 a[152:153], v1 offset:30720
v_mfma_f32_16x16x32_bf16 v[184:187], a[164:167], v[104:107], v[184:187]
ds_read_b64_tr_b16 a[154:155], v1 offset:31744
v_mfma_f32_16x16x32_bf16 v[188:191], a[164:167], v[108:111], v[188:191]
ds_read_b64_tr_b16 a[156:157], v2 offset:30720
s_waitcnt lgkmcnt(7)
v_mfma_f32_16x16x32_bf16 v[192:195], a[168:171], v[104:107], v[192:195]
ds_read_b64_tr_b16 a[158:159], v2 offset:31744
v_mfma_f32_16x16x32_bf16 v[196:199], a[168:171], v[108:111], v[196:199]
ds_read_b64_tr_b16 a[160:161], v1 offset:14336
v_mfma_f32_16x16x32_bf16 v[200:203], a[172:175], v[104:107], v[200:203]
ds_read_b64_tr_b16 a[162:163], v1 offset:15360
s_add_u32 m0, s92, 81920
v_mfma_f32_16x16x32_bf16 v[204:207], a[172:175], v[108:111], v[204:207]
ds_read_b64_tr_b16 a[164:165], v2 offset:14336
s_waitcnt lgkmcnt(7)
v_mfma_f32_16x16x32_bf16 v[176:179], a[144:147], v[120:123], v[176:179]
ds_read_b64_tr_b16 a[166:167], v2 offset:15360
s_add_u32 s32, s23, 148480
v_mfma_f32_16x16x32_bf16 v[180:183], a[144:147], v[124:127], v[180:183]
buffer_load_dwordx4 v12, s[8:11], s32 offen lds
ds_read_b64_tr_b16 a[168:169], v1 offset:32768
v_mfma_f32_16x16x32_bf16 v[184:187], a[148:151], v[120:123], v[184:187]
ds_read_b64_tr_b16 a[170:171], v1 offset:33792
v_mfma_f32_16x16x32_bf16 v[188:191], a[148:151], v[124:127], v[188:191]
ds_read_b64_tr_b16 a[172:173], v2 offset:32768
s_waitcnt lgkmcnt(7)
v_mfma_f32_16x16x32_bf16 v[192:195], a[152:155], v[120:123], v[192:195]
ds_read_b64_tr_b16 a[174:175], v2 offset:33792
v_mfma_f32_16x16x32_bf16 v[196:199], a[152:155], v[124:127], v[196:199]
ds_read_b64_tr_b16 a[144:145], v1 offset:16384
v_mfma_f32_16x16x32_bf16 v[200:203], a[156:159], v[120:123], v[200:203]
ds_read_b64_tr_b16 a[146:147], v1 offset:17408
v_mfma_f32_16x16x32_bf16 v[204:207], a[156:159], v[124:127], v[204:207]
ds_read_b64_tr_b16 a[148:149], v2 offset:16384
s_waitcnt lgkmcnt(7)
v_mfma_f32_16x16x32_bf16 v[176:179], a[160:163], v[136:139], v[176:179]
ds_read_b64_tr_b16 a[150:151], v2 offset:17408
v_mfma_f32_16x16x32_bf16 v[180:183], a[160:163], v[140:143], v[180:183]
ds_read_b64_tr_b16 a[152:153], v1 offset:34816
v_mfma_f32_16x16x32_bf16 v[184:187], a[164:167], v[136:139], v[184:187]
ds_read_b64_tr_b16 a[154:155], v1 offset:35840
v_mfma_f32_16x16x32_bf16 v[188:191], a[164:167], v[140:143], v[188:191]
ds_read_b64_tr_b16 a[156:157], v2 offset:34816
s_waitcnt lgkmcnt(7)
v_mfma_f32_16x16x32_bf16 v[192:195], a[168:171], v[136:139], v[192:195]
ds_read_b64_tr_b16 a[158:159], v2 offset:35840
s_add_u32 s34, s28, 12288
v_mfma_f32_16x16x32_bf16 v[196:199], a[168:171], v[140:143], v[196:199]
s_waitcnt vmcnt(14)
s_barrier
ds_read_b64_tr_b16 a[160:161], v1 offset:36864
v_mfma_f32_16x16x32_bf16 v[200:203], a[172:175], v[136:139], v[200:203]
ds_read_b64_tr_b16 a[162:163], v1 offset:37888
v_mfma_f32_16x16x32_bf16 v[204:207], a[172:175], v[140:143], v[204:207]
ds_read_b64_tr_b16 a[164:165], v2 offset:36864
s_waitcnt lgkmcnt(7)
v_mfma_f32_16x16x32_bf16 v[176:179], a[144:147], v[152:155], v[176:179]
ds_read_b64_tr_b16 a[166:167], v2 offset:37888
v_mfma_f32_16x16x32_bf16 v[180:183], a[144:147], v[156:159], v[180:183]
ds_read_b64_tr_b16 a[168:169], v1 offset:55296
v_mfma_f32_16x16x32_bf16 v[184:187], a[148:151], v[152:155], v[184:187]
ds_read_b64_tr_b16 a[170:171], v1 offset:56320
v_mfma_f32_16x16x32_bf16 v[188:191], a[148:151], v[156:159], v[188:191]
ds_read_b64_tr_b16 a[172:173], v2 offset:55296
s_waitcnt lgkmcnt(7)
v_mfma_f32_16x16x32_bf16 v[192:195], a[152:155], v[152:155], v[192:195]
ds_read_b64_tr_b16 a[174:175], v2 offset:56320
v_mfma_f32_16x16x32_bf16 v[196:199], a[152:155], v[156:159], v[196:199]
ds_read_b64_tr_b16 a[144:145], v1 offset:38912
v_cvt_pk_bf16_f32 v240, v176, v177
v_mfma_f32_16x16x32_bf16 v[200:203], a[156:159], v[152:155], v[200:203]
ds_read_b64_tr_b16 a[146:147], v1 offset:39936
v_cvt_pk_bf16_f32 v241, v178, v179
v_mfma_f32_16x16x32_bf16 v[204:207], a[156:159], v[156:159], v[204:207]
ds_read_b64_tr_b16 a[148:149], v2 offset:38912
s_waitcnt lgkmcnt(7)
v_mfma_f32_16x16x32_bf16 v[208:211], a[160:163], v[24:27], 0
ds_read_b64_tr_b16 a[150:151], v2 offset:39936
buffer_load_dword v171, v22, s[16:19], s25 offen sc1
v_mfma_f32_16x16x32_bf16 v[212:215], a[160:163], v[28:31], 0
ds_read_b64_tr_b16 a[152:153], v1 offset:57344
v_cvt_pk_bf16_f32 v242, v184, v185
v_mfma_f32_16x16x32_bf16 v[216:219], a[164:167], v[24:27], 0
ds_read_b64_tr_b16 a[154:155], v1 offset:58368
v_cvt_pk_bf16_f32 v243, v186, v187
v_mfma_f32_16x16x32_bf16 v[220:223], a[164:167], v[28:31], 0
ds_read_b64_tr_b16 a[156:157], v2 offset:57344
buffer_store_dwordx4 v[240:243], v7, s[16:19], s34 offen sc1
s_waitcnt lgkmcnt(7)
v_mfma_f32_16x16x32_bf16 v[224:227], a[168:171], v[24:27], 0
ds_read_b64_tr_b16 a[158:159], v2 offset:58368
v_cvt_pk_bf16_f32 v244, v180, v181
v_mfma_f32_16x16x32_bf16 v[228:231], a[168:171], v[28:31], 0
ds_read_b64_tr_b16 a[160:161], v1 offset:40960
v_cvt_pk_bf16_f32 v245, v182, v183
v_mfma_f32_16x16x32_bf16 v[232:235], a[172:175], v[24:27], 0
ds_read_b64_tr_b16 a[162:163], v1 offset:41984
v_cvt_pk_bf16_f32 v246, v188, v189
v_mfma_f32_16x16x32_bf16 v[236:239], a[172:175], v[28:31], 0
ds_read_b64_tr_b16 a[164:165], v2 offset:40960
s_waitcnt lgkmcnt(7)
v_mfma_f32_16x16x32_bf16 v[208:211], a[144:147], v[40:43], v[208:211]
ds_read_b64_tr_b16 a[166:167], v2 offset:41984
v_cvt_pk_bf16_f32 v247, v190, v191
v_mfma_f32_16x16x32_bf16 v[212:215], a[144:147], v[44:47], v[212:215]
ds_read_b64_tr_b16 a[168:169], v1 offset:59392
buffer_store_dwordx4 v[244:247], v16, s[16:19], s34 offen sc1
v_mfma_f32_16x16x32_bf16 v[216:219], a[148:151], v[40:43], v[216:219]
ds_read_b64_tr_b16 a[170:171], v1 offset:60416
v_mfma_f32_16x16x32_bf16 v[220:223], a[148:151], v[44:47], v[220:223]
ds_read_b64_tr_b16 a[172:173], v2 offset:59392
s_waitcnt lgkmcnt(7)
v_mfma_f32_16x16x32_bf16 v[224:227], a[152:155], v[40:43], v[224:227]
ds_read_b64_tr_b16 a[174:175], v2 offset:60416
v_mfma_f32_16x16x32_bf16 v[228:231], a[152:155], v[44:47], v[228:231]
ds_read_b64_tr_b16 a[144:145], v1 offset:43008
v_cvt_pk_bf16_f32 v248, v192, v193
v_mfma_f32_16x16x32_bf16 v[232:235], a[156:159], v[40:43], v[232:235]
ds_read_b64_tr_b16 a[146:147], v1 offset:44032
v_cvt_pk_bf16_f32 v249, v194, v195
v_mfma_f32_16x16x32_bf16 v[236:239], a[156:159], v[44:47], v[236:239]
ds_read_b64_tr_b16 a[148:149], v2 offset:43008
s_waitcnt lgkmcnt(7)
v_mfma_f32_16x16x32_bf16 v[208:211], a[160:163], v[56:59], v[208:211]
ds_read_b64_tr_b16 a[150:151], v2 offset:44032
v_cvt_pk_bf16_f32 v250, v200, v201
v_mfma_f32_16x16x32_bf16 v[212:215], a[160:163], v[60:63], v[212:215]
ds_read_b64_tr_b16 a[152:153], v1 offset:61440
v_cvt_pk_bf16_f32 v251, v202, v203
v_mfma_f32_16x16x32_bf16 v[216:219], a[164:167], v[56:59], v[216:219]
ds_read_b64_tr_b16 a[154:155], v1 offset:62464
buffer_store_dwordx4 v[248:251], v7, s[16:19], s34 offen offset:1024 sc1
v_mfma_f32_16x16x32_bf16 v[220:223], a[164:167], v[60:63], v[220:223]
ds_read_b64_tr_b16 a[156:157], v2 offset:61440
s_waitcnt lgkmcnt(7)
v_mfma_f32_16x16x32_bf16 v[224:227], a[168:171], v[56:59], v[224:227]
ds_read_b64_tr_b16 a[158:159], v2 offset:62464
v_cvt_pk_bf16_f32 v252, v196, v197
v_mfma_f32_16x16x32_bf16 v[228:231], a[168:171], v[60:63], v[228:231]
ds_read_b64_tr_b16 a[160:161], v1 offset:45056
v_cvt_pk_bf16_f32 v253, v198, v199
v_mfma_f32_16x16x32_bf16 v[232:235], a[172:175], v[56:59], v[232:235]
ds_read_b64_tr_b16 a[162:163], v1 offset:46080
v_cvt_pk_bf16_f32 v254, v204, v205
v_mfma_f32_16x16x32_bf16 v[236:239], a[172:175], v[60:63], v[236:239]
ds_read_b64_tr_b16 a[164:165], v2 offset:45056
s_waitcnt vmcnt(3)
v_cmp_ne_u32 vcc, 1, v171
s_nop 1
s_cbranch_vccnz K3_SPIN0
K3_GOT0:
s_waitcnt lgkmcnt(7)
v_mfma_f32_16x16x32_bf16 v[208:211], a[144:147], v[72:75], v[208:211]
ds_read_b64_tr_b16 a[166:167], v2 offset:46080
v_cvt_pk_bf16_f32 v255, v206, v207
v_mfma_f32_16x16x32_bf16 v[212:215], a[144:147], v[76:79], v[212:215]
ds_read_b64_tr_b16 a[168:169], v1 offset:63488
buffer_store_dwordx4 v[252:255], v16, s[16:19], s34 offen offset:1024 sc1
v_mfma_f32_16x16x32_bf16 v[216:219], a[148:151], v[72:75], v[216:219]
ds_read_b64_tr_b16 a[170:171], v1 offset:64512
s_add_u32 s39, s24, 16777216
v_mfma_f32_16x16x32_bf16 v[220:223], a[148:151], v[76:79], v[220:223]
ds_read_b64_tr_b16 a[172:173], v2 offset:63488
buffer_load_dwordx4 v[32:35], v19, s[16:19], s39 offen sc1
s_waitcnt lgkmcnt(7)
v_mfma_f32_16x16x32_bf16 v[224:227], a[152:155], v[72:75], v[224:227]
ds_read_b64_tr_b16 a[174:175], v2 offset:64512
v_mfma_f32_16x16x32_bf16 v[228:231], a[152:155], v[76:79], v[228:231]
ds_read_b64_tr_b16 a[144:145], v1 offset:47104
s_add_u32 s40, s24, 19136512
v_mfma_f32_16x16x32_bf16 v[232:235], a[156:159], v[72:75], v[232:235]
ds_read_b64_tr_b16 a[146:147], v1 offset:48128
buffer_load_dwordx4 v[36:39], v19, s[16:19], s40 offen sc1
v_mfma_f32_16x16x32_bf16 v[236:239], a[156:159], v[76:79], v[236:239]
ds_read_b64_tr_b16 a[148:149], v2 offset:47104
s_waitcnt lgkmcnt(7)
v_mfma_f32_16x16x32_bf16 v[208:211], a[160:163], v[88:91], v[208:211]
ds_read_b64_tr_b16 a[150:151], v2 offset:48128
v_mfma_f32_16x16x32_bf16 v[212:215], a[160:163], v[92:95], v[212:215]
ds_read_b64_tr_b16 a[152:153], v3
v_mfma_f32_16x16x32_bf16 v[216:219], a[164:167], v[88:91], v[216:219]
ds_read_b64_tr_b16 a[154:155], v3 offset:1024
v_mfma_f32_16x16x32_bf16 v[220:223], a[164:167], v[92:95], v[220:223]
ds_read_b64_tr_b16 a[156:157], v4
s_waitcnt lgkmcnt(7)
v_mfma_f32_16x16x32_bf16 v[224:227], a[168:171], v[88:91], v[224:227]
ds_read_b64_tr_b16 a[158:159], v4 offset:1024
s_add_u32 s39, s24, 21495808
v_mfma_f32_16x16x32_bf16 v[228:231], a[168:171], v[92:95], v[228:231]
ds_read_b64_tr_b16 a[160:161], v1 offset:49152
buffer_load_dwordx4 v[48:51], v19, s[16:19], s39 offen sc1
v_mfma_f32_16x16x32_bf16 v[232:235], a[172:175], v[88:91], v[232:235]
ds_read_b64_tr_b16 a[162:163], v1 offset:50176
v_mfma_f32_16x16x32_bf16 v[236:239], a[172:175], v[92:95], v[236:239]
ds_read_b64_tr_b16 a[164:165], v2 offset:49152
s_waitcnt lgkmcnt(7)
v_mfma_f32_16x16x32_bf16 v[208:211], a[144:147], v[104:107], v[208:211]
ds_read_b64_tr_b16 a[166:167], v2 offset:50176
v_mfma_f32_16x16x32_bf16 v[212:215], a[144:147], v[108:111], v[212:215]
ds_read_b64_tr_b16 a[168:169], v3 offset:2048
s_add_u32 s40, s24, 23855104
v_mfma_f32_16x16x32_bf16 v[216:219], a[148:151], v[104:107], v[216:219]
ds_read_b64_tr_b16 a[170:171], v3 offset:3072
buffer_load_dwordx4 v[52:55], v19, s[16:19], s40 offen sc1
v_mfma_f32_16x16x32_bf16 v[220:223], a[148:151], v[108:111], v[220:223]
ds_read_b64_tr_b16 a[172:173], v4 offset:2048
s_waitcnt lgkmcnt(7)
v_mfma_f32_16x16x32_bf16 v[224:227], a[152:155], v[104:107], v[224:227]
ds_read_b64_tr_b16 a[174:175], v4 offset:3072
v_mfma_f32_16x16x32_bf16 v[228:231], a[152:155], v[108:111], v[228:231]
ds_read_b64_tr_b16 a[144:145], v1 offset:51200
v_mfma_f32_16x16x32_bf16 v[232:235], a[156:159], v[104:107], v[232:235]
ds_read_b64_tr_b16 a[146:147], v1 offset:52224
v_mfma_f32_16x16x32_bf16 v[236:239], a[156:159], v[108:111], v[236:239]
ds_read_b64_tr_b16 a[148:149], v2 offset:51200
s_waitcnt lgkmcnt(7)
v_mfma_f32_16x16x32_bf16 v[208:211], a[160:163], v[120:123], v[208:211]
ds_read_b64_tr_b16 a[150:151], v2 offset:52224
s_add_u32 s39, s24, 26214400
v_mfma_f32_16x16x32_bf16 v[212:215], a[160:163], v[124:127], v[212:215]
ds_read_b64_tr_b16 a[152:153], v3 offset:4096
buffer_load_dwordx4 v[64:67], v19, s[16:19], s39 offen sc1
v_mfma_f32_16x16x32_bf16 v[216:219], a[164:167], v[120:123], v[216:219]
ds_read_b64_tr_b16 a[154:155], v3 offset:5120
v_mfma_f32_16x16x32_bf16 v[220:223], a[164:167], v[124:127], v[220:223]
ds_read_b64_tr_b16 a[156:157], v4 offset:4096
s_waitcnt lgkmcnt(7)
v_mfma_f32_16x16x32_bf16 v[224:227], a[168:171], v[120:123], v[224:227]
ds_read_b64_tr_b16 a[158:159], v4 offset:5120
v_mfma_f32_16x16x32_bf16 v[228:231], a[168:171], v[124:127], v[228:231]
ds_read_b64_tr_b16 a[160:161], v1 offset:53248
s_add_u32 s40, s24, 28573696
v_mfma_f32_16x16x32_bf16 v[232:235], a[172:175], v[120:123], v[232:235]
ds_read_b64_tr_b16 a[162:163], v1 offset:54272
buffer_load_dwordx4 v[68:71], v19, s[16:19], s40 offen sc1
v_mfma_f32_16x16x32_bf16 v[236:239], a[172:175], v[124:127], v[236:239]
ds_read_b64_tr_b16 a[164:165], v2 offset:53248
s_waitcnt lgkmcnt(7)
v_mfma_f32_16x16x32_bf16 v[208:211], a[144:147], v[136:139], v[208:211]
ds_read_b64_tr_b16 a[166:167], v2 offset:54272
v_mfma_f32_16x16x32_bf16 v[212:215], a[144:147], v[140:143], v[212:215]
ds_read_b64_tr_b16 a[168:169], v3 offset:6144
v_mfma_f32_16x16x32_bf16 v[216:219], a[148:151], v[136:139], v[216:219]
ds_read_b64_tr_b16 a[170:171], v3 offset:7168
v_mfma_f32_16x16x32_bf16 v[220:223], a[148:151], v[140:143], v[220:223]
ds_read_b64_tr_b16 a[172:173], v4 offset:6144
s_waitcnt lgkmcnt(7)
v_mfma_f32_16x16x32_bf16 v[224:227], a[152:155], v[136:139], v[224:227]
ds_read_b64_tr_b16 a[174:175], v4 offset:7168
s_add_u32 s39, s24, 30932992
v_mfma_f32_16x16x32_bf16 v[228:231], a[152:155], v[140:143], v[228:231]
s_barrier
s_add_u32 s41, s25, 128
buffer_store_dword v172, v23, s[16:19], s41 offen sc1
ds_read_b64_tr_b16 a[144:145], v3 offset:8192
v_mfma_f32_16x16x32_bf16 v[232:235], a[156:159], v[136:139], v[232:235]
ds_read_b64_tr_b16 a[146:147], v3 offset:9216
buffer_load_dwordx4 v[80:83], v19, s[16:19], s39 offen sc1
v_mfma_f32_16x16x32_bf16 v[236:239], a[156:159], v[140:143], v[236:239]
ds_read_b64_tr_b16 a[148:149], v4 offset:8192
s_waitcnt lgkmcnt(7)
v_mfma_f32_16x16x32_bf16 v[208:211], a[160:163], v[152:155], v[208:211]
ds_read_b64_tr_b16 a[150:151], v4 offset:9216
v_mfma_f32_16x16x32_bf16 v[212:215], a[160:163], v[156:159], v[212:215]
ds_read_b64_tr_b16 a[152:153], v3 offset:26624
s_add_u32 s40, s24, 33292288
v_mfma_f32_16x16x32_bf16 v[216:219], a[164:167], v[152:155], v[216:219]
ds_read_b64_tr_b16 a[154:155], v3 offset:27648
buffer_load_dwordx4 v[84:87], v19, s[16:19], s40 offen sc1
v_mfma_f32_16x16x32_bf16 v[220:223], a[164:167], v[156:159], v[220:223]
ds_read_b64_tr_b16 a[156:157], v4 offset:26624
s_waitcnt lgkmcnt(7)
v_mfma_f32_16x16x32_bf16 v[224:227], a[168:171], v[152:155], v[224:227]
ds_read_b64_tr_b16 a[158:159], v4 offset:27648
v_mfma_f32_16x16x32_bf16 v[228:231], a[168:171], v[156:159], v[228:231]
ds_read_b64_tr_b16 a[160:161], v3 offset:10240
v_cvt_pk_bf16_f32 v240, v208, v209
v_mfma_f32_16x16x32_bf16 v[232:235], a[172:175], v[152:155], v[232:235]
ds_read_b64_tr_b16 a[162:163], v3 offset:11264
v_cvt_pk_bf16_f32 v241, v210, v211
v_mfma_f32_16x16x32_bf16 v[236:239], a[172:175], v[156:159], v[236:239]
ds_read_b64_tr_b16 a[164:165], v4 offset:10240
s_waitcnt lgkmcnt(7)
v_mfma_f32_16x16x32_bf16 v[176:179], a[144:147], v[24:27], 0
ds_read_b64_tr_b16 a[166:167], v4 offset:11264
s_add_u32 s39, s24, 35651584
v_mfma_f32_16x16x32_bf16 v[180:183], a[144:147], v[28:31], 0
ds_read_b64_tr_b16 a[168:169], v3 offset:28672
buffer_load_dwordx4 v[96:99], v19, s[16:19], s39 offen sc1
v_mfma_f32_16x16x32_bf16 v[184:187], a[148:151], v[24:27], 0
ds_read_b64_tr_b16 a[170:171], v3 offset:29696
v_cvt_pk_bf16_f32 v242, v216, v217
v_mfma_f32_16x16x32_bf16 v[188:191], a[148:151], v[28:31], 0
ds_read_b64_tr_b16 a[172:173], v4 offset:28672
v_cvt_pk_bf16_f32 v243, v218, v219
buffer_store_dwordx4 v[240:243], v7, s[16:19], s34 offen offset:2048 sc1
s_waitcnt lgkmcnt(7)
v_mfma_f32_16x16x32_bf16 v[192:195], a[152:155], v[24:27], 0
ds_read_b64_tr_b16 a[174:175], v4 offset:29696
v_cvt_pk_bf16_f32 v244, v212, v213
v_mfma_f32_16x16x32_bf16 v[196:199], a[152:155], v[28:31], 0
ds_read_b64_tr_b16 a[144:145], v3 offset:12288
s_add_u32 s40, s24, 38010880
v_mfma_f32_16x16x32_bf16 v[200:203], a[156:159], v[24:27], 0
ds_read_b64_tr_b16 a[146:147], v3 offset:13312
buffer_load_dwordx4 v[100:103], v19, s[16:19], s40 offen sc1
v_mfma_f32_16x16x32_bf16 v[204:207], a[156:159], v[28:31], 0
ds_read_b64_tr_b16 a[148:149], v4 offset:12288
s_waitcnt lgkmcnt(7)
v_mfma_f32_16x16x32_bf16 v[176:179], a[160:163], v[40:43], v[176:179]
ds_read_b64_tr_b16 a[150:151], v4 offset:13312
v_cvt_pk_bf16_f32 v245, v214, v215
v_mfma_f32_16x16x32_bf16 v[180:183], a[160:163], v[44:47], v[180:183]
ds_read_b64_tr_b16 a[152:153], v3 offset:30720
v_cvt_pk_bf16_f32 v246, v220, v221
v_cvt_pk_bf16_f32 v247, v222, v223
buffer_store_dwordx4 v[244:247], v16, s[16:19], s34 offen offset:2048 sc1
v_mfma_f32_16x16x32_bf16 v[184:187], a[164:167], v[40:43], v[184:187]
ds_read_b64_tr_b16 a[154:155], v3 offset:31744
v_mfma_f32_16x16x32_bf16 v[188:191], a[164:167], v[44:47], v[188:191]
ds_read_b64_tr_b16 a[156:157], v4 offset:30720
s_waitcnt lgkmcnt(7)
v_mfma_f32_16x16x32_bf16 v[192:195], a[168:171], v[40:43], v[192:195]
ds_read_b64_tr_b16 a[158:159], v4 offset:31744
s_add_u32 s39, s24, 40370176
v_mfma_f32_16x16x32_bf16 v[196:199], a[168:171], v[44:47], v[196:199]
ds_read_b64_tr_b16 a[160:161], v3 offset:14336
buffer_load_dwordx4 v[112:115], v19, s[16:19], s39 offen sc1
v_mfma_f32_16x16x32_bf16 v[200:203], a[172:175], v[40:43], v[200:203]
ds_read_b64_tr_b16 a[162:163], v3 offset:15360
v_cvt_pk_bf16_f32 v248, v224, v225
v_mfma_f32_16x16x32_bf16 v[204:207], a[172:175], v[44:47], v[204:207]
ds_read_b64_tr_b16 a[164:165], v4 offset:14336
s_waitcnt lgkmcnt(7)
v_mfma_f32_16x16x32_bf16 v[176:179], a[144:147], v[56:59], v[176:179]
ds_read_b64_tr_b16 a[166:167], v4 offset:15360
v_cvt_pk_bf16_f32 v249, v226, v227
v_mfma_f32_16x16x32_bf16 v[180:183], a[144:147], v[60:63], v[180:183]
ds_read_b64_tr_b16 a[168:169], v3 offset:32768
v_cvt_pk_bf16_f32 v250, v232, v233
v_mfma_f32_16x16x32_bf16 v[184:187], a[148:151], v[56:59], v[184:187]
ds_read_b64_tr_b16 a[170:171], v3 offset:33792
v_cvt_pk_bf16_f32 v251, v234, v235
v_mfma_f32_16x16x32_bf16 v[188:191], a[148:151], v[60:63], v[188:191]
ds_read_b64_tr_b16 a[172:173], v4 offset:32768
buffer_store_dwordx4 v[248:251], v7, s[16:19], s34 offen offset:3072 sc1
s_waitcnt lgkmcnt(7)
v_mfma_f32_16x16x32_bf16 v[192:195], a[152:155], v[56:59], v[192:195]
ds_read_b64_tr_b16 a[174:175], v4 offset:33792
s_add_u32 s40, s24, 42729472
buffer_load_dwordx4 v[116:119], v19, s[16:19], s40 offen sc1
v_mfma_f32_16x16x32_bf16 v[196:199], a[152:155], v[60:63], v[196:199]
ds_read_b64_tr_b16 a[144:145], v3 offset:16384
v_cvt_pk_bf16_f32 v252, v228, v229
v_mfma_f32_16x16x32_bf16 v[200:203], a[156:159], v[56:59], v[200:203]
ds_read_b64_tr_b16 a[146:147], v3 offset:17408
v_cvt_pk_bf16_f32 v253, v230, v231
v_mfma_f32_16x16x32_bf16 v[204:207], a[156:159], v[60:63], v[204:207]
ds_read_b64_tr_b16 a[148:149], v4 offset:16384
s_waitcnt lgkmcnt(7)
v_mfma_f32_16x16x32_bf16 v[176:179], a[160:163], v[72:75], v[176:179]
ds_read_b64_tr_b16 a[150:151], v4 offset:17408
v_cvt_pk_bf16_f32 v254, v236, v237
v_mfma_f32_16x16x32_bf16 v[180:183], a[160:163], v[76:79], v[180:183]
ds_read_b64_tr_b16 a[152:153], v3 offset:34816
v_cvt_pk_bf16_f32 v255, v238, v239
buffer_store_dwordx4 v[252:255], v16, s[16:19], s34 offen offset:3072 sc1
v_mfma_f32_16x16x32_bf16 v[184:187], a[164:167], v[72:75], v[184:187]
ds_read_b64_tr_b16 a[154:155], v3 offset:35840
s_add_u32 s39, s24, 45088768
buffer_load_dwordx4 v[128:131], v19, s[16:19], s39 offen sc1
v_mfma_f32_16x16x32_bf16 v[188:191], a[164:167], v[76:79], v[188:191]
ds_read_b64_tr_b16 a[156:157], v4 offset:34816
s_waitcnt lgkmcnt(7)
v_mfma_f32_16x16x32_bf16 v[192:195], a[168:171], v[72:75], v[192:195]
ds_read_b64_tr_b16 a[158:159], v4 offset:35840
v_mfma_f32_16x16x32_bf16 v[196:199], a[168:171], v[76:79], v[196:199]
ds_read_b64_tr_b16 a[160:161], v3 offset:18432
s_add_u32 s40, s24, 47448064
v_mfma_f32_16x16x32_bf16 v[200:203], a[172:175], v[72:75], v[200:203]
ds_read_b64_tr_b16 a[162:163], v3 offset:19456
buffer_load_dwordx4 v[132:135], v19, s[16:19], s40 offen sc1
v_mfma_f32_16x16x32_bf16 v[204:207], a[172:175], v[76:79], v[204:207]
ds_read_b64_tr_b16 a[164:165], v4 offset:18432
s_waitcnt lgkmcnt(7)
v_mfma_f32_16x16x32_bf16 v[176:179], a[144:147], v[88:91], v[176:179]
ds_read_b64_tr_b16 a[166:167], v4 offset:19456
v_mfma_f32_16x16x32_bf16 v[180:183], a[144:147], v[92:95], v[180:183]
ds_read_b64_tr_b16 a[168:169], v3 offset:36864
v_mfma_f32_16x16x32_bf16 v[184:187], a[148:151], v[88:91], v[184:187]
ds_read_b64_tr_b16 a[170:171], v3 offset:37888
v_mfma_f32_16x16x32_bf16 v[188:191], a[148:151], v[92:95], v[188:191]
ds_read_b64_tr_b16 a[172:173], v4 offset:36864
s_waitcnt lgkmcnt(7)
v_mfma_f32_16x16x32_bf16 v[192:195], a[152:155], v[88:91], v[192:195]
ds_read_b64_tr_b16 a[174:175], v4 offset:37888
s_add_u32 s39, s24, 49807360
v_mfma_f32_16x16x32_bf16 v[196:199], a[152:155], v[92:95], v[196:199]
ds_read_b64_tr_b16 a[144:145], v3 offset:20480
buffer_load_dwordx4 v[144:147], v19, s[16:19], s39 offen sc1
v_mfma_f32_16x16x32_bf16 v[200:203], a[156:159], v[88:91], v[200:203]
ds_read_b64_tr_b16 a[146:147], v3 offset:21504
v_mfma_f32_16x16x32_bf16 v[204:207], a[156:159], v[92:95], v[204:207]
ds_read_b64_tr_b16 a[148:149], v4 offset:20480
s_waitcnt lgkmcnt(7)
v_mfma_f32_16x16x32_bf16 v[176:179], a[160:163], v[104:107], v[176:179]
ds_read_b64_tr_b16 a[150:151], v4 offset:21504
v_mfma_f32_16x16x32_bf16 v[180:183], a[160:163], v[108:111], v[180:183]
ds_read_b64_tr_b16 a[152:153], v3 offset:38912
s_add_u32 s40, s24, 52166656
v_mfma_f32_16x16x32_bf16 v[184:187], a[164:167], v[104:107], v[184:187]
ds_read_b64_tr_b16 a[154:155], v3 offset:39936
buffer_load_dwordx4 v[148:151], v19, s[16:19], s40 offen sc1
v_mfma_f32_16x16x32_bf16 v[188:191], a[164:167], v[108:111], v[188:191]
ds_read_b64_tr_b16 a[156:157], v4 offset:38912
s_waitcnt lgkmcnt(7)
v_mfma_f32_16x16x32_bf16 v[192:195], a[168:171], v[104:107], v[192:195]
ds_read_b64_tr_b16 a[158:159], v4 offset:39936
v_mfma_f32_16x16x32_bf16 v[196:199], a[168:171], v[108:111], v[196:199]
ds_read_b64_tr_b16 a[160:161], v3 offset:22528
v_mfma_f32_16x16x32_bf16 v[200:203], a[172:175], v[104:107], v[200:203]
ds_read_b64_tr_b16 a[162:163], v3 offset:23552
v_mfma_f32_16x16x32_bf16 v[204:207], a[172:175], v[108:111], v[204:207]
ds_read_b64_tr_b16 a[164:165], v4 offset:22528
s_waitcnt lgkmcnt(7)
v_mfma_f32_16x16x32_bf16 v[176:179], a[144:147], v[120:123], v[176:179]
ds_read_b64_tr_b16 a[166:167], v4 offset:23552
v_mfma_f32_16x16x32_bf16 v[180:183], a[144:147], v[124:127], v[180:183]
ds_read_b64_tr_b16 a[168:169], v3 offset:40960
v_mfma_f32_16x16x32_bf16 v[184:187], a[148:151], v[120:123], v[184:187]
ds_read_b64_tr_b16 a[170:171], v3 offset:41984
v_mfma_f32_16x16x32_bf16 v[188:191], a[148:151], v[124:127], v[188:191]
ds_read_b64_tr_b16 a[172:173], v4 offset:40960
s_waitcnt lgkmcnt(7)
v_mfma_f32_16x16x32_bf16 v[192:195], a[152:155], v[120:123], v[192:195]
ds_read_b64_tr_b16 a[174:175], v4 offset:41984
v_mfma_f32_16x16x32_bf16 v[196:199], a[152:155], v[124:127], v[196:199]
ds_read_b64_tr_b16 a[144:145], v3 offset:24576
v_mfma_f32_16x16x32_bf16 v[200:203], a[156:159], v[120:123], v[200:203]
ds_read_b64_tr_b16 a[146:147], v3 offset:25600
v_mfma_f32_16x16x32_bf16 v[204:207], a[156:159], v[124:127], v[204:207]
ds_read_b64_tr_b16 a[148:149], v4 offset:24576
s_waitcnt lgkmcnt(7)
v_mfma_f32_16x16x32_bf16 v[176:179], a[160:163], v[136:139], v[176:179]
ds_read_b64_tr_b16 a[150:151], v4 offset:25600
v_mfma_f32_16x16x32_bf16 v[180:183], a[160:163], v[140:143], v[180:183]
ds_read_b64_tr_b16 a[152:153], v3 offset:43008
v_mfma_f32_16x16x32_bf16 v[184:187], a[164:167], v[136:139], v[184:187]
ds_read_b64_tr_b16 a[154:155], v3 offset:44032
v_mfma_f32_16x16x32_bf16 v[188:191], a[164:167], v[140:143], v[188:191]
ds_read_b64_tr_b16 a[156:157], v4 offset:43008
s_waitcnt lgkmcnt(7)
v_mfma_f32_16x16x32_bf16 v[192:195], a[168:171], v[136:139], v[192:195]
ds_read_b64_tr_b16 a[158:159], v4 offset:44032
s_add_u32 s34, s28, 16384
v_mfma_f32_16x16x32_bf16 v[196:199], a[168:171], v[140:143], v[196:199]
v_mfma_f32_16x16x32_bf16 v[200:203], a[172:175], v[136:139], v[200:203]
v_mfma_f32_16x16x32_bf16 v[204:207], a[172:175], v[140:143], v[204:207]
s_waitcnt lgkmcnt(4)
v_mfma_f32_16x16x32_bf16 v[176:179], a[144:147], v[152:155], v[176:179]
v_mfma_f32_16x16x32_bf16 v[180:183], a[144:147], v[156:159], v[180:183]
v_mfma_f32_16x16x32_bf16 v[184:187], a[148:151], v[152:155], v[184:187]
v_mfma_f32_16x16x32_bf16 v[188:191], a[148:151], v[156:159], v[188:191]
s_waitcnt lgkmcnt(0)
v_mfma_f32_16x16x32_bf16 v[192:195], a[152:155], v[152:155], v[192:195]
v_mfma_f32_16x16x32_bf16 v[196:199], a[152:155], v[156:159], v[196:199]
s_nop 1
v_cvt_pk_bf16_f32 v240, v176, v177
v_cvt_pk_bf16_f32 v241, v178, v179
v_mfma_f32_16x16x32_bf16 v[200:203], a[156:159], v[152:155], v[200:203]
v_cvt_pk_bf16_f32 v242, v184, v185
v_cvt_pk_bf16_f32 v243, v186, v187
v_mfma_f32_16x16x32_bf16 v[204:207], a[156:159], v[156:159], v[204:207]
buffer_store_dwordx4 v[240:243], v7, s[16:19], s34 offen sc1
s_add_u32 s29, s25, 128
buffer_load_dword v171, v22, s[16:19], s29 offen sc1
v_cvt_pk_bf16_f32 v244, v180, v181
v_cvt_pk_bf16_f32 v245, v182, v183
v_cvt_pk_bf16_f32 v246, v188, v189
v_cvt_pk_bf16_f32 v247, v190, v191
buffer_store_dwordx4 v[244:247], v16, s[16:19], s34 offen sc1
v_cvt_pk_bf16_f32 v248, v192, v193
v_cvt_pk_bf16_f32 v249, v194, v195
v_cvt_pk_bf16_f32 v250, v200, v201
v_cvt_pk_bf16_f32 v251, v202, v203
buffer_store_dwordx4 v[248:251], v7, s[16:19], s34 offen offset:1024 sc1
v_cvt_pk_bf16_f32 v252, v196, v197
v_cvt_pk_bf16_f32 v253, v198, v199
v_cvt_pk_bf16_f32 v254, v204, v205
v_cvt_pk_bf16_f32 v255, v206, v207
buffer_store_dwordx4 v[252:255], v16, s[16:19], s34 offen offset:1024 sc1
s_waitcnt vmcnt(9)
s_barrier
s_add_u32 s41, s25, 256
buffer_store_dword v172, v23, s[16:19], s41 offen sc1
v_lshlrev_b32 v1, 16, v32
v_and_b32 v2, 0xffff0000, v32
v_lshlrev_b32 v3, 16, v33
v_and_b32 v4, 0xffff0000, v33
v_lshlrev_b32 v5, 16, v34
v_and_b32 v6, 0xffff0000, v34
v_lshlrev_b32 v12, 16, v35
v_and_b32 v13, 0xffff0000, v35
v_lshlrev_b32 v152, 16, v36
v_and_b32 v153, 0xffff0000, v36
v_lshlrev_b32 v154, 16, v37
v_and_b32 v155, 0xffff0000, v37
v_lshlrev_b32 v156, 16, v38
v_and_b32 v157, 0xffff0000, v38
v_lshlrev_b32 v158, 16, v39
v_and_b32 v159, 0xffff0000, v39
v_add_f32 v1, v1, v152
v_add_f32 v2, v2, v153
v_add_f32 v3, v3, v154
v_add_f32 v4, v4, v155
v_add_f32 v5, v5, v156
v_add_f32 v6, v6, v157
v_add_f32 v12, v12, v158
v_add_f32 v13, v13, v159
v_lshlrev_b32 v152, 16, v48
v_and_b32 v153, 0xffff0000, v48
v_lshlrev_b32 v154, 16, v49
v_and_b32 v155, 0xffff0000, v49
v_lshlrev_b32 v156, 16, v50
v_and_b32 v157, 0xffff0000, v50
v_lshlrev_b32 v158, 16, v51
v_and_b32 v159, 0xffff0000, v51
v_add_f32 v1, v1, v152
v_add_f32 v2, v2, v153
v_add_f32 v3, v3, v154
v_add_f32 v4, v4, v155
v_add_f32 v5, v5, v156
v_add_f32 v6, v6, v157
v_add_f32 v12, v12, v158
v_add_f32 v13, v13, v159
v_lshlrev_b32 v152, 16, v52
v_and_b32 v153, 0xffff0000, v52
v_lshlrev_b32 v154, 16, v53
v_and_b32 v155, 0xffff0000, v53
v_lshlrev_b32 v156, 16, v54
v_and_b32 v157, 0xffff0000, v54
v_lshlrev_b32 v158, 16, v55
v_and_b32 v159, 0xffff0000, v55
v_add_f32 v1, v1, v152
v_add_f32 v2, v2, v153
v_add_f32 v3, v3, v154
v_add_f32 v4, v4, v155
v_add_f32 v5, v5, v156
v_add_f32 v6, v6, v157
v_add_f32 v12, v12, v158
v_add_f32 v13, v13, v159
v_lshlrev_b32 v152, 16, v64
v_and_b32 v153, 0xffff0000, v64
v_lshlrev_b32 v154, 16, v65
v_and_b32 v155, 0xffff0000, v65
v_lshlrev_b32 v156, 16, v66
v_and_b32 v157, 0xffff0000, v66
v_lshlrev_b32 v158, 16, v67
v_and_b32 v159, 0xffff0000, v67
v_add_f32 v1, v1, v152
v_add_f32 v2, v2, v153
v_add_f32 v3, v3, v154
v_add_f32 v4, v4, v155
v_add_f32 v5, v5, v156
v_add_f32 v6, v6, v157
v_add_f32 v12, v12, v158
v_add_f32 v13, v13, v159
v_lshlrev_b32 v152, 16, v68
v_and_b32 v153, 0xffff0000, v68
v_lshlrev_b32 v154, 16, v69
v_and_b32 v155, 0xffff0000, v69
v_lshlrev_b32 v156, 16, v70
v_and_b32 v157, 0xffff0000, v70
v_lshlrev_b32 v158, 16, v71
v_and_b32 v159, 0xffff0000, v71
v_add_f32 v1, v1, v152
v_add_f32 v2, v2, v153
v_add_f32 v3, v3, v154
v_add_f32 v4, v4, v155
v_add_f32 v5, v5, v156
v_add_f32 v6, v6, v157
v_add_f32 v12, v12, v158
v_add_f32 v13, v13, v159
v_lshlrev_b32 v152, 16, v80
v_and_b32 v153, 0xffff0000, v80
v_lshlrev_b32 v154, 16, v81
v_and_b32 v155, 0xffff0000, v81
v_lshlrev_b32 v156, 16, v82
v_and_b32 v157, 0xffff0000, v82
v_lshlrev_b32 v158, 16, v83
v_and_b32 v159, 0xffff0000, v83
v_add_f32 v1, v1, v152
v_add_f32 v2, v2, v153
v_add_f32 v3, v3, v154
v_add_f32 v4, v4, v155
v_add_f32 v5, v5, v156
v_add_f32 v6, v6, v157
v_add_f32 v12, v12, v158
v_add_f32 v13, v13, v159
v_lshlrev_b32 v152, 16, v84
v_and_b32 v153, 0xffff0000, v84
v_lshlrev_b32 v154, 16, v85
v_and_b32 v155, 0xffff0000, v85
v_lshlrev_b32 v156, 16, v86
v_and_b32 v157, 0xffff0000, v86
v_lshlrev_b32 v158, 16, v87
v_and_b32 v159, 0xffff0000, v87
v_add_f32 v1, v1, v152
v_add_f32 v2, v2, v153
v_add_f32 v3, v3, v154
v_add_f32 v4, v4, v155
v_add_f32 v5, v5, v156
v_add_f32 v6, v6, v157
v_add_f32 v12, v12, v158
v_add_f32 v13, v13, v159
v_lshlrev_b32 v152, 16, v96
v_and_b32 v153, 0xffff0000, v96
v_lshlrev_b32 v154, 16, v97
v_and_b32 v155, 0xffff0000, v97
v_lshlrev_b32 v156, 16, v98
v_and_b32 v157, 0xffff0000, v98
v_lshlrev_b32 v158, 16, v99
v_and_b32 v159, 0xffff0000, v99
v_add_f32 v1, v1, v152
v_add_f32 v2, v2, v153
v_add_f32 v3, v3, v154
v_add_f32 v4, v4, v155
v_add_f32 v5, v5, v156
v_add_f32 v6, v6, v157
v_add_f32 v12, v12, v158
v_add_f32 v13, v13, v159
v_lshlrev_b32 v152, 16, v100
v_and_b32 v153, 0xffff0000, v100
v_lshlrev_b32 v154, 16, v101
v_and_b32 v155, 0xffff0000, v101
v_lshlrev_b32 v156, 16, v102
v_and_b32 v157, 0xffff0000, v102
v_lshlrev_b32 v158, 16, v103
v_and_b32 v159, 0xffff0000, v103
v_add_f32 v1, v1, v152
v_add_f32 v2, v2, v153
v_add_f32 v3, v3, v154
v_add_f32 v4, v4, v155
v_add_f32 v5, v5, v156
v_add_f32 v6, v6, v157
v_add_f32 v12, v12, v158
v_add_f32 v13, v13, v159
v_lshlrev_b32 v152, 16, v112
v_and_b32 v153, 0xffff0000, v112
v_lshlrev_b32 v154, 16, v113
v_and_b32 v155, 0xffff0000, v113
v_lshlrev_b32 v156, 16, v114
v_and_b32 v157, 0xffff0000, v114
v_lshlrev_b32 v158, 16, v115
v_and_b32 v159, 0xffff0000, v115
v_add_f32 v1, v1, v152
v_add_f32 v2, v2, v153
v_add_f32 v3, v3, v154
v_add_f32 v4, v4, v155
v_add_f32 v5, v5, v156
v_add_f32 v6, v6, v157
v_add_f32 v12, v12, v158
v_add_f32 v13, v13, v159
v_lshlrev_b32 v152, 16, v116
v_and_b32 v153, 0xffff0000, v116
v_lshlrev_b32 v154, 16, v117
v_and_b32 v155, 0xffff0000, v117
v_lshlrev_b32 v156, 16, v118
v_and_b32 v157, 0xffff0000, v118
v_lshlrev_b32 v158, 16, v119
v_and_b32 v159, 0xffff0000, v119
v_add_f32 v1, v1, v152
v_add_f32 v2, v2, v153
v_add_f32 v3, v3, v154
v_add_f32 v4, v4, v155
v_add_f32 v5, v5, v156
v_add_f32 v6, v6, v157
v_add_f32 v12, v12, v158
v_add_f32 v13, v13, v159
s_waitcnt vmcnt(9)
v_lshlrev_b32 v152, 16, v128
v_and_b32 v153, 0xffff0000, v128
v_lshlrev_b32 v154, 16, v129
v_and_b32 v155, 0xffff0000, v129
v_lshlrev_b32 v156, 16, v130
v_and_b32 v157, 0xffff0000, v130
v_lshlrev_b32 v158, 16, v131
v_and_b32 v159, 0xffff0000, v131
v_add_f32 v1, v1, v152
v_add_f32 v2, v2, v153
v_add_f32 v3, v3, v154
v_add_f32 v4, v4, v155
v_add_f32 v5, v5, v156
v_add_f32 v6, v6, v157
v_add_f32 v12, v12, v158
v_add_f32 v13, v13, v159
s_waitcnt vmcnt(8)
v_lshlrev_b32 v152, 16, v132
v_and_b32 v153, 0xffff0000, v132
v_lshlrev_b32 v154, 16, v133
v_and_b32 v155, 0xffff0000, v133
v_lshlrev_b32 v156, 16, v134
v_and_b32 v157, 0xffff0000, v134
v_lshlrev_b32 v158, 16, v135
v_and_b32 v159, 0xffff0000, v135
v_add_f32 v1, v1, v152
v_add_f32 v2, v2, v153
v_add_f32 v3, v3, v154
v_add_f32 v4, v4, v155
v_add_f32 v5, v5, v156
v_add_f32 v6, v6, v157
v_add_f32 v12, v12, v158
v_add_f32 v13, v13, v159
s_waitcnt vmcnt(7)
v_lshlrev_b32 v152, 16, v144
v_and_b32 v153, 0xffff0000, v144
v_lshlrev_b32 v154, 16, v145
v_and_b32 v155, 0xffff0000, v145
v_lshlrev_b32 v156, 16, v146
v_and_b32 v157, 0xffff0000, v146
v_lshlrev_b32 v158, 16, v147
v_and_b32 v159, 0xffff0000, v147
v_add_f32 v1, v1, v152
v_add_f32 v2, v2, v153
v_add_f32 v3, v3, v154
v_add_f32 v4, v4, v155
v_add_f32 v5, v5, v156
v_add_f32 v6, v6, v157
v_add_f32 v12, v12, v158
v_add_f32 v13, v13, v159
s_waitcnt vmcnt(6)
v_lshlrev_b32 v152, 16, v148
v_and_b32 v153, 0xffff0000, v148
v_lshlrev_b32 v154, 16, v149
v_and_b32 v155, 0xffff0000, v149
v_lshlrev_b32 v156, 16, v150
v_and_b32 v157, 0xffff0000, v150
v_lshlrev_b32 v158, 16, v151
v_and_b32 v159, 0xffff0000, v151
v_add_f32 v1, v1, v152
v_add_f32 v2, v2, v153
v_add_f32 v3, v3, v154
v_add_f32 v4, v4, v155
v_add_f32 v5, v5, v156
v_add_f32 v6, v6, v157
v_add_f32 v12, v12, v158
v_add_f32 v13, v13, v159
ds_read_b128 v[36:39], v168 offset:11520
ds_read_b128 v[48:51], v168 offset:11584
v_lshlrev_b32 v152, 16, v160
v_and_b32 v153, 0xffff0000, v160
v_lshlrev_b32 v154, 16, v161
v_and_b32 v155, 0xffff0000, v161
v_lshlrev_b32 v156, 16, v162
v_and_b32 v157, 0xffff0000, v162
v_lshlrev_b32 v158, 16, v163
v_and_b32 v159, 0xffff0000, v163
s_waitcnt lgkmcnt(1)
v_fmac_f32 v152, v1, v36
v_fmac_f32 v153, v2, v37
v_fmac_f32 v154, v3, v38
v_fmac_f32 v155, v4, v39
s_waitcnt lgkmcnt(0)
v_fmac_f32 v156, v5, v48
v_fmac_f32 v157, v6, v49
v_fmac_f32 v158, v12, v50
v_fmac_f32 v159, v13, v51
v_cvt_pk_bf16_f32 v52, v152, v153
v_cvt_pk_bf16_f32 v53, v154, v155
v_cvt_pk_bf16_f32 v54, v156, v157
v_cvt_pk_bf16_f32 v55, v158, v159
s_waitcnt vmcnt(1)
s_barrier
s_add_u32 s41, s25, 384
buffer_store_dword v172, v23, s[16:19], s41 offen sc1
v_cmp_ne_u32 vcc, 1, v171
s_nop 1
s_cbranch_vccnz K3_SPIN1
K3_GOT1:
s_add_u32 s39, s24, 16777216
buffer_load_dwordx4 v[24:27], v20, s[16:19], s39 offen sc1
s_add_u32 s40, s24, 19136512
buffer_load_dwordx4 v[28:31], v20, s[16:19], s40 offen sc1
s_add_u32 s39, s24, 21495808
buffer_load_dwordx4 v[40:43], v20, s[16:19], s39 offen sc1
s_add_u32 s40, s24, 23855104
buffer_load_dwordx4 v[44:47], v20, s[16:19], s40 offen sc1
s_add_u32 s39, s24, 26214400
buffer_load_dwordx4 v[56:59], v20, s[16:19], s39 offen sc1
s_add_u32 s40, s24, 28573696
buffer_load_dwordx4 v[60:63], v20, s[16:19], s40 offen sc1
s_add_u32 s39, s24, 30932992
buffer_load_dwordx4 v[72:75], v20, s[16:19], s39 offen sc1
s_add_u32 s40, s24, 33292288
buffer_load_dwordx4 v[76:79], v20, s[16:19], s40 offen sc1
s_add_u32 s39, s24, 35651584
buffer_load_dwordx4 v[88:91], v20, s[16:19], s39 offen sc1
s_add_u32 s40, s24, 38010880
buffer_load_dwordx4 v[92:95], v20, s[16:19], s40 offen sc1
s_add_u32 s39, s24, 40370176
buffer_load_dwordx4 v[104:107], v20, s[16:19], s39 offen sc1
s_add_u32 s40, s24, 42729472
buffer_load_dwordx4 v[108:111], v20, s[16:19], s40 offen sc1
s_add_u32 s39, s24, 45088768
buffer_load_dwordx4 v[120:123], v20, s[16:19], s39 offen sc1
s_add_u32 s40, s24, 47448064
buffer_load_dwordx4 v[124:127], v20, s[16:19], s40 offen sc1
s_add_u32 s39, s24, 49807360
buffer_load_dwordx4 v[136:139], v20, s[16:19], s39 offen sc1
s_add_u32 s40, s24, 52166656
buffer_load_dwordx4 v[140:143], v20, s[16:19], s40 offen sc1
s_waitcnt vmcnt(15)
v_lshlrev_b32 v240, 16, v24
v_and_b32 v241, 0xffff0000, v24
v_lshlrev_b32 v242, 16, v25
v_and_b32 v243, 0xffff0000, v25
v_lshlrev_b32 v244, 16, v26
v_and_b32 v245, 0xffff0000, v26
v_lshlrev_b32 v246, 16, v27
v_and_b32 v247, 0xffff0000, v27
s_waitcnt vmcnt(14)
v_lshlrev_b32 v152, 16, v28
v_and_b32 v153, 0xffff0000, v28
v_lshlrev_b32 v154, 16, v29
v_and_b32 v155, 0xffff0000, v29
v_lshlrev_b32 v156, 16, v30
v_and_b32 v157, 0xffff0000, v30
v_lshlrev_b32 v158, 16, v31
v_and_b32 v159, 0xffff0000, v31
v_add_f32 v240, v240, v152
v_add_f32 v241, v241, v153
v_add_f32 v242, v242, v154
v_add_f32 v243, v243, v155
v_add_f32 v244, v244, v156
v_add_f32 v245, v245, v157
v_add_f32 v246, v246, v158
v_add_f32 v247, v247, v159
s_waitcnt vmcnt(13)
v_lshlrev_b32 v152, 16, v40
v_and_b32 v153, 0xffff0000, v40
v_lshlrev_b32 v154, 16, v41
v_and_b32 v155, 0xffff0000, v41
v_lshlrev_b32 v156, 16, v42
v_and_b32 v157, 0xffff0000, v42
v_lshlrev_b32 v158, 16, v43
v_and_b32 v159, 0xffff0000, v43
v_add_f32 v240, v240, v152
v_add_f32 v241, v241, v153
v_add_f32 v242, v242, v154
v_add_f32 v243, v243, v155
v_add_f32 v244, v244, v156
v_add_f32 v245, v245, v157
v_add_f32 v246, v246, v158
v_add_f32 v247, v247, v159
s_waitcnt vmcnt(12)
v_lshlrev_b32 v152, 16, v44
v_and_b32 v153, 0xffff0000, v44
v_lshlrev_b32 v154, 16, v45
v_and_b32 v155, 0xffff0000, v45
v_lshlrev_b32 v156, 16, v46
v_and_b32 v157, 0xffff0000, v46
v_lshlrev_b32 v158, 16, v47
v_and_b32 v159, 0xffff0000, v47
v_add_f32 v240, v240, v152
v_add_f32 v241, v241, v153
v_add_f32 v242, v242, v154
v_add_f32 v243, v243, v155
v_add_f32 v244, v244, v156
v_add_f32 v245, v245, v157
v_add_f32 v246, v246, v158
v_add_f32 v247, v247, v159
s_waitcnt vmcnt(11)
v_lshlrev_b32 v152, 16, v56
v_and_b32 v153, 0xffff0000, v56
v_lshlrev_b32 v154, 16, v57
v_and_b32 v155, 0xffff0000, v57
v_lshlrev_b32 v156, 16, v58
v_and_b32 v157, 0xffff0000, v58
v_lshlrev_b32 v158, 16, v59
v_and_b32 v159, 0xffff0000, v59
v_add_f32 v240, v240, v152
v_add_f32 v241, v241, v153
v_add_f32 v242, v242, v154
v_add_f32 v243, v243, v155
v_add_f32 v244, v244, v156
v_add_f32 v245, v245, v157
v_add_f32 v246, v246, v158
v_add_f32 v247, v247, v159
s_waitcnt vmcnt(10)
v_lshlrev_b32 v152, 16, v60
v_and_b32 v153, 0xffff0000, v60
v_lshlrev_b32 v154, 16, v61
v_and_b32 v155, 0xffff0000, v61
v_lshlrev_b32 v156, 16, v62
v_and_b32 v157, 0xffff0000, v62
v_lshlrev_b32 v158, 16, v63
v_and_b32 v159, 0xffff0000, v63
v_add_f32 v240, v240, v152
v_add_f32 v241, v241, v153
v_add_f32 v242, v242, v154
v_add_f32 v243, v243, v155
v_add_f32 v244, v244, v156
v_add_f32 v245, v245, v157
v_add_f32 v246, v246, v158
v_add_f32 v247, v247, v159
s_waitcnt vmcnt(9)
v_lshlrev_b32 v152, 16, v72
v_and_b32 v153, 0xffff0000, v72
v_lshlrev_b32 v154, 16, v73
v_and_b32 v155, 0xffff0000, v73
v_lshlrev_b32 v156, 16, v74
v_and_b32 v157, 0xffff0000, v74
v_lshlrev_b32 v158, 16, v75
v_and_b32 v159, 0xffff0000, v75
v_add_f32 v240, v240, v152
v_add_f32 v241, v241, v153
v_add_f32 v242, v242, v154
v_add_f32 v243, v243, v155
v_add_f32 v244, v244, v156
v_add_f32 v245, v245, v157
v_add_f32 v246, v246, v158
v_add_f32 v247, v247, v159
s_waitcnt vmcnt(8)
v_lshlrev_b32 v152, 16, v76
v_and_b32 v153, 0xffff0000, v76
v_lshlrev_b32 v154, 16, v77
v_and_b32 v155, 0xffff0000, v77
v_lshlrev_b32 v156, 16, v78
v_and_b32 v157, 0xffff0000, v78
v_lshlrev_b32 v158, 16, v79
v_and_b32 v159, 0xffff0000, v79
v_add_f32 v240, v240, v152
v_add_f32 v241, v241, v153
v_add_f32 v242, v242, v154
v_add_f32 v243, v243, v155
v_add_f32 v244, v244, v156
v_add_f32 v245, v245, v157
v_add_f32 v246, v246, v158
v_add_f32 v247, v247, v159
s_waitcnt vmcnt(7)
v_lshlrev_b32 v152, 16, v88
v_and_b32 v153, 0xffff0000, v88
v_lshlrev_b32 v154, 16, v89
v_and_b32 v155, 0xffff0000, v89
v_lshlrev_b32 v156, 16, v90
v_and_b32 v157, 0xffff0000, v90
v_lshlrev_b32 v158, 16, v91
v_and_b32 v159, 0xffff0000, v91
v_add_f32 v240, v240, v152
v_add_f32 v241, v241, v153
v_add_f32 v242, v242, v154
v_add_f32 v243, v243, v155
v_add_f32 v244, v244, v156
v_add_f32 v245, v245, v157
v_add_f32 v246, v246, v158
v_add_f32 v247, v247, v159
s_waitcnt vmcnt(6)
v_lshlrev_b32 v152, 16, v92
v_and_b32 v153, 0xffff0000, v92
v_lshlrev_b32 v154, 16, v93
v_and_b32 v155, 0xffff0000, v93
v_lshlrev_b32 v156, 16, v94
v_and_b32 v157, 0xffff0000, v94
v_lshlrev_b32 v158, 16, v95
v_and_b32 v159, 0xffff0000, v95
v_add_f32 v240, v240, v152
v_add_f32 v241, v241, v153
v_add_f32 v242, v242, v154
v_add_f32 v243, v243, v155
v_add_f32 v244, v244, v156
v_add_f32 v245, v245, v157
v_add_f32 v246, v246, v158
v_add_f32 v247, v247, v159
s_waitcnt vmcnt(5)
v_lshlrev_b32 v152, 16, v104
v_and_b32 v153, 0xffff0000, v104
v_lshlrev_b32 v154, 16, v105
v_and_b32 v155, 0xffff0000, v105
v_lshlrev_b32 v156, 16, v106
v_and_b32 v157, 0xffff0000, v106
v_lshlrev_b32 v158, 16, v107
v_and_b32 v159, 0xffff0000, v107
v_add_f32 v240, v240, v152
v_add_f32 v241, v241, v153
v_add_f32 v242, v242, v154
v_add_f32 v243, v243, v155
v_add_f32 v244, v244, v156
v_add_f32 v245, v245, v157
v_add_f32 v246, v246, v158
v_add_f32 v247, v247, v159
s_waitcnt vmcnt(4)
v_lshlrev_b32 v152, 16, v108
v_and_b32 v153, 0xffff0000, v108
v_lshlrev_b32 v154, 16, v109
v_and_b32 v155, 0xffff0000, v109
v_lshlrev_b32 v156, 16, v110
v_and_b32 v157, 0xffff0000, v110
v_lshlrev_b32 v158, 16, v111
v_and_b32 v159, 0xffff0000, v111
v_add_f32 v240, v240, v152
v_add_f32 v241, v241, v153
v_add_f32 v242, v242, v154
v_add_f32 v243, v243, v155
v_add_f32 v244, v244, v156
v_add_f32 v245, v245, v157
v_add_f32 v246, v246, v158
v_add_f32 v247, v247, v159
s_waitcnt vmcnt(3)
v_lshlrev_b32 v152, 16, v120
v_and_b32 v153, 0xffff0000, v120
v_lshlrev_b32 v154, 16, v121
v_and_b32 v155, 0xffff0000, v121
v_lshlrev_b32 v156, 16, v122
v_and_b32 v157, 0xffff0000, v122
v_lshlrev_b32 v158, 16, v123
v_and_b32 v159, 0xffff0000, v123
v_add_f32 v240, v240, v152
v_add_f32 v241, v241, v153
v_add_f32 v242, v242, v154
v_add_f32 v243, v243, v155
v_add_f32 v244, v244, v156
v_add_f32 v245, v245, v157
v_add_f32 v246, v246, v158
v_add_f32 v247, v247, v159
s_waitcnt vmcnt(2)
v_lshlrev_b32 v152, 16, v124
v_and_b32 v153, 0xffff0000, v124
v_lshlrev_b32 v154, 16, v125
v_and_b32 v155, 0xffff0000, v125
v_lshlrev_b32 v156, 16, v126
v_and_b32 v157, 0xffff0000, v126
v_lshlrev_b32 v158, 16, v127
v_and_b32 v159, 0xffff0000, v127
v_add_f32 v240, v240, v152
v_add_f32 v241, v241, v153
v_add_f32 v242, v242, v154
v_add_f32 v243, v243, v155
v_add_f32 v244, v244, v156
v_add_f32 v245, v245, v157
v_add_f32 v246, v246, v158
v_add_f32 v247, v247, v159
s_waitcnt vmcnt(1)
v_lshlrev_b32 v152, 16, v136
v_and_b32 v153, 0xffff0000, v136
v_lshlrev_b32 v154, 16, v137
v_and_b32 v155, 0xffff0000, v137
v_lshlrev_b32 v156, 16, v138
v_and_b32 v157, 0xffff0000, v138
v_lshlrev_b32 v158, 16, v139
v_and_b32 v159, 0xffff0000, v139
v_add_f32 v240, v240, v152
v_add_f32 v241, v241, v153
v_add_f32 v242, v242, v154
v_add_f32 v243, v243, v155
v_add_f32 v244, v244, v156
v_add_f32 v245, v245, v157
v_add_f32 v246, v246, v158
v_add_f32 v247, v247, v159
s_waitcnt vmcnt(0)
v_lshlrev_b32 v152, 16, v140
v_and_b32 v153, 0xffff0000, v140
v_lshlrev_b32 v154, 16, v141
v_and_b32 v155, 0xffff0000, v141
v_lshlrev_b32 v156, 16, v142
v_and_b32 v157, 0xffff0000, v142
v_lshlrev_b32 v158, 16, v143
v_and_b32 v159, 0xffff0000, v143
v_add_f32 v240, v240, v152
v_add_f32 v241, v241, v153
v_add_f32 v242, v242, v154
v_add_f32 v243, v243, v155
v_add_f32 v244, v244, v156
v_add_f32 v245, v245, v157
v_add_f32 v246, v246, v158
v_add_f32 v247, v247, v159
buffer_load_dword v171, v22, s[16:19], s27 offen sc1
ds_read_b128 v[36:39], v169 offset:11520
ds_read_b128 v[48:51], v169 offset:11584
v_lshlrev_b32 v152, 16, v164
v_and_b32 v153, 0xffff0000, v164
v_lshlrev_b32 v154, 16, v165
v_and_b32 v155, 0xffff0000, v165
v_lshlrev_b32 v156, 16, v166
v_and_b32 v157, 0xffff0000, v166
v_lshlrev_b32 v158, 16, v167
v_and_b32 v159, 0xffff0000, v167
s_waitcnt lgkmcnt(1)
v_fmac_f32 v152, v240, v36
v_fmac_f32 v153, v241, v37
v_fmac_f32 v154, v242, v38
v_fmac_f32 v155, v243, v39
s_waitcnt lgkmcnt(0)
v_fmac_f32 v156, v244, v48
v_fmac_f32 v157, v245, v49
v_fmac_f32 v158, v246, v50
v_fmac_f32 v159, v247, v51
v_cvt_pk_bf16_f32 v64, v152, v153
v_cvt_pk_bf16_f32 v65, v154, v155
v_cvt_pk_bf16_f32 v66, v156, v157
v_cvt_pk_bf16_f32 v67, v158, v159
s_waitcnt vmcnt(0)
v_cmp_ne_u32 vcc, 1, v171
s_nop 1
s_cbranch_vccnz K3_SPIN2
K3_GOT2:
s_add_u32 s39, s24, 16777216
buffer_load_dwordx4 v[176:179], v21, s[16:19], s39 offen sc1
s_add_u32 s40, s24, 19136512
buffer_load_dwordx4 v[180:183], v21, s[16:19], s40 offen sc1
s_add_u32 s39, s24, 21495808
buffer_load_dwordx4 v[184:187], v21, s[16:19], s39 offen sc1
s_add_u32 s40, s24, 23855104
buffer_load_dwordx4 v[188:191], v21, s[16:19], s40 offen sc1
s_add_u32 s39, s24, 26214400
buffer_load_dwordx4 v[192:195], v21, s[16:19], s39 offen sc1
s_add_u32 s40, s24, 28573696
buffer_load_dwordx4 v[196:199], v21, s[16:19], s40 offen sc1
s_add_u32 s39, s24, 30932992
buffer_load_dwordx4 v[200:203], v21, s[16:19], s39 offen sc1
s_add_u32 s40, s24, 33292288
buffer_load_dwordx4 v[204:207], v21, s[16:19], s40 offen sc1
s_add_u32 s39, s24, 35651584
buffer_load_dwordx4 v[208:211], v21, s[16:19], s39 offen sc1
s_add_u32 s40, s24, 38010880
buffer_load_dwordx4 v[212:215], v21, s[16:19], s40 offen sc1
s_add_u32 s39, s24, 40370176
buffer_load_dwordx4 v[216:219], v21, s[16:19], s39 offen sc1
s_add_u32 s40, s24, 42729472
buffer_load_dwordx4 v[220:223], v21, s[16:19], s40 offen sc1
s_add_u32 s39, s24, 45088768
buffer_load_dwordx4 v[224:227], v21, s[16:19], s39 offen sc1
s_add_u32 s40, s24, 47448064
buffer_load_dwordx4 v[228:231], v21, s[16:19], s40 offen sc1
s_add_u32 s39, s24, 49807360
buffer_load_dwordx4 v[232:235], v21, s[16:19], s39 offen sc1
s_add_u32 s40, s24, 52166656
buffer_load_dwordx4 v[236:239], v21, s[16:19], s40 offen sc1
buffer_store_dwordx2 v[52:53], v173, s[12:15], s93 offen
buffer_store_dwordx2 v[54:55], v173, s[12:15], s93 offen offset:32
buffer_store_dwordx2 v[64:65], v174, s[12:15], s93 offen
buffer_store_dwordx2 v[66:67], v174, s[12:15], s93 offen offset:32
s_waitcnt vmcnt(19)
v_lshlrev_b32 v248, 16, v176
v_and_b32 v249, 0xffff0000, v176
v_lshlrev_b32 v250, 16, v177
v_and_b32 v251, 0xffff0000, v177
v_lshlrev_b32 v252, 16, v178
v_and_b32 v253, 0xffff0000, v178
v_lshlrev_b32 v254, 16, v179
v_and_b32 v255, 0xffff0000, v179
s_waitcnt vmcnt(18)
v_lshlrev_b32 v152, 16, v180
v_and_b32 v153, 0xffff0000, v180
v_lshlrev_b32 v154, 16, v181
v_and_b32 v155, 0xffff0000, v181
v_lshlrev_b32 v156, 16, v182
v_and_b32 v157, 0xffff0000, v182
v_lshlrev_b32 v158, 16, v183
v_and_b32 v159, 0xffff0000, v183
v_add_f32 v248, v248, v152
v_add_f32 v249, v249, v153
v_add_f32 v250, v250, v154
v_add_f32 v251, v251, v155
v_add_f32 v252, v252, v156
v_add_f32 v253, v253, v157
v_add_f32 v254, v254, v158
v_add_f32 v255, v255, v159
s_waitcnt vmcnt(17)
v_lshlrev_b32 v152, 16, v184
v_and_b32 v153, 0xffff0000, v184
v_lshlrev_b32 v154, 16, v185
v_and_b32 v155, 0xffff0000, v185
v_lshlrev_b32 v156, 16, v186
v_and_b32 v157, 0xffff0000, v186
v_lshlrev_b32 v158, 16, v187
v_and_b32 v159, 0xffff0000, v187
v_add_f32 v248, v248, v152
v_add_f32 v249, v249, v153
v_add_f32 v250, v250, v154
v_add_f32 v251, v251, v155
v_add_f32 v252, v252, v156
v_add_f32 v253, v253, v157
v_add_f32 v254, v254, v158
v_add_f32 v255, v255, v159
s_waitcnt vmcnt(16)
v_lshlrev_b32 v152, 16, v188
v_and_b32 v153, 0xffff0000, v188
v_lshlrev_b32 v154, 16, v189
v_and_b32 v155, 0xffff0000, v189
v_lshlrev_b32 v156, 16, v190
v_and_b32 v157, 0xffff0000, v190
v_lshlrev_b32 v158, 16, v191
v_and_b32 v159, 0xffff0000, v191
v_add_f32 v248, v248, v152
v_add_f32 v249, v249, v153
v_add_f32 v250, v250, v154
v_add_f32 v251, v251, v155
v_add_f32 v252, v252, v156
v_add_f32 v253, v253, v157
v_add_f32 v254, v254, v158
v_add_f32 v255, v255, v159
s_waitcnt vmcnt(15)
v_lshlrev_b32 v152, 16, v192
v_and_b32 v153, 0xffff0000, v192
v_lshlrev_b32 v154, 16, v193
v_and_b32 v155, 0xffff0000, v193
v_lshlrev_b32 v156, 16, v194
v_and_b32 v157, 0xffff0000, v194
v_lshlrev_b32 v158, 16, v195
v_and_b32 v159, 0xffff0000, v195
v_add_f32 v248, v248, v152
v_add_f32 v249, v249, v153
v_add_f32 v250, v250, v154
v_add_f32 v251, v251, v155
v_add_f32 v252, v252, v156
v_add_f32 v253, v253, v157
v_add_f32 v254, v254, v158
v_add_f32 v255, v255, v159
s_waitcnt vmcnt(14)
v_lshlrev_b32 v152, 16, v196
v_and_b32 v153, 0xffff0000, v196
v_lshlrev_b32 v154, 16, v197
v_and_b32 v155, 0xffff0000, v197
v_lshlrev_b32 v156, 16, v198
v_and_b32 v157, 0xffff0000, v198
v_lshlrev_b32 v158, 16, v199
v_and_b32 v159, 0xffff0000, v199
v_add_f32 v248, v248, v152
v_add_f32 v249, v249, v153
v_add_f32 v250, v250, v154
v_add_f32 v251, v251, v155
v_add_f32 v252, v252, v156
v_add_f32 v253, v253, v157
v_add_f32 v254, v254, v158
v_add_f32 v255, v255, v159
s_waitcnt vmcnt(13)
v_lshlrev_b32 v152, 16, v200
v_and_b32 v153, 0xffff0000, v200
v_lshlrev_b32 v154, 16, v201
v_and_b32 v155, 0xffff0000, v201
v_lshlrev_b32 v156, 16, v202
v_and_b32 v157, 0xffff0000, v202
v_lshlrev_b32 v158, 16, v203
v_and_b32 v159, 0xffff0000, v203
v_add_f32 v248, v248, v152
v_add_f32 v249, v249, v153
v_add_f32 v250, v250, v154
v_add_f32 v251, v251, v155
v_add_f32 v252, v252, v156
v_add_f32 v253, v253, v157
v_add_f32 v254, v254, v158
v_add_f32 v255, v255, v159
s_waitcnt vmcnt(12)
v_lshlrev_b32 v152, 16, v204
v_and_b32 v153, 0xffff0000, v204
v_lshlrev_b32 v154, 16, v205
v_and_b32 v155, 0xffff0000, v205
v_lshlrev_b32 v156, 16, v206
v_and_b32 v157, 0xffff0000, v206
v_lshlrev_b32 v158, 16, v207
v_and_b32 v159, 0xffff0000, v207
v_add_f32 v248, v248, v152
v_add_f32 v249, v249, v153
v_add_f32 v250, v250, v154
v_add_f32 v251, v251, v155
v_add_f32 v252, v252, v156
v_add_f32 v253, v253, v157
v_add_f32 v254, v254, v158
v_add_f32 v255, v255, v159
s_waitcnt vmcnt(11)
v_lshlrev_b32 v152, 16, v208
v_and_b32 v153, 0xffff0000, v208
v_lshlrev_b32 v154, 16, v209
v_and_b32 v155, 0xffff0000, v209
v_lshlrev_b32 v156, 16, v210
v_and_b32 v157, 0xffff0000, v210
v_lshlrev_b32 v158, 16, v211
v_and_b32 v159, 0xffff0000, v211
v_add_f32 v248, v248, v152
v_add_f32 v249, v249, v153
v_add_f32 v250, v250, v154
v_add_f32 v251, v251, v155
v_add_f32 v252, v252, v156
v_add_f32 v253, v253, v157
v_add_f32 v254, v254, v158
v_add_f32 v255, v255, v159
s_waitcnt vmcnt(10)
v_lshlrev_b32 v152, 16, v212
v_and_b32 v153, 0xffff0000, v212
v_lshlrev_b32 v154, 16, v213
v_and_b32 v155, 0xffff0000, v213
v_lshlrev_b32 v156, 16, v214
v_and_b32 v157, 0xffff0000, v214
v_lshlrev_b32 v158, 16, v215
v_and_b32 v159, 0xffff0000, v215
v_add_f32 v248, v248, v152
v_add_f32 v249, v249, v153
v_add_f32 v250, v250, v154
v_add_f32 v251, v251, v155
v_add_f32 v252, v252, v156
v_add_f32 v253, v253, v157
v_add_f32 v254, v254, v158
v_add_f32 v255, v255, v159
s_waitcnt vmcnt(9)
v_lshlrev_b32 v152, 16, v216
v_and_b32 v153, 0xffff0000, v216
v_lshlrev_b32 v154, 16, v217
v_and_b32 v155, 0xffff0000, v217
v_lshlrev_b32 v156, 16, v218
v_and_b32 v157, 0xffff0000, v218
v_lshlrev_b32 v158, 16, v219
v_and_b32 v159, 0xffff0000, v219
v_add_f32 v248, v248, v152
v_add_f32 v249, v249, v153
v_add_f32 v250, v250, v154
v_add_f32 v251, v251, v155
v_add_f32 v252, v252, v156
v_add_f32 v253, v253, v157
v_add_f32 v254, v254, v158
v_add_f32 v255, v255, v159
s_waitcnt vmcnt(8)
v_lshlrev_b32 v152, 16, v220
v_and_b32 v153, 0xffff0000, v220
v_lshlrev_b32 v154, 16, v221
v_and_b32 v155, 0xffff0000, v221
v_lshlrev_b32 v156, 16, v222
v_and_b32 v157, 0xffff0000, v222
v_lshlrev_b32 v158, 16, v223
v_and_b32 v159, 0xffff0000, v223
v_add_f32 v248, v248, v152
v_add_f32 v249, v249, v153
v_add_f32 v250, v250, v154
v_add_f32 v251, v251, v155
v_add_f32 v252, v252, v156
v_add_f32 v253, v253, v157
v_add_f32 v254, v254, v158
v_add_f32 v255, v255, v159
s_waitcnt vmcnt(7)
v_lshlrev_b32 v152, 16, v224
v_and_b32 v153, 0xffff0000, v224
v_lshlrev_b32 v154, 16, v225
v_and_b32 v155, 0xffff0000, v225
v_lshlrev_b32 v156, 16, v226
v_and_b32 v157, 0xffff0000, v226
v_lshlrev_b32 v158, 16, v227
v_and_b32 v159, 0xffff0000, v227
v_add_f32 v248, v248, v152
v_add_f32 v249, v249, v153
v_add_f32 v250, v250, v154
v_add_f32 v251, v251, v155
v_add_f32 v252, v252, v156
v_add_f32 v253, v253, v157
v_add_f32 v254, v254, v158
v_add_f32 v255, v255, v159
s_waitcnt vmcnt(6)
v_lshlrev_b32 v152, 16, v228
v_and_b32 v153, 0xffff0000, v228
v_lshlrev_b32 v154, 16, v229
v_and_b32 v155, 0xffff0000, v229
v_lshlrev_b32 v156, 16, v230
v_and_b32 v157, 0xffff0000, v230
v_lshlrev_b32 v158, 16, v231
v_and_b32 v159, 0xffff0000, v231
v_add_f32 v248, v248, v152
v_add_f32 v249, v249, v153
v_add_f32 v250, v250, v154
v_add_f32 v251, v251, v155
v_add_f32 v252, v252, v156
v_add_f32 v253, v253, v157
v_add_f32 v254, v254, v158
v_add_f32 v255, v255, v159
s_waitcnt vmcnt(5)
v_lshlrev_b32 v152, 16, v232
v_and_b32 v153, 0xffff0000, v232
v_lshlrev_b32 v154, 16, v233
v_and_b32 v155, 0xffff0000, v233
v_lshlrev_b32 v156, 16, v234
v_and_b32 v157, 0xffff0000, v234
v_lshlrev_b32 v158, 16, v235
v_and_b32 v159, 0xffff0000, v235
v_add_f32 v248, v248, v152
v_add_f32 v249, v249, v153
v_add_f32 v250, v250, v154
v_add_f32 v251, v251, v155
v_add_f32 v252, v252, v156
v_add_f32 v253, v253, v157
v_add_f32 v254, v254, v158
v_add_f32 v255, v255, v159
s_waitcnt vmcnt(4)
v_lshlrev_b32 v152, 16, v236
v_and_b32 v153, 0xffff0000, v236
v_lshlrev_b32 v154, 16, v237
v_and_b32 v155, 0xffff0000, v237
v_lshlrev_b32 v156, 16, v238
v_and_b32 v157, 0xffff0000, v238
v_lshlrev_b32 v158, 16, v239
v_and_b32 v159, 0xffff0000, v239
v_add_f32 v248, v248, v152
v_add_f32 v249, v249, v153
v_add_f32 v250, v250, v154
v_add_f32 v251, v251, v155
v_add_f32 v252, v252, v156
v_add_f32 v253, v253, v157
v_add_f32 v254, v254, v158
v_add_f32 v255, v255, v159
ds_read_b128 v[36:39], v170 offset:11520
ds_read_b128 v[48:51], v170 offset:11584
v_lshlrev_b32 v152, 16, v8
v_and_b32 v153, 0xffff0000, v8
v_lshlrev_b32 v154, 16, v9
v_and_b32 v155, 0xffff0000, v9
v_lshlrev_b32 v156, 16, v10
v_and_b32 v157, 0xffff0000, v10
v_lshlrev_b32 v158, 16, v11
v_and_b32 v159, 0xffff0000, v11
s_waitcnt lgkmcnt(1)
v_fmac_f32 v152, v248, v36
v_fmac_f32 v153, v249, v37
v_fmac_f32 v154, v250, v38
v_fmac_f32 v155, v251, v39
s_waitcnt lgkmcnt(0)
v_fmac_f32 v156, v252, v48
v_fmac_f32 v157, v253, v49
v_fmac_f32 v158, v254, v50
v_fmac_f32 v159, v255, v51
v_cvt_pk_bf16_f32 v68, v152, v153
v_cvt_pk_bf16_f32 v69, v154, v155
v_cvt_pk_bf16_f32 v70, v156, v157
v_cvt_pk_bf16_f32 v71, v158, v159
buffer_store_dwordx2 v[68:69], v175, s[12:15], s93 offen
buffer_store_dwordx2 v[70:71], v175, s[12:15], s93 offen offset:32
K1_END:
s_endpgm
K1_SPIN0:
s_cmp_eq_u32 s38, 0
s_cbranch_scc1 K1_GOT0
s_sub_u32 s38, s38, 1
s_sleep 1
buffer_load_dword v252, v250, s[16:19], s25 offen sc1
s_waitcnt vmcnt(0)
v_cmp_ne_u32 vcc, 1, v252
s_nop 1
s_cbranch_vccnz K1_SPIN0
s_branch K1_GOT0
K1_SPIN1:
s_cmp_eq_u32 s38, 0
s_cbranch_scc1 K1_GOT1
s_sub_u32 s38, s38, 1
s_sleep 1
buffer_load_dword v252, v250, s[16:19], s29 offen sc1
s_waitcnt vmcnt(0)
v_cmp_ne_u32 vcc, 1, v252
s_nop 1
s_cbranch_vccnz K1_SPIN1
s_branch K1_GOT1
K1_SPIN2:
s_cmp_eq_u32 s38, 0
s_cbranch_scc1 K1_GOT2
s_sub_u32 s38, s38, 1
s_sleep 1
buffer_load_dword v252, v250, s[16:19], s27 offen sc1
s_waitcnt vmcnt(0)
v_cmp_ne_u32 vcc, 1, v252
s_nop 1
s_cbranch_vccnz K1_SPIN2
s_branch K1_GOT2
K1_SPIN4:
s_cmp_eq_u32 s38, 0
s_cbranch_scc1 K1_GOT4
s_sub_u32 s38, s38, 1
s_sleep 1
buffer_load_dword v252, v250, s[16:19], s41 offen sc1
s_waitcnt vmcnt(0)
v_cmp_ne_u32 vcc, 1, v252
s_nop 1
s_cbranch_vccnz K1_SPIN4
s_branch K1_GOT4
K3_SPIN0:
s_cmp_eq_u32 s38, 0
s_cbranch_scc1 K3_GOT0
s_sub_u32 s38, s38, 1
s_sleep 1
buffer_load_dword v171, v22, s[16:19], s25 offen sc1
s_waitcnt vmcnt(0)
v_cmp_ne_u32 vcc, 1, v171
s_nop 1
s_cbranch_vccnz K3_SPIN0
s_branch K3_GOT0
K3_SPIN1:
s_cmp_eq_u32 s38, 0
s_cbranch_scc1 K3_GOT1
s_sub_u32 s38, s38, 1
s_sleep 1
buffer_load_dword v171, v22, s[16:19], s29 offen sc1
s_waitcnt vmcnt(0)
v_cmp_ne_u32 vcc, 1, v171
s_nop 1
s_cbranch_vccnz K3_SPIN1
s_branch K3_GOT1
K3_SPIN2:
s_cmp_eq_u32 s38, 0
s_cbranch_scc1 K3_GOT2
s_sub_u32 s38, s38, 1
s_sleep 1
buffer_load_dword v171, v22, s[16:19], s27 offen sc1
s_waitcnt vmcnt(0)
v_cmp_ne_u32 vcc, 1, v171
s_nop 1
s_cbranch_vccnz K3_SPIN2
s_branch K3_GOT2
K1_STUB0:
s_call_b64 s[46:47], K1_SLOW0
s_branch K1_BACK0
K1_STUB1:
s_call_b64 s[46:47], K1_SLOW1
s_branch K1_BACK1
K1_STUB2:
s_call_b64 s[46:47], K1_SLOW0
s_branch K1_BACK2
K1_STUB3:
s_call_b64 s[46:47], K1_SLOW1
s_branch K1_BACK3
K1_STUB4:
s_call_b64 s[46:47], K1_SLOW0
s_branch K1_BACK4
K1_STUB5:
s_call_b64 s[46:47], K1_SLOW1
s_branch K1_BACK5
K1_STUB6:
s_call_b64 s[46:47], K1_SLOW0
s_branch K1_BACK6
K1_STUB7:
s_call_b64 s[46:47], K1_SLOW1
s_branch K1_BACK7
K1_STUB8:
s_call_b64 s[46:47], K1_SLOW0
s_branch K1_BACK8
K1_STUB9:
s_call_b64 s[46:47], K1_SLOW1
s_branch K1_BACK9
K1_STUB10:
s_call_b64 s[46:47], K1_SLOW0
s_branch K1_BACK10
K1_STUB11:
s_call_b64 s[46:47], K1_SLOW1
s_branch K1_BACK11
K1_STUB12:
s_call_b64 s[46:47], K1_SLOW0
s_branch K1_BACK12
K1_STUB13:
s_call_b64 s[46:47], K1_SLOW1
s_branch K1_BACK13
K1_STUB14:
s_call_b64 s[46:47], K1_SLOW0
s_branch K1_BACK14
K1_STUB15:
s_call_b64 s[46:47], K1_SLOW1
s_branch K1_BACK15
K1_SLOW0:
s_nop 15
v_max3_f32 v248, v24, v25, v26
v_max3_f32 v248, v248, v27, v28
v_max3_f32 v248, v248, v29, v30
v_max_f32 v248, v248, v31
v_mov_b32 v250, v248
s_nop 1
v_permlane16_swap_b32 v248, v250
v_max_f32 v248, v248, v250
v_mov_b32 v250, v248
s_nop 1
v_permlane32_swap_b32 v248, v250
v_max_f32 v248, v248, v250
v_max_f32 v248, 0, v248
v_exp_f32_e64 v249, -v248
s_nop 0
v_mul_f32 v136, v136, v249
v_sub_f32 v120, v120, v248
v_sub_f32 v121, v121, v248
v_sub_f32 v122, v122, v248
v_sub_f32 v123, v123, v248
v_sub_f32 v24, v24, v248
v_sub_f32 v25, v25, v248
v_sub_f32 v26, v26, v248
v_sub_f32 v27, v27, v248
v_sub_f32 v28, v28, v248
v_sub_f32 v29, v29, v248
v_sub_f32 v30, v30, v248
v_sub_f32 v31, v31, v248
v_sub_f32 v56, v56, v248
v_sub_f32 v57, v57, v248
v_sub_f32 v58, v58, v248
v_sub_f32 v59, v59, v248
v_sub_f32 v60, v60, v248
v_sub_f32 v61, v61, v248
v_sub_f32 v62, v62, v248
v_sub_f32 v63, v63, v248
v_accvgpr_read_b32 v252, a0
v_accvgpr_read_b32 v253, a1
v_accvgpr_read_b32 v254, a2
v_accvgpr_read_b32 v255, a3
v_mul_f32 v252, v252, v249
v_mul_f32 v253, v253, v249
v_mul_f32 v254, v254, v249
v_mul_f32 v255, v255, v249
v_accvgpr_write_b32 a0, v252
v_accvgpr_write_b32 a1, v253
v_accvgpr_write_b32 a2, v254
v_accvgpr_write_b32 a3, v255
v_accvgpr_read_b32 v252, a4
v_accvgpr_read_b32 v253, a5
v_accvgpr_read_b32 v254, a6
v_accvgpr_read_b32 v255, a7
v_mul_f32 v252, v252, v249
v_mul_f32 v253, v253, v249
v_mul_f32 v254, v254, v249
v_mul_f32 v255, v255, v249
v_accvgpr_write_b32 a4, v252
v_accvgpr_write_b32 a5, v253
v_accvgpr_write_b32 a6, v254
v_accvgpr_write_b32 a7, v255
v_accvgpr_read_b32 v252, a8
v_accvgpr_read_b32 v253, a9
v_accvgpr_read_b32 v254, a10
v_accvgpr_read_b32 v255, a11
v_mul_f32 v252, v252, v249
v_mul_f32 v253, v253, v249
v_mul_f32 v254, v254, v249
v_mul_f32 v255, v255, v249
v_accvgpr_write_b32 a8, v252
v_accvgpr_write_b32 a9, v253
v_accvgpr_write_b32 a10, v254
v_accvgpr_write_b32 a11, v255
v_accvgpr_read_b32 v252, a12
v_accvgpr_read_b32 v253, a13
v_accvgpr_read_b32 v254, a14
v_accvgpr_read_b32 v255, a15
v_mul_f32 v252, v252, v249
v_mul_f32 v253, v253, v249
v_mul_f32 v254, v254, v249
v_mul_f32 v255, v255, v249
v_accvgpr_write_b32 a12, v252
v_accvgpr_write_b32 a13, v253
v_accvgpr_write_b32 a14, v254
v_accvgpr_write_b32 a15, v255
v_accvgpr_read_b32 v252, a16
v_accvgpr_read_b32 v253, a17
v_accvgpr_read_b32 v254, a18
v_accvgpr_read_b32 v255, a19
v_mul_f32 v252, v252, v249
v_mul_f32 v253, v253, v249
v_mul_f32 v254, v254, v249
v_mul_f32 v255, v255, v249
v_accvgpr_write_b32 a16, v252
v_accvgpr_write_b32 a17, v253
v_accvgpr_write_b32 a18, v254
v_accvgpr_write_b32 a19, v255
v_accvgpr_read_b32 v252, a20
v_accvgpr_read_b32 v253, a21
v_accvgpr_read_b32 v254, a22
v_accvgpr_read_b32 v255, a23
v_mul_f32 v252, v252, v249
v_mul_f32 v253, v253, v249
v_mul_f32 v254, v254, v249
v_mul_f32 v255, v255, v249
v_accvgpr_write_b32 a20, v252
v_accvgpr_write_b32 a21, v253
v_accvgpr_write_b32 a22, v254
v_accvgpr_write_b32 a23, v255
v_accvgpr_read_b32 v252, a24
v_accvgpr_read_b32 v253, a25
v_accvgpr_read_b32 v254, a26
v_accvgpr_read_b32 v255, a27
v_mul_f32 v252, v252, v249
v_mul_f32 v253, v253, v249
v_mul_f32 v254, v254, v249
v_mul_f32 v255, v255, v249
v_accvgpr_write_b32 a24, v252
v_accvgpr_write_b32 a25, v253
v_accvgpr_write_b32 a26, v254
v_accvgpr_write_b32 a27, v255
v_accvgpr_read_b32 v252, a28
v_accvgpr_read_b32 v253, a29
v_accvgpr_read_b32 v254, a30
v_accvgpr_read_b32 v255, a31
v_mul_f32 v252, v252, v249
v_mul_f32 v253, v253, v249
v_mul_f32 v254, v254, v249
v_mul_f32 v255, v255, v249
v_accvgpr_write_b32 a28, v252
v_accvgpr_write_b32 a29, v253
v_accvgpr_write_b32 a30, v254
v_accvgpr_write_b32 a31, v255
v_exp_f32 v144, v24
v_exp_f32 v145, v25
v_exp_f32 v146, v26
v_exp_f32 v147, v27
v_add_f32 v140, v144, v145
v_cvt_pk_bf16_f32 v88, v144, v145
v_add_f32 v140, v140, v146
v_add_f32 v140, v140, v147
v_cvt_pk_bf16_f32 v89, v146, v147
v_exp_f32 v148, v28
v_exp_f32 v149, v29
v_exp_f32 v150, v30
v_exp_f32 v151, v31
v_add_f32 v140, v140, v148
v_add_f32 v140, v140, v149
v_cvt_pk_bf16_f32 v90, v148, v149
v_add_f32 v140, v140, v150
v_add_f32 v140, v140, v151
v_cvt_pk_bf16_f32 v91, v150, v151
v_max3_f32 v248, v32, v33, v34
v_max3_f32 v248, v248, v35, v36
v_max3_f32 v248, v248, v37, v38
v_max_f32 v248, v248, v39
v_mov_b32 v250, v248
s_nop 1
v_permlane16_swap_b32 v248, v250
v_max_f32 v248, v248, v250
v_mov_b32 v250, v248
s_nop 1
v_permlane32_swap_b32 v248, v250
v_max_f32 v248, v248, v250
v_max_f32 v248, 0, v248
v_exp_f32_e64 v249, -v248
s_nop 0
v_mul_f32 v137, v137, v249
v_sub_f32 v124, v124, v248
v_sub_f32 v125, v125, v248
v_sub_f32 v126, v126, v248
v_sub_f32 v127, v127, v248
v_sub_f32 v32, v32, v248
v_sub_f32 v33, v33, v248
v_sub_f32 v34, v34, v248
v_sub_f32 v35, v35, v248
v_sub_f32 v36, v36, v248
v_sub_f32 v37, v37, v248
v_sub_f32 v38, v38, v248
v_sub_f32 v39, v39, v248
v_sub_f32 v64, v64, v248
v_sub_f32 v65, v65, v248
v_sub_f32 v66, v66, v248
v_sub_f32 v67, v67, v248
v_sub_f32 v68, v68, v248
v_sub_f32 v69, v69, v248
v_sub_f32 v70, v70, v248
v_sub_f32 v71, v71, v248
v_accvgpr_read_b32 v252, a32
v_accvgpr_read_b32 v253, a33
v_accvgpr_read_b32 v254, a34
v_accvgpr_read_b32 v255, a35
v_mul_f32 v252, v252, v249
v_mul_f32 v253, v253, v249
v_mul_f32 v254, v254, v249
v_mul_f32 v255, v255, v249
v_accvgpr_write_b32 a32, v252
v_accvgpr_write_b32 a33, v253
v_accvgpr_write_b32 a34, v254
v_accvgpr_write_b32 a35, v255
v_accvgpr_read_b32 v252, a36
v_accvgpr_read_b32 v253, a37
v_accvgpr_read_b32 v254, a38
v_accvgpr_read_b32 v255, a39
v_mul_f32 v252, v252, v249
v_mul_f32 v253, v253, v249
v_mul_f32 v254, v254, v249
v_mul_f32 v255, v255, v249
v_accvgpr_write_b32 a36, v252
v_accvgpr_write_b32 a37, v253
v_accvgpr_write_b32 a38, v254
v_accvgpr_write_b32 a39, v255
v_accvgpr_read_b32 v252, a40
v_accvgpr_read_b32 v253, a41
v_accvgpr_read_b32 v254, a42
v_accvgpr_read_b32 v255, a43
v_mul_f32 v252, v252, v249
v_mul_f32 v253, v253, v249
v_mul_f32 v254, v254, v249
v_mul_f32 v255, v255, v249
v_accvgpr_write_b32 a40, v252
v_accvgpr_write_b32 a41, v253
v_accvgpr_write_b32 a42, v254
v_accvgpr_write_b32 a43, v255
v_accvgpr_read_b32 v252, a44
v_accvgpr_read_b32 v253, a45
v_accvgpr_read_b32 v254, a46
v_accvgpr_read_b32 v255, a47
v_mul_f32 v252, v252, v249
v_mul_f32 v253, v253, v249
v_mul_f32 v254, v254, v249
v_mul_f32 v255, v255, v249
v_accvgpr_write_b32 a44, v252
v_accvgpr_write_b32 a45, v253
v_accvgpr_write_b32 a46, v254
v_accvgpr_write_b32 a47, v255
v_accvgpr_read_b32 v252, a48
v_accvgpr_read_b32 v253, a49
v_accvgpr_read_b32 v254, a50
v_accvgpr_read_b32 v255, a51
v_mul_f32 v252, v252, v249
v_mul_f32 v253, v253, v249
v_mul_f32 v254, v254, v249
v_mul_f32 v255, v255, v249
v_accvgpr_write_b32 a48, v252
v_accvgpr_write_b32 a49, v253
v_accvgpr_write_b32 a50, v254
v_accvgpr_write_b32 a51, v255
v_accvgpr_read_b32 v252, a52
v_accvgpr_read_b32 v253, a53
v_accvgpr_read_b32 v254, a54
v_accvgpr_read_b32 v255, a55
v_mul_f32 v252, v252, v249
v_mul_f32 v253, v253, v249
v_mul_f32 v254, v254, v249
v_mul_f32 v255, v255, v249
v_accvgpr_write_b32 a52, v252
v_accvgpr_write_b32 a53, v253
v_accvgpr_write_b32 a54, v254
v_accvgpr_write_b32 a55, v255
v_accvgpr_read_b32 v252, a56
v_accvgpr_read_b32 v253, a57
v_accvgpr_read_b32 v254, a58
v_accvgpr_read_b32 v255, a59
v_mul_f32 v252, v252, v249
v_mul_f32 v253, v253, v249
v_mul_f32 v254, v254, v249
v_mul_f32 v255, v255, v249
v_accvgpr_write_b32 a56, v252
v_accvgpr_write_b32 a57, v253
v_accvgpr_write_b32 a58, v254
v_accvgpr_write_b32 a59, v255
v_accvgpr_read_b32 v252, a60
v_accvgpr_read_b32 v253, a61
v_accvgpr_read_b32 v254, a62
v_accvgpr_read_b32 v255, a63
v_mul_f32 v252, v252, v249
v_mul_f32 v253, v253, v249
v_mul_f32 v254, v254, v249
v_mul_f32 v255, v255, v249
v_accvgpr_write_b32 a60, v252
v_accvgpr_write_b32 a61, v253
v_accvgpr_write_b32 a62, v254
v_accvgpr_write_b32 a63, v255
v_exp_f32 v144, v32
v_exp_f32 v145, v33
v_exp_f32 v146, v34
v_exp_f32 v147, v35
v_add_f32 v141, v144, v145
v_cvt_pk_bf16_f32 v92, v144, v145
v_add_f32 v141, v141, v146
v_add_f32 v141, v141, v147
v_cvt_pk_bf16_f32 v93, v146, v147
v_exp_f32 v148, v36
v_exp_f32 v149, v37
v_exp_f32 v150, v38
v_exp_f32 v151, v39
v_add_f32 v141, v141, v148
v_add_f32 v141, v141, v149
v_cvt_pk_bf16_f32 v94, v148, v149
v_add_f32 v141, v141, v150
v_add_f32 v141, v141, v151
v_cvt_pk_bf16_f32 v95, v150, v151
v_max3_f32 v248, v40, v41, v42
v_max3_f32 v248, v248, v43, v44
v_max3_f32 v248, v248, v45, v46
v_max_f32 v248, v248, v47
v_mov_b32 v250, v248
s_nop 1
v_permlane16_swap_b32 v248, v250
v_max_f32 v248, v248, v250
v_mov_b32 v250, v248
s_nop 1
v_permlane32_swap_b32 v248, v250
v_max_f32 v248, v248, v250
v_max_f32 v248, 0, v248
v_exp_f32_e64 v249, -v248
s_nop 0
v_mul_f32 v138, v138, v249
v_sub_f32 v128, v128, v248
v_sub_f32 v129, v129, v248
v_sub_f32 v130, v130, v248
v_sub_f32 v131, v131, v248
v_sub_f32 v40, v40, v248
v_sub_f32 v41, v41, v248
v_sub_f32 v42, v42, v248
v_sub_f32 v43, v43, v248
v_sub_f32 v44, v44, v248
v_sub_f32 v45, v45, v248
v_sub_f32 v46, v46, v248
v_sub_f32 v47, v47, v248
v_sub_f32 v72, v72, v248
v_sub_f32 v73, v73, v248
v_sub_f32 v74, v74, v248
v_sub_f32 v75, v75, v248
v_sub_f32 v76, v76, v248
v_sub_f32 v77, v77, v248
v_sub_f32 v78, v78, v248
v_sub_f32 v79, v79, v248
v_accvgpr_read_b32 v252, a64
v_accvgpr_read_b32 v253, a65
v_accvgpr_read_b32 v254, a66
v_accvgpr_read_b32 v255, a67
v_mul_f32 v252, v252, v249
v_mul_f32 v253, v253, v249
v_mul_f32 v254, v254, v249
v_mul_f32 v255, v255, v249
v_accvgpr_write_b32 a64, v252
v_accvgpr_write_b32 a65, v253
v_accvgpr_write_b32 a66, v254
v_accvgpr_write_b32 a67, v255
v_accvgpr_read_b32 v252, a68
v_accvgpr_read_b32 v253, a69
v_accvgpr_read_b32 v254, a70
v_accvgpr_read_b32 v255, a71
v_mul_f32 v252, v252, v249
v_mul_f32 v253, v253, v249
v_mul_f32 v254, v254, v249
v_mul_f32 v255, v255, v249
v_accvgpr_write_b32 a68, v252
v_accvgpr_write_b32 a69, v253
v_accvgpr_write_b32 a70, v254
v_accvgpr_write_b32 a71, v255
v_accvgpr_read_b32 v252, a72
v_accvgpr_read_b32 v253, a73
v_accvgpr_read_b32 v254, a74
v_accvgpr_read_b32 v255, a75
v_mul_f32 v252, v252, v249
v_mul_f32 v253, v253, v249
v_mul_f32 v254, v254, v249
v_mul_f32 v255, v255, v249
v_accvgpr_write_b32 a72, v252
v_accvgpr_write_b32 a73, v253
v_accvgpr_write_b32 a74, v254
v_accvgpr_write_b32 a75, v255
v_accvgpr_read_b32 v252, a76
v_accvgpr_read_b32 v253, a77
v_accvgpr_read_b32 v254, a78
v_accvgpr_read_b32 v255, a79
v_mul_f32 v252, v252, v249
v_mul_f32 v253, v253, v249
v_mul_f32 v254, v254, v249
v_mul_f32 v255, v255, v249
v_accvgpr_write_b32 a76, v252
v_accvgpr_write_b32 a77, v253
v_accvgpr_write_b32 a78, v254
v_accvgpr_write_b32 a79, v255
v_accvgpr_read_b32 v252, a80
v_accvgpr_read_b32 v253, a81
v_accvgpr_read_b32 v254, a82
v_accvgpr_read_b32 v255, a83
v_mul_f32 v252, v252, v249
v_mul_f32 v253, v253, v249
v_mul_f32 v254, v254, v249
v_mul_f32 v255, v255, v249
v_accvgpr_write_b32 a80, v252
v_accvgpr_write_b32 a81, v253
v_accvgpr_write_b32 a82, v254
v_accvgpr_write_b32 a83, v255
v_accvgpr_read_b32 v252, a84
v_accvgpr_read_b32 v253, a85
v_accvgpr_read_b32 v254, a86
v_accvgpr_read_b32 v255, a87
v_mul_f32 v252, v252, v249
v_mul_f32 v253, v253, v249
v_mul_f32 v254, v254, v249
v_mul_f32 v255, v255, v249
v_accvgpr_write_b32 a84, v252
v_accvgpr_write_b32 a85, v253
v_accvgpr_write_b32 a86, v254
v_accvgpr_write_b32 a87, v255
v_accvgpr_read_b32 v252, a88
v_accvgpr_read_b32 v253, a89
v_accvgpr_read_b32 v254, a90
v_accvgpr_read_b32 v255, a91
v_mul_f32 v252, v252, v249
v_mul_f32 v253, v253, v249
v_mul_f32 v254, v254, v249
v_mul_f32 v255, v255, v249
v_accvgpr_write_b32 a88, v252
v_accvgpr_write_b32 a89, v253
v_accvgpr_write_b32 a90, v254
v_accvgpr_write_b32 a91, v255
v_accvgpr_read_b32 v252, a92
v_accvgpr_read_b32 v253, a93
v_accvgpr_read_b32 v254, a94
v_accvgpr_read_b32 v255, a95
v_mul_f32 v252, v252, v249
v_mul_f32 v253, v253, v249
v_mul_f32 v254, v254, v249
v_mul_f32 v255, v255, v249
v_accvgpr_write_b32 a92, v252
v_accvgpr_write_b32 a93, v253
v_accvgpr_write_b32 a94, v254
v_accvgpr_write_b32 a95, v255
v_exp_f32 v144, v40
v_exp_f32 v145, v41
v_exp_f32 v146, v42
v_exp_f32 v147, v43
v_add_f32 v142, v144, v145
v_cvt_pk_bf16_f32 v96, v144, v145
v_add_f32 v142, v142, v146
v_add_f32 v142, v142, v147
v_cvt_pk_bf16_f32 v97, v146, v147
v_exp_f32 v148, v44
v_exp_f32 v149, v45
v_exp_f32 v150, v46
v_exp_f32 v151, v47
v_add_f32 v142, v142, v148
v_add_f32 v142, v142, v149
v_cvt_pk_bf16_f32 v98, v148, v149
v_add_f32 v142, v142, v150
v_add_f32 v142, v142, v151
v_cvt_pk_bf16_f32 v99, v150, v151
v_max3_f32 v248, v48, v49, v50
v_max3_f32 v248, v248, v51, v52
v_max3_f32 v248, v248, v53, v54
v_max_f32 v248, v248, v55
v_mov_b32 v250, v248
s_nop 1
v_permlane16_swap_b32 v248, v250
v_max_f32 v248, v248, v250
v_mov_b32 v250, v248
s_nop 1
v_permlane32_swap_b32 v248, v250
v_max_f32 v248, v248, v250
v_max_f32 v248, 0, v248
v_exp_f32_e64 v249, -v248
s_nop 0
v_mul_f32 v139, v139, v249
v_sub_f32 v132, v132, v248
v_sub_f32 v133, v133, v248
v_sub_f32 v134, v134, v248
v_sub_f32 v135, v135, v248
v_sub_f32 v48, v48, v248
v_sub_f32 v49, v49, v248
v_sub_f32 v50, v50, v248
v_sub_f32 v51, v51, v248
v_sub_f32 v52, v52, v248
v_sub_f32 v53, v53, v248
v_sub_f32 v54, v54, v248
v_sub_f32 v55, v55, v248
v_sub_f32 v80, v80, v248
v_sub_f32 v81, v81, v248
v_sub_f32 v82, v82, v248
v_sub_f32 v83, v83, v248
v_sub_f32 v84, v84, v248
v_sub_f32 v85, v85, v248
v_sub_f32 v86, v86, v248
v_sub_f32 v87, v87, v248
v_accvgpr_read_b32 v252, a96
v_accvgpr_read_b32 v253, a97
v_accvgpr_read_b32 v254, a98
v_accvgpr_read_b32 v255, a99
v_mul_f32 v252, v252, v249
v_mul_f32 v253, v253, v249
v_mul_f32 v254, v254, v249
v_mul_f32 v255, v255, v249
v_accvgpr_write_b32 a96, v252
v_accvgpr_write_b32 a97, v253
v_accvgpr_write_b32 a98, v254
v_accvgpr_write_b32 a99, v255
v_accvgpr_read_b32 v252, a100
v_accvgpr_read_b32 v253, a101
v_accvgpr_read_b32 v254, a102
v_accvgpr_read_b32 v255, a103
v_mul_f32 v252, v252, v249
v_mul_f32 v253, v253, v249
v_mul_f32 v254, v254, v249
v_mul_f32 v255, v255, v249
v_accvgpr_write_b32 a100, v252
v_accvgpr_write_b32 a101, v253
v_accvgpr_write_b32 a102, v254
v_accvgpr_write_b32 a103, v255
v_accvgpr_read_b32 v252, a104
v_accvgpr_read_b32 v253, a105
v_accvgpr_read_b32 v254, a106
v_accvgpr_read_b32 v255, a107
v_mul_f32 v252, v252, v249
v_mul_f32 v253, v253, v249
v_mul_f32 v254, v254, v249
v_mul_f32 v255, v255, v249
v_accvgpr_write_b32 a104, v252
v_accvgpr_write_b32 a105, v253
v_accvgpr_write_b32 a106, v254
v_accvgpr_write_b32 a107, v255
v_accvgpr_read_b32 v252, a108
v_accvgpr_read_b32 v253, a109
v_accvgpr_read_b32 v254, a110
v_accvgpr_read_b32 v255, a111
v_mul_f32 v252, v252, v249
v_mul_f32 v253, v253, v249
v_mul_f32 v254, v254, v249
v_mul_f32 v255, v255, v249
v_accvgpr_write_b32 a108, v252
v_accvgpr_write_b32 a109, v253
v_accvgpr_write_b32 a110, v254
v_accvgpr_write_b32 a111, v255
v_accvgpr_read_b32 v252, a112
v_accvgpr_read_b32 v253, a113
v_accvgpr_read_b32 v254, a114
v_accvgpr_read_b32 v255, a115
v_mul_f32 v252, v252, v249
v_mul_f32 v253, v253, v249
v_mul_f32 v254, v254, v249
v_mul_f32 v255, v255, v249
v_accvgpr_write_b32 a112, v252
v_accvgpr_write_b32 a113, v253
v_accvgpr_write_b32 a114, v254
v_accvgpr_write_b32 a115, v255
v_accvgpr_read_b32 v252, a116
v_accvgpr_read_b32 v253, a117
v_accvgpr_read_b32 v254, a118
v_accvgpr_read_b32 v255, a119
v_mul_f32 v252, v252, v249
v_mul_f32 v253, v253, v249
v_mul_f32 v254, v254, v249
v_mul_f32 v255, v255, v249
v_accvgpr_write_b32 a116, v252
v_accvgpr_write_b32 a117, v253
v_accvgpr_write_b32 a118, v254
v_accvgpr_write_b32 a119, v255
v_accvgpr_read_b32 v252, a120
v_accvgpr_read_b32 v253, a121
v_accvgpr_read_b32 v254, a122
v_accvgpr_read_b32 v255, a123
v_mul_f32 v252, v252, v249
v_mul_f32 v253, v253, v249
v_mul_f32 v254, v254, v249
v_mul_f32 v255, v255, v249
v_accvgpr_write_b32 a120, v252
v_accvgpr_write_b32 a121, v253
v_accvgpr_write_b32 a122, v254
v_accvgpr_write_b32 a123, v255
v_accvgpr_read_b32 v252, a124
v_accvgpr_read_b32 v253, a125
v_accvgpr_read_b32 v254, a126
v_accvgpr_read_b32 v255, a127
v_mul_f32 v252, v252, v249
v_mul_f32 v253, v253, v249
v_mul_f32 v254, v254, v249
v_mul_f32 v255, v255, v249
v_accvgpr_write_b32 a124, v252
v_accvgpr_write_b32 a125, v253
v_accvgpr_write_b32 a126, v254
v_accvgpr_write_b32 a127, v255
v_exp_f32 v144, v48
v_exp_f32 v145, v49
v_exp_f32 v146, v50
v_exp_f32 v147, v51
v_add_f32 v143, v144, v145
v_cvt_pk_bf16_f32 v100, v144, v145
v_add_f32 v143, v143, v146
v_add_f32 v143, v143, v147
v_cvt_pk_bf16_f32 v101, v146, v147
v_exp_f32 v148, v52
v_exp_f32 v149, v53
v_exp_f32 v150, v54
v_exp_f32 v151, v55
v_add_f32 v143, v143, v148
v_add_f32 v143, v143, v149
v_cvt_pk_bf16_f32 v102, v148, v149
v_add_f32 v143, v143, v150
v_add_f32 v143, v143, v151
v_cvt_pk_bf16_f32 v103, v150, v151
s_nop 7
s_setpc_b64 s[46:47]
K1_SLOW1:
s_nop 15
v_max3_f32 v248, v56, v57, v58
v_max3_f32 v248, v248, v59, v60
v_max3_f32 v248, v248, v61, v62
v_max_f32 v248, v248, v63
v_mov_b32 v250, v248
s_nop 1
v_permlane16_swap_b32 v248, v250
v_max_f32 v248, v248, v250
v_mov_b32 v250, v248
s_nop 1
v_permlane32_swap_b32 v248, v250
v_max_f32 v248, v248, v250
v_max_f32 v248, 0, v248
v_exp_f32_e64 v249, -v248
s_nop 0
v_mul_f32 v136, v136, v249
v_sub_f32 v120, v120, v248
v_sub_f32 v121, v121, v248
v_sub_f32 v122, v122, v248
v_sub_f32 v123, v123, v248
v_sub_f32 v24, v24, v248
v_sub_f32 v25, v25, v248
v_sub_f32 v26, v26, v248
v_sub_f32 v27, v27, v248
v_sub_f32 v28, v28, v248
v_sub_f32 v29, v29, v248
v_sub_f32 v30, v30, v248
v_sub_f32 v31, v31, v248
v_sub_f32 v56, v56, v248
v_sub_f32 v57, v57, v248
v_sub_f32 v58, v58, v248
v_sub_f32 v59, v59, v248
v_sub_f32 v60, v60, v248
v_sub_f32 v61, v61, v248
v_sub_f32 v62, v62, v248
v_sub_f32 v63, v63, v248
v_accvgpr_read_b32 v252, a0
v_accvgpr_read_b32 v253, a1
v_accvgpr_read_b32 v254, a2
v_accvgpr_read_b32 v255, a3
v_mul_f32 v252, v252, v249
v_mul_f32 v253, v253, v249
v_mul_f32 v254, v254, v249
v_mul_f32 v255, v255, v249
v_accvgpr_write_b32 a0, v252
v_accvgpr_write_b32 a1, v253
v_accvgpr_write_b32 a2, v254
v_accvgpr_write_b32 a3, v255
v_accvgpr_read_b32 v252, a4
v_accvgpr_read_b32 v253, a5
v_accvgpr_read_b32 v254, a6
v_accvgpr_read_b32 v255, a7
v_mul_f32 v252, v252, v249
v_mul_f32 v253, v253, v249
v_mul_f32 v254, v254, v249
v_mul_f32 v255, v255, v249
v_accvgpr_write_b32 a4, v252
v_accvgpr_write_b32 a5, v253
v_accvgpr_write_b32 a6, v254
v_accvgpr_write_b32 a7, v255
v_accvgpr_read_b32 v252, a8
v_accvgpr_read_b32 v253, a9
v_accvgpr_read_b32 v254, a10
v_accvgpr_read_b32 v255, a11
v_mul_f32 v252, v252, v249
v_mul_f32 v253, v253, v249
v_mul_f32 v254, v254, v249
v_mul_f32 v255, v255, v249
v_accvgpr_write_b32 a8, v252
v_accvgpr_write_b32 a9, v253
v_accvgpr_write_b32 a10, v254
v_accvgpr_write_b32 a11, v255
v_accvgpr_read_b32 v252, a12
v_accvgpr_read_b32 v253, a13
v_accvgpr_read_b32 v254, a14
v_accvgpr_read_b32 v255, a15
v_mul_f32 v252, v252, v249
v_mul_f32 v253, v253, v249
v_mul_f32 v254, v254, v249
v_mul_f32 v255, v255, v249
v_accvgpr_write_b32 a12, v252
v_accvgpr_write_b32 a13, v253
v_accvgpr_write_b32 a14, v254
v_accvgpr_write_b32 a15, v255
v_accvgpr_read_b32 v252, a16
v_accvgpr_read_b32 v253, a17
v_accvgpr_read_b32 v254, a18
v_accvgpr_read_b32 v255, a19
v_mul_f32 v252, v252, v249
v_mul_f32 v253, v253, v249
v_mul_f32 v254, v254, v249
v_mul_f32 v255, v255, v249
v_accvgpr_write_b32 a16, v252
v_accvgpr_write_b32 a17, v253
v_accvgpr_write_b32 a18, v254
v_accvgpr_write_b32 a19, v255
v_accvgpr_read_b32 v252, a20
v_accvgpr_read_b32 v253, a21
v_accvgpr_read_b32 v254, a22
v_accvgpr_read_b32 v255, a23
v_mul_f32 v252, v252, v249
v_mul_f32 v253, v253, v249
v_mul_f32 v254, v254, v249
v_mul_f32 v255, v255, v249
v_accvgpr_write_b32 a20, v252
v_accvgpr_write_b32 a21, v253
v_accvgpr_write_b32 a22, v254
v_accvgpr_write_b32 a23, v255
v_accvgpr_read_b32 v252, a24
v_accvgpr_read_b32 v253, a25
v_accvgpr_read_b32 v254, a26
v_accvgpr_read_b32 v255, a27
v_mul_f32 v252, v252, v249
v_mul_f32 v253, v253, v249
v_mul_f32 v254, v254, v249
v_mul_f32 v255, v255, v249
v_accvgpr_write_b32 a24, v252
v_accvgpr_write_b32 a25, v253
v_accvgpr_write_b32 a26, v254
v_accvgpr_write_b32 a27, v255
v_accvgpr_read_b32 v252, a28
v_accvgpr_read_b32 v253, a29
v_accvgpr_read_b32 v254, a30
v_accvgpr_read_b32 v255, a31
v_mul_f32 v252, v252, v249
v_mul_f32 v253, v253, v249
v_mul_f32 v254, v254, v249
v_mul_f32 v255, v255, v249
v_accvgpr_write_b32 a28, v252
v_accvgpr_write_b32 a29, v253
v_accvgpr_write_b32 a30, v254
v_accvgpr_write_b32 a31, v255
v_exp_f32 v144, v56
v_exp_f32 v145, v57
v_exp_f32 v146, v58
v_exp_f32 v147, v59
v_add_f32 v140, v144, v145
v_cvt_pk_bf16_f32 v104, v144, v145
v_add_f32 v140, v140, v146
v_add_f32 v140, v140, v147
v_cvt_pk_bf16_f32 v105, v146, v147
v_exp_f32 v148, v60
v_exp_f32 v149, v61
v_exp_f32 v150, v62
v_exp_f32 v151, v63
v_add_f32 v140, v140, v148
v_add_f32 v140, v140, v149
v_cvt_pk_bf16_f32 v106, v148, v149
v_add_f32 v140, v140, v150
v_add_f32 v140, v140, v151
v_cvt_pk_bf16_f32 v107, v150, v151
v_max3_f32 v248, v64, v65, v66
v_max3_f32 v248, v248, v67, v68
v_max3_f32 v248, v248, v69, v70
v_max_f32 v248, v248, v71
v_mov_b32 v250, v248
s_nop 1
v_permlane16_swap_b32 v248, v250
v_max_f32 v248, v248, v250
v_mov_b32 v250, v248
s_nop 1
v_permlane32_swap_b32 v248, v250
v_max_f32 v248, v248, v250
v_max_f32 v248, 0, v248
v_exp_f32_e64 v249, -v248
s_nop 0
v_mul_f32 v137, v137, v249
v_sub_f32 v124, v124, v248
v_sub_f32 v125, v125, v248
v_sub_f32 v126, v126, v248
v_sub_f32 v127, v127, v248
v_sub_f32 v32, v32, v248
v_sub_f32 v33, v33, v248
v_sub_f32 v34, v34, v248
v_sub_f32 v35, v35, v248
v_sub_f32 v36, v36, v248
v_sub_f32 v37, v37, v248
v_sub_f32 v38, v38, v248
v_sub_f32 v39, v39, v248
v_sub_f32 v64, v64, v248
v_sub_f32 v65, v65, v248
v_sub_f32 v66, v66, v248
v_sub_f32 v67, v67, v248
v_sub_f32 v68, v68, v248
v_sub_f32 v69, v69, v248
v_sub_f32 v70, v70, v248
v_sub_f32 v71, v71, v248
v_accvgpr_read_b32 v252, a32
v_accvgpr_read_b32 v253, a33
v_accvgpr_read_b32 v254, a34
v_accvgpr_read_b32 v255, a35
v_mul_f32 v252, v252, v249
v_mul_f32 v253, v253, v249
v_mul_f32 v254, v254, v249
v_mul_f32 v255, v255, v249
v_accvgpr_write_b32 a32, v252
v_accvgpr_write_b32 a33, v253
v_accvgpr_write_b32 a34, v254
v_accvgpr_write_b32 a35, v255
v_accvgpr_read_b32 v252, a36
v_accvgpr_read_b32 v253, a37
v_accvgpr_read_b32 v254, a38
v_accvgpr_read_b32 v255, a39
v_mul_f32 v252, v252, v249
v_mul_f32 v253, v253, v249
v_mul_f32 v254, v254, v249
v_mul_f32 v255, v255, v249
v_accvgpr_write_b32 a36, v252
v_accvgpr_write_b32 a37, v253
v_accvgpr_write_b32 a38, v254
v_accvgpr_write_b32 a39, v255
v_accvgpr_read_b32 v252, a40
v_accvgpr_read_b32 v253, a41
v_accvgpr_read_b32 v254, a42
v_accvgpr_read_b32 v255, a43
v_mul_f32 v252, v252, v249
v_mul_f32 v253, v253, v249
v_mul_f32 v254, v254, v249
v_mul_f32 v255, v255, v249
v_accvgpr_write_b32 a40, v252
v_accvgpr_write_b32 a41, v253
v_accvgpr_write_b32 a42, v254
v_accvgpr_write_b32 a43, v255
v_accvgpr_read_b32 v252, a44
v_accvgpr_read_b32 v253, a45
v_accvgpr_read_b32 v254, a46
v_accvgpr_read_b32 v255, a47
v_mul_f32 v252, v252, v249
v_mul_f32 v253, v253, v249
v_mul_f32 v254, v254, v249
v_mul_f32 v255, v255, v249
v_accvgpr_write_b32 a44, v252
v_accvgpr_write_b32 a45, v253
v_accvgpr_write_b32 a46, v254
v_accvgpr_write_b32 a47, v255
v_accvgpr_read_b32 v252, a48
v_accvgpr_read_b32 v253, a49
v_accvgpr_read_b32 v254, a50
v_accvgpr_read_b32 v255, a51
v_mul_f32 v252, v252, v249
v_mul_f32 v253, v253, v249
v_mul_f32 v254, v254, v249
v_mul_f32 v255, v255, v249
v_accvgpr_write_b32 a48, v252
v_accvgpr_write_b32 a49, v253
v_accvgpr_write_b32 a50, v254
v_accvgpr_write_b32 a51, v255
v_accvgpr_read_b32 v252, a52
v_accvgpr_read_b32 v253, a53
v_accvgpr_read_b32 v254, a54
v_accvgpr_read_b32 v255, a55
v_mul_f32 v252, v252, v249
v_mul_f32 v253, v253, v249
v_mul_f32 v254, v254, v249
v_mul_f32 v255, v255, v249
v_accvgpr_write_b32 a52, v252
v_accvgpr_write_b32 a53, v253
v_accvgpr_write_b32 a54, v254
v_accvgpr_write_b32 a55, v255
v_accvgpr_read_b32 v252, a56
v_accvgpr_read_b32 v253, a57
v_accvgpr_read_b32 v254, a58
v_accvgpr_read_b32 v255, a59
v_mul_f32 v252, v252, v249
v_mul_f32 v253, v253, v249
v_mul_f32 v254, v254, v249
v_mul_f32 v255, v255, v249
v_accvgpr_write_b32 a56, v252
v_accvgpr_write_b32 a57, v253
v_accvgpr_write_b32 a58, v254
v_accvgpr_write_b32 a59, v255
v_accvgpr_read_b32 v252, a60
v_accvgpr_read_b32 v253, a61
v_accvgpr_read_b32 v254, a62
v_accvgpr_read_b32 v255, a63
v_mul_f32 v252, v252, v249
v_mul_f32 v253, v253, v249
v_mul_f32 v254, v254, v249
v_mul_f32 v255, v255, v249
v_accvgpr_write_b32 a60, v252
v_accvgpr_write_b32 a61, v253
v_accvgpr_write_b32 a62, v254
v_accvgpr_write_b32 a63, v255
v_exp_f32 v144, v64
v_exp_f32 v145, v65
v_exp_f32 v146, v66
v_exp_f32 v147, v67
v_add_f32 v141, v144, v145
v_cvt_pk_bf16_f32 v108, v144, v145
v_add_f32 v141, v141, v146
v_add_f32 v141, v141, v147
v_cvt_pk_bf16_f32 v109, v146, v147
v_exp_f32 v148, v68
v_exp_f32 v149, v69
v_exp_f32 v150, v70
v_exp_f32 v151, v71
v_add_f32 v141, v141, v148
v_add_f32 v141, v141, v149
v_cvt_pk_bf16_f32 v110, v148, v149
v_add_f32 v141, v141, v150
v_add_f32 v141, v141, v151
v_cvt_pk_bf16_f32 v111, v150, v151
v_max3_f32 v248, v72, v73, v74
v_max3_f32 v248, v248, v75, v76
v_max3_f32 v248, v248, v77, v78
v_max_f32 v248, v248, v79
v_mov_b32 v250, v248
s_nop 1
v_permlane16_swap_b32 v248, v250
v_max_f32 v248, v248, v250
v_mov_b32 v250, v248
s_nop 1
v_permlane32_swap_b32 v248, v250
v_max_f32 v248, v248, v250
v_max_f32 v248, 0, v248
v_exp_f32_e64 v249, -v248
s_nop 0
v_mul_f32 v138, v138, v249
v_sub_f32 v128, v128, v248
v_sub_f32 v129, v129, v248
v_sub_f32 v130, v130, v248
v_sub_f32 v131, v131, v248
v_sub_f32 v40, v40, v248
v_sub_f32 v41, v41, v248
v_sub_f32 v42, v42, v248
v_sub_f32 v43, v43, v248
v_sub_f32 v44, v44, v248
v_sub_f32 v45, v45, v248
v_sub_f32 v46, v46, v248
v_sub_f32 v47, v47, v248
v_sub_f32 v72, v72, v248
v_sub_f32 v73, v73, v248
v_sub_f32 v74, v74, v248
v_sub_f32 v75, v75, v248
v_sub_f32 v76, v76, v248
v_sub_f32 v77, v77, v248
v_sub_f32 v78, v78, v248
v_sub_f32 v79, v79, v248
v_accvgpr_read_b32 v252, a64
v_accvgpr_read_b32 v253, a65
v_accvgpr_read_b32 v254, a66
v_accvgpr_read_b32 v255, a67
v_mul_f32 v252, v252, v249
v_mul_f32 v253, v253, v249
v_mul_f32 v254, v254, v249
v_mul_f32 v255, v255, v249
v_accvgpr_write_b32 a64, v252
v_accvgpr_write_b32 a65, v253
v_accvgpr_write_b32 a66, v254
v_accvgpr_write_b32 a67, v255
v_accvgpr_read_b32 v252, a68
v_accvgpr_read_b32 v253, a69
v_accvgpr_read_b32 v254, a70
v_accvgpr_read_b32 v255, a71
v_mul_f32 v252, v252, v249
v_mul_f32 v253, v253, v249
v_mul_f32 v254, v254, v249
v_mul_f32 v255, v255, v249
v_accvgpr_write_b32 a68, v252
v_accvgpr_write_b32 a69, v253
v_accvgpr_write_b32 a70, v254
v_accvgpr_write_b32 a71, v255
v_accvgpr_read_b32 v252, a72
v_accvgpr_read_b32 v253, a73
v_accvgpr_read_b32 v254, a74
v_accvgpr_read_b32 v255, a75
v_mul_f32 v252, v252, v249
v_mul_f32 v253, v253, v249
v_mul_f32 v254, v254, v249
v_mul_f32 v255, v255, v249
v_accvgpr_write_b32 a72, v252
v_accvgpr_write_b32 a73, v253
v_accvgpr_write_b32 a74, v254
v_accvgpr_write_b32 a75, v255
v_accvgpr_read_b32 v252, a76
v_accvgpr_read_b32 v253, a77
v_accvgpr_read_b32 v254, a78
v_accvgpr_read_b32 v255, a79
v_mul_f32 v252, v252, v249
v_mul_f32 v253, v253, v249
v_mul_f32 v254, v254, v249
v_mul_f32 v255, v255, v249
v_accvgpr_write_b32 a76, v252
v_accvgpr_write_b32 a77, v253
v_accvgpr_write_b32 a78, v254
v_accvgpr_write_b32 a79, v255
v_accvgpr_read_b32 v252, a80
v_accvgpr_read_b32 v253, a81
v_accvgpr_read_b32 v254, a82
v_accvgpr_read_b32 v255, a83
v_mul_f32 v252, v252, v249
v_mul_f32 v253, v253, v249
v_mul_f32 v254, v254, v249
v_mul_f32 v255, v255, v249
v_accvgpr_write_b32 a80, v252
v_accvgpr_write_b32 a81, v253
v_accvgpr_write_b32 a82, v254
v_accvgpr_write_b32 a83, v255
v_accvgpr_read_b32 v252, a84
v_accvgpr_read_b32 v253, a85
v_accvgpr_read_b32 v254, a86
v_accvgpr_read_b32 v255, a87
v_mul_f32 v252, v252, v249
v_mul_f32 v253, v253, v249
v_mul_f32 v254, v254, v249
v_mul_f32 v255, v255, v249
v_accvgpr_write_b32 a84, v252
v_accvgpr_write_b32 a85, v253
v_accvgpr_write_b32 a86, v254
v_accvgpr_write_b32 a87, v255
v_accvgpr_read_b32 v252, a88
v_accvgpr_read_b32 v253, a89
v_accvgpr_read_b32 v254, a90
v_accvgpr_read_b32 v255, a91
v_mul_f32 v252, v252, v249
v_mul_f32 v253, v253, v249
v_mul_f32 v254, v254, v249
v_mul_f32 v255, v255, v249
v_accvgpr_write_b32 a88, v252
v_accvgpr_write_b32 a89, v253
v_accvgpr_write_b32 a90, v254
v_accvgpr_write_b32 a91, v255
v_accvgpr_read_b32 v252, a92
v_accvgpr_read_b32 v253, a93
v_accvgpr_read_b32 v254, a94
v_accvgpr_read_b32 v255, a95
v_mul_f32 v252, v252, v249
v_mul_f32 v253, v253, v249
v_mul_f32 v254, v254, v249
v_mul_f32 v255, v255, v249
v_accvgpr_write_b32 a92, v252
v_accvgpr_write_b32 a93, v253
v_accvgpr_write_b32 a94, v254
v_accvgpr_write_b32 a95, v255
v_exp_f32 v144, v72
v_exp_f32 v145, v73
v_exp_f32 v146, v74
v_exp_f32 v147, v75
v_add_f32 v142, v144, v145
v_cvt_pk_bf16_f32 v112, v144, v145
v_add_f32 v142, v142, v146
v_add_f32 v142, v142, v147
v_cvt_pk_bf16_f32 v113, v146, v147
v_exp_f32 v148, v76
v_exp_f32 v149, v77
v_exp_f32 v150, v78
v_exp_f32 v151, v79
v_add_f32 v142, v142, v148
v_add_f32 v142, v142, v149
v_cvt_pk_bf16_f32 v114, v148, v149
v_add_f32 v142, v142, v150
v_add_f32 v142, v142, v151
v_cvt_pk_bf16_f32 v115, v150, v151
v_max3_f32 v248, v80, v81, v82
v_max3_f32 v248, v248, v83, v84
v_max3_f32 v248, v248, v85, v86
v_max_f32 v248, v248, v87
v_mov_b32 v250, v248
s_nop 1
v_permlane16_swap_b32 v248, v250
v_max_f32 v248, v248, v250
v_mov_b32 v250, v248
s_nop 1
v_permlane32_swap_b32 v248, v250
v_max_f32 v248, v248, v250
v_max_f32 v248, 0, v248
v_exp_f32_e64 v249, -v248
s_nop 0
v_mul_f32 v139, v139, v249
v_sub_f32 v132, v132, v248
v_sub_f32 v133, v133, v248
v_sub_f32 v134, v134, v248
v_sub_f32 v135, v135, v248
v_sub_f32 v48, v48, v248
v_sub_f32 v49, v49, v248
v_sub_f32 v50, v50, v248
v_sub_f32 v51, v51, v248
v_sub_f32 v52, v52, v248
v_sub_f32 v53, v53, v248
v_sub_f32 v54, v54, v248
v_sub_f32 v55, v55, v248
v_sub_f32 v80, v80, v248
v_sub_f32 v81, v81, v248
v_sub_f32 v82, v82, v248
v_sub_f32 v83, v83, v248
v_sub_f32 v84, v84, v248
v_sub_f32 v85, v85, v248
v_sub_f32 v86, v86, v248
v_sub_f32 v87, v87, v248
v_accvgpr_read_b32 v252, a96
v_accvgpr_read_b32 v253, a97
v_accvgpr_read_b32 v254, a98
v_accvgpr_read_b32 v255, a99
v_mul_f32 v252, v252, v249
v_mul_f32 v253, v253, v249
v_mul_f32 v254, v254, v249
v_mul_f32 v255, v255, v249
v_accvgpr_write_b32 a96, v252
v_accvgpr_write_b32 a97, v253
v_accvgpr_write_b32 a98, v254
v_accvgpr_write_b32 a99, v255
v_accvgpr_read_b32 v252, a100
v_accvgpr_read_b32 v253, a101
v_accvgpr_read_b32 v254, a102
v_accvgpr_read_b32 v255, a103
v_mul_f32 v252, v252, v249
v_mul_f32 v253, v253, v249
v_mul_f32 v254, v254, v249
v_mul_f32 v255, v255, v249
v_accvgpr_write_b32 a100, v252
v_accvgpr_write_b32 a101, v253
v_accvgpr_write_b32 a102, v254
v_accvgpr_write_b32 a103, v255
v_accvgpr_read_b32 v252, a104
v_accvgpr_read_b32 v253, a105
v_accvgpr_read_b32 v254, a106
v_accvgpr_read_b32 v255, a107
v_mul_f32 v252, v252, v249
v_mul_f32 v253, v253, v249
v_mul_f32 v254, v254, v249
v_mul_f32 v255, v255, v249
v_accvgpr_write_b32 a104, v252
v_accvgpr_write_b32 a105, v253
v_accvgpr_write_b32 a106, v254
v_accvgpr_write_b32 a107, v255
v_accvgpr_read_b32 v252, a108
v_accvgpr_read_b32 v253, a109
v_accvgpr_read_b32 v254, a110
v_accvgpr_read_b32 v255, a111
v_mul_f32 v252, v252, v249
v_mul_f32 v253, v253, v249
v_mul_f32 v254, v254, v249
v_mul_f32 v255, v255, v249
v_accvgpr_write_b32 a108, v252
v_accvgpr_write_b32 a109, v253
v_accvgpr_write_b32 a110, v254
v_accvgpr_write_b32 a111, v255
v_accvgpr_read_b32 v252, a112
v_accvgpr_read_b32 v253, a113
v_accvgpr_read_b32 v254, a114
v_accvgpr_read_b32 v255, a115
v_mul_f32 v252, v252, v249
v_mul_f32 v253, v253, v249
v_mul_f32 v254, v254, v249
v_mul_f32 v255, v255, v249
v_accvgpr_write_b32 a112, v252
v_accvgpr_write_b32 a113, v253
v_accvgpr_write_b32 a114, v254
v_accvgpr_write_b32 a115, v255
v_accvgpr_read_b32 v252, a116
v_accvgpr_read_b32 v253, a117
v_accvgpr_read_b32 v254, a118
v_accvgpr_read_b32 v255, a119
v_mul_f32 v252, v252, v249
v_mul_f32 v253, v253, v249
v_mul_f32 v254, v254, v249
v_mul_f32 v255, v255, v249
v_accvgpr_write_b32 a116, v252
v_accvgpr_write_b32 a117, v253
v_accvgpr_write_b32 a118, v254
v_accvgpr_write_b32 a119, v255
v_accvgpr_read_b32 v252, a120
v_accvgpr_read_b32 v253, a121
v_accvgpr_read_b32 v254, a122
v_accvgpr_read_b32 v255, a123
v_mul_f32 v252, v252, v249
v_mul_f32 v253, v253, v249
v_mul_f32 v254, v254, v249
v_mul_f32 v255, v255, v249
v_accvgpr_write_b32 a120, v252
v_accvgpr_write_b32 a121, v253
v_accvgpr_write_b32 a122, v254
v_accvgpr_write_b32 a123, v255
v_accvgpr_read_b32 v252, a124
v_accvgpr_read_b32 v253, a125
v_accvgpr_read_b32 v254, a126
v_accvgpr_read_b32 v255, a127
v_mul_f32 v252, v252, v249
v_mul_f32 v253, v253, v249
v_mul_f32 v254, v254, v249
v_mul_f32 v255, v255, v249
v_accvgpr_write_b32 a124, v252
v_accvgpr_write_b32 a125, v253
v_accvgpr_write_b32 a126, v254
v_accvgpr_write_b32 a127, v255
v_exp_f32 v144, v80
v_exp_f32 v145, v81
v_exp_f32 v146, v82
v_exp_f32 v147, v83
v_add_f32 v143, v144, v145
v_cvt_pk_bf16_f32 v116, v144, v145
v_add_f32 v143, v143, v146
v_add_f32 v143, v143, v147
v_cvt_pk_bf16_f32 v117, v146, v147
v_exp_f32 v148, v84
v_exp_f32 v149, v85
v_exp_f32 v150, v86
v_exp_f32 v151, v87
v_add_f32 v143, v143, v148
v_add_f32 v143, v143, v149
v_cvt_pk_bf16_f32 v118, v148, v149
v_add_f32 v143, v143, v150
v_add_f32 v143, v143, v151
v_cvt_pk_bf16_f32 v119, v150, v151
s_nop 7
s_setpc_b64 s[46:47]
K1_CODE_END:
K3_CODE_END:
.section .rodata,"a"
.p2align 6
k1_kernel_kdl:
.amdhsa_kernel k1_kernel
  .amdhsa_next_free_vgpr 472
  .amdhsa_next_free_sgpr 102
  .amdhsa_accum_offset 256
  .amdhsa_group_segment_fixed_size 0
  .amdhsa_kernarg_size 112
  .amdhsa_user_sgpr_count 2
  .amdhsa_user_sgpr_kernarg_segment_ptr 1
  .amdhsa_system_sgpr_workgroup_id_x 1
  .amdhsa_float_denorm_mode_32 3
.end_amdhsa_kernel
```
